```python
import torch

def _softmax(x, axis=-1):
    return torch.softmax(x, dim=axis)

def _gelu(x):
    return torch.nn.functional.gelu(x, approximate='tanh')

def _silu(x):
    return torch.nn.functional.silu(x)

def _sigmoid(x):
    return torch.sigmoid(x)

def _layernorm(x, axis=-1, eps=1e-05):
    m = x.mean(dim=axis, keepdim=True)
    v = x.var(dim=axis, keepdim=True, unbiased=False)
    return (x - m) / torch.sqrt(v + eps)

def _scatter_add(tgt, idx, src, axis=0):
    return tgt.clone().index_add_(axis, idx, src)

def _segment_sum(src, seg, n):
    out = torch.zeros((n,) + src.shape[1:], dtype=src.dtype)
    return out.index_add_(0, seg, src)

def _pad(x, pw):
    flat = tuple((v for pair in reversed(pw) for v in pair))
    return torch.nn.functional.pad(x, flat)
kernel_name = 'adaLN_cond__ssm_conv_s4__glu_gated_bilinear__prompt'

def setup_inputs():

    _w = lambda a: (lambda t: t.to(torch.bfloat16) if t.is_floating_point() else t)(torch.as_tensor(a))

    def _A_setup():
        B, L, D, N = (1, 2048, 576, 128)
        A_re = -(lambda _x: torch.exp(torch.as_tensor(_x)))((lambda *s: torch.randn(*s, dtype=torch.bfloat16) * 3.2)(D, N))
        A_im = torch.pi * (lambda *s: torch.randn(*s, dtype=torch.bfloat16) * 0.05)(D, N)
        B_re = (lambda *s: torch.randn(*s, dtype=torch.bfloat16) * 0.1)(D, N)
        B_im = (lambda *s: torch.randn(*s, dtype=torch.bfloat16) * 0.1)(D, N)
        C_re = (lambda *s: torch.randn(*s, dtype=torch.bfloat16) * 0.1)(D, N)
        C_im = (lambda *s: torch.randn(*s, dtype=torch.bfloat16) * 0.1)(D, N)
        log_dt = (lambda *s: torch.randn(*s, dtype=torch.bfloat16) * 0.05)(D) * 0.5 - 4.0
        Dskip = (lambda *s: torch.randn(*s, dtype=torch.bfloat16) * 0.05)(D)
        return {'u': _w((lambda *s: torch.randn(*s, dtype=torch.bfloat16) * 0.05)(B, L, D)), 'A_re': _w(A_re), 'A_im': _w(A_im), 'B_re': _w(B_re), 'B_im': _w(B_im), 'C_re': _w(C_re), 'C_im': _w(C_im), 'log_dt': _w(log_dt), 'Dskip': _w(Dskip)}
    _A_in = _A_setup()

    def _B_setup():
        B, S, D, F = (1, 2048, 576, 4608)
        return {'x': _w((lambda *s: torch.randn(*s, dtype=torch.bfloat16) * 0.05)(B, S, D)), 'w_gate': _w((lambda *s: torch.randn(*s, dtype=torch.bfloat16) * 0.8)(D, F) * D ** (-0.5)), 'w_up': _w((lambda *s: torch.randn(*s, dtype=torch.bfloat16) * 0.8)(D, F) * D ** (-0.5)), 'w_down': _w((lambda *s: torch.randn(*s, dtype=torch.bfloat16) * 0.8)(F, D) * F ** (-0.5))}
    _B_in = _B_setup()
    return {'A_u': _A_in['u'], 'A_A_re': _A_in['A_re'], 'A_A_im': _A_in['A_im'], 'A_B_re': _A_in['B_re'], 'A_B_im': _A_in['B_im'], 'A_C_re': _A_in['C_re'], 'A_C_im': _A_in['C_im'], 'A_log_dt': _A_in['log_dt'], 'A_Dskip': _A_in['Dskip'], 'B_x': _B_in['x'], 'B_w_gate': _B_in['w_gate'], 'B_w_up': _B_in['w_up'], 'B_w_down': _B_in['w_down'], 'c': _w((lambda *s: torch.randn(*s, dtype=torch.bfloat16) * 0.2)(1, 576) * 8.0), 'w_mod': _w((lambda *s: torch.randn(*s, dtype=torch.bfloat16) * 0.2)(576, 6 * 576) * 576 ** (-0.5) * 8.0)}

def reference(A_u, A_A_re, A_A_im, A_B_re, A_B_im, A_C_re, A_C_im, A_log_dt, A_Dskip, B_x, B_w_gate, B_w_up, B_w_down, c, w_mod):

    def _A_ref(u, A_re, A_im, B_re, B_im, C_re, C_im, log_dt, Dskip):
        Bsz, L, D = u.shape
        dt = torch.exp(log_dt)[:, None]
        A = A_re + 1j * A_im
        Bc = B_re + 1j * B_im
        Cc = C_re + 1j * C_im
        logdA = dt * A
        dB = dt * Bc
        l = (lambda x, dt: x.to(dt))(torch.arange(L), A_re.dtype)
        P = torch.exp(logdA[:, :, None] * l[None, None, :])
        K = torch.einsum('dn,dnl,dn->dl', Cc, P, dB).real
        L2 = 2 * L
        Kp = _pad(K, ((0, 0), (0, L)))
        up = (lambda x, *d: x.permute(*d))(u, 0, 2, 1)
        up = _pad(up, ((0, 0), (0, 0), (0, L)))
        Kf = (lambda x, axes=(-2, -1): torch.fft.rfft2(x.float(), dim=axes))(Kp[:, None, :], axes=(-2, -1))
        Uf = (lambda x, axes=(-2, -1): torch.fft.rfft2(x.float(), dim=axes))(up[:, :, None, :], axes=(-2, -1))
        Yf = Uf * Kf[None, :, :, :]
        y = (lambda x, s, axes=(-2, -1): torch.fft.irfft2(x, s=s, dim=axes).to(torch.bfloat16))(Yf, (1, L2), axes=(-2, -1))[:, :, 0, :L]
        y = (lambda x, *d: x.permute(*d))(y, 0, 2, 1) + u * Dskip[None, None, :]
        return y

    def _B_ref(x, w_gate, w_up, w_down):
        g = torch.einsum('bsd,df->bsf', x, w_gate)
        u = torch.einsum('bsd,df->bsf', x, w_up)
        h = g * u
        return torch.einsum('bsf,fd->bsd', h, w_down)
    x = A_u
    mod = (_silu(c) @ w_mod).reshape(c.shape[0], 6, 1, -1)
    sa, ca, ga, sb, cb, gb = (mod[:, 0].clone(), mod[:, 1].clone(), mod[:, 2].clone(), mod[:, 3].clone(), mod[:, 4].clone(), mod[:, 5].clone())
    h = _layernorm(x, axis=-1) * (1 + ca) + sa
    x = x + ga * _A_ref(h, A_A_re, A_A_im, A_B_re, A_B_im, A_C_re, A_C_im, A_log_dt, A_Dskip)
    h = _layernorm(x, axis=-1) * (1 + cb) + sb
    x = x + gb * _B_ref(h, B_w_gate, B_w_up, B_w_down)
    return x
```

```asm
; @launch kernel=front_kernel grid=(921,1,1) block=(256,1,1) lds=38912
; @launch kernel=gg_kernel grid=(256,1,1) block=(256,1,1) lds=159744
.amdgcn_target "amdgcn-amd-amdhsa--gfx950"
.text
.globl front_kernel
.p2align 8
.type front_kernel,@function
front_kernel:
    s_load_dwordx2 s[6:7], s[0:1], 136
    s_load_dwordx2 s[34:35], s[0:1], 128
    s_cmp_lg_u32 s2, 0
    s_cbranch_scc1 KF_NM
    v_and_b32 v3, 63, v0
    v_lshlrev_b32 v44, 6, v3
    v_mov_b32 v4, 0
    v_lshrrev_b32 v9, 6, v0
    v_lshl_add_u32 v45, v9, 12, v44
    s_mov_b32 s44, 14417920
    s_waitcnt vmcnt(0) lgkmcnt(0)
    s_mov_b32 s8, s6
    s_and_b32 s9, s7, 0xffff
    s_mov_b32 s10, 0x10000000
    s_mov_b32 s11, 0x00020000
    buffer_store_dword v4, v45, s[8:11], s44 offen sc1
    s_branch KF_FIN
KF_NM:
    s_cmp_lt_u32 s2, 237
    s_cbranch_scc1 KF_PR
    s_add_u32 s3, s2, 579
    s_sub_u32 s2, s2, 16
    s_cmp_lt_u32 s2, 240
    s_cselect_b32 s2, s3, s2
    s_cmp_lt_u32 s2, 816
    s_cbranch_scc1 KF_CH
    s_cmp_ge_u32 s3, 835
    s_cselect_b32 s3, 19, 0
    s_add_u32 s2, s2, s3
    s_branch KF_WARM
KF_PR:
    s_add_u32 s2, s2, 127
    s_cmp_lt_u32 s2, 236
    s_cbranch_scc1 KF_MOD
    s_sub_u32 s2, s2, 236
    s_setprio 3
    s_load_dwordx2 s[4:5], s[0:1], 0
    v_lshrrev_b32 v1, 4, v0
    v_and_b32 v2, 15, v0
    v_mul_u32_u24 v3, 1152, v1
    v_lshl_add_u32 v3, v2, 3, v3
    s_mul_i32 s3, s2, 18432
    s_waitcnt vmcnt(0) lgkmcnt(0)
    s_mov_b32 s12, s4
    s_and_b32 s13, s5, 0xffff
    s_mov_b32 s14, 0x240000
    s_mov_b32 s15, 0x00020000
    s_mov_b32 s8, s6
    s_and_b32 s9, s7, 0xffff
    s_mov_b32 s10, 0x10000000
    s_mov_b32 s11, 0x00020000
    s_mov_b32 s24, s34
    s_and_b32 s25, s35, 0xffff
    s_mov_b32 s26, 0x100
    s_mov_b32 s27, 0x00020000
    buffer_load_dwordx2 v[10:11], v3, s[12:15], s3 offen offset:0
    buffer_load_dwordx2 v[12:13], v3, s[12:15], s3 offen offset:128
    buffer_load_dwordx2 v[14:15], v3, s[12:15], s3 offen offset:256
    buffer_load_dwordx2 v[16:17], v3, s[12:15], s3 offen offset:384
    buffer_load_dwordx2 v[18:19], v3, s[12:15], s3 offen offset:512
    buffer_load_dwordx2 v[20:21], v3, s[12:15], s3 offen offset:640
    buffer_load_dwordx2 v[22:23], v3, s[12:15], s3 offen offset:768
    buffer_load_dwordx2 v[24:25], v3, s[12:15], s3 offen offset:896
    buffer_load_dwordx2 v[26:27], v3, s[12:15], s3 offen offset:1024
    v_mul_u32_u24 v4, 1216, v1
    v_lshl_add_u32 v4, v2, 3, v4
    s_waitcnt vmcnt(8)
    v_lshlrev_b32 v28, 16, v10
    v_and_b32 v29, 0xffff0000, v10
    v_lshlrev_b32 v30, 16, v11
    v_and_b32 v31, 0xffff0000, v11
    ds_write_b64 v4, v[10:11] offset:19456
    s_waitcnt vmcnt(7)
    v_lshlrev_b32 v32, 16, v12
    v_and_b32 v33, 0xffff0000, v12
    v_lshlrev_b32 v34, 16, v13
    v_and_b32 v35, 0xffff0000, v13
    ds_write_b64 v4, v[12:13] offset:19584
    s_waitcnt vmcnt(6)
    v_lshlrev_b32 v36, 16, v14
    v_and_b32 v37, 0xffff0000, v14
    v_lshlrev_b32 v38, 16, v15
    v_and_b32 v39, 0xffff0000, v15
    ds_write_b64 v4, v[14:15] offset:19712
    s_waitcnt vmcnt(5)
    v_lshlrev_b32 v40, 16, v16
    v_and_b32 v41, 0xffff0000, v16
    v_lshlrev_b32 v42, 16, v17
    v_and_b32 v43, 0xffff0000, v17
    ds_write_b64 v4, v[16:17] offset:19840
    s_waitcnt vmcnt(4)
    v_lshlrev_b32 v44, 16, v18
    v_and_b32 v45, 0xffff0000, v18
    v_lshlrev_b32 v46, 16, v19
    v_and_b32 v47, 0xffff0000, v19
    ds_write_b64 v4, v[18:19] offset:19968
    s_waitcnt vmcnt(3)
    v_lshlrev_b32 v48, 16, v20
    v_and_b32 v49, 0xffff0000, v20
    v_lshlrev_b32 v50, 16, v21
    v_and_b32 v51, 0xffff0000, v21
    ds_write_b64 v4, v[20:21] offset:20096
    s_waitcnt vmcnt(2)
    v_lshlrev_b32 v52, 16, v22
    v_and_b32 v53, 0xffff0000, v22
    v_lshlrev_b32 v54, 16, v23
    v_and_b32 v55, 0xffff0000, v23
    ds_write_b64 v4, v[22:23] offset:20224
    s_waitcnt vmcnt(1)
    v_lshlrev_b32 v56, 16, v24
    v_and_b32 v57, 0xffff0000, v24
    v_lshlrev_b32 v58, 16, v25
    v_and_b32 v59, 0xffff0000, v25
    ds_write_b64 v4, v[24:25] offset:20352
    s_waitcnt vmcnt(0)
    v_lshlrev_b32 v60, 16, v26
    v_and_b32 v61, 0xffff0000, v26
    v_lshlrev_b32 v62, 16, v27
    v_and_b32 v63, 0xffff0000, v27
    ds_write_b64 v4, v[26:27] offset:20480
    v_pk_add_f32 v[64:65], v[28:29], v[30:31]
    v_pk_add_f32 v[66:67], v[32:33], v[34:35]
    v_pk_add_f32 v[64:65], v[64:65], v[36:37]
    v_pk_add_f32 v[66:67], v[66:67], v[38:39]
    v_pk_add_f32 v[64:65], v[64:65], v[40:41]
    v_pk_add_f32 v[66:67], v[66:67], v[42:43]
    v_pk_add_f32 v[64:65], v[64:65], v[44:45]
    v_pk_add_f32 v[66:67], v[66:67], v[46:47]
    v_pk_add_f32 v[64:65], v[64:65], v[48:49]
    v_pk_add_f32 v[66:67], v[66:67], v[50:51]
    v_pk_add_f32 v[64:65], v[64:65], v[52:53]
    v_pk_add_f32 v[66:67], v[66:67], v[54:55]
    v_pk_add_f32 v[64:65], v[64:65], v[56:57]
    v_pk_add_f32 v[66:67], v[66:67], v[58:59]
    v_pk_add_f32 v[64:65], v[64:65], v[60:61]
    v_pk_add_f32 v[66:67], v[66:67], v[62:63]
    v_pk_add_f32 v[64:65], v[64:65], v[66:67]
    v_add_f32 v5, v64, v65
    s_nop 1
    v_add_f32_dpp v5, v5, v5 row_ror:8 row_mask:0xf bank_mask:0xf
    s_nop 1
    v_add_f32_dpp v5, v5, v5 row_ror:4 row_mask:0xf bank_mask:0xf
    s_nop 1
    v_add_f32_dpp v5, v5, v5 row_ror:2 row_mask:0xf bank_mask:0xf
    s_nop 1
    v_add_f32_dpp v5, v5, v5 row_ror:1 row_mask:0xf bank_mask:0xf
    v_mul_f32 v5, 0x3ae38e39, v5
    v_sub_f32 v68, 0, v5
    v_sub_f32 v69, 0, v5
    v_pk_add_f32 v[70:71], v[28:29], v[68:69]
    v_pk_mul_f32 v[64:65], v[70:71], v[70:71]
    v_pk_add_f32 v[72:73], v[30:31], v[68:69]
    v_pk_mul_f32 v[66:67], v[72:73], v[72:73]
    v_pk_add_f32 v[70:71], v[32:33], v[68:69]
    v_pk_fma_f32 v[64:65], v[70:71], v[70:71], v[64:65]
    v_pk_add_f32 v[72:73], v[34:35], v[68:69]
    v_pk_fma_f32 v[66:67], v[72:73], v[72:73], v[66:67]
    v_pk_add_f32 v[70:71], v[36:37], v[68:69]
    v_pk_fma_f32 v[64:65], v[70:71], v[70:71], v[64:65]
    v_pk_add_f32 v[72:73], v[38:39], v[68:69]
    v_pk_fma_f32 v[66:67], v[72:73], v[72:73], v[66:67]
    v_pk_add_f32 v[70:71], v[40:41], v[68:69]
    v_pk_fma_f32 v[64:65], v[70:71], v[70:71], v[64:65]
    v_pk_add_f32 v[72:73], v[42:43], v[68:69]
    v_pk_fma_f32 v[66:67], v[72:73], v[72:73], v[66:67]
    v_pk_add_f32 v[70:71], v[44:45], v[68:69]
    v_pk_fma_f32 v[64:65], v[70:71], v[70:71], v[64:65]
    v_pk_add_f32 v[72:73], v[46:47], v[68:69]
    v_pk_fma_f32 v[66:67], v[72:73], v[72:73], v[66:67]
    v_pk_add_f32 v[70:71], v[48:49], v[68:69]
    v_pk_fma_f32 v[64:65], v[70:71], v[70:71], v[64:65]
    v_pk_add_f32 v[72:73], v[50:51], v[68:69]
    v_pk_fma_f32 v[66:67], v[72:73], v[72:73], v[66:67]
    v_pk_add_f32 v[70:71], v[52:53], v[68:69]
    v_pk_fma_f32 v[64:65], v[70:71], v[70:71], v[64:65]
    v_pk_add_f32 v[72:73], v[54:55], v[68:69]
    v_pk_fma_f32 v[66:67], v[72:73], v[72:73], v[66:67]
    v_pk_add_f32 v[70:71], v[56:57], v[68:69]
    v_pk_fma_f32 v[64:65], v[70:71], v[70:71], v[64:65]
    v_pk_add_f32 v[72:73], v[58:59], v[68:69]
    v_pk_fma_f32 v[66:67], v[72:73], v[72:73], v[66:67]
    v_pk_add_f32 v[70:71], v[60:61], v[68:69]
    v_pk_fma_f32 v[64:65], v[70:71], v[70:71], v[64:65]
    v_pk_add_f32 v[72:73], v[62:63], v[68:69]
    v_pk_fma_f32 v[66:67], v[72:73], v[72:73], v[66:67]
    v_pk_add_f32 v[64:65], v[64:65], v[66:67]
    v_add_f32 v6, v64, v65
    s_nop 1
    v_add_f32_dpp v6, v6, v6 row_ror:8 row_mask:0xf bank_mask:0xf
    s_nop 1
    v_add_f32_dpp v6, v6, v6 row_ror:4 row_mask:0xf bank_mask:0xf
    s_nop 1
    v_add_f32_dpp v6, v6, v6 row_ror:2 row_mask:0xf bank_mask:0xf
    s_nop 1
    v_add_f32_dpp v6, v6, v6 row_ror:1 row_mask:0xf bank_mask:0xf
    v_mul_f32 v6, 0x3ae38e39, v6
    v_cvt_pk_bf16_f32 v6, v6, v6
    v_and_b32 v6, 0xffff0000, v6
    v_add_f32 v6, 0x3727c5ac, v6
    v_cvt_pk_bf16_f32 v6, v6, v6
    v_and_b32 v6, 0xffff0000, v6
    v_sqrt_f32 v6, v6
    s_nop 0
    v_cvt_pk_bf16_f32 v6, v6, v6
    v_and_b32 v6, 0xffff0000, v6
    v_rcp_f32 v64, v6
    v_cvt_pk_bf16_f32 v5, v5, v5
    v_and_b32 v5, 0xffff0000, v5
    v_mov_b32 v65, v64
    v_sub_f32 v68, 0, v5
    v_sub_f32 v69, 0, v5
    v_pk_add_f32 v[28:29], v[28:29], v[68:69]
    v_cvt_pk_bf16_f32 v8, v28, v29
    v_lshlrev_b32 v28, 16, v8
    v_and_b32 v29, 0xffff0000, v8
    v_pk_mul_f32 v[28:29], v[28:29], v[64:65]
    v_cvt_pk_bf16_f32 v10, v28, v29
    v_pk_add_f32 v[30:31], v[30:31], v[68:69]
    v_cvt_pk_bf16_f32 v8, v30, v31
    v_lshlrev_b32 v30, 16, v8
    v_and_b32 v31, 0xffff0000, v8
    v_pk_mul_f32 v[30:31], v[30:31], v[64:65]
    v_cvt_pk_bf16_f32 v11, v30, v31
    ds_write_b64 v4, v[10:11] offset:0
    v_pk_add_f32 v[32:33], v[32:33], v[68:69]
    v_cvt_pk_bf16_f32 v8, v32, v33
    v_lshlrev_b32 v32, 16, v8
    v_and_b32 v33, 0xffff0000, v8
    v_pk_mul_f32 v[32:33], v[32:33], v[64:65]
    v_cvt_pk_bf16_f32 v12, v32, v33
    v_pk_add_f32 v[34:35], v[34:35], v[68:69]
    v_cvt_pk_bf16_f32 v8, v34, v35
    v_lshlrev_b32 v34, 16, v8
    v_and_b32 v35, 0xffff0000, v8
    v_pk_mul_f32 v[34:35], v[34:35], v[64:65]
    v_cvt_pk_bf16_f32 v13, v34, v35
    ds_write_b64 v4, v[12:13] offset:128
    v_pk_add_f32 v[36:37], v[36:37], v[68:69]
    v_cvt_pk_bf16_f32 v8, v36, v37
    v_lshlrev_b32 v36, 16, v8
    v_and_b32 v37, 0xffff0000, v8
    v_pk_mul_f32 v[36:37], v[36:37], v[64:65]
    v_cvt_pk_bf16_f32 v14, v36, v37
    v_pk_add_f32 v[38:39], v[38:39], v[68:69]
    v_cvt_pk_bf16_f32 v8, v38, v39
    v_lshlrev_b32 v38, 16, v8
    v_and_b32 v39, 0xffff0000, v8
    v_pk_mul_f32 v[38:39], v[38:39], v[64:65]
    v_cvt_pk_bf16_f32 v15, v38, v39
    ds_write_b64 v4, v[14:15] offset:256
    v_pk_add_f32 v[40:41], v[40:41], v[68:69]
    v_cvt_pk_bf16_f32 v8, v40, v41
    v_lshlrev_b32 v40, 16, v8
    v_and_b32 v41, 0xffff0000, v8
    v_pk_mul_f32 v[40:41], v[40:41], v[64:65]
    v_cvt_pk_bf16_f32 v16, v40, v41
    v_pk_add_f32 v[42:43], v[42:43], v[68:69]
    v_cvt_pk_bf16_f32 v8, v42, v43
    v_lshlrev_b32 v42, 16, v8
    v_and_b32 v43, 0xffff0000, v8
    v_pk_mul_f32 v[42:43], v[42:43], v[64:65]
    v_cvt_pk_bf16_f32 v17, v42, v43
    ds_write_b64 v4, v[16:17] offset:384
    v_pk_add_f32 v[44:45], v[44:45], v[68:69]
    v_cvt_pk_bf16_f32 v8, v44, v45
    v_lshlrev_b32 v44, 16, v8
    v_and_b32 v45, 0xffff0000, v8
    v_pk_mul_f32 v[44:45], v[44:45], v[64:65]
    v_cvt_pk_bf16_f32 v18, v44, v45
    v_pk_add_f32 v[46:47], v[46:47], v[68:69]
    v_cvt_pk_bf16_f32 v8, v46, v47
    v_lshlrev_b32 v46, 16, v8
    v_and_b32 v47, 0xffff0000, v8
    v_pk_mul_f32 v[46:47], v[46:47], v[64:65]
    v_cvt_pk_bf16_f32 v19, v46, v47
    ds_write_b64 v4, v[18:19] offset:512
    v_pk_add_f32 v[48:49], v[48:49], v[68:69]
    v_cvt_pk_bf16_f32 v8, v48, v49
    v_lshlrev_b32 v48, 16, v8
    v_and_b32 v49, 0xffff0000, v8
    v_pk_mul_f32 v[48:49], v[48:49], v[64:65]
    v_cvt_pk_bf16_f32 v20, v48, v49
    v_pk_add_f32 v[50:51], v[50:51], v[68:69]
    v_cvt_pk_bf16_f32 v8, v50, v51
    v_lshlrev_b32 v50, 16, v8
    v_and_b32 v51, 0xffff0000, v8
    v_pk_mul_f32 v[50:51], v[50:51], v[64:65]
    v_cvt_pk_bf16_f32 v21, v50, v51
    ds_write_b64 v4, v[20:21] offset:640
    v_pk_add_f32 v[52:53], v[52:53], v[68:69]
    v_cvt_pk_bf16_f32 v8, v52, v53
    v_lshlrev_b32 v52, 16, v8
    v_and_b32 v53, 0xffff0000, v8
    v_pk_mul_f32 v[52:53], v[52:53], v[64:65]
    v_cvt_pk_bf16_f32 v22, v52, v53
    v_pk_add_f32 v[54:55], v[54:55], v[68:69]
    v_cvt_pk_bf16_f32 v8, v54, v55
    v_lshlrev_b32 v54, 16, v8
    v_and_b32 v55, 0xffff0000, v8
    v_pk_mul_f32 v[54:55], v[54:55], v[64:65]
    v_cvt_pk_bf16_f32 v23, v54, v55
    ds_write_b64 v4, v[22:23] offset:768
    v_pk_add_f32 v[56:57], v[56:57], v[68:69]
    v_cvt_pk_bf16_f32 v8, v56, v57
    v_lshlrev_b32 v56, 16, v8
    v_and_b32 v57, 0xffff0000, v8
    v_pk_mul_f32 v[56:57], v[56:57], v[64:65]
    v_cvt_pk_bf16_f32 v24, v56, v57
    v_pk_add_f32 v[58:59], v[58:59], v[68:69]
    v_cvt_pk_bf16_f32 v8, v58, v59
    v_lshlrev_b32 v58, 16, v8
    v_and_b32 v59, 0xffff0000, v8
    v_pk_mul_f32 v[58:59], v[58:59], v[64:65]
    v_cvt_pk_bf16_f32 v25, v58, v59
    ds_write_b64 v4, v[24:25] offset:896
    v_pk_add_f32 v[60:61], v[60:61], v[68:69]
    v_cvt_pk_bf16_f32 v8, v60, v61
    v_lshlrev_b32 v60, 16, v8
    v_and_b32 v61, 0xffff0000, v8
    v_pk_mul_f32 v[60:61], v[60:61], v[64:65]
    v_cvt_pk_bf16_f32 v26, v60, v61
    v_pk_add_f32 v[62:63], v[62:63], v[68:69]
    v_cvt_pk_bf16_f32 v8, v62, v63
    v_lshlrev_b32 v62, 16, v8
    v_and_b32 v63, 0xffff0000, v8
    v_pk_mul_f32 v[62:63], v[62:63], v[64:65]
    v_cvt_pk_bf16_f32 v27, v62, v63
    ds_write_b64 v4, v[26:27] offset:1024
    v_and_b32 v1, 63, v0
    v_lshrrev_b32 v2, 6, v0
    s_nop 0
    v_readfirstlane_b32 s16, v2
    v_bfe_u32 v5, v1, 4, 1
    v_lshrrev_b32 v6, 5, v1
    v_bfe_u32 v7, v1, 2, 2
    v_and_b32 v8, 3, v1
    v_lshl_add_u32 v7, v5, 3, v7
    v_lshl_add_u32 v7, v6, 4, v7
    v_mul_u32_u24 v7, 1216, v7
    v_lshl_add_u32 v7, v8, 3, v7
    s_mul_i32 s19, s16, 288
    v_add_u32 v7, s19, v7
    v_and_b32 v9, 15, v1
    v_lshlrev_b32 v9, 6, v9
    v_lshrrev_b32 v3, 4, v1
    v_lshl_add_u32 v9, v3, 4, v9
    s_lshl_b32 s21, s3, 1
    s_mul_i32 s22, s16, 9216
    s_add_u32 s21, s21, s22
    s_add_u32 s22, s21, 4096
    s_add_u32 s23, s21, 8192
    v_mov_b32 v100, 248
    s_cmp_lg_u32 s16, 0
    s_cbranch_scc1 KF_LA
    v_mov_b32 v100, 248
    buffer_load_dword v101, v100, s[24:27], 0 offen sc1
KF_LA:
    s_waitcnt lgkmcnt(0)
    s_barrier
    ds_read_b64_tr_b16 v[28:29], v7 offset:0
    ds_read_b64_tr_b16 v[30:31], v7 offset:4864
    ds_read_b64_tr_b16 v[32:33], v7 offset:32
    ds_read_b64_tr_b16 v[34:35], v7 offset:4896
    ds_read_b64_tr_b16 v[36:37], v7 offset:64
    ds_read_b64_tr_b16 v[38:39], v7 offset:4928
    ds_read_b64_tr_b16 v[40:41], v7 offset:96
    ds_read_b64_tr_b16 v[42:43], v7 offset:4960
    ds_read_b64_tr_b16 v[44:45], v7 offset:128
    ds_read_b64_tr_b16 v[46:47], v7 offset:4992
    ds_read_b64_tr_b16 v[48:49], v7 offset:160
    ds_read_b64_tr_b16 v[50:51], v7 offset:5024
    ds_read_b64_tr_b16 v[52:53], v7 offset:192
    ds_read_b64_tr_b16 v[54:55], v7 offset:5056
    ds_read_b64_tr_b16 v[56:57], v7 offset:224
    ds_read_b64_tr_b16 v[58:59], v7 offset:5088
    ds_read_b64_tr_b16 v[60:61], v7 offset:256
    ds_read_b64_tr_b16 v[62:63], v7 offset:5120
    s_waitcnt lgkmcnt(15)
    buffer_store_dwordx4 v[28:31], v9, s[8:11], s21 offen offset:0 sc1
    s_waitcnt lgkmcnt(14)
    buffer_store_dwordx4 v[32:35], v9, s[8:11], s21 offen offset:1024 sc1
    s_waitcnt lgkmcnt(12)
    buffer_store_dwordx4 v[36:39], v9, s[8:11], s21 offen offset:2048 sc1
    s_waitcnt lgkmcnt(10)
    buffer_store_dwordx4 v[40:43], v9, s[8:11], s21 offen offset:3072 sc1
    s_waitcnt lgkmcnt(8)
    buffer_store_dwordx4 v[44:47], v9, s[8:11], s22 offen offset:0 sc1
    s_waitcnt lgkmcnt(6)
    buffer_store_dwordx4 v[48:51], v9, s[8:11], s22 offen offset:1024 sc1
    s_waitcnt lgkmcnt(4)
    buffer_store_dwordx4 v[52:55], v9, s[8:11], s22 offen offset:2048 sc1
    s_waitcnt lgkmcnt(2)
    buffer_store_dwordx4 v[56:59], v9, s[8:11], s22 offen offset:3072 sc1
    s_waitcnt lgkmcnt(0)
    buffer_store_dwordx4 v[60:63], v9, s[8:11], s23 offen offset:0 sc1
    s_waitcnt vmcnt(0) lgkmcnt(0)
    s_barrier
    s_cmp_lg_u32 s16, 0
    s_cbranch_scc1 KF_LE
    s_mov_b32 s21, 0x8000
KF_S1:
    v_cmp_ne_u32 vcc, 0, v101
    s_cbranch_vccnz KF_S1_X
    buffer_load_dword v101, v100, s[24:27], 0 offen sc1
    s_waitcnt vmcnt(0)
    s_sub_u32 s21, s21, 1
    s_cbranch_scc0 KF_S1
KF_S1_X:
    v_mov_b32 v1, s2
    v_mov_b32 v2, 1
    v_lshlrev_b32 v3, 6, v1
    s_mov_b32 s20, 14417920
    s_mov_b64 exec, 1
    buffer_store_dword v2, v3, s[8:11], s20 offen sc1
KF_LE:
    s_endpgm
KF_MOD:
    s_setprio 3
    s_load_dwordx2 s[4:5], s[0:1], 112
    s_load_dwordx2 s[16:17], s[0:1], 104
    s_sub_u32 s3, s2, 128
    s_cmp_ge_u32 s3, 54
    s_cselect_b32 s20, 1, 0
    s_mul_i32 s21, s20, 54
    s_sub_u32 s21, s3, s21
    v_lshrrev_b32 v1, 3, v0
    v_and_b32 v2, 7, v0
    v_mul_u32_u24 v3, 6912, v1
    v_lshl_add_u32 v3, v2, 4, v3
    v_lshlrev_b32 v4, 1, v1
    s_mul_i32 s22, s20, 1990656
    s_lshl_b32 s23, s21, 7
    s_add_u32 s22, s22, s23
    s_mul_i32 s23, s20, 576
    s_waitcnt vmcnt(0) lgkmcnt(0)
    s_mov_b32 s12, s4
    s_and_b32 s13, s5, 0xffff
    s_mov_b32 s14, 0x3cc000
    s_mov_b32 s15, 0x00020000
    s_mov_b32 s28, s16
    s_and_b32 s29, s17, 0xffff
    s_mov_b32 s30, 0x480
    s_mov_b32 s31, 0x00020000
    s_mov_b32 s8, s6
    s_and_b32 s9, s7, 0xffff
    s_mov_b32 s10, 0x10000000
    s_mov_b32 s11, 0x00020000
    s_mov_b32 s24, s34
    s_and_b32 s25, s35, 0xffff
    s_mov_b32 s26, 0x100
    s_mov_b32 s27, 0x00020000
    buffer_load_ushort v10, v4, s[28:31], s23 offen offset:0
    buffer_load_ushort v11, v4, s[28:31], s23 offen offset:64
    buffer_load_ushort v12, v4, s[28:31], s23 offen offset:128
    buffer_load_ushort v13, v4, s[28:31], s23 offen offset:192
    buffer_load_ushort v14, v4, s[28:31], s23 offen offset:256
    buffer_load_ushort v15, v4, s[28:31], s23 offen offset:320
    buffer_load_ushort v16, v4, s[28:31], s23 offen offset:384
    buffer_load_ushort v17, v4, s[28:31], s23 offen offset:448
    buffer_load_ushort v18, v4, s[28:31], s23 offen offset:512
    buffer_load_dwordx4 v[20:23], v3, s[12:15], s22 offen
    s_add_u32 s22, s22, 221184
    buffer_load_dwordx4 v[24:27], v3, s[12:15], s22 offen
    s_add_u32 s22, s22, 221184
    buffer_load_dwordx4 v[28:31], v3, s[12:15], s22 offen
    s_add_u32 s22, s22, 221184
    buffer_load_dwordx4 v[32:35], v3, s[12:15], s22 offen
    s_add_u32 s22, s22, 221184
    buffer_load_dwordx4 v[36:39], v3, s[12:15], s22 offen
    s_add_u32 s22, s22, 221184
    buffer_load_dwordx4 v[40:43], v3, s[12:15], s22 offen
    s_add_u32 s22, s22, 221184
    buffer_load_dwordx4 v[44:47], v3, s[12:15], s22 offen
    s_add_u32 s22, s22, 221184
    buffer_load_dwordx4 v[48:51], v3, s[12:15], s22 offen
    s_add_u32 s22, s22, 221184
    buffer_load_dwordx4 v[52:55], v3, s[12:15], s22 offen
    v_mov_b32 v56, 0
    v_mov_b32 v57, 0
    v_mov_b32 v58, 0
    v_mov_b32 v59, 0
    v_mov_b32 v60, 0
    v_mov_b32 v61, 0
    v_mov_b32 v62, 0
    v_mov_b32 v63, 0
    s_waitcnt vmcnt(9)
    v_lshlrev_b32 v10, 16, v10
    v_mul_f32 v5, 0xbfb8aa3b, v10
    v_exp_f32 v5, v5
    s_nop 0
    v_add_f32 v5, 1.0, v5
    v_rcp_f32 v5, v5
    s_nop 0
    v_mul_f32 v10, v10, v5
    v_cvt_pk_bf16_f32 v10, v10, v10
    v_and_b32 v10, 0xffff0000, v10
    v_lshlrev_b32 v11, 16, v11
    v_mul_f32 v5, 0xbfb8aa3b, v11
    v_exp_f32 v5, v5
    s_nop 0
    v_add_f32 v5, 1.0, v5
    v_rcp_f32 v5, v5
    s_nop 0
    v_mul_f32 v11, v11, v5
    v_cvt_pk_bf16_f32 v11, v11, v11
    v_and_b32 v11, 0xffff0000, v11
    v_lshlrev_b32 v12, 16, v12
    v_mul_f32 v5, 0xbfb8aa3b, v12
    v_exp_f32 v5, v5
    s_nop 0
    v_add_f32 v5, 1.0, v5
    v_rcp_f32 v5, v5
    s_nop 0
    v_mul_f32 v12, v12, v5
    v_cvt_pk_bf16_f32 v12, v12, v12
    v_and_b32 v12, 0xffff0000, v12
    v_lshlrev_b32 v13, 16, v13
    v_mul_f32 v5, 0xbfb8aa3b, v13
    v_exp_f32 v5, v5
    s_nop 0
    v_add_f32 v5, 1.0, v5
    v_rcp_f32 v5, v5
    s_nop 0
    v_mul_f32 v13, v13, v5
    v_cvt_pk_bf16_f32 v13, v13, v13
    v_and_b32 v13, 0xffff0000, v13
    v_lshlrev_b32 v14, 16, v14
    v_mul_f32 v5, 0xbfb8aa3b, v14
    v_exp_f32 v5, v5
    s_nop 0
    v_add_f32 v5, 1.0, v5
    v_rcp_f32 v5, v5
    s_nop 0
    v_mul_f32 v14, v14, v5
    v_cvt_pk_bf16_f32 v14, v14, v14
    v_and_b32 v14, 0xffff0000, v14
    v_lshlrev_b32 v15, 16, v15
    v_mul_f32 v5, 0xbfb8aa3b, v15
    v_exp_f32 v5, v5
    s_nop 0
    v_add_f32 v5, 1.0, v5
    v_rcp_f32 v5, v5
    s_nop 0
    v_mul_f32 v15, v15, v5
    v_cvt_pk_bf16_f32 v15, v15, v15
    v_and_b32 v15, 0xffff0000, v15
    v_lshlrev_b32 v16, 16, v16
    v_mul_f32 v5, 0xbfb8aa3b, v16
    v_exp_f32 v5, v5
    s_nop 0
    v_add_f32 v5, 1.0, v5
    v_rcp_f32 v5, v5
    s_nop 0
    v_mul_f32 v16, v16, v5
    v_cvt_pk_bf16_f32 v16, v16, v16
    v_and_b32 v16, 0xffff0000, v16
    v_lshlrev_b32 v17, 16, v17
    v_mul_f32 v5, 0xbfb8aa3b, v17
    v_exp_f32 v5, v5
    s_nop 0
    v_add_f32 v5, 1.0, v5
    v_rcp_f32 v5, v5
    s_nop 0
    v_mul_f32 v17, v17, v5
    v_cvt_pk_bf16_f32 v17, v17, v17
    v_and_b32 v17, 0xffff0000, v17
    v_lshlrev_b32 v18, 16, v18
    v_mul_f32 v5, 0xbfb8aa3b, v18
    v_exp_f32 v5, v5
    s_nop 0
    v_add_f32 v5, 1.0, v5
    v_rcp_f32 v5, v5
    s_nop 0
    v_mul_f32 v18, v18, v5
    v_cvt_pk_bf16_f32 v18, v18, v18
    v_and_b32 v18, 0xffff0000, v18
    s_waitcnt vmcnt(8)
    v_lshlrev_b32 v5, 16, v20
    v_and_b32 v6, 0xffff0000, v20
    v_fmac_f32 v56, v10, v5
    v_fmac_f32 v57, v10, v6
    v_lshlrev_b32 v5, 16, v21
    v_and_b32 v6, 0xffff0000, v21
    v_fmac_f32 v58, v10, v5
    v_fmac_f32 v59, v10, v6
    v_lshlrev_b32 v5, 16, v22
    v_and_b32 v6, 0xffff0000, v22
    v_fmac_f32 v60, v10, v5
    v_fmac_f32 v61, v10, v6
    v_lshlrev_b32 v5, 16, v23
    v_and_b32 v6, 0xffff0000, v23
    v_fmac_f32 v62, v10, v5
    v_fmac_f32 v63, v10, v6
    s_waitcnt vmcnt(7)
    v_lshlrev_b32 v5, 16, v24
    v_and_b32 v6, 0xffff0000, v24
    v_fmac_f32 v56, v11, v5
    v_fmac_f32 v57, v11, v6
    v_lshlrev_b32 v5, 16, v25
    v_and_b32 v6, 0xffff0000, v25
    v_fmac_f32 v58, v11, v5
    v_fmac_f32 v59, v11, v6
    v_lshlrev_b32 v5, 16, v26
    v_and_b32 v6, 0xffff0000, v26
    v_fmac_f32 v60, v11, v5
    v_fmac_f32 v61, v11, v6
    v_lshlrev_b32 v5, 16, v27
    v_and_b32 v6, 0xffff0000, v27
    v_fmac_f32 v62, v11, v5
    v_fmac_f32 v63, v11, v6
    s_waitcnt vmcnt(6)
    v_lshlrev_b32 v5, 16, v28
    v_and_b32 v6, 0xffff0000, v28
    v_fmac_f32 v56, v12, v5
    v_fmac_f32 v57, v12, v6
    v_lshlrev_b32 v5, 16, v29
    v_and_b32 v6, 0xffff0000, v29
    v_fmac_f32 v58, v12, v5
    v_fmac_f32 v59, v12, v6
    v_lshlrev_b32 v5, 16, v30
    v_and_b32 v6, 0xffff0000, v30
    v_fmac_f32 v60, v12, v5
    v_fmac_f32 v61, v12, v6
    v_lshlrev_b32 v5, 16, v31
    v_and_b32 v6, 0xffff0000, v31
    v_fmac_f32 v62, v12, v5
    v_fmac_f32 v63, v12, v6
    s_waitcnt vmcnt(5)
    v_lshlrev_b32 v5, 16, v32
    v_and_b32 v6, 0xffff0000, v32
    v_fmac_f32 v56, v13, v5
    v_fmac_f32 v57, v13, v6
    v_lshlrev_b32 v5, 16, v33
    v_and_b32 v6, 0xffff0000, v33
    v_fmac_f32 v58, v13, v5
    v_fmac_f32 v59, v13, v6
    v_lshlrev_b32 v5, 16, v34
    v_and_b32 v6, 0xffff0000, v34
    v_fmac_f32 v60, v13, v5
    v_fmac_f32 v61, v13, v6
    v_lshlrev_b32 v5, 16, v35
    v_and_b32 v6, 0xffff0000, v35
    v_fmac_f32 v62, v13, v5
    v_fmac_f32 v63, v13, v6
    s_waitcnt vmcnt(4)
    v_lshlrev_b32 v5, 16, v36
    v_and_b32 v6, 0xffff0000, v36
    v_fmac_f32 v56, v14, v5
    v_fmac_f32 v57, v14, v6
    v_lshlrev_b32 v5, 16, v37
    v_and_b32 v6, 0xffff0000, v37
    v_fmac_f32 v58, v14, v5
    v_fmac_f32 v59, v14, v6
    v_lshlrev_b32 v5, 16, v38
    v_and_b32 v6, 0xffff0000, v38
    v_fmac_f32 v60, v14, v5
    v_fmac_f32 v61, v14, v6
    v_lshlrev_b32 v5, 16, v39
    v_and_b32 v6, 0xffff0000, v39
    v_fmac_f32 v62, v14, v5
    v_fmac_f32 v63, v14, v6
    s_waitcnt vmcnt(3)
    v_lshlrev_b32 v5, 16, v40
    v_and_b32 v6, 0xffff0000, v40
    v_fmac_f32 v56, v15, v5
    v_fmac_f32 v57, v15, v6
    v_lshlrev_b32 v5, 16, v41
    v_and_b32 v6, 0xffff0000, v41
    v_fmac_f32 v58, v15, v5
    v_fmac_f32 v59, v15, v6
    v_lshlrev_b32 v5, 16, v42
    v_and_b32 v6, 0xffff0000, v42
    v_fmac_f32 v60, v15, v5
    v_fmac_f32 v61, v15, v6
    v_lshlrev_b32 v5, 16, v43
    v_and_b32 v6, 0xffff0000, v43
    v_fmac_f32 v62, v15, v5
    v_fmac_f32 v63, v15, v6
    s_waitcnt vmcnt(2)
    v_lshlrev_b32 v5, 16, v44
    v_and_b32 v6, 0xffff0000, v44
    v_fmac_f32 v56, v16, v5
    v_fmac_f32 v57, v16, v6
    v_lshlrev_b32 v5, 16, v45
    v_and_b32 v6, 0xffff0000, v45
    v_fmac_f32 v58, v16, v5
    v_fmac_f32 v59, v16, v6
    v_lshlrev_b32 v5, 16, v46
    v_and_b32 v6, 0xffff0000, v46
    v_fmac_f32 v60, v16, v5
    v_fmac_f32 v61, v16, v6
    v_lshlrev_b32 v5, 16, v47
    v_and_b32 v6, 0xffff0000, v47
    v_fmac_f32 v62, v16, v5
    v_fmac_f32 v63, v16, v6
    s_waitcnt vmcnt(1)
    v_lshlrev_b32 v5, 16, v48
    v_and_b32 v6, 0xffff0000, v48
    v_fmac_f32 v56, v17, v5
    v_fmac_f32 v57, v17, v6
    v_lshlrev_b32 v5, 16, v49
    v_and_b32 v6, 0xffff0000, v49
    v_fmac_f32 v58, v17, v5
    v_fmac_f32 v59, v17, v6
    v_lshlrev_b32 v5, 16, v50
    v_and_b32 v6, 0xffff0000, v50
    v_fmac_f32 v60, v17, v5
    v_fmac_f32 v61, v17, v6
    v_lshlrev_b32 v5, 16, v51
    v_and_b32 v6, 0xffff0000, v51
    v_fmac_f32 v62, v17, v5
    v_fmac_f32 v63, v17, v6
    s_waitcnt vmcnt(0)
    v_lshlrev_b32 v5, 16, v52
    v_and_b32 v6, 0xffff0000, v52
    v_fmac_f32 v56, v18, v5
    v_fmac_f32 v57, v18, v6
    v_lshlrev_b32 v5, 16, v53
    v_and_b32 v6, 0xffff0000, v53
    v_fmac_f32 v58, v18, v5
    v_fmac_f32 v59, v18, v6
    v_lshlrev_b32 v5, 16, v54
    v_and_b32 v6, 0xffff0000, v54
    v_fmac_f32 v60, v18, v5
    v_fmac_f32 v61, v18, v6
    v_lshlrev_b32 v5, 16, v55
    v_and_b32 v6, 0xffff0000, v55
    v_fmac_f32 v62, v18, v5
    v_fmac_f32 v63, v18, v6
    v_lshlrev_b32 v5, 8, v1
    v_lshl_add_u32 v5, v2, 5, v5
    ds_write_b128 v5, v[56:59]
    ds_write_b128 v5, v[60:63] offset:16
    v_lshlrev_b32 v6, 2, v0
    v_lshrrev_b32 v7, 6, v0
    s_nop 0
    v_readfirstlane_b32 s16, v7
    s_waitcnt lgkmcnt(0)
    s_barrier
    s_cmp_lg_u32 s16, 0
    s_cbranch_scc1 KF_END
    v_mov_b32 v100, 248
    buffer_load_dword v101, v100, s[24:27], 0 offen sc1
    ds_read_b32 v10, v6 offset:0
    ds_read_b32 v11, v6 offset:256
    ds_read_b32 v12, v6 offset:512
    ds_read_b32 v13, v6 offset:768
    ds_read_b32 v14, v6 offset:1024
    ds_read_b32 v15, v6 offset:1280
    ds_read_b32 v16, v6 offset:1536
    ds_read_b32 v17, v6 offset:1792
    ds_read_b32 v18, v6 offset:2048
    ds_read_b32 v19, v6 offset:2304
    ds_read_b32 v20, v6 offset:2560
    ds_read_b32 v21, v6 offset:2816
    ds_read_b32 v22, v6 offset:3072
    ds_read_b32 v23, v6 offset:3328
    ds_read_b32 v24, v6 offset:3584
    ds_read_b32 v25, v6 offset:3840
    ds_read_b32 v26, v6 offset:4096
    ds_read_b32 v27, v6 offset:4352
    ds_read_b32 v28, v6 offset:4608
    ds_read_b32 v29, v6 offset:4864
    ds_read_b32 v30, v6 offset:5120
    ds_read_b32 v31, v6 offset:5376
    ds_read_b32 v32, v6 offset:5632
    ds_read_b32 v33, v6 offset:5888
    ds_read_b32 v34, v6 offset:6144
    ds_read_b32 v35, v6 offset:6400
    ds_read_b32 v36, v6 offset:6656
    ds_read_b32 v37, v6 offset:6912
    ds_read_b32 v38, v6 offset:7168
    ds_read_b32 v39, v6 offset:7424
    ds_read_b32 v40, v6 offset:7680
    ds_read_b32 v41, v6 offset:7936
    s_waitcnt lgkmcnt(0)
    v_add_f32 v10, v10, v26
    v_add_f32 v11, v11, v27
    v_add_f32 v12, v12, v28
    v_add_f32 v13, v13, v29
    v_add_f32 v14, v14, v30
    v_add_f32 v15, v15, v31
    v_add_f32 v16, v16, v32
    v_add_f32 v17, v17, v33
    v_add_f32 v18, v18, v34
    v_add_f32 v19, v19, v35
    v_add_f32 v20, v20, v36
    v_add_f32 v21, v21, v37
    v_add_f32 v22, v22, v38
    v_add_f32 v23, v23, v39
    v_add_f32 v24, v24, v40
    v_add_f32 v25, v25, v41
    v_add_f32 v10, v10, v18
    v_add_f32 v11, v11, v19
    v_add_f32 v12, v12, v20
    v_add_f32 v13, v13, v21
    v_add_f32 v14, v14, v22
    v_add_f32 v15, v15, v23
    v_add_f32 v16, v16, v24
    v_add_f32 v17, v17, v25
    v_add_f32 v10, v10, v14
    v_add_f32 v11, v11, v15
    v_add_f32 v12, v12, v16
    v_add_f32 v13, v13, v17
    v_add_f32 v10, v10, v12
    v_add_f32 v11, v11, v13
    v_add_f32 v10, v10, v11
    s_mul_i32 s22, s20, 13824
    s_lshl_b32 s23, s21, 8
    s_add_u32 s22, s22, s23
    s_add_u32 s22, s22, 14155776
    buffer_store_dword v10, v6, s[8:11], s22 offen sc1
    s_waitcnt vmcnt(0) lgkmcnt(0)
    s_mov_b32 s21, 0x8000
KF_S2:
    v_cmp_ne_u32 vcc, 0, v101
    s_cbranch_vccnz KF_S2_X
    buffer_load_dword v101, v100, s[24:27], 0 offen sc1
    s_waitcnt vmcnt(0)
    s_sub_u32 s21, s21, 1
    s_cbranch_scc0 KF_S2
KF_S2_X:
    v_mov_b32 v1, s2
    v_mov_b32 v2, 1
    v_lshlrev_b32 v3, 6, v1
    s_mov_b32 s20, 14417920
    s_mov_b64 exec, 1
    buffer_store_dword v2, v3, s[8:11], s20 offen sc1
    s_endpgm
KF_FIN:
    s_setprio 3
    v_lshlrev_b32 v1, 2, v0
    v_lshlrev_b32 v3, 2, v3
    v_lshlrev_b32 v2, 4, v0
    v_mov_b32 v5, 0
    v_mov_b32 v6, 0
    v_mov_b32 v7, 0
    s_mov_b32 s24, s34
    s_and_b32 s25, s35, 0xffff
    s_mov_b32 s26, 0x100
    s_mov_b32 s27, 0x00020000
    v_readfirstlane_b32 s16, v9
    s_mov_b32 s45, 14422016
    s_mov_b32 s46, 14426112
    s_mov_b32 s47, 14430208
    s_mov_b32 s36, 0x8000
    s_mov_b32 s38, 0xffffffff
    s_mov_b32 s39, 0xfff
    s_mov_b32 s40, 0xffffffff
    s_mov_b32 s41, 0x7ffffff
    s_mov_b32 s37, 0x01010101
    s_waitcnt vmcnt(0) lgkmcnt(0)
    s_barrier
    s_cmp_lg_u32 s16, 0
    s_cbranch_scc1 KF_FB
    v_mov_b32 v8, 248
    v_mov_b32 v9, 1
    s_mov_b64 exec, 1
    buffer_store_dword v9, v8, s[24:27], 0 offen sc1
    s_mov_b64 exec, -1
KF_PF:
    buffer_load_dword v45, v44, s[8:11], s44 offen sc1
    buffer_load_dword v46, v44, s[8:11], s45 offen sc1
    buffer_load_dword v47, v44, s[8:11], s46 offen sc1
    buffer_load_dword v48, v44, s[8:11], s47 offen sc1
    s_waitcnt vmcnt(0)
    v_min_u32 v45, v45, v46
    v_min_u32 v45, v45, v47
    v_cmp_eq_u32 vcc, 0, v48
    s_nop 0
    s_and_b64 s[42:43], vcc, s[38:39]
    v_cmp_eq_u32 vcc, 0, v45
    s_nop 0
    s_or_b64 s[42:43], s[42:43], vcc
    s_cbranch_scc0 KF_PF_X
    s_sub_u32 s36, s36, 1
    s_cbranch_scc0 KF_PF
KF_PF_X:
    v_mov_b32 v8, 252
    v_mov_b32 v9, 1
    s_mov_b64 exec, 1
    buffer_store_dword v9, v8, s[24:27], 0 offen sc1
    s_mov_b64 exec, -1
KF_FB:
    s_barrier
    v_mov_b32 v40, 1
    v_lshlrev_b32 v41, 6, v0
    s_mov_b32 s20, 14352384
    buffer_store_dword v40, v41, s[8:11], s20 offen sc1
    s_mov_b32 s20, 14368768
    buffer_store_dword v40, v41, s[8:11], s20 offen sc1
    s_mov_b32 s20, 14385152
    s_cmp_lg_u32 s16, 0
    s_cbranch_scc1 KF_FC
    buffer_store_dword v40, v41, s[8:11], s20 offen sc1
KF_FC:
    s_mov_b32 s20, 14286848
    buffer_store_dwordx4 v[4:7], v2, s[8:11], s20 offen
    s_mov_b32 s20, 14290944
    buffer_store_dwordx4 v[4:7], v2, s[8:11], s20 offen
    s_mov_b32 s20, 14295040
    buffer_store_dwordx4 v[4:7], v2, s[8:11], s20 offen
    s_mov_b32 s20, 14299136
    buffer_store_dwordx4 v[4:7], v2, s[8:11], s20 offen
    s_mov_b32 s20, 14162688
    buffer_load_dword v10, v1, s[8:11], s20 offen sc1
    s_mov_b32 s20, 14176512
    buffer_load_dword v11, v1, s[8:11], s20 offen sc1
    s_mov_b32 s20, 14163712
    buffer_load_dword v12, v1, s[8:11], s20 offen sc1
    s_mov_b32 s20, 14177536
    buffer_load_dword v13, v1, s[8:11], s20 offen sc1
    s_mov_b32 s20, 14164736
    buffer_load_dword v14, v1, s[8:11], s20 offen sc1
    s_mov_b32 s20, 14178560
    buffer_load_dword v15, v1, s[8:11], s20 offen sc1
    s_mov_b32 s20, 14165760
    buffer_load_dword v16, v1, s[8:11], s20 offen sc1
    s_mov_b32 s20, 14179584
    buffer_load_dword v17, v1, s[8:11], s20 offen sc1
    s_mov_b32 s20, 14166784
    buffer_load_dword v18, v1, s[8:11], s20 offen sc1
    s_mov_b32 s20, 14180608
    buffer_load_dword v19, v1, s[8:11], s20 offen sc1
    s_mov_b32 s20, 14167808
    buffer_load_dword v20, v1, s[8:11], s20 offen sc1
    s_mov_b32 s20, 14181632
    buffer_load_dword v21, v1, s[8:11], s20 offen sc1
    s_mov_b32 s20, 14168832
    buffer_load_dword v22, v1, s[8:11], s20 offen sc1
    s_mov_b32 s20, 14182656
    buffer_load_dword v23, v1, s[8:11], s20 offen sc1
    s_waitcnt vmcnt(0) lgkmcnt(0)
    v_add_f32 v10, v10, v11
    v_cvt_pk_bf16_f32 v10, v10, v10
    v_and_b32 v10, 0xffff0000, v10
    v_add_f32 v11, 1.0, v10
    v_cvt_pk_bf16_f32 v11, v11, v11
    v_and_b32 v11, 0xffff0000, v11
    v_add_u32 v2, 0, v0
    v_subrev_u32 v3, 576, v2
    v_cmp_gt_u32 vcc, 576, v3
    s_nop 1
    v_cndmask_b32 v10, v10, v11, vcc
    s_mov_b32 s20, 14221312
    buffer_store_dword v10, v1, s[8:11], s20 offen
    v_add_f32 v12, v12, v13
    v_cvt_pk_bf16_f32 v12, v12, v12
    v_and_b32 v12, 0xffff0000, v12
    v_add_f32 v13, 1.0, v12
    v_cvt_pk_bf16_f32 v13, v13, v13
    v_and_b32 v13, 0xffff0000, v13
    v_add_u32 v2, 256, v0
    v_subrev_u32 v3, 576, v2
    v_cmp_gt_u32 vcc, 576, v3
    s_nop 1
    v_cndmask_b32 v12, v12, v13, vcc
    s_mov_b32 s20, 14222336
    buffer_store_dword v12, v1, s[8:11], s20 offen
    v_add_f32 v14, v14, v15
    v_cvt_pk_bf16_f32 v14, v14, v14
    v_and_b32 v14, 0xffff0000, v14
    v_add_f32 v15, 1.0, v14
    v_cvt_pk_bf16_f32 v15, v15, v15
    v_and_b32 v15, 0xffff0000, v15
    v_add_u32 v2, 512, v0
    v_subrev_u32 v3, 576, v2
    v_cmp_gt_u32 vcc, 576, v3
    s_nop 1
    v_cndmask_b32 v14, v14, v15, vcc
    s_mov_b32 s20, 14223360
    buffer_store_dword v14, v1, s[8:11], s20 offen
    v_add_f32 v16, v16, v17
    v_cvt_pk_bf16_f32 v16, v16, v16
    v_and_b32 v16, 0xffff0000, v16
    v_add_f32 v17, 1.0, v16
    v_cvt_pk_bf16_f32 v17, v17, v17
    v_and_b32 v17, 0xffff0000, v17
    v_add_u32 v2, 768, v0
    v_subrev_u32 v3, 576, v2
    v_cmp_gt_u32 vcc, 576, v3
    s_nop 1
    v_cndmask_b32 v16, v16, v17, vcc
    s_mov_b32 s20, 14224384
    buffer_store_dword v16, v1, s[8:11], s20 offen
    v_add_f32 v18, v18, v19
    v_cvt_pk_bf16_f32 v18, v18, v18
    v_and_b32 v18, 0xffff0000, v18
    v_add_f32 v19, 1.0, v18
    v_cvt_pk_bf16_f32 v19, v19, v19
    v_and_b32 v19, 0xffff0000, v19
    v_add_u32 v2, 1024, v0
    v_subrev_u32 v3, 576, v2
    v_cmp_gt_u32 vcc, 576, v3
    s_nop 1
    v_cndmask_b32 v18, v18, v19, vcc
    s_mov_b32 s20, 14225408
    buffer_store_dword v18, v1, s[8:11], s20 offen
    v_add_f32 v20, v20, v21
    v_cvt_pk_bf16_f32 v20, v20, v20
    v_and_b32 v20, 0xffff0000, v20
    v_add_f32 v21, 1.0, v20
    v_cvt_pk_bf16_f32 v21, v21, v21
    v_and_b32 v21, 0xffff0000, v21
    v_add_u32 v2, 1280, v0
    v_subrev_u32 v3, 576, v2
    v_cmp_gt_u32 vcc, 576, v3
    s_nop 1
    v_cndmask_b32 v20, v20, v21, vcc
    s_mov_b32 s20, 14226432
    buffer_store_dword v20, v1, s[8:11], s20 offen
    v_add_f32 v22, v22, v23
    v_cvt_pk_bf16_f32 v22, v22, v22
    v_and_b32 v22, 0xffff0000, v22
    v_add_f32 v23, 1.0, v22
    v_cvt_pk_bf16_f32 v23, v23, v23
    v_and_b32 v23, 0xffff0000, v23
    v_add_u32 v2, 1536, v0
    v_subrev_u32 v3, 576, v2
    v_cmp_gt_u32 vcc, 576, v3
    s_nop 1
    v_cndmask_b32 v22, v22, v23, vcc
    s_mov_b32 s20, 14227456
    v_cmp_gt_u32 vcc, 1728, v2
    s_nop 0
    s_and_saveexec_b64 s[22:23], vcc
    s_cbranch_execz KF_END
    buffer_store_dword v22, v1, s[8:11], s20 offen
    s_endpgm
KF_CH:
    s_setprio 2
    s_load_dwordx8 s[16:23], s[0:1], 8
    s_load_dwordx8 s[24:31], s[0:1], 40
    s_sub_u32 s3, s2, 240
    s_and_b32 s4, s3, 7
    s_lshr_b32 s3, s3, 3
    s_mul_i32 s4, s4, 72
    s_add_u32 s3, s3, s4
    v_and_b32 v1, 63, v0
    v_lshrrev_b32 v2, 6, v0
    v_lshrrev_b32 v3, 4, v1
    v_and_b32 v4, 15, v0
    v_and_b32 v5, 31, v0
    v_lshl_add_u32 v5, v2, 5, v5
    v_lshlrev_b32 v6, 4, v5
    v_lshlrev_b32 v5, 1, v5
    s_lshl_b32 s4, s3, 8
    v_add_u32 v5, s4, v5
    s_lshl_b32 s5, s3, 1
    v_mov_b32 v15, s5
    s_waitcnt vmcnt(0) lgkmcnt(0)
    s_mov_b32 s8, s6
    s_and_b32 s9, s7, 0xffff
    s_mov_b32 s10, 0x10000000
    s_mov_b32 s11, 0x00020000
    s_sub_u32 s42, s2, 240
    s_lshl_b32 s42, s42, 6
    s_add_u32 s42, s42, 14352384
    v_mov_b32 v62, 0
    v_cmp_eq_u32 vcc, 192, v0
    s_nop 0
    s_and_saveexec_b64 s[44:45], vcc
    s_cbranch_execz KF_CH_R
    buffer_store_dword v62, v62, s[8:11], s42 offen sc1
KF_CH_R:
    s_mov_b64 exec, -1
    global_load_ushort v7, v15, s[28:29]
    global_load_ushort v28, v5, s[16:17]
    global_load_ushort v29, v5, s[18:19]
    global_load_ushort v30, v5, s[20:21]
    global_load_ushort v31, v5, s[22:23]
    global_load_ushort v32, v5, s[24:25]
    global_load_ushort v33, v5, s[26:27]
    global_load_ushort v63, v15, s[30:31]
    s_setprio 0
    v_and_b32 v12, 7, v4
    v_lshrrev_b32 v13, 3, v4
    v_lshl_add_u32 v8, v13, 7, v12
    v_lshrrev_b32 v12, 2, v4
    v_lshlrev_b32 v12, 7, v12
    v_and_b32 v13, 3, v4
    v_lshl_add_u32 v12, v13, 1, v12
    v_add_u32 v12, 256, v12
    v_subrev_u32 v13, 8, v4
    v_lshrrev_b32 v13, 1, v13
    v_lshlrev_b32 v13, 7, v13
    v_and_b32 v14, 1, v4
    v_lshl_add_u32 v13, v14, 2, v13
    v_add_u32 v13, 512, v13
    v_cmp_gt_u32 vcc, 8, v4
    s_nop 1
    v_cndmask_b32 v9, v13, v12, vcc
    v_lshlrev_b32 v12, 7, v4
    v_add_u32 v12, 1024, v12
    v_mov_b32 v13, 2048
    v_cndmask_b32 v10, v13, v12, vcc
    v_lshlrev_b32 v11, 3, v4
    v_lshlrev_b32 v12, 2, v4
    ds_write_b32 v12, v8 offset:24576
    ds_write_b32 v12, v9 offset:24640
    ds_write_b32 v12, v10 offset:24704
    v_cvt_f32_u32 v8, v8
    v_cvt_f32_u32 v9, v9
    v_cvt_f32_u32 v10, v10
    v_cvt_f32_u32 v11, v11
    v_lshlrev_b32 v12, 9, v2
    v_lshl_add_u32 v12, v3, 6, v12
    s_mov_b32 s33, 0x07060302
    s_waitcnt vmcnt(1)
    v_lshlrev_b32 v7, 16, v7
    v_mul_f32 v7, 0x3fb8aa3b, v7
    v_exp_f32 v7, v7
    s_nop 0
    v_cvt_pk_bf16_f32 v7, v7, v7
    v_and_b32 v7, 0xffff0000, v7
    v_lshlrev_b32 v28, 16, v28
    v_lshlrev_b32 v29, 16, v29
    v_lshlrev_b32 v30, 16, v30
    v_lshlrev_b32 v31, 16, v31
    v_lshlrev_b32 v32, 16, v32
    v_lshlrev_b32 v33, 16, v33
    v_mul_f32 v28, v7, v28
    v_mul_f32 v29, v7, v29
    v_mul_f32 v30, v7, v30
    v_mul_f32 v31, v7, v31
    v_mul_f32 v36, 0x3fb8aa3b, v28
    v_mul_f32 v37, 0x3e22f983, v29
    v_mul_f32 v38, v32, v30
    v_mul_f32 v39, v32, v31
    v_fma_f32 v38, -v33, v31, v38
    v_fmac_f32 v39, v33, v30
    ds_write_b128 v6, v[36:39] offset:29184
    ds_read_b128 v[64:67], v12 offset:29184
    ds_read_b128 v[68:71], v12 offset:29200
    ds_read_b128 v[72:75], v12 offset:29216
    ds_read_b128 v[76:79], v12 offset:29232
    ds_read_b128 v[80:83], v12 offset:29440
    ds_read_b128 v[84:87], v12 offset:29456
    ds_read_b128 v[88:91], v12 offset:29472
    ds_read_b128 v[92:95], v12 offset:29488
    s_mov_b32 s24, s34
    s_and_b32 s25, s35, 0xffff
    s_mov_b32 s26, 0x100
    s_mov_b32 s27, 0x00020000
    s_waitcnt lgkmcnt(7)
    v_mul_f32 v45, v64, v11
    v_mul_f32 v46, v65, v11
    v_mul_f32 v36, v64, v8
    v_mul_f32 v37, v65, v8
    v_mul_f32 v39, v64, v9
    v_mul_f32 v40, v65, v9
    v_mul_f32 v42, v64, v10
    v_mul_f32 v43, v65, v10
    v_exp_f32 v45, v45
    v_fract_f32 v46, v46
    v_exp_f32 v36, v36
    v_fract_f32 v37, v37
    v_exp_f32 v39, v39
    v_fract_f32 v40, v40
    v_exp_f32 v42, v42
    v_fract_f32 v43, v43
    v_cos_f32 v47, v46
    v_sin_f32 v46, v46
    v_cos_f32 v38, v37
    v_sin_f32 v37, v37
    v_cos_f32 v41, v40
    v_sin_f32 v40, v40
    v_cos_f32 v44, v43
    v_sin_f32 v43, v43
    v_mul_f32 v46, v45, v46
    v_mul_f32 v45, v45, v47
    v_mul_f32 v37, v36, v37
    v_mul_f32 v36, v36, v38
    v_mul_f32 v40, v39, v40
    v_mul_f32 v39, v39, v41
    v_mul_f32 v43, v42, v43
    v_mul_f32 v42, v42, v44
    v_mul_f32 v48, v66, v45
    v_mul_f32 v49, v66, v46
    v_fma_f32 v48, -v67, v46, v48
    v_fma_f32 v49, -v67, v45, -v49
    v_perm_b32 v96, v37, v36, s33
    v_and_b32 v50, 0xffff0000, v36
    v_and_b32 v51, 0xffff0000, v37
    v_sub_f32 v50, v36, v50
    v_sub_f32 v51, v37, v51
    v_perm_b32 v100, v51, v50, s33
    v_perm_b32 v104, v40, v39, s33
    v_and_b32 v50, 0xffff0000, v39
    v_and_b32 v51, 0xffff0000, v40
    v_sub_f32 v50, v39, v50
    v_sub_f32 v51, v40, v51
    v_perm_b32 v108, v51, v50, s33
    v_perm_b32 v112, v43, v42, s33
    v_and_b32 v50, 0xffff0000, v42
    v_and_b32 v51, 0xffff0000, v43
    v_sub_f32 v50, v42, v50
    v_sub_f32 v51, v43, v51
    v_perm_b32 v116, v51, v50, s33
    v_perm_b32 v120, v49, v48, s33
    v_and_b32 v50, 0xffff0000, v48
    v_and_b32 v51, 0xffff0000, v49
    v_sub_f32 v50, v48, v50
    v_sub_f32 v51, v49, v51
    v_perm_b32 v124, v51, v50, s33
    s_waitcnt lgkmcnt(6)
    v_mul_f32 v45, v68, v11
    v_mul_f32 v46, v69, v11
    v_mul_f32 v36, v68, v8
    v_mul_f32 v37, v69, v8
    v_mul_f32 v39, v68, v9
    v_mul_f32 v40, v69, v9
    v_mul_f32 v42, v68, v10
    v_mul_f32 v43, v69, v10
    v_exp_f32 v45, v45
    v_fract_f32 v46, v46
    v_exp_f32 v36, v36
    v_fract_f32 v37, v37
    v_exp_f32 v39, v39
    v_fract_f32 v40, v40
    v_exp_f32 v42, v42
    v_fract_f32 v43, v43
    v_cos_f32 v47, v46
    v_sin_f32 v46, v46
    v_cos_f32 v38, v37
    v_sin_f32 v37, v37
    v_cos_f32 v41, v40
    v_sin_f32 v40, v40
    v_cos_f32 v44, v43
    v_sin_f32 v43, v43
    v_mul_f32 v46, v45, v46
    v_mul_f32 v45, v45, v47
    v_mul_f32 v37, v36, v37
    v_mul_f32 v36, v36, v38
    v_mul_f32 v40, v39, v40
    v_mul_f32 v39, v39, v41
    v_mul_f32 v43, v42, v43
    v_mul_f32 v42, v42, v44
    v_mul_f32 v48, v70, v45
    v_mul_f32 v49, v70, v46
    v_fma_f32 v48, -v71, v46, v48
    v_fma_f32 v49, -v71, v45, -v49
    v_perm_b32 v97, v37, v36, s33
    v_and_b32 v50, 0xffff0000, v36
    v_and_b32 v51, 0xffff0000, v37
    v_sub_f32 v50, v36, v50
    v_sub_f32 v51, v37, v51
    v_perm_b32 v101, v51, v50, s33
    v_perm_b32 v105, v40, v39, s33
    v_and_b32 v50, 0xffff0000, v39
    v_and_b32 v51, 0xffff0000, v40
    v_sub_f32 v50, v39, v50
    v_sub_f32 v51, v40, v51
    v_perm_b32 v109, v51, v50, s33
    v_perm_b32 v113, v43, v42, s33
    v_and_b32 v50, 0xffff0000, v42
    v_and_b32 v51, 0xffff0000, v43
    v_sub_f32 v50, v42, v50
    v_sub_f32 v51, v43, v51
    v_perm_b32 v117, v51, v50, s33
    v_perm_b32 v121, v49, v48, s33
    v_and_b32 v50, 0xffff0000, v48
    v_and_b32 v51, 0xffff0000, v49
    v_sub_f32 v50, v48, v50
    v_sub_f32 v51, v49, v51
    v_perm_b32 v125, v51, v50, s33
    s_waitcnt lgkmcnt(5)
    v_mul_f32 v45, v72, v11
    v_mul_f32 v46, v73, v11
    v_mul_f32 v36, v72, v8
    v_mul_f32 v37, v73, v8
    v_mul_f32 v39, v72, v9
    v_mul_f32 v40, v73, v9
    v_mul_f32 v42, v72, v10
    v_mul_f32 v43, v73, v10
    v_exp_f32 v45, v45
    v_fract_f32 v46, v46
    v_exp_f32 v36, v36
    v_fract_f32 v37, v37
    v_exp_f32 v39, v39
    v_fract_f32 v40, v40
    v_exp_f32 v42, v42
    v_fract_f32 v43, v43
    v_cos_f32 v47, v46
    v_sin_f32 v46, v46
    v_cos_f32 v38, v37
    v_sin_f32 v37, v37
    v_cos_f32 v41, v40
    v_sin_f32 v40, v40
    v_cos_f32 v44, v43
    v_sin_f32 v43, v43
    v_mul_f32 v46, v45, v46
    v_mul_f32 v45, v45, v47
    v_mul_f32 v37, v36, v37
    v_mul_f32 v36, v36, v38
    v_mul_f32 v40, v39, v40
    v_mul_f32 v39, v39, v41
    v_mul_f32 v43, v42, v43
    v_mul_f32 v42, v42, v44
    v_mul_f32 v48, v74, v45
    v_mul_f32 v49, v74, v46
    v_fma_f32 v48, -v75, v46, v48
    v_fma_f32 v49, -v75, v45, -v49
    v_perm_b32 v98, v37, v36, s33
    v_and_b32 v50, 0xffff0000, v36
    v_and_b32 v51, 0xffff0000, v37
    v_sub_f32 v50, v36, v50
    v_sub_f32 v51, v37, v51
    v_perm_b32 v102, v51, v50, s33
    v_perm_b32 v106, v40, v39, s33
    v_and_b32 v50, 0xffff0000, v39
    v_and_b32 v51, 0xffff0000, v40
    v_sub_f32 v50, v39, v50
    v_sub_f32 v51, v40, v51
    v_perm_b32 v110, v51, v50, s33
    v_perm_b32 v114, v43, v42, s33
    v_and_b32 v50, 0xffff0000, v42
    v_and_b32 v51, 0xffff0000, v43
    v_sub_f32 v50, v42, v50
    v_sub_f32 v51, v43, v51
    v_perm_b32 v118, v51, v50, s33
    v_perm_b32 v122, v49, v48, s33
    v_and_b32 v50, 0xffff0000, v48
    v_and_b32 v51, 0xffff0000, v49
    v_sub_f32 v50, v48, v50
    v_sub_f32 v51, v49, v51
    v_perm_b32 v126, v51, v50, s33
    s_waitcnt lgkmcnt(4)
    v_mul_f32 v45, v76, v11
    v_mul_f32 v46, v77, v11
    v_mul_f32 v36, v76, v8
    v_mul_f32 v37, v77, v8
    v_mul_f32 v39, v76, v9
    v_mul_f32 v40, v77, v9
    v_mul_f32 v42, v76, v10
    v_mul_f32 v43, v77, v10
    v_exp_f32 v45, v45
    v_fract_f32 v46, v46
    v_exp_f32 v36, v36
    v_fract_f32 v37, v37
    v_exp_f32 v39, v39
    v_fract_f32 v40, v40
    v_exp_f32 v42, v42
    v_fract_f32 v43, v43
    v_cos_f32 v47, v46
    v_sin_f32 v46, v46
    v_cos_f32 v38, v37
    v_sin_f32 v37, v37
    v_cos_f32 v41, v40
    v_sin_f32 v40, v40
    v_cos_f32 v44, v43
    v_sin_f32 v43, v43
    v_mul_f32 v46, v45, v46
    v_mul_f32 v45, v45, v47
    v_mul_f32 v37, v36, v37
    v_mul_f32 v36, v36, v38
    v_mul_f32 v40, v39, v40
    v_mul_f32 v39, v39, v41
    v_mul_f32 v43, v42, v43
    v_mul_f32 v42, v42, v44
    v_mul_f32 v48, v78, v45
    v_mul_f32 v49, v78, v46
    v_fma_f32 v48, -v79, v46, v48
    v_fma_f32 v49, -v79, v45, -v49
    v_perm_b32 v99, v37, v36, s33
    v_and_b32 v50, 0xffff0000, v36
    v_and_b32 v51, 0xffff0000, v37
    v_sub_f32 v50, v36, v50
    v_sub_f32 v51, v37, v51
    v_perm_b32 v103, v51, v50, s33
    v_perm_b32 v107, v40, v39, s33
    v_and_b32 v50, 0xffff0000, v39
    v_and_b32 v51, 0xffff0000, v40
    v_sub_f32 v50, v39, v50
    v_sub_f32 v51, v40, v51
    v_perm_b32 v111, v51, v50, s33
    v_perm_b32 v115, v43, v42, s33
    v_and_b32 v50, 0xffff0000, v42
    v_and_b32 v51, 0xffff0000, v43
    v_sub_f32 v50, v42, v50
    v_sub_f32 v51, v43, v51
    v_perm_b32 v119, v51, v50, s33
    v_perm_b32 v123, v49, v48, s33
    v_and_b32 v50, 0xffff0000, v48
    v_and_b32 v51, 0xffff0000, v49
    v_sub_f32 v50, v48, v50
    v_sub_f32 v51, v49, v51
    v_perm_b32 v127, v51, v50, s33
    s_waitcnt lgkmcnt(3)
    v_mul_f32 v45, v80, v11
    v_mul_f32 v46, v81, v11
    v_mfma_f32_16x16x32_bf16 v[16:19], v[100:103], v[120:123], 0
    v_mul_f32 v36, v80, v8
    v_mul_f32 v37, v81, v8
    v_mul_f32 v39, v80, v9
    v_mfma_f32_16x16x32_bf16 v[20:23], v[108:111], v[120:123], 0
    v_mul_f32 v40, v81, v9
    v_mul_f32 v42, v80, v10
    v_mul_f32 v43, v81, v10
    v_mfma_f32_16x16x32_bf16 v[24:27], v[116:119], v[120:123], 0
    v_exp_f32 v45, v45
    v_fract_f32 v46, v46
    v_exp_f32 v36, v36
    v_mfma_f32_16x16x32_bf16 v[16:19], v[96:99], v[124:127], v[16:19]
    v_fract_f32 v37, v37
    v_exp_f32 v39, v39
    v_fract_f32 v40, v40
    v_mfma_f32_16x16x32_bf16 v[20:23], v[104:107], v[124:127], v[20:23]
    v_exp_f32 v42, v42
    v_fract_f32 v43, v43
    v_cos_f32 v47, v46
    v_mfma_f32_16x16x32_bf16 v[24:27], v[112:115], v[124:127], v[24:27]
    v_sin_f32 v46, v46
    v_cos_f32 v38, v37
    v_sin_f32 v37, v37
    v_mfma_f32_16x16x32_bf16 v[16:19], v[96:99], v[120:123], v[16:19]
    v_cos_f32 v41, v40
    v_sin_f32 v40, v40
    v_cos_f32 v44, v43
    v_mfma_f32_16x16x32_bf16 v[20:23], v[104:107], v[120:123], v[20:23]
    v_sin_f32 v43, v43
    v_mul_f32 v46, v45, v46
    v_mul_f32 v45, v45, v47
    v_mfma_f32_16x16x32_bf16 v[24:27], v[112:115], v[120:123], v[24:27]
    v_mul_f32 v37, v36, v37
    v_mul_f32 v36, v36, v38
    v_mul_f32 v40, v39, v40
    v_mul_f32 v39, v39, v41
    v_mul_f32 v43, v42, v43
    v_mul_f32 v42, v42, v44
    v_mul_f32 v48, v82, v45
    v_mul_f32 v49, v82, v46
    v_fma_f32 v48, -v83, v46, v48
    v_fma_f32 v49, -v83, v45, -v49
    v_perm_b32 v96, v37, v36, s33
    v_and_b32 v50, 0xffff0000, v36
    v_and_b32 v51, 0xffff0000, v37
    v_sub_f32 v50, v36, v50
    v_sub_f32 v51, v37, v51
    v_perm_b32 v100, v51, v50, s33
    v_perm_b32 v104, v40, v39, s33
    v_and_b32 v50, 0xffff0000, v39
    v_and_b32 v51, 0xffff0000, v40
    v_sub_f32 v50, v39, v50
    v_sub_f32 v51, v40, v51
    v_perm_b32 v108, v51, v50, s33
    v_perm_b32 v112, v43, v42, s33
    v_and_b32 v50, 0xffff0000, v42
    v_and_b32 v51, 0xffff0000, v43
    v_sub_f32 v50, v42, v50
    v_sub_f32 v51, v43, v51
    v_perm_b32 v116, v51, v50, s33
    v_perm_b32 v120, v49, v48, s33
    v_and_b32 v50, 0xffff0000, v48
    v_and_b32 v51, 0xffff0000, v49
    v_sub_f32 v50, v48, v50
    v_sub_f32 v51, v49, v51
    v_perm_b32 v124, v51, v50, s33
    s_waitcnt lgkmcnt(2)
    v_mul_f32 v45, v84, v11
    v_mul_f32 v46, v85, v11
    v_mul_f32 v36, v84, v8
    v_mul_f32 v37, v85, v8
    v_mul_f32 v39, v84, v9
    v_mul_f32 v40, v85, v9
    v_mul_f32 v42, v84, v10
    v_mul_f32 v43, v85, v10
    v_exp_f32 v45, v45
    v_fract_f32 v46, v46
    v_exp_f32 v36, v36
    v_fract_f32 v37, v37
    v_exp_f32 v39, v39
    v_fract_f32 v40, v40
    v_exp_f32 v42, v42
    v_fract_f32 v43, v43
    v_cos_f32 v47, v46
    v_sin_f32 v46, v46
    v_cos_f32 v38, v37
    v_sin_f32 v37, v37
    v_cos_f32 v41, v40
    v_sin_f32 v40, v40
    v_cos_f32 v44, v43
    v_sin_f32 v43, v43
    v_mul_f32 v46, v45, v46
    v_mul_f32 v45, v45, v47
    v_mul_f32 v37, v36, v37
    v_mul_f32 v36, v36, v38
    v_mul_f32 v40, v39, v40
    v_mul_f32 v39, v39, v41
    v_mul_f32 v43, v42, v43
    v_mul_f32 v42, v42, v44
    v_mul_f32 v48, v86, v45
    v_mul_f32 v49, v86, v46
    v_fma_f32 v48, -v87, v46, v48
    v_fma_f32 v49, -v87, v45, -v49
    v_perm_b32 v97, v37, v36, s33
    v_and_b32 v50, 0xffff0000, v36
    v_and_b32 v51, 0xffff0000, v37
    v_sub_f32 v50, v36, v50
    v_sub_f32 v51, v37, v51
    v_perm_b32 v101, v51, v50, s33
    v_perm_b32 v105, v40, v39, s33
    v_and_b32 v50, 0xffff0000, v39
    v_and_b32 v51, 0xffff0000, v40
    v_sub_f32 v50, v39, v50
    v_sub_f32 v51, v40, v51
    v_perm_b32 v109, v51, v50, s33
    v_perm_b32 v113, v43, v42, s33
    v_and_b32 v50, 0xffff0000, v42
    v_and_b32 v51, 0xffff0000, v43
    v_sub_f32 v50, v42, v50
    v_sub_f32 v51, v43, v51
    v_perm_b32 v117, v51, v50, s33
    v_perm_b32 v121, v49, v48, s33
    v_and_b32 v50, 0xffff0000, v48
    v_and_b32 v51, 0xffff0000, v49
    v_sub_f32 v50, v48, v50
    v_sub_f32 v51, v49, v51
    v_perm_b32 v125, v51, v50, s33
    s_waitcnt lgkmcnt(1)
    v_mul_f32 v45, v88, v11
    v_mul_f32 v46, v89, v11
    v_mul_f32 v36, v88, v8
    v_mul_f32 v37, v89, v8
    v_mul_f32 v39, v88, v9
    v_mul_f32 v40, v89, v9
    v_mul_f32 v42, v88, v10
    v_mul_f32 v43, v89, v10
    v_exp_f32 v45, v45
    v_fract_f32 v46, v46
    v_exp_f32 v36, v36
    v_fract_f32 v37, v37
    v_exp_f32 v39, v39
    v_fract_f32 v40, v40
    v_exp_f32 v42, v42
    v_fract_f32 v43, v43
    v_cos_f32 v47, v46
    v_sin_f32 v46, v46
    v_cos_f32 v38, v37
    v_sin_f32 v37, v37
    v_cos_f32 v41, v40
    v_sin_f32 v40, v40
    v_cos_f32 v44, v43
    v_sin_f32 v43, v43
    v_mul_f32 v46, v45, v46
    v_mul_f32 v45, v45, v47
    v_mul_f32 v37, v36, v37
    v_mul_f32 v36, v36, v38
    v_mul_f32 v40, v39, v40
    v_mul_f32 v39, v39, v41
    v_mul_f32 v43, v42, v43
    v_mul_f32 v42, v42, v44
    v_mul_f32 v48, v90, v45
    v_mul_f32 v49, v90, v46
    v_fma_f32 v48, -v91, v46, v48
    v_fma_f32 v49, -v91, v45, -v49
    v_perm_b32 v98, v37, v36, s33
    v_and_b32 v50, 0xffff0000, v36
    v_and_b32 v51, 0xffff0000, v37
    v_sub_f32 v50, v36, v50
    v_sub_f32 v51, v37, v51
    v_perm_b32 v102, v51, v50, s33
    v_perm_b32 v106, v40, v39, s33
    v_and_b32 v50, 0xffff0000, v39
    v_and_b32 v51, 0xffff0000, v40
    v_sub_f32 v50, v39, v50
    v_sub_f32 v51, v40, v51
    v_perm_b32 v110, v51, v50, s33
    v_perm_b32 v114, v43, v42, s33
    v_and_b32 v50, 0xffff0000, v42
    v_and_b32 v51, 0xffff0000, v43
    v_sub_f32 v50, v42, v50
    v_sub_f32 v51, v43, v51
    v_perm_b32 v118, v51, v50, s33
    v_perm_b32 v122, v49, v48, s33
    v_and_b32 v50, 0xffff0000, v48
    v_and_b32 v51, 0xffff0000, v49
    v_sub_f32 v50, v48, v50
    v_sub_f32 v51, v49, v51
    v_perm_b32 v126, v51, v50, s33
    s_waitcnt lgkmcnt(0)
    v_mul_f32 v45, v92, v11
    v_mul_f32 v46, v93, v11
    v_mul_f32 v36, v92, v8
    v_mul_f32 v37, v93, v8
    v_mul_f32 v39, v92, v9
    v_mul_f32 v40, v93, v9
    v_mul_f32 v42, v92, v10
    v_mul_f32 v43, v93, v10
    v_exp_f32 v45, v45
    v_fract_f32 v46, v46
    v_exp_f32 v36, v36
    v_fract_f32 v37, v37
    v_exp_f32 v39, v39
    v_fract_f32 v40, v40
    v_exp_f32 v42, v42
    v_fract_f32 v43, v43
    v_cos_f32 v47, v46
    v_sin_f32 v46, v46
    v_cos_f32 v38, v37
    v_sin_f32 v37, v37
    v_cos_f32 v41, v40
    v_sin_f32 v40, v40
    v_cos_f32 v44, v43
    v_sin_f32 v43, v43
    v_mul_f32 v46, v45, v46
    v_mul_f32 v45, v45, v47
    v_mul_f32 v37, v36, v37
    v_mul_f32 v36, v36, v38
    v_mul_f32 v40, v39, v40
    v_mul_f32 v39, v39, v41
    v_mul_f32 v43, v42, v43
    v_mul_f32 v42, v42, v44
    v_mul_f32 v48, v94, v45
    v_mul_f32 v49, v94, v46
    v_fma_f32 v48, -v95, v46, v48
    v_fma_f32 v49, -v95, v45, -v49
    v_perm_b32 v99, v37, v36, s33
    v_and_b32 v50, 0xffff0000, v36
    v_and_b32 v51, 0xffff0000, v37
    v_sub_f32 v50, v36, v50
    v_sub_f32 v51, v37, v51
    v_perm_b32 v103, v51, v50, s33
    v_perm_b32 v107, v40, v39, s33
    v_and_b32 v50, 0xffff0000, v39
    v_and_b32 v51, 0xffff0000, v40
    v_sub_f32 v50, v39, v50
    v_sub_f32 v51, v40, v51
    v_perm_b32 v111, v51, v50, s33
    v_perm_b32 v115, v43, v42, s33
    v_and_b32 v50, 0xffff0000, v42
    v_and_b32 v51, 0xffff0000, v43
    v_sub_f32 v50, v42, v50
    v_sub_f32 v51, v43, v51
    v_perm_b32 v119, v51, v50, s33
    v_perm_b32 v123, v49, v48, s33
    v_and_b32 v50, 0xffff0000, v48
    v_and_b32 v51, 0xffff0000, v49
    v_sub_f32 v50, v48, v50
    v_sub_f32 v51, v49, v51
    v_perm_b32 v127, v51, v50, s33
    v_mfma_f32_16x16x32_bf16 v[16:19], v[100:103], v[120:123], v[16:19]
    v_mfma_f32_16x16x32_bf16 v[20:23], v[108:111], v[120:123], v[20:23]
    v_mfma_f32_16x16x32_bf16 v[24:27], v[116:119], v[120:123], v[24:27]
    v_mfma_f32_16x16x32_bf16 v[16:19], v[96:99], v[124:127], v[16:19]
    v_mfma_f32_16x16x32_bf16 v[20:23], v[104:107], v[124:127], v[20:23]
    v_mfma_f32_16x16x32_bf16 v[24:27], v[112:115], v[124:127], v[24:27]
    v_mfma_f32_16x16x32_bf16 v[16:19], v[96:99], v[120:123], v[16:19]
    v_mfma_f32_16x16x32_bf16 v[20:23], v[104:107], v[120:123], v[20:23]
    v_mfma_f32_16x16x32_bf16 v[24:27], v[112:115], v[120:123], v[24:27]
    v_mul_u32_u24 v12, 3072, v2
    v_lshl_add_u32 v12, v1, 4, v12
    s_nop 3
    ds_write_b128 v12, v[16:19] offset:0
    ds_write_b128 v12, v[20:23] offset:1024
    ds_write_b128 v12, v[24:27] offset:2048
    v_readfirstlane_b32 s16, v2
    v_lshlrev_b32 v13, 4, v0
    v_lshlrev_b32 v14, 6, v2
    v_lshl_add_u32 v14, v3, 4, v14
    v_lshlrev_b32 v12, 3, v0
    v_subrev_u32 v64, 1, v12
    v_max_i32 v64, 0, v64
    v_add_u32 v65, 0, v12
    v_add_u32 v66, 1, v12
    v_add_u32 v67, 2, v12
    v_add_u32 v68, 3, v12
    v_add_u32 v69, 4, v12
    v_add_u32 v70, 5, v12
    v_add_u32 v71, 6, v12
    v_add_u32 v72, 7, v12
    v_mov_b32 v73, 0
    v_cvt_f32_u32 v64, v64
    v_cvt_f32_u32 v65, v65
    v_cvt_f32_u32 v66, v66
    v_cvt_f32_u32 v67, v67
    v_cvt_f32_u32 v68, v68
    v_cvt_f32_u32 v69, v69
    v_cvt_f32_u32 v70, v70
    v_cvt_f32_u32 v71, v71
    v_cvt_f32_u32 v72, v72
    v_cvt_f32_u32 v73, v73
    v_cvt_pk_bf16_f32 v15, v64, v65
    v_lshlrev_b32 v64, 16, v15
    v_and_b32 v65, 0xffff0000, v15
    v_cvt_pk_bf16_f32 v15, v66, v67
    v_lshlrev_b32 v66, 16, v15
    v_and_b32 v67, 0xffff0000, v15
    v_cvt_pk_bf16_f32 v15, v68, v69
    v_lshlrev_b32 v68, 16, v15
    v_and_b32 v69, 0xffff0000, v15
    v_cvt_pk_bf16_f32 v15, v70, v71
    v_lshlrev_b32 v70, 16, v15
    v_and_b32 v71, 0xffff0000, v15
    v_cvt_pk_bf16_f32 v15, v72, v73
    v_lshlrev_b32 v72, 16, v15
    v_and_b32 v73, 0xffff0000, v15
    v_cvt_u32_f32 v64, v64
    v_lshlrev_b32 v64, 1, v64
    v_cvt_u32_f32 v65, v65
    v_lshlrev_b32 v65, 1, v65
    v_cvt_u32_f32 v66, v66
    v_lshlrev_b32 v66, 1, v66
    v_cvt_u32_f32 v67, v67
    v_lshlrev_b32 v67, 1, v67
    v_cvt_u32_f32 v68, v68
    v_lshlrev_b32 v68, 1, v68
    v_cvt_u32_f32 v69, v69
    v_lshlrev_b32 v69, 1, v69
    v_cvt_u32_f32 v70, v70
    v_lshlrev_b32 v70, 1, v70
    v_cvt_u32_f32 v71, v71
    v_lshlrev_b32 v71, 1, v71
    v_cvt_u32_f32 v72, v72
    v_lshlrev_b32 v72, 1, v72
    s_waitcnt lgkmcnt(0)
    s_barrier
    s_cmp_eq_u32 s16, 3
    s_cbranch_scc1 KF_CH_P
    ds_read_b128 v[16:19], v13 offset:0
    ds_read_b128 v[20:23], v13 offset:3072
    ds_read_b128 v[24:27], v13 offset:6144
    ds_read_b128 v[28:31], v13 offset:9216
    ds_read_b128 v[32:35], v14 offset:24576
    s_waitcnt lgkmcnt(0)
    v_add_f32 v16, v16, v20
    v_add_f32 v24, v24, v28
    v_lshl_add_u32 v32, v4, 3, v32
    v_add_f32 v17, v17, v21
    v_add_f32 v25, v25, v29
    v_lshl_add_u32 v33, v4, 3, v33
    v_add_f32 v18, v18, v22
    v_add_f32 v26, v26, v30
    v_lshl_add_u32 v34, v4, 3, v34
    v_add_f32 v19, v19, v23
    v_add_f32 v27, v27, v31
    v_lshl_add_u32 v35, v4, 3, v35
    v_add_f32 v16, v16, v24
    v_lshlrev_b32 v32, 1, v32
    v_add_f32 v17, v17, v25
    v_lshlrev_b32 v33, 1, v33
    v_add_f32 v18, v18, v26
    v_lshlrev_b32 v34, 1, v34
    v_add_f32 v19, v19, v27
    v_lshlrev_b32 v35, 1, v35
    v_cvt_pk_bf16_f32 v16, v16, v16
    v_cvt_pk_bf16_f32 v17, v17, v17
    v_cvt_pk_bf16_f32 v18, v18, v18
    v_cvt_pk_bf16_f32 v19, v19, v19
    ds_write_b16 v32, v16 offset:24832
    ds_write_b16 v33, v17 offset:24832
    ds_write_b16 v34, v18 offset:24832
    ds_write_b16 v35, v19 offset:24832
    s_branch KF_CH_C
KF_CH_P:
    v_mov_b32 v16, 252
    s_mov_b32 s36, 0x2000
    buffer_load_dword v17, v62, s[8:11], s42 offen sc1
KF_PC:
    buffer_load_dword v18, v62, s[8:11], s42 offen sc1
    s_waitcnt vmcnt(1)
    v_cmp_ne_u32 vcc, 0, v17
    s_cbranch_vccnz KF_PC_X
    buffer_load_dword v17, v62, s[8:11], s42 offen sc1
    s_waitcnt vmcnt(1)
    v_cmp_ne_u32 vcc, 0, v18
    s_cbranch_vccnz KF_PC_X
    s_sub_u32 s36, s36, 1
    s_cbranch_scc1 KF_PC_X
    s_and_b32 s37, s36, 15
    s_cbranch_scc1 KF_PC
    buffer_load_dword v20, v16, s[24:27], 0 offen sc1
    s_waitcnt vmcnt(0)
    v_cmp_ne_u32 vcc, 0, v20
    s_cbranch_vccz KF_PC
KF_PC_X:
    s_waitcnt vmcnt(0)
KF_CH_C:
    v_lshrrev_b32 v16, 1, v0
    v_mul_u32_u24 v16, 36864, v16
    v_and_b32 v17, 1, v0
    v_lshl_add_u32 v16, v17, 4, v16
    v_mul_u32_u24 v17, 36864, v4
    v_lshl_add_u32 v17, v3, 3, v17
    s_lshl_b32 s17, s3, 6
    s_mul_i32 s18, s16, 1179648
    s_add_u32 s18, s18, s17
    s_add_u32 s19, s18, 589824
    s_lshl_b32 s20, s3, 2
    v_mov_b32 v18, s20
    s_mov_b32 s21, 14155776
    s_mov_b32 s22, 14169600
    s_mov_b32 s23, 14160384
    s_mov_b32 s32, 14174208
    s_waitcnt lgkmcnt(0)
    s_barrier
    buffer_load_dwordx4 v[20:23], v16, s[8:11], s17 offen sc1
    buffer_load_dword v24, v18, s[8:11], s21 offen sc1
    buffer_load_dword v25, v18, s[8:11], s22 offen sc1
    buffer_load_dword v26, v18, s[8:11], s21 offen offset:2304 sc1
    buffer_load_dword v27, v18, s[8:11], s22 offen offset:2304 sc1
    buffer_load_dword v60, v18, s[8:11], s23 offen sc1
    buffer_load_dword v61, v18, s[8:11], s32 offen sc1
    buffer_load_dwordx2 v[56:57], v17, s[8:11], s18 offen offset:32 sc1
    buffer_load_dwordx2 v[58:59], v17, s[8:11], s19 offen offset:32 sc1
    ds_read_u16 v80, v64 offset:24832
    ds_read_u16 v81, v65 offset:24832
    ds_read_u16 v82, v66 offset:24832
    ds_read_u16 v83, v67 offset:24832
    ds_read_u16 v84, v68 offset:24832
    ds_read_u16 v85, v69 offset:24832
    ds_read_u16 v86, v70 offset:24832
    ds_read_u16 v87, v71 offset:24832
    ds_read_u16 v88, v72 offset:24832
    v_mov_b32 v28, 0
    v_mov_b32 v29, 0
    v_mul_u32_u24 v30, 4160, v3
    v_lshl_add_u32 v30, v4, 1, v30
    v_and_b32 v30, -4, v30
    ds_write_b32 v30, v28
    v_lshlrev_b32 v31, 3, v1
    ds_write_b64 v31, v[28:29] offset:31232
    v_add_u32 v31, 8352, v28
    ds_write_b32 v31, v28
    ds_write_b32 v31, v28 offset:4160
    v_cmp_eq_u32 vcc, 0, v0
    s_waitcnt lgkmcnt(0)
    s_nop 0
    v_cndmask_b32 v80, v80, v28, vcc
    v_lshl_or_b32 v32, v82, 16, v81
    v_lshl_or_b32 v36, v81, 16, v80
    v_lshl_or_b32 v33, v84, 16, v83
    v_lshl_or_b32 v37, v83, 16, v82
    v_lshl_or_b32 v34, v86, 16, v85
    v_lshl_or_b32 v38, v85, 16, v84
    v_lshl_or_b32 v35, v88, 16, v87
    v_lshl_or_b32 v39, v87, 16, v86
    v_add_u32 v30, 8356, v13
    v_add_u32 v31, 12516, v13
    ds_write_b128 v13, v[32:35] offset:32
    ds_write_b128 v13, v[36:39] offset:4192
    ds_write2_b32 v30, v32, v33 offset0:0 offset1:1
    ds_write2_b32 v30, v34, v35 offset0:2 offset1:3
    ds_write2_b32 v31, v36, v37 offset0:0 offset1:1
    ds_write2_b32 v31, v38, v39 offset0:2 offset1:3
    s_lshl_b32 s20, s16, 7
    v_lshlrev_b32 v18, 5, v4
    v_lshl_add_u32 v18, v3, 4, v18
    v_add_u32 v18, 31200, v18
    v_subrev_u32 v18, s20, v18
    v_bfe_u32 v19, v1, 2, 2
    v_mul_u32_u24 v19, 4160, v19
    v_and_b32 v14, 3, v1
    v_lshl_add_u32 v19, v14, 3, v19
    v_lshlrev_b32 v14, 4, v3
    v_sub_u32 v19, v19, v14
    v_add_u32 v19, 56, v19
    v_add_u32 v19, s20, v19
    s_lshl_b32 s20, s16, 10
    v_lshlrev_b32 v14, 5, v4
    v_lshl_add_u32 v14, v3, 3, v14
    v_add_u32 v14, 31744, v14
    v_add_u32 v14, s20, v14
    s_waitcnt vmcnt(4)
    v_add_f32 v24, v24, v25
    v_cvt_pk_bf16_f32 v24, v24, v24
    v_and_b32 v24, 0xffff0000, v24
    v_add_f32 v26, v26, v27
    v_cvt_pk_bf16_f32 v26, v26, v26
    v_and_b32 v26, 0xffff0000, v26
    v_add_f32 v26, 1.0, v26
    v_cvt_pk_bf16_f32 v26, v26, v26
    v_and_b32 v26, 0xffff0000, v26
    v_lshlrev_b32 v28, 16, v20
    v_and_b32 v29, 0xffff0000, v20
    v_mul_f32 v28, v28, v26
    v_mul_f32 v29, v29, v26
    v_cvt_pk_bf16_f32 v30, v28, v29
    v_lshlrev_b32 v28, 16, v30
    v_and_b32 v29, 0xffff0000, v30
    v_add_f32 v28, v28, v24
    v_add_f32 v29, v29, v24
    v_cvt_pk_bf16_f32 v20, v28, v29
    v_lshlrev_b32 v28, 16, v21
    v_and_b32 v29, 0xffff0000, v21
    v_mul_f32 v28, v28, v26
    v_mul_f32 v29, v29, v26
    v_cvt_pk_bf16_f32 v30, v28, v29
    v_lshlrev_b32 v28, 16, v30
    v_and_b32 v29, 0xffff0000, v30
    v_add_f32 v28, v28, v24
    v_add_f32 v29, v29, v24
    v_cvt_pk_bf16_f32 v21, v28, v29
    v_lshlrev_b32 v28, 16, v22
    v_and_b32 v29, 0xffff0000, v22
    v_mul_f32 v28, v28, v26
    v_mul_f32 v29, v29, v26
    v_cvt_pk_bf16_f32 v30, v28, v29
    v_lshlrev_b32 v28, 16, v30
    v_and_b32 v29, 0xffff0000, v30
    v_add_f32 v28, v28, v24
    v_add_f32 v29, v29, v24
    v_cvt_pk_bf16_f32 v22, v28, v29
    v_lshlrev_b32 v28, 16, v23
    v_and_b32 v29, 0xffff0000, v23
    v_mul_f32 v28, v28, v26
    v_mul_f32 v29, v29, v26
    v_cvt_pk_bf16_f32 v30, v28, v29
    v_lshlrev_b32 v28, 16, v30
    v_and_b32 v29, 0xffff0000, v30
    v_add_f32 v28, v28, v24
    v_add_f32 v29, v29, v24
    v_cvt_pk_bf16_f32 v23, v28, v29
    ds_write_b128 v13, v[20:23] offset:31744
    s_waitcnt lgkmcnt(0)
    s_barrier
    ds_read_b64_tr_b16 v[96:97], v19 offset:8
    ds_read_b64_tr_b16 v[98:99], v19 offset:0
    ds_read_b128 v[64:67], v18 offset:512
    ds_read_b128 v[68:71], v18 offset:1024
    ds_read_b128 v[72:75], v18 offset:1536
    ds_read_b128 v[76:79], v18 offset:2048
    ds_read_b128 v[80:83], v18 offset:2560
    ds_read_b128 v[84:87], v18 offset:3072
    ds_read_b128 v[88:91], v18 offset:3584
    ds_read_b128 v[92:95], v18 offset:4096
    ds_read_b64_tr_b16 v[100:101], v19 offset:520
    ds_read_b64_tr_b16 v[102:103], v19 offset:512
    ds_read_b64_tr_b16 v[104:105], v19 offset:1032
    ds_read_b64_tr_b16 v[106:107], v19 offset:1024
    ds_read_b64_tr_b16 v[108:109], v19 offset:1544
    ds_read_b64_tr_b16 v[110:111], v19 offset:1536
    ds_read_b64_tr_b16 v[112:113], v19 offset:2056
    ds_read_b64_tr_b16 v[114:115], v19 offset:2048
    ds_read_b64_tr_b16 v[116:117], v19 offset:2568
    ds_read_b64_tr_b16 v[118:119], v19 offset:2560
    ds_read_b64_tr_b16 v[120:121], v19 offset:3080
    ds_read_b64_tr_b16 v[122:123], v19 offset:3072
    ds_read_b64_tr_b16 v[124:125], v19 offset:3592
    ds_read_b64_tr_b16 v[126:127], v19 offset:3584
    s_waitcnt lgkmcnt(15)
    v_mfma_f32_16x16x32_bf16 v[20:23], v[96:99], v[64:67], 0
    v_mfma_f32_16x16x32_bf16 v[24:27], v[96:99], v[68:71], 0
    v_mfma_f32_16x16x32_bf16 v[28:31], v[96:99], v[72:75], 0
    v_mfma_f32_16x16x32_bf16 v[32:35], v[96:99], v[76:79], 0
    v_mfma_f32_16x16x32_bf16 v[36:39], v[96:99], v[80:83], 0
    v_mfma_f32_16x16x32_bf16 v[40:43], v[96:99], v[84:87], 0
    v_mfma_f32_16x16x32_bf16 v[44:47], v[96:99], v[88:91], 0
    s_waitcnt lgkmcnt(14)
    v_mfma_f32_16x16x32_bf16 v[48:51], v[96:99], v[92:95], 0
    ds_read_b128 v[92:95], v18 offset:4032
    ds_read_b64_tr_b16 v[96:97], v19 offset:72
    ds_read_b64_tr_b16 v[98:99], v19 offset:64
    s_waitcnt lgkmcnt(15)
    v_mfma_f32_16x16x32_bf16 v[24:27], v[100:103], v[64:67], v[24:27]
    v_mfma_f32_16x16x32_bf16 v[28:31], v[100:103], v[68:71], v[28:31]
    v_mfma_f32_16x16x32_bf16 v[32:35], v[100:103], v[72:75], v[32:35]
    v_mfma_f32_16x16x32_bf16 v[36:39], v[100:103], v[76:79], v[36:39]
    v_mfma_f32_16x16x32_bf16 v[40:43], v[100:103], v[80:83], v[40:43]
    v_mfma_f32_16x16x32_bf16 v[44:47], v[100:103], v[84:87], v[44:47]
    v_mfma_f32_16x16x32_bf16 v[48:51], v[100:103], v[88:91], v[48:51]
    ds_read_b128 v[88:91], v18 offset:3520
    ds_read_b64_tr_b16 v[100:101], v19 offset:584
    ds_read_b64_tr_b16 v[102:103], v19 offset:576
    s_waitcnt lgkmcnt(15)
    v_mfma_f32_16x16x32_bf16 v[28:31], v[104:107], v[64:67], v[28:31]
    v_mfma_f32_16x16x32_bf16 v[32:35], v[104:107], v[68:71], v[32:35]
    v_mfma_f32_16x16x32_bf16 v[36:39], v[104:107], v[72:75], v[36:39]
    v_mfma_f32_16x16x32_bf16 v[40:43], v[104:107], v[76:79], v[40:43]
    v_mfma_f32_16x16x32_bf16 v[44:47], v[104:107], v[80:83], v[44:47]
    v_mfma_f32_16x16x32_bf16 v[48:51], v[104:107], v[84:87], v[48:51]
    ds_read_b128 v[84:87], v18 offset:3008
    ds_read_b64_tr_b16 v[104:105], v19 offset:1096
    ds_read_b64_tr_b16 v[106:107], v19 offset:1088
    s_waitcnt lgkmcnt(15)
    v_mfma_f32_16x16x32_bf16 v[32:35], v[108:111], v[64:67], v[32:35]
    v_mfma_f32_16x16x32_bf16 v[36:39], v[108:111], v[68:71], v[36:39]
    v_mfma_f32_16x16x32_bf16 v[40:43], v[108:111], v[72:75], v[40:43]
    v_mfma_f32_16x16x32_bf16 v[44:47], v[108:111], v[76:79], v[44:47]
    v_mfma_f32_16x16x32_bf16 v[48:51], v[108:111], v[80:83], v[48:51]
    ds_read_b128 v[80:83], v18 offset:2496
    ds_read_b64_tr_b16 v[108:109], v19 offset:1608
    ds_read_b64_tr_b16 v[110:111], v19 offset:1600
    v_mfma_f32_16x16x32_bf16 v[36:39], v[112:115], v[64:67], v[36:39]
    v_mfma_f32_16x16x32_bf16 v[40:43], v[112:115], v[68:71], v[40:43]
    v_mfma_f32_16x16x32_bf16 v[44:47], v[112:115], v[72:75], v[44:47]
    v_mfma_f32_16x16x32_bf16 v[48:51], v[112:115], v[76:79], v[48:51]
    ds_read_b128 v[76:79], v18 offset:1984
    ds_read_b64_tr_b16 v[112:113], v19 offset:2120
    ds_read_b64_tr_b16 v[114:115], v19 offset:2112
    s_waitcnt lgkmcnt(15)
    v_mfma_f32_16x16x32_bf16 v[40:43], v[116:119], v[64:67], v[40:43]
    v_mfma_f32_16x16x32_bf16 v[44:47], v[116:119], v[68:71], v[44:47]
    v_mfma_f32_16x16x32_bf16 v[48:51], v[116:119], v[72:75], v[48:51]
    ds_read_b128 v[72:75], v18 offset:1472
    ds_read_b64_tr_b16 v[116:117], v19 offset:2632
    ds_read_b64_tr_b16 v[118:119], v19 offset:2624
    v_mfma_f32_16x16x32_bf16 v[44:47], v[120:123], v[64:67], v[44:47]
    v_mfma_f32_16x16x32_bf16 v[48:51], v[120:123], v[68:71], v[48:51]
    ds_read_b128 v[68:71], v18 offset:960
    ds_read_b64_tr_b16 v[120:121], v19 offset:3144
    ds_read_b64_tr_b16 v[122:123], v19 offset:3136
    v_mfma_f32_16x16x32_bf16 v[48:51], v[124:127], v[64:67], v[48:51]
    ds_read_b128 v[64:67], v18 offset:448
    ds_read_b64_tr_b16 v[124:125], v19 offset:3656
    ds_read_b64_tr_b16 v[126:127], v19 offset:3648
    s_waitcnt lgkmcnt(15)
    v_mfma_f32_16x16x32_bf16 v[48:51], v[96:99], v[92:95], v[48:51]
    v_mfma_f32_16x16x32_bf16 v[44:47], v[96:99], v[88:91], v[44:47]
    v_mfma_f32_16x16x32_bf16 v[40:43], v[96:99], v[84:87], v[40:43]
    s_waitcnt lgkmcnt(14)
    v_mfma_f32_16x16x32_bf16 v[36:39], v[96:99], v[80:83], v[36:39]
    s_waitcnt lgkmcnt(11)
    v_mfma_f32_16x16x32_bf16 v[32:35], v[96:99], v[76:79], v[32:35]
    s_waitcnt lgkmcnt(8)
    v_mfma_f32_16x16x32_bf16 v[28:31], v[96:99], v[72:75], v[28:31]
    s_waitcnt lgkmcnt(5)
    v_mfma_f32_16x16x32_bf16 v[24:27], v[96:99], v[68:71], v[24:27]
    s_waitcnt lgkmcnt(2)
    v_mfma_f32_16x16x32_bf16 v[20:23], v[96:99], v[64:67], v[20:23]
    v_mfma_f32_16x16x32_bf16 v[48:51], v[100:103], v[88:91], v[48:51]
    v_mfma_f32_16x16x32_bf16 v[44:47], v[100:103], v[84:87], v[44:47]
    v_mfma_f32_16x16x32_bf16 v[40:43], v[100:103], v[80:83], v[40:43]
    v_mfma_f32_16x16x32_bf16 v[36:39], v[100:103], v[76:79], v[36:39]
    v_mfma_f32_16x16x32_bf16 v[32:35], v[100:103], v[72:75], v[32:35]
    v_mfma_f32_16x16x32_bf16 v[28:31], v[100:103], v[68:71], v[28:31]
    v_mfma_f32_16x16x32_bf16 v[24:27], v[100:103], v[64:67], v[24:27]
    v_mfma_f32_16x16x32_bf16 v[48:51], v[104:107], v[84:87], v[48:51]
    v_mfma_f32_16x16x32_bf16 v[44:47], v[104:107], v[80:83], v[44:47]
    v_mfma_f32_16x16x32_bf16 v[40:43], v[104:107], v[76:79], v[40:43]
    v_mfma_f32_16x16x32_bf16 v[36:39], v[104:107], v[72:75], v[36:39]
    v_mfma_f32_16x16x32_bf16 v[32:35], v[104:107], v[68:71], v[32:35]
    v_mfma_f32_16x16x32_bf16 v[28:31], v[104:107], v[64:67], v[28:31]
    v_mfma_f32_16x16x32_bf16 v[48:51], v[108:111], v[80:83], v[48:51]
    v_mfma_f32_16x16x32_bf16 v[44:47], v[108:111], v[76:79], v[44:47]
    v_mfma_f32_16x16x32_bf16 v[40:43], v[108:111], v[72:75], v[40:43]
    v_mfma_f32_16x16x32_bf16 v[36:39], v[108:111], v[68:71], v[36:39]
    v_mfma_f32_16x16x32_bf16 v[32:35], v[108:111], v[64:67], v[32:35]
    v_mfma_f32_16x16x32_bf16 v[48:51], v[112:115], v[76:79], v[48:51]
    v_mfma_f32_16x16x32_bf16 v[44:47], v[112:115], v[72:75], v[44:47]
    v_mfma_f32_16x16x32_bf16 v[40:43], v[112:115], v[68:71], v[40:43]
    v_mfma_f32_16x16x32_bf16 v[36:39], v[112:115], v[64:67], v[36:39]
    v_mfma_f32_16x16x32_bf16 v[48:51], v[116:119], v[72:75], v[48:51]
    v_mfma_f32_16x16x32_bf16 v[44:47], v[116:119], v[68:71], v[44:47]
    v_mfma_f32_16x16x32_bf16 v[40:43], v[116:119], v[64:67], v[40:43]
    v_mfma_f32_16x16x32_bf16 v[48:51], v[120:123], v[68:71], v[48:51]
    v_mfma_f32_16x16x32_bf16 v[44:47], v[120:123], v[64:67], v[44:47]
    s_waitcnt lgkmcnt(0)
    v_mfma_f32_16x16x32_bf16 v[48:51], v[124:127], v[64:67], v[48:51]
    ds_read_b64 v[52:53], v14
    ds_read_b64 v[54:55], v14 offset:512
    s_lshl_b32 s20, s16, 13
    v_lshlrev_b32 v15, 4, v1
    v_add_u32 v16, s20, v15
    s_lshl_b32 s20, s16, 11
    v_add_u32 v15, s20, v15
    s_waitcnt lgkmcnt(0)
    s_barrier
    ds_write_b128 v16, v[20:23] offset:0
    ds_write_b128 v16, v[24:27] offset:1024
    ds_write_b128 v16, v[28:31] offset:2048
    ds_write_b128 v16, v[32:35] offset:3072
    ds_write_b128 v16, v[36:39] offset:4096
    ds_write_b128 v16, v[40:43] offset:5120
    ds_write_b128 v16, v[44:47] offset:6144
    ds_write_b128 v16, v[48:51] offset:7168
    s_waitcnt vmcnt(0)
    v_add_f32 v60, v60, v61
    v_cvt_pk_bf16_f32 v60, v60, v60
    v_and_b32 v60, 0xffff0000, v60
    v_lshlrev_b32 v63, 16, v63
    v_lshlrev_b32 v64, 16, v52
    v_and_b32 v65, 0xffff0000, v52
    v_mul_f32 v64, v64, v63
    v_mul_f32 v65, v65, v63
    v_cvt_pk_bf16_f32 v62, v64, v65
    v_lshlrev_b32 v64, 16, v62
    v_and_b32 v65, 0xffff0000, v62
    v_lshlrev_b32 v66, 16, v53
    v_and_b32 v67, 0xffff0000, v53
    v_mul_f32 v66, v66, v63
    v_mul_f32 v67, v67, v63
    v_cvt_pk_bf16_f32 v62, v66, v67
    v_lshlrev_b32 v66, 16, v62
    v_and_b32 v67, 0xffff0000, v62
    v_lshlrev_b32 v68, 16, v54
    v_and_b32 v69, 0xffff0000, v54
    v_mul_f32 v68, v68, v63
    v_mul_f32 v69, v69, v63
    v_cvt_pk_bf16_f32 v62, v68, v69
    v_lshlrev_b32 v68, 16, v62
    v_and_b32 v69, 0xffff0000, v62
    v_lshlrev_b32 v70, 16, v55
    v_and_b32 v71, 0xffff0000, v55
    v_mul_f32 v70, v70, v63
    v_mul_f32 v71, v71, v63
    v_cvt_pk_bf16_f32 v62, v70, v71
    v_lshlrev_b32 v70, 16, v62
    v_and_b32 v71, 0xffff0000, v62
    v_mul_u32_u24 v17, 18432, v4
    v_lshl_add_u32 v17, v3, 3, v17
    s_lshl_b32 s17, s3, 5
    s_mul_i32 s18, s16, 589824
    s_add_u32 s18, s18, s17
    s_add_u32 s18, s18, 7077888
    s_add_u32 s19, s18, 294912
    s_waitcnt lgkmcnt(0)
    s_barrier
    ds_read_b128 v[72:75], v15 offset:0
    ds_read_b128 v[76:79], v15 offset:8192
    ds_read_b128 v[80:83], v15 offset:16384
    ds_read_b128 v[84:87], v15 offset:24576
    ds_read_b128 v[88:91], v15 offset:1024
    ds_read_b128 v[92:95], v15 offset:9216
    ds_read_b128 v[96:99], v15 offset:17408
    ds_read_b128 v[100:103], v15 offset:25600
    s_waitcnt lgkmcnt(4)
    v_add_f32 v72, v72, v76
    v_add_f32 v80, v80, v84
    v_add_f32 v73, v73, v77
    v_add_f32 v81, v81, v85
    v_add_f32 v74, v74, v78
    v_add_f32 v82, v82, v86
    v_add_f32 v75, v75, v79
    v_add_f32 v83, v83, v87
    v_add_f32 v72, v72, v80
    v_add_f32 v73, v73, v81
    v_add_f32 v74, v74, v82
    v_add_f32 v75, v75, v83
    v_cvt_pk_bf16_f32 v62, v72, v73
    v_lshlrev_b32 v72, 16, v62
    v_and_b32 v73, 0xffff0000, v62
    v_add_f32 v72, v72, v64
    v_add_f32 v73, v73, v65
    v_cvt_pk_bf16_f32 v62, v72, v73
    v_lshlrev_b32 v72, 16, v62
    v_and_b32 v73, 0xffff0000, v62
    v_mul_f32 v72, v72, v60
    v_mul_f32 v73, v73, v60
    v_cvt_pk_bf16_f32 v62, v72, v73
    v_lshlrev_b32 v72, 16, v62
    v_and_b32 v73, 0xffff0000, v62
    v_lshlrev_b32 v61, 16, v56
    v_and_b32 v62, 0xffff0000, v56
    v_add_f32 v72, v72, v61
    v_add_f32 v73, v73, v62
    v_cvt_pk_bf16_f32 v56, v72, v73
    v_cvt_pk_bf16_f32 v62, v74, v75
    v_lshlrev_b32 v74, 16, v62
    v_and_b32 v75, 0xffff0000, v62
    v_add_f32 v74, v74, v66
    v_add_f32 v75, v75, v67
    v_cvt_pk_bf16_f32 v62, v74, v75
    v_lshlrev_b32 v74, 16, v62
    v_and_b32 v75, 0xffff0000, v62
    v_mul_f32 v74, v74, v60
    v_mul_f32 v75, v75, v60
    v_cvt_pk_bf16_f32 v62, v74, v75
    v_lshlrev_b32 v74, 16, v62
    v_and_b32 v75, 0xffff0000, v62
    v_lshlrev_b32 v61, 16, v57
    v_and_b32 v62, 0xffff0000, v57
    v_add_f32 v74, v74, v61
    v_add_f32 v75, v75, v62
    v_cvt_pk_bf16_f32 v57, v74, v75
    buffer_store_dwordx2 v[56:57], v17, s[8:11], s18 offen
    s_waitcnt lgkmcnt(0)
    v_add_f32 v88, v88, v92
    v_add_f32 v96, v96, v100
    v_add_f32 v89, v89, v93
    v_add_f32 v97, v97, v101
    v_add_f32 v90, v90, v94
    v_add_f32 v98, v98, v102
    v_add_f32 v91, v91, v95
    v_add_f32 v99, v99, v103
    v_add_f32 v88, v88, v96
    v_add_f32 v89, v89, v97
    v_add_f32 v90, v90, v98
    v_add_f32 v91, v91, v99
    v_cvt_pk_bf16_f32 v62, v88, v89
    v_lshlrev_b32 v88, 16, v62
    v_and_b32 v89, 0xffff0000, v62
    v_add_f32 v88, v88, v68
    v_add_f32 v89, v89, v69
    v_cvt_pk_bf16_f32 v62, v88, v89
    v_lshlrev_b32 v88, 16, v62
    v_and_b32 v89, 0xffff0000, v62
    v_mul_f32 v88, v88, v60
    v_mul_f32 v89, v89, v60
    v_cvt_pk_bf16_f32 v62, v88, v89
    v_lshlrev_b32 v88, 16, v62
    v_and_b32 v89, 0xffff0000, v62
    v_lshlrev_b32 v61, 16, v58
    v_and_b32 v62, 0xffff0000, v58
    v_add_f32 v88, v88, v61
    v_add_f32 v89, v89, v62
    v_cvt_pk_bf16_f32 v58, v88, v89
    v_cvt_pk_bf16_f32 v62, v90, v91
    v_lshlrev_b32 v90, 16, v62
    v_and_b32 v91, 0xffff0000, v62
    v_add_f32 v90, v90, v70
    v_add_f32 v91, v91, v71
    v_cvt_pk_bf16_f32 v62, v90, v91
    v_lshlrev_b32 v90, 16, v62
    v_and_b32 v91, 0xffff0000, v62
    v_mul_f32 v90, v90, v60
    v_mul_f32 v91, v91, v60
    v_cvt_pk_bf16_f32 v62, v90, v91
    v_lshlrev_b32 v90, 16, v62
    v_and_b32 v91, 0xffff0000, v62
    v_lshlrev_b32 v61, 16, v59
    v_and_b32 v62, 0xffff0000, v59
    v_add_f32 v90, v90, v61
    v_add_f32 v91, v91, v62
    v_cvt_pk_bf16_f32 v59, v90, v91
    buffer_store_dwordx2 v[58:59], v17, s[8:11], s19 offen
KF_END:
    s_endpgm
KF_WARM:
    s_cmp_ge_u32 s2, 924
    s_cbranch_scc1 KF_END
    s_load_dwordx4 s[12:15], s[0:1], 80
    s_load_dwordx2 s[16:17], s[0:1], 96
    s_sub_u32 s3, s2, 816
    v_lshlrev_b32 v1, 4, v0
    s_waitcnt vmcnt(0) lgkmcnt(0)
    s_cmp_ge_u32 s3, 36
    s_cselect_b32 s12, s14, s12
    s_cselect_b32 s13, s15, s13
    s_cselect_b32 s18, 36, 0
    s_cmp_ge_u32 s3, 72
    s_cselect_b32 s12, s16, s12
    s_cselect_b32 s13, s17, s13
    s_cselect_b32 s18, 72, s18
    s_sub_u32 s3, s3, s18
    s_mul_i32 s3, s3, 147456
    s_mov_b32 s8, s12
    s_and_b32 s9, s13, 0xffff
    s_mov_b32 s10, 0x510000
    s_mov_b32 s11, 0x00020000
KF_CP:
    s_getpc_b64 s[20:21]
    s_sub_u32 s20, s20, KF_CP+4-front_kernel
    s_subb_u32 s21, s21, 0
    v_lshlrev_b32 v2, 7, v0
    v_min_u32 v3, GG_END-front_kernel-8, v2
    global_load_dword v90, v3, s[20:21]
    v_add_u32 v2, 32768, v2
    v_min_u32 v3, GG_END-front_kernel-8, v2
    global_load_dword v91, v3, s[20:21]
    v_add_u32 v2, 32768, v2
    v_min_u32 v3, GG_END-front_kernel-8, v2
    global_load_dword v92, v3, s[20:21]
    v_add_u32 v2, 32768, v2
    s_mov_b32 s24, s6
    s_and_b32 s25, s7, 0xffff
    s_mov_b32 s26, 0x10000000
    s_mov_b32 s27, 0x00020000
    s_sub_u32 s22, s2, 816
    s_min_u32 s22, s22, 95
    s_mul_i32 s22, s22, 24576
    s_add_u32 s22, s22, 9437184
    v_mov_b32 v96, -1
    v_mov_b32 v97, -1
    v_mov_b32 v98, -1
    v_mov_b32 v99, -1
    buffer_store_dwordx4 v[96:99], v1, s[24:27], s22 offen
    s_add_u32 s22, s22, 4096
    buffer_store_dwordx4 v[96:99], v1, s[24:27], s22 offen
    s_add_u32 s22, s22, 4096
    buffer_store_dwordx4 v[96:99], v1, s[24:27], s22 offen
    s_add_u32 s22, s22, 4096
    buffer_store_dwordx4 v[96:99], v1, s[24:27], s22 offen
    s_add_u32 s22, s22, 4096
    buffer_store_dwordx4 v[96:99], v1, s[24:27], s22 offen
    s_add_u32 s22, s22, 4096
    buffer_store_dwordx4 v[96:99], v1, s[24:27], s22 offen
    s_add_u32 s22, s22, 4096
    buffer_load_dwordx4 v[4:7], v1, s[8:11], s3 offen
    s_add_u32 s3, s3, 4096
    buffer_load_dwordx4 v[8:11], v1, s[8:11], s3 offen
    s_add_u32 s3, s3, 4096
    buffer_load_dwordx4 v[12:15], v1, s[8:11], s3 offen
    s_add_u32 s3, s3, 4096
    buffer_load_dwordx4 v[16:19], v1, s[8:11], s3 offen
    s_add_u32 s3, s3, 4096
    buffer_load_dwordx4 v[20:23], v1, s[8:11], s3 offen
    s_add_u32 s3, s3, 4096
    buffer_load_dwordx4 v[24:27], v1, s[8:11], s3 offen
    s_add_u32 s3, s3, 4096
    s_waitcnt vmcnt(2)
    buffer_load_dwordx4 v[28:31], v1, s[8:11], s3 offen
    s_add_u32 s3, s3, 4096
    buffer_load_dwordx4 v[32:35], v1, s[8:11], s3 offen
    s_add_u32 s3, s3, 4096
    buffer_load_dwordx4 v[36:39], v1, s[8:11], s3 offen
    s_add_u32 s3, s3, 4096
    buffer_load_dwordx4 v[40:43], v1, s[8:11], s3 offen
    s_add_u32 s3, s3, 4096
    buffer_load_dwordx4 v[44:47], v1, s[8:11], s3 offen
    s_add_u32 s3, s3, 4096
    buffer_load_dwordx4 v[48:51], v1, s[8:11], s3 offen
    s_add_u32 s3, s3, 4096
    s_waitcnt vmcnt(2)
    buffer_load_dwordx4 v[52:55], v1, s[8:11], s3 offen
    s_add_u32 s3, s3, 4096
    buffer_load_dwordx4 v[56:59], v1, s[8:11], s3 offen
    s_add_u32 s3, s3, 4096
    buffer_load_dwordx4 v[60:63], v1, s[8:11], s3 offen
    s_add_u32 s3, s3, 4096
    buffer_load_dwordx4 v[64:67], v1, s[8:11], s3 offen
    s_add_u32 s3, s3, 4096
    buffer_load_dwordx4 v[68:71], v1, s[8:11], s3 offen
    s_add_u32 s3, s3, 4096
    buffer_load_dwordx4 v[72:75], v1, s[8:11], s3 offen
    s_add_u32 s3, s3, 4096
    s_waitcnt vmcnt(2)
    buffer_load_dwordx4 v[4:7], v1, s[8:11], s3 offen
    s_add_u32 s3, s3, 4096
    buffer_load_dwordx4 v[8:11], v1, s[8:11], s3 offen
    s_add_u32 s3, s3, 4096
    buffer_load_dwordx4 v[12:15], v1, s[8:11], s3 offen
    s_add_u32 s3, s3, 4096
    buffer_load_dwordx4 v[16:19], v1, s[8:11], s3 offen
    s_add_u32 s3, s3, 4096
    buffer_load_dwordx4 v[20:23], v1, s[8:11], s3 offen
    s_add_u32 s3, s3, 4096
    buffer_load_dwordx4 v[24:27], v1, s[8:11], s3 offen
    s_add_u32 s3, s3, 4096
    s_waitcnt vmcnt(2)
    buffer_load_dwordx4 v[28:31], v1, s[8:11], s3 offen
    s_add_u32 s3, s3, 4096
    buffer_load_dwordx4 v[32:35], v1, s[8:11], s3 offen
    s_add_u32 s3, s3, 4096
    buffer_load_dwordx4 v[36:39], v1, s[8:11], s3 offen
    s_add_u32 s3, s3, 4096
    buffer_load_dwordx4 v[40:43], v1, s[8:11], s3 offen
    s_add_u32 s3, s3, 4096
    buffer_load_dwordx4 v[44:47], v1, s[8:11], s3 offen
    s_add_u32 s3, s3, 4096
    buffer_load_dwordx4 v[48:51], v1, s[8:11], s3 offen
    s_add_u32 s3, s3, 4096
    s_waitcnt vmcnt(2)
    buffer_load_dwordx4 v[52:55], v1, s[8:11], s3 offen
    s_add_u32 s3, s3, 4096
    buffer_load_dwordx4 v[56:59], v1, s[8:11], s3 offen
    s_add_u32 s3, s3, 4096
    buffer_load_dwordx4 v[60:63], v1, s[8:11], s3 offen
    s_add_u32 s3, s3, 4096
    buffer_load_dwordx4 v[64:67], v1, s[8:11], s3 offen
    s_add_u32 s3, s3, 4096
    buffer_load_dwordx4 v[68:71], v1, s[8:11], s3 offen
    s_add_u32 s3, s3, 4096
    buffer_load_dwordx4 v[72:75], v1, s[8:11], s3 offen
    s_add_u32 s3, s3, 4096
    s_waitcnt vmcnt(2)
    s_endpgm
.globl gg_kernel
.p2align 8
.type gg_kernel,@function
gg_kernel:
    s_load_dwordx2 s[6:7], s[0:1], 136
    s_load_dwordx4 s[12:15], s[0:1], 80
    s_load_dwordx2 s[4:5], s[0:1], 96
    s_load_dwordx2 s[62:63], s[0:1], 120
    s_cmp_ge_u32 s2, 256
    s_cbranch_scc1 GG_END
    v_and_b32 v224, 63, v0
    v_lshrrev_b32 v225, 6, v0
    s_nop 0
    v_readfirstlane_b32 s16, v225
    v_lshlrev_b32 v237, 4, v224
    v_lshrrev_b32 v5, 4, v224
    v_lshlrev_b32 v6, 5, v5
    s_lshr_b32 s17, s2, 1
    s_mul_i32 s17, s17, 18432
    s_and_b32 s18, s2, 1
    s_mul_i32 s19, s16, 6144
    s_add_u32 s20, s17, s19
    s_add_u32 s20, s20, 7077888
    s_add_u32 s21, s20, 4096
    s_mul_i32 s22, s16, 768
    s_mul_i32 s23, s18, 384
    s_add_u32 s22, s22, s23
    s_add_u32 s22, s22, 14221312
    s_add_u32 s19, s19, 110592
    s_mul_i32 s51, s18, 3072
    s_mul_i32 s60, s16, 6144
    s_add_u32 s60, s60, s51
    s_add_u32 s60, s60, s17
    s_add_u32 s60, s60, 9437184
    s_mov_b32 s61, s19
    s_waitcnt vmcnt(0) lgkmcnt(0)
    s_mov_b32 s8, s6
    s_and_b32 s9, s7, 0xffff
    s_mov_b32 s10, 0x10000000
    s_mov_b32 s11, 0x00020000
    s_cmp_eq_u32 s16, 3
    s_cbranch_scc1 GG_S1
    s_mov_b32 m0, s19
    s_nop 0
    buffer_load_dwordx4 v237, s[8:11], s20 offen offset:0 lds
    buffer_load_dwordx4 v237, s[8:11], s20 offen offset:1024 lds
    buffer_load_dwordx4 v237, s[8:11], s20 offen offset:2048 lds
    buffer_load_dwordx4 v237, s[8:11], s20 offen offset:3072 lds
    s_add_u32 m0, s19, 4096
    s_nop 0
    buffer_load_dwordx4 v237, s[8:11], s21 offen offset:0 lds
    buffer_load_dwordx4 v237, s[8:11], s21 offen offset:1024 lds
    buffer_load_dwordx4 v[100:103], v6, s[8:11], s22 offen offset:0
    buffer_load_dwordx4 v[124:127], v6, s[8:11], s22 offen offset:2304
    buffer_load_dwordx4 v[104:107], v6, s[8:11], s22 offen offset:16
    buffer_load_dwordx4 v[128:131], v6, s[8:11], s22 offen offset:2320
    buffer_load_dwordx4 v[108:111], v6, s[8:11], s22 offen offset:128
    buffer_load_dwordx4 v[132:135], v6, s[8:11], s22 offen offset:2432
    buffer_load_dwordx4 v[112:115], v6, s[8:11], s22 offen offset:144
    buffer_load_dwordx4 v[136:139], v6, s[8:11], s22 offen offset:2448
    buffer_load_dwordx4 v[116:119], v6, s[8:11], s22 offen offset:256
    buffer_load_dwordx4 v[140:143], v6, s[8:11], s22 offen offset:2560
    buffer_load_dwordx4 v[120:123], v6, s[8:11], s22 offen offset:272
    buffer_load_dwordx4 v[144:147], v6, s[8:11], s22 offen offset:2576
GG_S1:
    v_mov_b32 v1, v224
    s_and_b32 s17, s2, 7
    s_lshr_b32 s18, s2, 3
    s_and_b32 s19, s18, 3
    s_lshl_b32 s17, s17, 2
    s_add_u32 s17, s17, s19
    s_lshr_b32 s18, s18, 2
    v_add_u32 v235, 0, v1
    v_mul_u32_u24 v236, 3641, v235
    v_lshrrev_b32 v236, 16, v236
    v_mul_u32_u24 v226, 18, v236
    v_sub_u32 v235, v235, v226
    v_lshrrev_b32 v226, 1, v236
    v_xor_b32 v226, v226, v236
    v_and_b32 v226, 4, v226
    v_mul_u32_u24 v226, 3, v226
    v_xor_b32 v236, v236, v226
    v_mul_u32_u24 v226, 9216, v236
    v_lshl_add_u32 v226, v235, 4, v226
    v_add_u32 v235, 64, v1
    v_mul_u32_u24 v236, 3641, v235
    v_lshrrev_b32 v236, 16, v236
    v_mul_u32_u24 v227, 18, v236
    v_sub_u32 v235, v235, v227
    v_lshrrev_b32 v227, 1, v236
    v_xor_b32 v227, v227, v236
    v_and_b32 v227, 4, v227
    v_mul_u32_u24 v227, 3, v227
    v_xor_b32 v236, v236, v227
    v_mul_u32_u24 v227, 9216, v236
    v_lshl_add_u32 v227, v235, 4, v227
    v_add_u32 v235, 128, v1
    v_mul_u32_u24 v236, 3641, v235
    v_lshrrev_b32 v236, 16, v236
    v_mul_u32_u24 v228, 18, v236
    v_sub_u32 v235, v235, v228
    v_lshrrev_b32 v228, 1, v236
    v_xor_b32 v228, v228, v236
    v_and_b32 v228, 4, v228
    v_mul_u32_u24 v228, 3, v228
    v_xor_b32 v236, v236, v228
    v_mul_u32_u24 v228, 9216, v236
    v_lshl_add_u32 v228, v235, 4, v228
    v_add_u32 v235, 192, v1
    v_mul_u32_u24 v236, 3641, v235
    v_lshrrev_b32 v236, 16, v236
    v_mul_u32_u24 v229, 18, v236
    v_sub_u32 v235, v235, v229
    v_lshrrev_b32 v229, 1, v236
    v_xor_b32 v229, v229, v236
    v_and_b32 v229, 4, v229
    v_mul_u32_u24 v229, 3, v229
    v_xor_b32 v236, v236, v229
    v_mul_u32_u24 v229, 9216, v236
    v_lshl_add_u32 v229, v235, 4, v229
    v_add_u32 v235, 256, v1
    v_mul_u32_u24 v236, 3641, v235
    v_lshrrev_b32 v236, 16, v236
    v_mul_u32_u24 v230, 18, v236
    v_sub_u32 v235, v235, v230
    v_lshrrev_b32 v230, 1, v236
    v_xor_b32 v230, v230, v236
    v_and_b32 v230, 4, v230
    v_mul_u32_u24 v230, 3, v230
    v_xor_b32 v236, v236, v230
    v_mul_u32_u24 v230, 9216, v236
    v_lshl_add_u32 v230, v235, 4, v230
    v_add_u32 v235, 320, v1
    v_mul_u32_u24 v236, 3641, v235
    v_lshrrev_b32 v236, 16, v236
    v_mul_u32_u24 v231, 18, v236
    v_sub_u32 v235, v235, v231
    v_lshrrev_b32 v231, 1, v236
    v_xor_b32 v231, v231, v236
    v_and_b32 v231, 4, v231
    v_mul_u32_u24 v231, 3, v231
    v_xor_b32 v236, v236, v231
    v_mul_u32_u24 v231, 9216, v236
    v_lshl_add_u32 v231, v235, 4, v231
    v_add_u32 v235, 384, v1
    v_mul_u32_u24 v236, 3641, v235
    v_lshrrev_b32 v236, 16, v236
    v_mul_u32_u24 v232, 18, v236
    v_sub_u32 v235, v235, v232
    v_lshrrev_b32 v232, 1, v236
    v_xor_b32 v232, v232, v236
    v_and_b32 v232, 4, v232
    v_mul_u32_u24 v232, 3, v232
    v_xor_b32 v236, v236, v232
    v_mul_u32_u24 v232, 9216, v236
    v_lshl_add_u32 v232, v235, 4, v232
    v_add_u32 v235, 448, v1
    v_mul_u32_u24 v236, 3641, v235
    v_lshrrev_b32 v236, 16, v236
    v_mul_u32_u24 v233, 18, v236
    v_sub_u32 v235, v235, v233
    v_lshrrev_b32 v233, 1, v236
    v_xor_b32 v233, v233, v236
    v_and_b32 v233, 4, v233
    v_mul_u32_u24 v233, 3, v233
    v_xor_b32 v236, v236, v233
    v_mul_u32_u24 v233, 9216, v236
    v_lshl_add_u32 v233, v235, 4, v233
    v_add_u32 v235, 512, v1
    v_mul_u32_u24 v236, 3641, v235
    v_lshrrev_b32 v236, 16, v236
    v_mul_u32_u24 v234, 18, v236
    v_sub_u32 v235, v235, v234
    v_lshrrev_b32 v234, 1, v236
    v_xor_b32 v234, v234, v236
    v_and_b32 v234, 4, v234
    v_mul_u32_u24 v234, 3, v234
    v_xor_b32 v236, v236, v234
    v_mul_u32_u24 v234, 9216, v236
    v_lshl_add_u32 v234, v235, 4, v234
    s_and_b32 s22, s16, 1
    s_lshr_b32 s23, s16, 1
    s_mul_i32 s28, s22, 294912
    s_mul_i32 s30, s17, 288
    s_add_u32 s28, s28, s30
    s_mul_i32 s29, s23, 18432
    s_mul_i32 s30, s22, 9216
    s_add_u32 s29, s29, s30
    s_lshl_b32 s31, s18, 4
    s_lshl_b32 s30, s16, 2
    s_add_u32 s31, s31, s30
    s_mul_i32 s32, s31, 18432
    s_add_u32 s32, s32, 9437184
    s_add_u32 s33, s28, 0
    s_add_u32 s42, s32, 0
    s_add_u32 s34, s28, 589824
    s_add_u32 s43, s32, 2048
    s_add_u32 s35, s28, 1179648
    s_add_u32 s44, s32, 4096
    s_add_u32 s36, s28, 1769472
    s_add_u32 s45, s32, 6144
    s_add_u32 s37, s28, 2359296
    s_add_u32 s46, s32, 8192
    s_add_u32 s38, s28, 2949120
    s_add_u32 s47, s32, 10240
    s_add_u32 s39, s28, 3538944
    s_add_u32 s48, s32, 12288
    s_add_u32 s40, s28, 4128768
    s_add_u32 s49, s32, 14336
    s_add_u32 s41, s28, 4718592
    s_add_u32 s50, s32, 16384
    s_cmp_ge_u32 s16, 2
    s_cselect_b32 s20, s14, s12
    s_cselect_b32 s21, s15, s13
    s_mov_b32 s24, s20
    s_and_b32 s25, s21, 0xffff
    s_mov_b32 s26, 0x510000
    s_mov_b32 s27, 0x00020000
    s_mov_b32 s12, s4
    s_and_b32 s13, s5, 0xffff
    s_mov_b32 s14, 0x510000
    s_mov_b32 s15, 0x00020000
    s_add_u32 m0, s29, 0
    s_nop 0
    buffer_load_dwordx4 v226, s[24:27], s33 offen lds
    s_add_u32 m0, s29, 1024
    s_nop 0
    buffer_load_dwordx4 v227, s[24:27], s33 offen lds
    s_add_u32 m0, s29, 2048
    s_nop 0
    buffer_load_dwordx4 v228, s[24:27], s33 offen lds
    s_add_u32 m0, s29, 3072
    s_nop 0
    buffer_load_dwordx4 v229, s[24:27], s33 offen lds
    s_add_u32 m0, s29, 4096
    s_nop 0
    buffer_load_dwordx4 v230, s[24:27], s33 offen lds
    s_add_u32 m0, s29, 5120
    s_nop 0
    buffer_load_dwordx4 v231, s[24:27], s33 offen lds
    s_add_u32 m0, s29, 6144
    s_nop 0
    buffer_load_dwordx4 v232, s[24:27], s33 offen lds
    s_add_u32 m0, s29, 7168
    s_nop 0
    buffer_load_dwordx4 v233, s[24:27], s33 offen lds
    s_add_u32 m0, s29, 8192
    s_nop 0
    buffer_load_dwordx4 v234, s[24:27], s33 offen lds
    s_cmp_eq_u32 s16, 3
    s_cbranch_scc1 GG_W3
    v_and_b32 v4, 15, v224
    v_bfe_u32 v7, v224, 2, 2
    v_lshlrev_b32 v7, 5, v7
    v_and_b32 v8, 3, v224
    v_lshl_add_u32 v7, v8, 3, v7
    v_lshl_add_u32 v7, v5, 8, v7
    v_add_u32 v7, s61, v7
    v_subrev_u32 v8, s51, v7
    v_add_u32 v7, s51, v7
    v_lshlrev_b32 v23, 4, v4
    v_add_u32 v23, 129024, v23
    v_lshl_add_u32 v22, v225, 2, v23
    s_waitcnt vmcnt(21)
    ds_read_b64_tr_b16 v[24:25], v7 offset:0
    ds_read_b64_tr_b16 v[26:27], v7 offset:128
    ds_read_b64_tr_b16 v[28:29], v7 offset:1024
    ds_read_b64_tr_b16 v[30:31], v7 offset:1152
    ds_read_b64_tr_b16 v[32:33], v7 offset:2048
    ds_read_b64_tr_b16 v[34:35], v7 offset:2176
    ds_read_b64_tr_b16 v[36:37], v8 offset:3072
    ds_read_b64_tr_b16 v[38:39], v8 offset:3200
    ds_read_b64_tr_b16 v[40:41], v8 offset:4096
    ds_read_b64_tr_b16 v[42:43], v8 offset:4224
    ds_read_b64_tr_b16 v[44:45], v8 offset:5120
    ds_read_b64_tr_b16 v[46:47], v8 offset:5248
    s_waitcnt lgkmcnt(10)
    v_lshlrev_b32 v48, 16, v24
    v_and_b32 v49, 0xffff0000, v24
    v_lshlrev_b32 v50, 16, v25
    v_and_b32 v51, 0xffff0000, v25
    v_lshlrev_b32 v52, 16, v26
    v_and_b32 v53, 0xffff0000, v26
    v_lshlrev_b32 v54, 16, v27
    v_and_b32 v55, 0xffff0000, v27
    s_waitcnt lgkmcnt(8)
    v_lshlrev_b32 v56, 16, v28
    v_and_b32 v57, 0xffff0000, v28
    v_lshlrev_b32 v58, 16, v29
    v_and_b32 v59, 0xffff0000, v29
    v_lshlrev_b32 v60, 16, v30
    v_and_b32 v61, 0xffff0000, v30
    v_lshlrev_b32 v62, 16, v31
    v_and_b32 v63, 0xffff0000, v31
    s_waitcnt lgkmcnt(6)
    v_lshlrev_b32 v64, 16, v32
    v_and_b32 v65, 0xffff0000, v32
    v_lshlrev_b32 v66, 16, v33
    v_and_b32 v67, 0xffff0000, v33
    v_lshlrev_b32 v68, 16, v34
    v_and_b32 v69, 0xffff0000, v34
    v_lshlrev_b32 v70, 16, v35
    v_and_b32 v71, 0xffff0000, v35
    s_waitcnt lgkmcnt(4)
    v_lshlrev_b32 v72, 16, v36
    v_and_b32 v73, 0xffff0000, v36
    v_lshlrev_b32 v74, 16, v37
    v_and_b32 v75, 0xffff0000, v37
    v_lshlrev_b32 v76, 16, v38
    v_and_b32 v77, 0xffff0000, v38
    v_lshlrev_b32 v78, 16, v39
    v_and_b32 v79, 0xffff0000, v39
    s_waitcnt lgkmcnt(2)
    v_lshlrev_b32 v80, 16, v40
    v_and_b32 v81, 0xffff0000, v40
    v_lshlrev_b32 v82, 16, v41
    v_and_b32 v83, 0xffff0000, v41
    v_lshlrev_b32 v84, 16, v42
    v_and_b32 v85, 0xffff0000, v42
    v_lshlrev_b32 v86, 16, v43
    v_and_b32 v87, 0xffff0000, v43
    s_waitcnt lgkmcnt(0)
    v_lshlrev_b32 v88, 16, v44
    v_and_b32 v89, 0xffff0000, v44
    v_lshlrev_b32 v90, 16, v45
    v_and_b32 v91, 0xffff0000, v45
    v_lshlrev_b32 v92, 16, v46
    v_and_b32 v93, 0xffff0000, v46
    v_lshlrev_b32 v94, 16, v47
    v_and_b32 v95, 0xffff0000, v47
    v_pk_add_f32 v[14:15], v[48:49], v[50:51]
    v_pk_add_f32 v[16:17], v[52:53], v[54:55]
    v_pk_add_f32 v[14:15], v[14:15], v[56:57]
    v_pk_add_f32 v[16:17], v[16:17], v[58:59]
    v_pk_add_f32 v[14:15], v[14:15], v[60:61]
    v_pk_add_f32 v[16:17], v[16:17], v[62:63]
    v_pk_add_f32 v[14:15], v[14:15], v[64:65]
    v_pk_add_f32 v[16:17], v[16:17], v[66:67]
    v_pk_add_f32 v[14:15], v[14:15], v[68:69]
    v_pk_add_f32 v[16:17], v[16:17], v[70:71]
    v_pk_add_f32 v[14:15], v[14:15], v[72:73]
    v_pk_add_f32 v[16:17], v[16:17], v[74:75]
    v_pk_add_f32 v[14:15], v[14:15], v[76:77]
    v_pk_add_f32 v[16:17], v[16:17], v[78:79]
    v_pk_add_f32 v[14:15], v[14:15], v[80:81]
    v_pk_add_f32 v[16:17], v[16:17], v[82:83]
    v_pk_add_f32 v[14:15], v[14:15], v[84:85]
    v_pk_add_f32 v[16:17], v[16:17], v[86:87]
    v_pk_add_f32 v[14:15], v[14:15], v[88:89]
    v_pk_add_f32 v[16:17], v[16:17], v[90:91]
    v_pk_add_f32 v[14:15], v[14:15], v[92:93]
    v_pk_add_f32 v[16:17], v[16:17], v[94:95]
    v_pk_add_f32 v[14:15], v[14:15], v[16:17]
    v_add_f32 v14, v14, v15
    v_mov_b32 v10, v14
    s_nop 1
    v_permlane32_swap_b32 v10, v14
    v_add_f32 v14, v14, v10
    v_mov_b32 v10, v14
    s_nop 1
    v_permlane16_swap_b32 v10, v14
    v_add_f32 v14, v14, v10
    v_mul_f32 v14, 0xbbaaaaab, v14
    v_mov_b32 v15, v14
    v_pk_add_f32 v[10:11], v[48:49], v[14:15]
    v_pk_mul_f32 v[16:17], v[10:11], v[10:11]
    v_pk_add_f32 v[12:13], v[50:51], v[14:15]
    v_pk_mul_f32 v[18:19], v[12:13], v[12:13]
    v_pk_add_f32 v[10:11], v[52:53], v[14:15]
    v_pk_fma_f32 v[16:17], v[10:11], v[10:11], v[16:17]
    v_pk_add_f32 v[12:13], v[54:55], v[14:15]
    v_pk_fma_f32 v[18:19], v[12:13], v[12:13], v[18:19]
    v_pk_add_f32 v[10:11], v[56:57], v[14:15]
    v_pk_fma_f32 v[16:17], v[10:11], v[10:11], v[16:17]
    v_pk_add_f32 v[12:13], v[58:59], v[14:15]
    v_pk_fma_f32 v[18:19], v[12:13], v[12:13], v[18:19]
    v_pk_add_f32 v[10:11], v[60:61], v[14:15]
    v_pk_fma_f32 v[16:17], v[10:11], v[10:11], v[16:17]
    v_pk_add_f32 v[12:13], v[62:63], v[14:15]
    v_pk_fma_f32 v[18:19], v[12:13], v[12:13], v[18:19]
    v_pk_add_f32 v[10:11], v[64:65], v[14:15]
    v_pk_fma_f32 v[16:17], v[10:11], v[10:11], v[16:17]
    v_pk_add_f32 v[12:13], v[66:67], v[14:15]
    v_pk_fma_f32 v[18:19], v[12:13], v[12:13], v[18:19]
    v_pk_add_f32 v[10:11], v[68:69], v[14:15]
    v_pk_fma_f32 v[16:17], v[10:11], v[10:11], v[16:17]
    v_pk_add_f32 v[12:13], v[70:71], v[14:15]
    v_pk_fma_f32 v[18:19], v[12:13], v[12:13], v[18:19]
    v_pk_add_f32 v[10:11], v[72:73], v[14:15]
    v_pk_fma_f32 v[16:17], v[10:11], v[10:11], v[16:17]
    v_pk_add_f32 v[12:13], v[74:75], v[14:15]
    v_pk_fma_f32 v[18:19], v[12:13], v[12:13], v[18:19]
    v_pk_add_f32 v[10:11], v[76:77], v[14:15]
    v_pk_fma_f32 v[16:17], v[10:11], v[10:11], v[16:17]
    v_pk_add_f32 v[12:13], v[78:79], v[14:15]
    v_pk_fma_f32 v[18:19], v[12:13], v[12:13], v[18:19]
    v_pk_add_f32 v[10:11], v[80:81], v[14:15]
    v_pk_fma_f32 v[16:17], v[10:11], v[10:11], v[16:17]
    v_pk_add_f32 v[12:13], v[82:83], v[14:15]
    v_pk_fma_f32 v[18:19], v[12:13], v[12:13], v[18:19]
    v_pk_add_f32 v[10:11], v[84:85], v[14:15]
    v_pk_fma_f32 v[16:17], v[10:11], v[10:11], v[16:17]
    v_pk_add_f32 v[12:13], v[86:87], v[14:15]
    v_pk_fma_f32 v[18:19], v[12:13], v[12:13], v[18:19]
    v_pk_add_f32 v[10:11], v[88:89], v[14:15]
    v_pk_fma_f32 v[16:17], v[10:11], v[10:11], v[16:17]
    v_pk_add_f32 v[12:13], v[90:91], v[14:15]
    v_pk_fma_f32 v[18:19], v[12:13], v[12:13], v[18:19]
    v_pk_add_f32 v[10:11], v[92:93], v[14:15]
    v_pk_fma_f32 v[16:17], v[10:11], v[10:11], v[16:17]
    v_pk_add_f32 v[12:13], v[94:95], v[14:15]
    v_pk_fma_f32 v[18:19], v[12:13], v[12:13], v[18:19]
    v_pk_add_f32 v[16:17], v[16:17], v[18:19]
    v_add_f32 v15, v16, v17
    v_mov_b32 v10, v15
    s_nop 1
    v_permlane32_swap_b32 v10, v15
    v_add_f32 v15, v15, v10
    v_mov_b32 v10, v15
    s_nop 1
    v_permlane16_swap_b32 v10, v15
    v_add_f32 v15, v15, v10
    ds_write_b32 v22, v14
    ds_write_b32 v22, v15 offset:256
    s_waitcnt lgkmcnt(0)
    s_barrier
    ds_read_b96 v[10:12], v23
    ds_read_b96 v[16:18], v23 offset:256
    s_waitcnt lgkmcnt(0)
    v_add_f32 v14, v10, v11
    v_add_f32 v15, v16, v17
    v_add_f32 v14, v14, v12
    v_add_f32 v15, v15, v18
    v_mul_f32 v14, 0xbeaaaaab, v14
    v_add_f32 v10, v10, v14
    v_add_f32 v11, v11, v14
    v_add_f32 v12, v12, v14
    v_mul_f32 v10, v10, v10
    v_fmac_f32 v10, v11, v11
    v_fmac_f32 v10, v12, v12
    v_mul_f32 v15, 0x3ae38e39, v15
    v_fmac_f32 v15, 0x3eaaaaab, v10
    v_cvt_pk_bf16_f32 v15, v15, v15
    v_and_b32 v15, 0xffff0000, v15
    v_add_f32 v15, 0x3727c5ac, v15
    v_cvt_pk_bf16_f32 v15, v15, v15
    v_and_b32 v15, 0xffff0000, v15
    v_sqrt_f32 v15, v15
    s_nop 0
    v_cvt_pk_bf16_f32 v15, v15, v15
    v_and_b32 v15, 0xffff0000, v15
    v_rcp_f32 v16, v15
    v_cvt_pk_bf16_f32 v14, v14, v14
    v_and_b32 v14, 0xffff0000, v14
    s_waitcnt vmcnt(9)
    v_sub_f32 v48, v48, v14
    v_sub_f32 v49, v49, v14
    v_cvt_pk_bf16_f32 v17, v48, v49
    v_lshlrev_b32 v48, 16, v17
    v_and_b32 v49, 0xffff0000, v17
    v_mul_f32 v18, v48, v16
    v_mul_f32 v19, v49, v16
    v_cvt_pk_bf16_f32 v17, v18, v19
    v_lshlrev_b32 v18, 16, v17
    v_and_b32 v19, 0xffff0000, v17
    v_mul_f32 v18, v18, v124
    v_mul_f32 v19, v19, v125
    v_cvt_pk_bf16_f32 v17, v18, v19
    v_lshlrev_b32 v18, 16, v17
    v_and_b32 v19, 0xffff0000, v17
    v_add_f32 v18, v18, v100
    v_add_f32 v19, v19, v101
    v_cvt_pk_bf16_f32 v36, v18, v19
    v_sub_f32 v50, v50, v14
    v_sub_f32 v51, v51, v14
    v_cvt_pk_bf16_f32 v17, v50, v51
    v_lshlrev_b32 v50, 16, v17
    v_and_b32 v51, 0xffff0000, v17
    v_mul_f32 v18, v50, v16
    v_mul_f32 v19, v51, v16
    v_cvt_pk_bf16_f32 v17, v18, v19
    v_lshlrev_b32 v18, 16, v17
    v_and_b32 v19, 0xffff0000, v17
    v_mul_f32 v18, v18, v126
    v_mul_f32 v19, v19, v127
    v_cvt_pk_bf16_f32 v17, v18, v19
    v_lshlrev_b32 v18, 16, v17
    v_and_b32 v19, 0xffff0000, v17
    v_add_f32 v18, v18, v102
    v_add_f32 v19, v19, v103
    v_cvt_pk_bf16_f32 v37, v18, v19
    v_sub_f32 v52, v52, v14
    v_sub_f32 v53, v53, v14
    v_cvt_pk_bf16_f32 v17, v52, v53
    v_lshlrev_b32 v52, 16, v17
    v_and_b32 v53, 0xffff0000, v17
    v_mul_f32 v18, v52, v16
    v_mul_f32 v19, v53, v16
    v_cvt_pk_bf16_f32 v17, v18, v19
    v_lshlrev_b32 v18, 16, v17
    v_and_b32 v19, 0xffff0000, v17
    v_mul_f32 v18, v18, v128
    v_mul_f32 v19, v19, v129
    v_cvt_pk_bf16_f32 v17, v18, v19
    v_lshlrev_b32 v18, 16, v17
    v_and_b32 v19, 0xffff0000, v17
    v_add_f32 v18, v18, v104
    v_add_f32 v19, v19, v105
    v_cvt_pk_bf16_f32 v38, v18, v19
    v_sub_f32 v54, v54, v14
    v_sub_f32 v55, v55, v14
    v_cvt_pk_bf16_f32 v17, v54, v55
    v_lshlrev_b32 v54, 16, v17
    v_and_b32 v55, 0xffff0000, v17
    v_mul_f32 v18, v54, v16
    v_mul_f32 v19, v55, v16
    v_cvt_pk_bf16_f32 v17, v18, v19
    v_lshlrev_b32 v18, 16, v17
    v_and_b32 v19, 0xffff0000, v17
    v_mul_f32 v18, v18, v130
    v_mul_f32 v19, v19, v131
    v_cvt_pk_bf16_f32 v17, v18, v19
    v_lshlrev_b32 v18, 16, v17
    v_and_b32 v19, 0xffff0000, v17
    v_add_f32 v18, v18, v106
    v_add_f32 v19, v19, v107
    v_cvt_pk_bf16_f32 v39, v18, v19
    buffer_store_dwordx4 v[36:39], v237, s[8:11], s60 offen offset:0 sc1
    v_sub_f32 v56, v56, v14
    v_sub_f32 v57, v57, v14
    v_cvt_pk_bf16_f32 v17, v56, v57
    v_lshlrev_b32 v56, 16, v17
    v_and_b32 v57, 0xffff0000, v17
    v_mul_f32 v18, v56, v16
    v_mul_f32 v19, v57, v16
    v_cvt_pk_bf16_f32 v17, v18, v19
    v_lshlrev_b32 v18, 16, v17
    v_and_b32 v19, 0xffff0000, v17
    v_mul_f32 v18, v18, v132
    v_mul_f32 v19, v19, v133
    v_cvt_pk_bf16_f32 v17, v18, v19
    v_lshlrev_b32 v18, 16, v17
    v_and_b32 v19, 0xffff0000, v17
    v_add_f32 v18, v18, v108
    v_add_f32 v19, v19, v109
    v_cvt_pk_bf16_f32 v40, v18, v19
    v_sub_f32 v58, v58, v14
    v_sub_f32 v59, v59, v14
    v_cvt_pk_bf16_f32 v17, v58, v59
    v_lshlrev_b32 v58, 16, v17
    v_and_b32 v59, 0xffff0000, v17
    v_mul_f32 v18, v58, v16
    v_mul_f32 v19, v59, v16
    v_cvt_pk_bf16_f32 v17, v18, v19
    v_lshlrev_b32 v18, 16, v17
    v_and_b32 v19, 0xffff0000, v17
    v_mul_f32 v18, v18, v134
    v_mul_f32 v19, v19, v135
    v_cvt_pk_bf16_f32 v17, v18, v19
    v_lshlrev_b32 v18, 16, v17
    v_and_b32 v19, 0xffff0000, v17
    v_add_f32 v18, v18, v110
    v_add_f32 v19, v19, v111
    v_cvt_pk_bf16_f32 v41, v18, v19
    v_sub_f32 v60, v60, v14
    v_sub_f32 v61, v61, v14
    v_cvt_pk_bf16_f32 v17, v60, v61
    v_lshlrev_b32 v60, 16, v17
    v_and_b32 v61, 0xffff0000, v17
    v_mul_f32 v18, v60, v16
    v_mul_f32 v19, v61, v16
    v_cvt_pk_bf16_f32 v17, v18, v19
    v_lshlrev_b32 v18, 16, v17
    v_and_b32 v19, 0xffff0000, v17
    v_mul_f32 v18, v18, v136
    v_mul_f32 v19, v19, v137
    v_cvt_pk_bf16_f32 v17, v18, v19
    v_lshlrev_b32 v18, 16, v17
    v_and_b32 v19, 0xffff0000, v17
    v_add_f32 v18, v18, v112
    v_add_f32 v19, v19, v113
    v_cvt_pk_bf16_f32 v42, v18, v19
    v_sub_f32 v62, v62, v14
    v_sub_f32 v63, v63, v14
    v_cvt_pk_bf16_f32 v17, v62, v63
    v_lshlrev_b32 v62, 16, v17
    v_and_b32 v63, 0xffff0000, v17
    v_mul_f32 v18, v62, v16
    v_mul_f32 v19, v63, v16
    v_cvt_pk_bf16_f32 v17, v18, v19
    v_lshlrev_b32 v18, 16, v17
    v_and_b32 v19, 0xffff0000, v17
    v_mul_f32 v18, v18, v138
    v_mul_f32 v19, v19, v139
    v_cvt_pk_bf16_f32 v17, v18, v19
    v_lshlrev_b32 v18, 16, v17
    v_and_b32 v19, 0xffff0000, v17
    v_add_f32 v18, v18, v114
    v_add_f32 v19, v19, v115
    v_cvt_pk_bf16_f32 v43, v18, v19
    buffer_store_dwordx4 v[40:43], v237, s[8:11], s60 offen offset:1024 sc1
    v_sub_f32 v64, v64, v14
    v_sub_f32 v65, v65, v14
    v_cvt_pk_bf16_f32 v17, v64, v65
    v_lshlrev_b32 v64, 16, v17
    v_and_b32 v65, 0xffff0000, v17
    v_mul_f32 v18, v64, v16
    v_mul_f32 v19, v65, v16
    v_cvt_pk_bf16_f32 v17, v18, v19
    v_lshlrev_b32 v18, 16, v17
    v_and_b32 v19, 0xffff0000, v17
    v_mul_f32 v18, v18, v140
    v_mul_f32 v19, v19, v141
    v_cvt_pk_bf16_f32 v17, v18, v19
    v_lshlrev_b32 v18, 16, v17
    v_and_b32 v19, 0xffff0000, v17
    v_add_f32 v18, v18, v116
    v_add_f32 v19, v19, v117
    v_cvt_pk_bf16_f32 v44, v18, v19
    v_sub_f32 v66, v66, v14
    v_sub_f32 v67, v67, v14
    v_cvt_pk_bf16_f32 v17, v66, v67
    v_lshlrev_b32 v66, 16, v17
    v_and_b32 v67, 0xffff0000, v17
    v_mul_f32 v18, v66, v16
    v_mul_f32 v19, v67, v16
    v_cvt_pk_bf16_f32 v17, v18, v19
    v_lshlrev_b32 v18, 16, v17
    v_and_b32 v19, 0xffff0000, v17
    v_mul_f32 v18, v18, v142
    v_mul_f32 v19, v19, v143
    v_cvt_pk_bf16_f32 v17, v18, v19
    v_lshlrev_b32 v18, 16, v17
    v_and_b32 v19, 0xffff0000, v17
    v_add_f32 v18, v18, v118
    v_add_f32 v19, v19, v119
    v_cvt_pk_bf16_f32 v45, v18, v19
    v_sub_f32 v68, v68, v14
    v_sub_f32 v69, v69, v14
    v_cvt_pk_bf16_f32 v17, v68, v69
    v_lshlrev_b32 v68, 16, v17
    v_and_b32 v69, 0xffff0000, v17
    v_mul_f32 v18, v68, v16
    v_mul_f32 v19, v69, v16
    v_cvt_pk_bf16_f32 v17, v18, v19
    v_lshlrev_b32 v18, 16, v17
    v_and_b32 v19, 0xffff0000, v17
    v_mul_f32 v18, v18, v144
    v_mul_f32 v19, v19, v145
    v_cvt_pk_bf16_f32 v17, v18, v19
    v_lshlrev_b32 v18, 16, v17
    v_and_b32 v19, 0xffff0000, v17
    v_add_f32 v18, v18, v120
    v_add_f32 v19, v19, v121
    v_cvt_pk_bf16_f32 v46, v18, v19
    v_sub_f32 v70, v70, v14
    v_sub_f32 v71, v71, v14
    v_cvt_pk_bf16_f32 v17, v70, v71
    v_lshlrev_b32 v70, 16, v17
    v_and_b32 v71, 0xffff0000, v17
    v_mul_f32 v18, v70, v16
    v_mul_f32 v19, v71, v16
    v_cvt_pk_bf16_f32 v17, v18, v19
    v_lshlrev_b32 v18, 16, v17
    v_and_b32 v19, 0xffff0000, v17
    v_mul_f32 v18, v18, v146
    v_mul_f32 v19, v19, v147
    v_cvt_pk_bf16_f32 v17, v18, v19
    v_lshlrev_b32 v18, 16, v17
    v_and_b32 v19, 0xffff0000, v17
    v_add_f32 v18, v18, v122
    v_add_f32 v19, v19, v123
    v_cvt_pk_bf16_f32 v47, v18, v19
    buffer_store_dwordx4 v[44:47], v237, s[8:11], s60 offen offset:2048 sc1
GG_CP0:
    s_getpc_b64 s[0:1]
    v_lshlrev_b32 v2, 7, v224
    s_lshl_b32 s20, s16, 13
    v_add_u32 v2, s20, v2
    v_min_u32 v3, GG_END-GG_CP0-8, v2
    global_load_dword v4, v3, s[0:1]
    v_add_u32 v2, 24576, v2
    v_min_u32 v3, GG_END-GG_CP0-8, v2
    global_load_dword v4, v3, s[0:1]
    v_add_u32 v238, 18432, v237
    v_add_u32 v239, 36864, v237
    v_add_u32 v240, 55296, v237
    v_lshrrev_b32 v2, 5, v224
    v_lshlrev_b32 v2, 4, v2
    v_bfe_u32 v3, v224, 4, 1
    v_lshl_add_u32 v2, v3, 2, v2
    v_bfe_u32 v3, v224, 2, 2
    v_add_u32 v2, v2, v3
    v_mul_u32_u24 v241, 288, v2
    v_and_b32 v2, 3, v224
    v_lshl_add_u32 v241, v2, 3, v241
    v_add_u32 v242, 36864, v241
    v_add_u32 v243, 73728, v241
    v_add_u32 v244, 110592, v241
    s_mul_i32 s20, s31, 147456
    s_mul_i32 s21, s17, 9
    s_lshr_b32 s21, s21, 1
    s_lshl_b32 s21, s21, 10
    s_add_u32 s20, s20, s21
    s_add_u32 s52, s20, 14680064
    s_add_u32 s53, s52, 147456
    s_add_u32 s54, s52, 294912
    s_add_u32 s55, s52, 442368
    s_add_u32 s56, s52, 4096
    s_add_u32 s57, s53, 4096
    s_add_u32 s58, s54, 4096
    s_add_u32 s59, s55, 4096
    v_add_u32 v19, 0, v1
    v_mul_u32_u24 v20, 3641, v19
    v_lshrrev_b32 v20, 16, v20
    v_mul_u32_u24 v10, 18, v20
    v_sub_u32 v19, v19, v10
    v_mul_u32_u24 v10, 1152, v20
    v_lshl_add_u32 v10, v19, 4, v10
    v_add_u32 v19, 64, v1
    v_mul_u32_u24 v20, 3641, v19
    v_lshrrev_b32 v20, 16, v20
    v_mul_u32_u24 v11, 18, v20
    v_sub_u32 v19, v19, v11
    v_mul_u32_u24 v11, 1152, v20
    v_lshl_add_u32 v11, v19, 4, v11
    v_add_u32 v19, 128, v1
    v_mul_u32_u24 v20, 3641, v19
    v_lshrrev_b32 v20, 16, v20
    v_mul_u32_u24 v12, 18, v20
    v_sub_u32 v19, v19, v12
    v_mul_u32_u24 v12, 1152, v20
    v_lshl_add_u32 v12, v19, 4, v12
    v_add_u32 v19, 192, v1
    v_mul_u32_u24 v20, 3641, v19
    v_lshrrev_b32 v20, 16, v20
    v_mul_u32_u24 v13, 18, v20
    v_sub_u32 v19, v19, v13
    v_mul_u32_u24 v13, 1152, v20
    v_lshl_add_u32 v13, v19, 4, v13
    v_add_u32 v19, 256, v1
    v_mul_u32_u24 v20, 3641, v19
    v_lshrrev_b32 v20, 16, v20
    v_mul_u32_u24 v14, 18, v20
    v_sub_u32 v19, v19, v14
    v_mul_u32_u24 v14, 1152, v20
    v_lshl_add_u32 v14, v19, 4, v14
    v_add_u32 v19, 320, v1
    v_mul_u32_u24 v20, 3641, v19
    v_lshrrev_b32 v20, 16, v20
    v_mul_u32_u24 v15, 18, v20
    v_sub_u32 v19, v19, v15
    v_mul_u32_u24 v15, 1152, v20
    v_lshl_add_u32 v15, v19, 4, v15
    v_add_u32 v19, 384, v1
    v_mul_u32_u24 v20, 3641, v19
    v_lshrrev_b32 v20, 16, v20
    v_mul_u32_u24 v16, 18, v20
    v_sub_u32 v19, v19, v16
    v_mul_u32_u24 v16, 1152, v20
    v_lshl_add_u32 v16, v19, 4, v16
    v_add_u32 v19, 448, v1
    v_mul_u32_u24 v20, 3641, v19
    v_lshrrev_b32 v20, 16, v20
    v_mul_u32_u24 v17, 18, v20
    v_sub_u32 v19, v19, v17
    v_mul_u32_u24 v17, 1152, v20
    v_lshl_add_u32 v17, v19, 4, v17
    v_add_u32 v19, 512, v1
    v_mul_u32_u24 v20, 3641, v19
    v_lshrrev_b32 v20, 16, v20
    v_mul_u32_u24 v18, 18, v20
    v_sub_u32 v19, v19, v18
    v_mul_u32_u24 v18, 1152, v20
    v_lshl_add_u32 v18, v19, 4, v18
    v_accvgpr_write_b32 a200, v10
    v_accvgpr_write_b32 a201, v11
    v_accvgpr_write_b32 a202, v12
    v_accvgpr_write_b32 a203, v13
    v_accvgpr_write_b32 a204, v14
    v_accvgpr_write_b32 a205, v15
    v_accvgpr_write_b32 a206, v16
    v_accvgpr_write_b32 a207, v17
    v_accvgpr_write_b32 a208, v18
    s_and_b32 s20, s2, 7
    s_lshr_b32 s21, s2, 3
    s_and_b32 s5, s21, 3
    s_lshr_b32 s4, s21, 2
    s_and_b32 s22, s20, 1
    s_lshl_b32 s22, s22, 3
    s_add_u32 s4, s4, s22
    s_lshr_b32 s3, s20, 1
    s_mul_i32 s60, s3, 1327104
    s_mul_i32 s20, s16, 36864
    s_add_u32 s60, s60, s20
    s_mul_i32 s20, s5, 288
    s_add_u32 s60, s60, s20
    s_add_u32 s61, s60, 147456
    s_mul_i32 s51, s16, 9216
    s_lshl_b32 s30, s18, 5
    s_add_u32 s30, s30, s17
    s_mul_i32 s30, s30, 36864
    s_add_u32 s30, s30, s51
    s_add_u32 s30, s30, 33554432
    s_add_u32 s32, s30, 4096
    s_add_u32 s28, s30, 8192
    v_mov_b32 v246, -1
    v_mov_b32 v247, -1
    v_mov_b32 v248, -1
    v_mov_b32 v249, -1
    s_add_u32 m0, s29, 36864
    s_nop 0
    buffer_load_dwordx4 v226, s[24:27], s34 offen lds
    s_add_u32 m0, s29, 37888
    s_nop 0
    buffer_load_dwordx4 v227, s[24:27], s34 offen lds
    s_add_u32 m0, s29, 38912
    s_nop 0
    buffer_load_dwordx4 v228, s[24:27], s34 offen lds
    s_add_u32 m0, s29, 39936
    s_nop 0
    buffer_load_dwordx4 v229, s[24:27], s34 offen lds
    s_add_u32 m0, s29, 40960
    s_nop 0
    buffer_load_dwordx4 v230, s[24:27], s34 offen lds
    s_add_u32 m0, s29, 41984
    s_nop 0
    buffer_load_dwordx4 v231, s[24:27], s34 offen lds
    s_add_u32 m0, s29, 43008
    s_nop 0
    buffer_load_dwordx4 v232, s[24:27], s34 offen lds
    s_add_u32 m0, s29, 44032
    s_nop 0
    buffer_load_dwordx4 v233, s[24:27], s34 offen lds
    s_add_u32 m0, s29, 45056
    s_nop 0
    buffer_load_dwordx4 v234, s[24:27], s34 offen lds
    s_branch GG_R4
GG_W3:
    v_add_u32 v238, 18432, v237
    v_add_u32 v239, 36864, v237
    v_add_u32 v240, 55296, v237
    v_lshrrev_b32 v2, 5, v224
    v_lshlrev_b32 v2, 4, v2
    v_bfe_u32 v3, v224, 4, 1
    v_lshl_add_u32 v2, v3, 2, v2
    v_bfe_u32 v3, v224, 2, 2
    v_add_u32 v2, v2, v3
    v_mul_u32_u24 v241, 288, v2
    v_and_b32 v2, 3, v224
    v_lshl_add_u32 v241, v2, 3, v241
    v_add_u32 v242, 36864, v241
    v_add_u32 v243, 73728, v241
    v_add_u32 v244, 110592, v241
    s_mul_i32 s20, s31, 147456
    s_mul_i32 s21, s17, 9
    s_lshr_b32 s21, s21, 1
    s_lshl_b32 s21, s21, 10
    s_add_u32 s20, s20, s21
    s_add_u32 s52, s20, 14680064
    s_add_u32 s53, s52, 147456
    s_add_u32 s54, s52, 294912
    s_add_u32 s55, s52, 442368
    s_add_u32 s56, s52, 4096
    s_add_u32 s57, s53, 4096
    s_add_u32 s58, s54, 4096
    s_add_u32 s59, s55, 4096
    v_add_u32 v19, 0, v1
    v_mul_u32_u24 v20, 3641, v19
    v_lshrrev_b32 v20, 16, v20
    v_mul_u32_u24 v10, 18, v20
    v_sub_u32 v19, v19, v10
    v_mul_u32_u24 v10, 1152, v20
    v_lshl_add_u32 v10, v19, 4, v10
    v_add_u32 v19, 64, v1
    v_mul_u32_u24 v20, 3641, v19
    v_lshrrev_b32 v20, 16, v20
    v_mul_u32_u24 v11, 18, v20
    v_sub_u32 v19, v19, v11
    v_mul_u32_u24 v11, 1152, v20
    v_lshl_add_u32 v11, v19, 4, v11
    v_add_u32 v19, 128, v1
    v_mul_u32_u24 v20, 3641, v19
    v_lshrrev_b32 v20, 16, v20
    v_mul_u32_u24 v12, 18, v20
    v_sub_u32 v19, v19, v12
    v_mul_u32_u24 v12, 1152, v20
    v_lshl_add_u32 v12, v19, 4, v12
    v_add_u32 v19, 192, v1
    v_mul_u32_u24 v20, 3641, v19
    v_lshrrev_b32 v20, 16, v20
    v_mul_u32_u24 v13, 18, v20
    v_sub_u32 v19, v19, v13
    v_mul_u32_u24 v13, 1152, v20
    v_lshl_add_u32 v13, v19, 4, v13
    v_add_u32 v19, 256, v1
    v_mul_u32_u24 v20, 3641, v19
    v_lshrrev_b32 v20, 16, v20
    v_mul_u32_u24 v14, 18, v20
    v_sub_u32 v19, v19, v14
    v_mul_u32_u24 v14, 1152, v20
    v_lshl_add_u32 v14, v19, 4, v14
    v_add_u32 v19, 320, v1
    v_mul_u32_u24 v20, 3641, v19
    v_lshrrev_b32 v20, 16, v20
    v_mul_u32_u24 v15, 18, v20
    v_sub_u32 v19, v19, v15
    v_mul_u32_u24 v15, 1152, v20
    v_lshl_add_u32 v15, v19, 4, v15
    v_add_u32 v19, 384, v1
    v_mul_u32_u24 v20, 3641, v19
    v_lshrrev_b32 v20, 16, v20
    v_mul_u32_u24 v16, 18, v20
    v_sub_u32 v19, v19, v16
    v_mul_u32_u24 v16, 1152, v20
    v_lshl_add_u32 v16, v19, 4, v16
    v_add_u32 v19, 448, v1
    v_mul_u32_u24 v20, 3641, v19
    v_lshrrev_b32 v20, 16, v20
    v_mul_u32_u24 v17, 18, v20
    v_sub_u32 v19, v19, v17
    v_mul_u32_u24 v17, 1152, v20
    v_lshl_add_u32 v17, v19, 4, v17
    v_add_u32 v19, 512, v1
    v_mul_u32_u24 v20, 3641, v19
    v_lshrrev_b32 v20, 16, v20
    v_mul_u32_u24 v18, 18, v20
    v_sub_u32 v19, v19, v18
    v_mul_u32_u24 v18, 1152, v20
    v_lshl_add_u32 v18, v19, 4, v18
    v_accvgpr_write_b32 a200, v10
    v_accvgpr_write_b32 a201, v11
    v_accvgpr_write_b32 a202, v12
    v_accvgpr_write_b32 a203, v13
    v_accvgpr_write_b32 a204, v14
    v_accvgpr_write_b32 a205, v15
    v_accvgpr_write_b32 a206, v16
    v_accvgpr_write_b32 a207, v17
    v_accvgpr_write_b32 a208, v18
    s_and_b32 s20, s2, 7
    s_lshr_b32 s21, s2, 3
    s_and_b32 s5, s21, 3
    s_lshr_b32 s4, s21, 2
    s_and_b32 s22, s20, 1
    s_lshl_b32 s22, s22, 3
    s_add_u32 s4, s4, s22
    s_lshr_b32 s3, s20, 1
    s_mul_i32 s60, s3, 1327104
    s_mul_i32 s20, s16, 36864
    s_add_u32 s60, s60, s20
    s_mul_i32 s20, s5, 288
    s_add_u32 s60, s60, s20
    s_add_u32 s61, s60, 147456
    s_mul_i32 s51, s16, 9216
    s_lshl_b32 s30, s18, 5
    s_add_u32 s30, s30, s17
    s_mul_i32 s30, s30, 36864
    s_add_u32 s30, s30, s51
    s_add_u32 s30, s30, 33554432
    s_add_u32 s32, s30, 4096
    s_add_u32 s28, s30, 8192
    v_mov_b32 v246, -1
    v_mov_b32 v247, -1
    v_mov_b32 v248, -1
    v_mov_b32 v249, -1
    s_add_u32 m0, s29, 36864
    s_nop 0
    buffer_load_dwordx4 v226, s[24:27], s34 offen lds
    s_add_u32 m0, s29, 37888
    s_nop 0
    buffer_load_dwordx4 v227, s[24:27], s34 offen lds
    s_add_u32 m0, s29, 38912
    s_nop 0
    buffer_load_dwordx4 v228, s[24:27], s34 offen lds
    s_add_u32 m0, s29, 39936
    s_nop 0
    buffer_load_dwordx4 v229, s[24:27], s34 offen lds
    s_add_u32 m0, s29, 40960
    s_nop 0
    buffer_load_dwordx4 v230, s[24:27], s34 offen lds
    s_add_u32 m0, s29, 41984
    s_nop 0
    buffer_load_dwordx4 v231, s[24:27], s34 offen lds
    s_add_u32 m0, s29, 43008
    s_nop 0
    buffer_load_dwordx4 v232, s[24:27], s34 offen lds
    s_add_u32 m0, s29, 44032
    s_nop 0
    buffer_load_dwordx4 v233, s[24:27], s34 offen lds
    s_add_u32 m0, s29, 45056
    s_nop 0
    buffer_load_dwordx4 v234, s[24:27], s34 offen lds
    s_barrier
GG_R4:
    buffer_load_dwordx4 a[88:91], v237, s[8:11], s42 offen offset:0 sc1
    buffer_load_dwordx4 a[92:95], v238, s[8:11], s42 offen offset:0 sc1
    buffer_load_dwordx4 a[96:99], v239, s[8:11], s42 offen offset:0 sc1
    buffer_load_dwordx4 a[100:103], v240, s[8:11], s42 offen offset:0 sc1
    buffer_load_dwordx4 a[104:107], v237, s[8:11], s42 offen offset:1024 sc1
    buffer_load_dwordx4 a[108:111], v238, s[8:11], s42 offen offset:1024 sc1
    buffer_load_dwordx4 a[112:115], v239, s[8:11], s42 offen offset:1024 sc1
    buffer_load_dwordx4 a[116:119], v240, s[8:11], s42 offen offset:1024 sc1
    s_waitcnt vmcnt(22)
    s_barrier
    s_mov_b32 s6, 0x8000
    ds_read_b64_tr_b16 a[64:65], v241 offset:0
    ds_read_b64_tr_b16 a[66:67], v241 offset:2304
    ds_read_b64_tr_b16 a[68:69], v241 offset:18432
    ds_read_b64_tr_b16 a[70:71], v241 offset:20736
    ds_read_b64_tr_b16 a[72:73], v241 offset:32
    ds_read_b64_tr_b16 a[74:75], v241 offset:2336
    ds_read_b64_tr_b16 a[76:77], v241 offset:18464
    ds_read_b64_tr_b16 a[78:79], v241 offset:20768
    ds_read_b64_tr_b16 a[80:81], v241 offset:64
    ds_read_b64_tr_b16 a[82:83], v241 offset:2368
    s_waitcnt vmcnt(4)
    v_accvgpr_read_b32 v250, a88
    v_accvgpr_read_b32 v251, a92
    v_accvgpr_read_b32 v252, a96
    v_accvgpr_read_b32 v253, a100
    v_max3_u32 v250, v250, v251, v252
    v_max_u32 v250, v250, v253
    v_cmp_eq_u32 vcc, -1, v250
    s_cbranch_vccnz GG_SL0
GG_RT0:
    s_waitcnt lgkmcnt(8)
    v_mfma_f32_16x16x32_bf16 v[0:3], a[64:67], a[88:91], 0
    ds_read_b64_tr_b16 a[84:85], v241 offset:18496
    v_mfma_f32_16x16x32_bf16 v[4:7], a[64:67], a[92:95], 0
    ds_read_b64_tr_b16 a[86:87], v241 offset:20800
    v_mfma_f32_16x16x32_bf16 v[8:11], a[64:67], a[96:99], 0
    buffer_load_dwordx4 a[120:123], v237, s[8:11], s43 offen offset:0 sc1
    v_mfma_f32_16x16x32_bf16 v[12:15], a[64:67], a[100:103], 0
    s_waitcnt lgkmcnt(8)
    v_mfma_f32_16x16x32_bf16 v[16:19], a[68:71], a[88:91], 0
    ds_read_b64_tr_b16 a[64:65], v241 offset:96
    v_mfma_f32_16x16x32_bf16 v[20:23], a[68:71], a[92:95], 0
    ds_read_b64_tr_b16 a[66:67], v241 offset:2400
    v_mfma_f32_16x16x32_bf16 v[24:27], a[68:71], a[96:99], 0
    buffer_load_dwordx4 a[124:127], v238, s[8:11], s43 offen offset:0 sc1
    v_mfma_f32_16x16x32_bf16 v[28:31], a[68:71], a[100:103], 0
    s_waitcnt lgkmcnt(8)
    v_mfma_f32_16x16x32_bf16 v[32:35], a[72:75], a[88:91], 0
    ds_read_b64_tr_b16 a[68:69], v241 offset:18528
    v_mfma_f32_16x16x32_bf16 v[36:39], a[72:75], a[92:95], 0
    ds_read_b64_tr_b16 a[70:71], v241 offset:20832
    v_mfma_f32_16x16x32_bf16 v[40:43], a[72:75], a[96:99], 0
    v_mfma_f32_16x16x32_bf16 v[44:47], a[72:75], a[100:103], 0
    s_waitcnt lgkmcnt(8)
    v_mfma_f32_16x16x32_bf16 v[48:51], a[76:79], a[88:91], 0
    ds_read_b64_tr_b16 a[72:73], v241 offset:128
    v_mfma_f32_16x16x32_bf16 v[52:55], a[76:79], a[92:95], 0
    ds_read_b64_tr_b16 a[74:75], v241 offset:2432
    v_mfma_f32_16x16x32_bf16 v[56:59], a[76:79], a[96:99], 0
    buffer_load_dwordx4 a[128:131], v239, s[8:11], s43 offen offset:0 sc1
    v_mfma_f32_16x16x32_bf16 v[60:63], a[76:79], a[100:103], 0
    s_waitcnt lgkmcnt(8)
    v_mfma_f32_16x16x32_bf16 v[64:67], a[80:83], a[88:91], 0
    ds_read_b64_tr_b16 a[76:77], v241 offset:18560
    v_mfma_f32_16x16x32_bf16 v[68:71], a[80:83], a[92:95], 0
    ds_read_b64_tr_b16 a[78:79], v241 offset:20864
    v_mfma_f32_16x16x32_bf16 v[72:75], a[80:83], a[96:99], 0
    buffer_load_dwordx4 a[132:135], v240, s[8:11], s43 offen offset:0 sc1
    v_mfma_f32_16x16x32_bf16 v[76:79], a[80:83], a[100:103], 0
    s_waitcnt lgkmcnt(8)
    v_mfma_f32_16x16x32_bf16 v[80:83], a[84:87], a[88:91], 0
    ds_read_b64_tr_b16 a[80:81], v241 offset:160
    v_mfma_f32_16x16x32_bf16 v[84:87], a[84:87], a[92:95], 0
    ds_read_b64_tr_b16 a[82:83], v241 offset:2464
    v_mfma_f32_16x16x32_bf16 v[88:91], a[84:87], a[96:99], 0
    v_mfma_f32_16x16x32_bf16 v[92:95], a[84:87], a[100:103], 0
    s_waitcnt lgkmcnt(8)
    v_mfma_f32_16x16x32_bf16 v[96:99], a[64:67], a[88:91], 0
    ds_read_b64_tr_b16 a[84:85], v241 offset:18592
    v_mfma_f32_16x16x32_bf16 v[100:103], a[64:67], a[92:95], 0
    ds_read_b64_tr_b16 a[86:87], v241 offset:20896
    v_mfma_f32_16x16x32_bf16 v[104:107], a[64:67], a[96:99], 0
    buffer_load_dwordx4 a[136:139], v237, s[8:11], s43 offen offset:1024 sc1
    v_mfma_f32_16x16x32_bf16 v[108:111], a[64:67], a[100:103], 0
    s_waitcnt lgkmcnt(8)
    v_mfma_f32_16x16x32_bf16 v[112:115], a[68:71], a[88:91], 0
    ds_read_b64_tr_b16 a[64:65], v241 offset:192
    v_mfma_f32_16x16x32_bf16 v[116:119], a[68:71], a[92:95], 0
    ds_read_b64_tr_b16 a[66:67], v241 offset:2496
    v_mfma_f32_16x16x32_bf16 v[120:123], a[68:71], a[96:99], 0
    buffer_load_dwordx4 a[140:143], v238, s[8:11], s43 offen offset:1024 sc1
    v_mfma_f32_16x16x32_bf16 v[124:127], a[68:71], a[100:103], 0
    s_waitcnt lgkmcnt(8)
    v_mfma_f32_16x16x32_bf16 v[128:131], a[72:75], a[88:91], 0
    ds_read_b64_tr_b16 a[68:69], v241 offset:18624
    v_mfma_f32_16x16x32_bf16 v[132:135], a[72:75], a[92:95], 0
    ds_read_b64_tr_b16 a[70:71], v241 offset:20928
    v_mfma_f32_16x16x32_bf16 v[136:139], a[72:75], a[96:99], 0
    v_mfma_f32_16x16x32_bf16 v[140:143], a[72:75], a[100:103], 0
    s_waitcnt lgkmcnt(8)
    v_mfma_f32_16x16x32_bf16 v[144:147], a[76:79], a[88:91], 0
    ds_read_b64_tr_b16 a[72:73], v241 offset:224
    v_mfma_f32_16x16x32_bf16 v[148:151], a[76:79], a[92:95], 0
    ds_read_b64_tr_b16 a[74:75], v241 offset:2528
    v_mfma_f32_16x16x32_bf16 v[152:155], a[76:79], a[96:99], 0
    buffer_load_dwordx4 a[144:147], v239, s[8:11], s43 offen offset:1024 sc1
    v_mfma_f32_16x16x32_bf16 v[156:159], a[76:79], a[100:103], 0
    s_waitcnt lgkmcnt(8)
    v_mfma_f32_16x16x32_bf16 v[160:163], a[80:83], a[88:91], 0
    ds_read_b64_tr_b16 a[76:77], v241 offset:18656
    v_mfma_f32_16x16x32_bf16 v[164:167], a[80:83], a[92:95], 0
    ds_read_b64_tr_b16 a[78:79], v241 offset:20960
    v_mfma_f32_16x16x32_bf16 v[168:171], a[80:83], a[96:99], 0
    buffer_load_dwordx4 a[148:151], v240, s[8:11], s43 offen offset:1024 sc1
    v_mfma_f32_16x16x32_bf16 v[172:175], a[80:83], a[100:103], 0
    s_waitcnt lgkmcnt(8)
    v_mfma_f32_16x16x32_bf16 v[176:179], a[84:87], a[88:91], 0
    ds_read_b64_tr_b16 a[80:81], v241 offset:256
    v_mfma_f32_16x16x32_bf16 v[180:183], a[84:87], a[92:95], 0
    ds_read_b64_tr_b16 a[82:83], v241 offset:2560
    v_mfma_f32_16x16x32_bf16 v[184:187], a[84:87], a[96:99], 0
    v_mfma_f32_16x16x32_bf16 v[188:191], a[84:87], a[100:103], 0
    s_waitcnt vmcnt(8)
    s_waitcnt lgkmcnt(8)
    v_mfma_f32_16x16x32_bf16 v[192:195], a[64:67], a[88:91], 0
    ds_read_b64_tr_b16 a[84:85], v241 offset:18688
    v_accvgpr_read_b32 v250, a104
    v_mfma_f32_16x16x32_bf16 v[196:199], a[64:67], a[92:95], 0
    ds_read_b64_tr_b16 a[86:87], v241 offset:20992
    v_accvgpr_read_b32 v251, a108
    v_mfma_f32_16x16x32_bf16 v[200:203], a[64:67], a[96:99], 0
    buffer_load_dwordx4 a[152:155], v237, s[8:11], s44 offen offset:0 sc1
    v_mfma_f32_16x16x32_bf16 v[204:207], a[64:67], a[100:103], 0
    v_accvgpr_read_b32 v252, a112
    v_accvgpr_read_b32 v253, a116
    s_waitcnt lgkmcnt(8)
    v_mfma_f32_16x16x32_bf16 v[208:211], a[68:71], a[88:91], 0
    ds_read_b64_tr_b16 a[64:65], v241 offset:9216
    v_max3_u32 v250, v250, v251, v252
    v_mfma_f32_16x16x32_bf16 v[212:215], a[68:71], a[92:95], 0
    ds_read_b64_tr_b16 a[66:67], v241 offset:11520
    v_max_u32 v250, v250, v253
    v_mfma_f32_16x16x32_bf16 v[216:219], a[68:71], a[96:99], 0
    buffer_load_dwordx4 a[156:159], v238, s[8:11], s44 offen offset:0 sc1
    v_mfma_f32_16x16x32_bf16 v[220:223], a[68:71], a[100:103], 0
    v_cmp_eq_u32 vcc, -1, v250
    s_waitcnt lgkmcnt(8)
    v_mfma_f32_16x16x32_bf16 a[0:3], a[72:75], a[88:91], 0
    ds_read_b64_tr_b16 a[68:69], v241 offset:27648
    v_mfma_f32_16x16x32_bf16 a[4:7], a[72:75], a[92:95], 0
    ds_read_b64_tr_b16 a[70:71], v241 offset:29952
    v_mfma_f32_16x16x32_bf16 a[8:11], a[72:75], a[96:99], 0
    v_mfma_f32_16x16x32_bf16 a[12:15], a[72:75], a[100:103], 0
    s_waitcnt lgkmcnt(8)
    v_mfma_f32_16x16x32_bf16 a[16:19], a[76:79], a[88:91], 0
    ds_read_b64_tr_b16 a[72:73], v241 offset:9248
    v_mfma_f32_16x16x32_bf16 a[20:23], a[76:79], a[92:95], 0
    ds_read_b64_tr_b16 a[74:75], v241 offset:11552
    v_mfma_f32_16x16x32_bf16 a[24:27], a[76:79], a[96:99], 0
    buffer_load_dwordx4 a[160:163], v239, s[8:11], s44 offen offset:0 sc1
    v_mfma_f32_16x16x32_bf16 a[28:31], a[76:79], a[100:103], 0
    s_cbranch_vccnz GG_SL1
GG_RT1:
    s_waitcnt lgkmcnt(8)
    v_mfma_f32_16x16x32_bf16 a[32:35], a[80:83], a[88:91], 0
    ds_read_b64_tr_b16 a[76:77], v241 offset:27680
    v_mfma_f32_16x16x32_bf16 a[36:39], a[80:83], a[92:95], 0
    ds_read_b64_tr_b16 a[78:79], v241 offset:29984
    v_mfma_f32_16x16x32_bf16 a[40:43], a[80:83], a[96:99], 0
    buffer_load_dwordx4 a[164:167], v240, s[8:11], s44 offen offset:0 sc1
    v_mfma_f32_16x16x32_bf16 a[44:47], a[80:83], a[100:103], 0
    s_waitcnt lgkmcnt(8)
    v_mfma_f32_16x16x32_bf16 a[48:51], a[84:87], a[88:91], 0
    ds_read_b64_tr_b16 a[80:81], v241 offset:9280
    v_mfma_f32_16x16x32_bf16 a[52:55], a[84:87], a[92:95], 0
    ds_read_b64_tr_b16 a[82:83], v241 offset:11584
    v_mfma_f32_16x16x32_bf16 a[56:59], a[84:87], a[96:99], 0
    v_mfma_f32_16x16x32_bf16 a[60:63], a[84:87], a[100:103], 0
    s_waitcnt lgkmcnt(8)
    v_mfma_f32_16x16x32_bf16 v[0:3], a[64:67], a[104:107], v[0:3]
    ds_read_b64_tr_b16 a[84:85], v241 offset:27712
    v_mfma_f32_16x16x32_bf16 v[4:7], a[64:67], a[108:111], v[4:7]
    ds_read_b64_tr_b16 a[86:87], v241 offset:30016
    v_mfma_f32_16x16x32_bf16 v[8:11], a[64:67], a[112:115], v[8:11]
    s_add_u32 m0, s29, 73728
    s_nop 0
    buffer_load_dwordx4 v226, s[24:27], s35 offen lds
    v_mfma_f32_16x16x32_bf16 v[12:15], a[64:67], a[116:119], v[12:15]
    s_waitcnt lgkmcnt(8)
    v_mfma_f32_16x16x32_bf16 v[16:19], a[68:71], a[104:107], v[16:19]
    ds_read_b64_tr_b16 a[64:65], v241 offset:9312
    v_mfma_f32_16x16x32_bf16 v[20:23], a[68:71], a[108:111], v[20:23]
    ds_read_b64_tr_b16 a[66:67], v241 offset:11616
    v_mfma_f32_16x16x32_bf16 v[24:27], a[68:71], a[112:115], v[24:27]
    s_add_u32 m0, s29, 74752
    s_nop 0
    buffer_load_dwordx4 v227, s[24:27], s35 offen lds
    v_mfma_f32_16x16x32_bf16 v[28:31], a[68:71], a[116:119], v[28:31]
    s_waitcnt lgkmcnt(8)
    v_mfma_f32_16x16x32_bf16 v[32:35], a[72:75], a[104:107], v[32:35]
    ds_read_b64_tr_b16 a[68:69], v241 offset:27744
    v_mfma_f32_16x16x32_bf16 v[36:39], a[72:75], a[108:111], v[36:39]
    ds_read_b64_tr_b16 a[70:71], v241 offset:30048
    v_mfma_f32_16x16x32_bf16 v[40:43], a[72:75], a[112:115], v[40:43]
    v_mfma_f32_16x16x32_bf16 v[44:47], a[72:75], a[116:119], v[44:47]
    s_waitcnt lgkmcnt(8)
    v_mfma_f32_16x16x32_bf16 v[48:51], a[76:79], a[104:107], v[48:51]
    ds_read_b64_tr_b16 a[72:73], v241 offset:9344
    v_mfma_f32_16x16x32_bf16 v[52:55], a[76:79], a[108:111], v[52:55]
    ds_read_b64_tr_b16 a[74:75], v241 offset:11648
    v_mfma_f32_16x16x32_bf16 v[56:59], a[76:79], a[112:115], v[56:59]
    s_add_u32 m0, s29, 75776
    s_nop 0
    buffer_load_dwordx4 v228, s[24:27], s35 offen lds
    v_mfma_f32_16x16x32_bf16 v[60:63], a[76:79], a[116:119], v[60:63]
    s_waitcnt lgkmcnt(8)
    v_mfma_f32_16x16x32_bf16 v[64:67], a[80:83], a[104:107], v[64:67]
    ds_read_b64_tr_b16 a[76:77], v241 offset:27776
    v_mfma_f32_16x16x32_bf16 v[68:71], a[80:83], a[108:111], v[68:71]
    ds_read_b64_tr_b16 a[78:79], v241 offset:30080
    v_mfma_f32_16x16x32_bf16 v[72:75], a[80:83], a[112:115], v[72:75]
    s_add_u32 m0, s29, 76800
    s_nop 0
    buffer_load_dwordx4 v229, s[24:27], s35 offen lds
    v_mfma_f32_16x16x32_bf16 v[76:79], a[80:83], a[116:119], v[76:79]
    s_waitcnt lgkmcnt(8)
    v_mfma_f32_16x16x32_bf16 v[80:83], a[84:87], a[104:107], v[80:83]
    ds_read_b64_tr_b16 a[80:81], v241 offset:9376
    v_mfma_f32_16x16x32_bf16 v[84:87], a[84:87], a[108:111], v[84:87]
    ds_read_b64_tr_b16 a[82:83], v241 offset:11680
    v_mfma_f32_16x16x32_bf16 v[88:91], a[84:87], a[112:115], v[88:91]
    v_mfma_f32_16x16x32_bf16 v[92:95], a[84:87], a[116:119], v[92:95]
    s_waitcnt lgkmcnt(8)
    v_mfma_f32_16x16x32_bf16 v[96:99], a[64:67], a[104:107], v[96:99]
    ds_read_b64_tr_b16 a[84:85], v241 offset:27808
    v_mfma_f32_16x16x32_bf16 v[100:103], a[64:67], a[108:111], v[100:103]
    ds_read_b64_tr_b16 a[86:87], v241 offset:30112
    v_mfma_f32_16x16x32_bf16 v[104:107], a[64:67], a[112:115], v[104:107]
    s_add_u32 m0, s29, 77824
    s_nop 0
    buffer_load_dwordx4 v230, s[24:27], s35 offen lds
    v_mfma_f32_16x16x32_bf16 v[108:111], a[64:67], a[116:119], v[108:111]
    s_waitcnt lgkmcnt(8)
    v_mfma_f32_16x16x32_bf16 v[112:115], a[68:71], a[104:107], v[112:115]
    ds_read_b64_tr_b16 a[64:65], v241 offset:9408
    v_mfma_f32_16x16x32_bf16 v[116:119], a[68:71], a[108:111], v[116:119]
    ds_read_b64_tr_b16 a[66:67], v241 offset:11712
    v_mfma_f32_16x16x32_bf16 v[120:123], a[68:71], a[112:115], v[120:123]
    s_add_u32 m0, s29, 78848
    s_nop 0
    buffer_load_dwordx4 v231, s[24:27], s35 offen lds
    v_mfma_f32_16x16x32_bf16 v[124:127], a[68:71], a[116:119], v[124:127]
    s_waitcnt lgkmcnt(8)
    v_mfma_f32_16x16x32_bf16 v[128:131], a[72:75], a[104:107], v[128:131]
    ds_read_b64_tr_b16 a[68:69], v241 offset:27840
    v_mfma_f32_16x16x32_bf16 v[132:135], a[72:75], a[108:111], v[132:135]
    ds_read_b64_tr_b16 a[70:71], v241 offset:30144
    v_mfma_f32_16x16x32_bf16 v[136:139], a[72:75], a[112:115], v[136:139]
    v_mfma_f32_16x16x32_bf16 v[140:143], a[72:75], a[116:119], v[140:143]
    s_waitcnt lgkmcnt(8)
    v_mfma_f32_16x16x32_bf16 v[144:147], a[76:79], a[104:107], v[144:147]
    ds_read_b64_tr_b16 a[72:73], v241 offset:9440
    v_mfma_f32_16x16x32_bf16 v[148:151], a[76:79], a[108:111], v[148:151]
    ds_read_b64_tr_b16 a[74:75], v241 offset:11744
    v_mfma_f32_16x16x32_bf16 v[152:155], a[76:79], a[112:115], v[152:155]
    s_add_u32 m0, s29, 79872
    s_nop 0
    buffer_load_dwordx4 v232, s[24:27], s35 offen lds
    v_mfma_f32_16x16x32_bf16 v[156:159], a[76:79], a[116:119], v[156:159]
    s_waitcnt lgkmcnt(8)
    v_mfma_f32_16x16x32_bf16 v[160:163], a[80:83], a[104:107], v[160:163]
    ds_read_b64_tr_b16 a[76:77], v241 offset:27872
    v_mfma_f32_16x16x32_bf16 v[164:167], a[80:83], a[108:111], v[164:167]
    ds_read_b64_tr_b16 a[78:79], v241 offset:30176
    v_mfma_f32_16x16x32_bf16 v[168:171], a[80:83], a[112:115], v[168:171]
    s_add_u32 m0, s29, 80896
    s_nop 0
    buffer_load_dwordx4 v233, s[24:27], s35 offen lds
    v_mfma_f32_16x16x32_bf16 v[172:175], a[80:83], a[116:119], v[172:175]
    s_waitcnt lgkmcnt(8)
    v_mfma_f32_16x16x32_bf16 v[176:179], a[84:87], a[104:107], v[176:179]
    ds_read_b64_tr_b16 a[80:81], v241 offset:9472
    v_mfma_f32_16x16x32_bf16 v[180:183], a[84:87], a[108:111], v[180:183]
    ds_read_b64_tr_b16 a[82:83], v241 offset:11776
    v_mfma_f32_16x16x32_bf16 v[184:187], a[84:87], a[112:115], v[184:187]
    v_mfma_f32_16x16x32_bf16 v[188:191], a[84:87], a[116:119], v[188:191]
    s_waitcnt vmcnt(16)
    s_waitcnt lgkmcnt(8)
    v_mfma_f32_16x16x32_bf16 v[192:195], a[64:67], a[104:107], v[192:195]
    ds_read_b64_tr_b16 a[84:85], v241 offset:27904
    v_accvgpr_read_b32 v250, a120
    v_mfma_f32_16x16x32_bf16 v[196:199], a[64:67], a[108:111], v[196:199]
    ds_read_b64_tr_b16 a[86:87], v241 offset:30208
    v_accvgpr_read_b32 v251, a124
    v_mfma_f32_16x16x32_bf16 v[200:203], a[64:67], a[112:115], v[200:203]
    s_add_u32 m0, s29, 81920
    s_nop 0
    buffer_load_dwordx4 v234, s[24:27], s35 offen lds
    v_mfma_f32_16x16x32_bf16 v[204:207], a[64:67], a[116:119], v[204:207]
    v_accvgpr_read_b32 v252, a128
    v_accvgpr_read_b32 v253, a132
    s_barrier
    s_waitcnt lgkmcnt(8)
    v_mfma_f32_16x16x32_bf16 v[208:211], a[68:71], a[104:107], v[208:211]
    ds_read_b64_tr_b16 a[64:65], v242 offset:0
    v_max3_u32 v250, v250, v251, v252
    v_mfma_f32_16x16x32_bf16 v[212:215], a[68:71], a[108:111], v[212:215]
    ds_read_b64_tr_b16 a[66:67], v242 offset:2304
    v_max_u32 v250, v250, v253
    v_mfma_f32_16x16x32_bf16 v[216:219], a[68:71], a[112:115], v[216:219]
    buffer_load_dwordx4 a[168:171], v237, s[8:11], s44 offen offset:1024 sc1
    v_mfma_f32_16x16x32_bf16 v[220:223], a[68:71], a[116:119], v[220:223]
    v_cmp_eq_u32 vcc, -1, v250
    s_waitcnt lgkmcnt(8)
    v_mfma_f32_16x16x32_bf16 a[0:3], a[72:75], a[104:107], a[0:3]
    ds_read_b64_tr_b16 a[68:69], v242 offset:18432
    v_mfma_f32_16x16x32_bf16 a[4:7], a[72:75], a[108:111], a[4:7]
    ds_read_b64_tr_b16 a[70:71], v242 offset:20736
    v_mfma_f32_16x16x32_bf16 a[8:11], a[72:75], a[112:115], a[8:11]
    v_mfma_f32_16x16x32_bf16 a[12:15], a[72:75], a[116:119], a[12:15]
    s_waitcnt lgkmcnt(8)
    v_mfma_f32_16x16x32_bf16 a[16:19], a[76:79], a[104:107], a[16:19]
    ds_read_b64_tr_b16 a[72:73], v242 offset:32
    v_mfma_f32_16x16x32_bf16 a[20:23], a[76:79], a[108:111], a[20:23]
    ds_read_b64_tr_b16 a[74:75], v242 offset:2336
    v_mfma_f32_16x16x32_bf16 a[24:27], a[76:79], a[112:115], a[24:27]
    buffer_load_dwordx4 a[172:175], v238, s[8:11], s44 offen offset:1024 sc1
    v_mfma_f32_16x16x32_bf16 a[28:31], a[76:79], a[116:119], a[28:31]
    s_cbranch_vccnz GG_SL2
GG_RT2:
    s_waitcnt lgkmcnt(8)
    v_mfma_f32_16x16x32_bf16 a[32:35], a[80:83], a[104:107], a[32:35]
    ds_read_b64_tr_b16 a[76:77], v242 offset:18464
    v_mfma_f32_16x16x32_bf16 a[36:39], a[80:83], a[108:111], a[36:39]
    ds_read_b64_tr_b16 a[78:79], v242 offset:20768
    v_mfma_f32_16x16x32_bf16 a[40:43], a[80:83], a[112:115], a[40:43]
    buffer_load_dwordx4 a[176:179], v239, s[8:11], s44 offen offset:1024 sc1
    v_mfma_f32_16x16x32_bf16 a[44:47], a[80:83], a[116:119], a[44:47]
    s_waitcnt lgkmcnt(8)
    v_mfma_f32_16x16x32_bf16 a[48:51], a[84:87], a[104:107], a[48:51]
    ds_read_b64_tr_b16 a[80:81], v242 offset:64
    v_mfma_f32_16x16x32_bf16 a[52:55], a[84:87], a[108:111], a[52:55]
    ds_read_b64_tr_b16 a[82:83], v242 offset:2368
    v_mfma_f32_16x16x32_bf16 a[56:59], a[84:87], a[112:115], a[56:59]
    v_mfma_f32_16x16x32_bf16 a[60:63], a[84:87], a[116:119], a[60:63]
    s_waitcnt lgkmcnt(8)
    v_mfma_f32_16x16x32_bf16 v[0:3], a[64:67], a[120:123], v[0:3]
    ds_read_b64_tr_b16 a[84:85], v242 offset:18496
    v_mfma_f32_16x16x32_bf16 v[4:7], a[64:67], a[124:127], v[4:7]
    ds_read_b64_tr_b16 a[86:87], v242 offset:20800
    v_mfma_f32_16x16x32_bf16 v[8:11], a[64:67], a[128:131], v[8:11]
    buffer_load_dwordx4 a[180:183], v240, s[8:11], s44 offen offset:1024 sc1
    v_mfma_f32_16x16x32_bf16 v[12:15], a[64:67], a[132:135], v[12:15]
    s_waitcnt lgkmcnt(8)
    v_mfma_f32_16x16x32_bf16 v[16:19], a[68:71], a[120:123], v[16:19]
    ds_read_b64_tr_b16 a[64:65], v242 offset:96
    v_mfma_f32_16x16x32_bf16 v[20:23], a[68:71], a[124:127], v[20:23]
    ds_read_b64_tr_b16 a[66:67], v242 offset:2400
    v_mfma_f32_16x16x32_bf16 v[24:27], a[68:71], a[128:131], v[24:27]
    buffer_load_dwordx4 a[184:187], v237, s[8:11], s45 offen offset:0 sc1
    v_mfma_f32_16x16x32_bf16 v[28:31], a[68:71], a[132:135], v[28:31]
    s_waitcnt lgkmcnt(8)
    v_mfma_f32_16x16x32_bf16 v[32:35], a[72:75], a[120:123], v[32:35]
    ds_read_b64_tr_b16 a[68:69], v242 offset:18528
    v_mfma_f32_16x16x32_bf16 v[36:39], a[72:75], a[124:127], v[36:39]
    ds_read_b64_tr_b16 a[70:71], v242 offset:20832
    v_mfma_f32_16x16x32_bf16 v[40:43], a[72:75], a[128:131], v[40:43]
    v_mfma_f32_16x16x32_bf16 v[44:47], a[72:75], a[132:135], v[44:47]
    s_waitcnt lgkmcnt(8)
    v_mfma_f32_16x16x32_bf16 v[48:51], a[76:79], a[120:123], v[48:51]
    ds_read_b64_tr_b16 a[72:73], v242 offset:128
    v_mfma_f32_16x16x32_bf16 v[52:55], a[76:79], a[124:127], v[52:55]
    ds_read_b64_tr_b16 a[74:75], v242 offset:2432
    v_mfma_f32_16x16x32_bf16 v[56:59], a[76:79], a[128:131], v[56:59]
    buffer_load_dwordx4 a[188:191], v238, s[8:11], s45 offen offset:0 sc1
    v_mfma_f32_16x16x32_bf16 v[60:63], a[76:79], a[132:135], v[60:63]
    s_waitcnt lgkmcnt(8)
    v_mfma_f32_16x16x32_bf16 v[64:67], a[80:83], a[120:123], v[64:67]
    ds_read_b64_tr_b16 a[76:77], v242 offset:18560
    v_mfma_f32_16x16x32_bf16 v[68:71], a[80:83], a[124:127], v[68:71]
    ds_read_b64_tr_b16 a[78:79], v242 offset:20864
    v_mfma_f32_16x16x32_bf16 v[72:75], a[80:83], a[128:131], v[72:75]
    buffer_load_dwordx4 a[192:195], v239, s[8:11], s45 offen offset:0 sc1
    v_mfma_f32_16x16x32_bf16 v[76:79], a[80:83], a[132:135], v[76:79]
    s_waitcnt lgkmcnt(8)
    v_mfma_f32_16x16x32_bf16 v[80:83], a[84:87], a[120:123], v[80:83]
    ds_read_b64_tr_b16 a[80:81], v242 offset:160
    v_mfma_f32_16x16x32_bf16 v[84:87], a[84:87], a[124:127], v[84:87]
    ds_read_b64_tr_b16 a[82:83], v242 offset:2464
    v_mfma_f32_16x16x32_bf16 v[88:91], a[84:87], a[128:131], v[88:91]
    v_mfma_f32_16x16x32_bf16 v[92:95], a[84:87], a[132:135], v[92:95]
    s_waitcnt lgkmcnt(8)
    v_mfma_f32_16x16x32_bf16 v[96:99], a[64:67], a[120:123], v[96:99]
    ds_read_b64_tr_b16 a[84:85], v242 offset:18592
    v_mfma_f32_16x16x32_bf16 v[100:103], a[64:67], a[124:127], v[100:103]
    ds_read_b64_tr_b16 a[86:87], v242 offset:20896
    v_mfma_f32_16x16x32_bf16 v[104:107], a[64:67], a[128:131], v[104:107]
    buffer_load_dwordx4 a[196:199], v240, s[8:11], s45 offen offset:0 sc1
    v_mfma_f32_16x16x32_bf16 v[108:111], a[64:67], a[132:135], v[108:111]
    s_waitcnt lgkmcnt(8)
    v_mfma_f32_16x16x32_bf16 v[112:115], a[68:71], a[120:123], v[112:115]
    ds_read_b64_tr_b16 a[64:65], v242 offset:192
    v_mfma_f32_16x16x32_bf16 v[116:119], a[68:71], a[124:127], v[116:119]
    ds_read_b64_tr_b16 a[66:67], v242 offset:2496
    v_mfma_f32_16x16x32_bf16 v[120:123], a[68:71], a[128:131], v[120:123]
    s_add_u32 m0, s29, 110592
    s_nop 0
    buffer_load_dwordx4 v226, s[24:27], s36 offen lds
    v_mfma_f32_16x16x32_bf16 v[124:127], a[68:71], a[132:135], v[124:127]
    s_waitcnt lgkmcnt(8)
    v_mfma_f32_16x16x32_bf16 v[128:131], a[72:75], a[120:123], v[128:131]
    ds_read_b64_tr_b16 a[68:69], v242 offset:18624
    v_mfma_f32_16x16x32_bf16 v[132:135], a[72:75], a[124:127], v[132:135]
    ds_read_b64_tr_b16 a[70:71], v242 offset:20928
    v_mfma_f32_16x16x32_bf16 v[136:139], a[72:75], a[128:131], v[136:139]
    v_mfma_f32_16x16x32_bf16 v[140:143], a[72:75], a[132:135], v[140:143]
    s_waitcnt lgkmcnt(8)
    v_mfma_f32_16x16x32_bf16 v[144:147], a[76:79], a[120:123], v[144:147]
    ds_read_b64_tr_b16 a[72:73], v242 offset:224
    v_mfma_f32_16x16x32_bf16 v[148:151], a[76:79], a[124:127], v[148:151]
    ds_read_b64_tr_b16 a[74:75], v242 offset:2528
    v_mfma_f32_16x16x32_bf16 v[152:155], a[76:79], a[128:131], v[152:155]
    s_add_u32 m0, s29, 111616
    s_nop 0
    buffer_load_dwordx4 v227, s[24:27], s36 offen lds
    v_mfma_f32_16x16x32_bf16 v[156:159], a[76:79], a[132:135], v[156:159]
    s_waitcnt lgkmcnt(8)
    v_mfma_f32_16x16x32_bf16 v[160:163], a[80:83], a[120:123], v[160:163]
    ds_read_b64_tr_b16 a[76:77], v242 offset:18656
    v_mfma_f32_16x16x32_bf16 v[164:167], a[80:83], a[124:127], v[164:167]
    ds_read_b64_tr_b16 a[78:79], v242 offset:20960
    v_mfma_f32_16x16x32_bf16 v[168:171], a[80:83], a[128:131], v[168:171]
    s_add_u32 m0, s29, 112640
    s_nop 0
    buffer_load_dwordx4 v228, s[24:27], s36 offen lds
    v_mfma_f32_16x16x32_bf16 v[172:175], a[80:83], a[132:135], v[172:175]
    s_waitcnt lgkmcnt(8)
    v_mfma_f32_16x16x32_bf16 v[176:179], a[84:87], a[120:123], v[176:179]
    ds_read_b64_tr_b16 a[80:81], v242 offset:256
    v_mfma_f32_16x16x32_bf16 v[180:183], a[84:87], a[124:127], v[180:183]
    ds_read_b64_tr_b16 a[82:83], v242 offset:2560
    v_mfma_f32_16x16x32_bf16 v[184:187], a[84:87], a[128:131], v[184:187]
    v_mfma_f32_16x16x32_bf16 v[188:191], a[84:87], a[132:135], v[188:191]
    s_waitcnt vmcnt(24)
    s_waitcnt lgkmcnt(8)
    v_mfma_f32_16x16x32_bf16 v[192:195], a[64:67], a[120:123], v[192:195]
    ds_read_b64_tr_b16 a[84:85], v242 offset:18688
    v_accvgpr_read_b32 v250, a136
    v_mfma_f32_16x16x32_bf16 v[196:199], a[64:67], a[124:127], v[196:199]
    ds_read_b64_tr_b16 a[86:87], v242 offset:20992
    v_accvgpr_read_b32 v251, a140
    v_mfma_f32_16x16x32_bf16 v[200:203], a[64:67], a[128:131], v[200:203]
    s_add_u32 m0, s29, 113664
    s_nop 0
    buffer_load_dwordx4 v229, s[24:27], s36 offen lds
    v_mfma_f32_16x16x32_bf16 v[204:207], a[64:67], a[132:135], v[204:207]
    v_accvgpr_read_b32 v252, a144
    v_accvgpr_read_b32 v253, a148
    s_waitcnt lgkmcnt(8)
    v_mfma_f32_16x16x32_bf16 v[208:211], a[68:71], a[120:123], v[208:211]
    ds_read_b64_tr_b16 a[64:65], v242 offset:9216
    v_max3_u32 v250, v250, v251, v252
    v_mfma_f32_16x16x32_bf16 v[212:215], a[68:71], a[124:127], v[212:215]
    ds_read_b64_tr_b16 a[66:67], v242 offset:11520
    v_max_u32 v250, v250, v253
    v_mfma_f32_16x16x32_bf16 v[216:219], a[68:71], a[128:131], v[216:219]
    s_add_u32 m0, s29, 114688
    s_nop 0
    buffer_load_dwordx4 v230, s[24:27], s36 offen lds
    v_mfma_f32_16x16x32_bf16 v[220:223], a[68:71], a[132:135], v[220:223]
    v_cmp_eq_u32 vcc, -1, v250
    s_waitcnt lgkmcnt(8)
    v_mfma_f32_16x16x32_bf16 a[0:3], a[72:75], a[120:123], a[0:3]
    ds_read_b64_tr_b16 a[68:69], v242 offset:27648
    v_mfma_f32_16x16x32_bf16 a[4:7], a[72:75], a[124:127], a[4:7]
    ds_read_b64_tr_b16 a[70:71], v242 offset:29952
    v_mfma_f32_16x16x32_bf16 a[8:11], a[72:75], a[128:131], a[8:11]
    v_mfma_f32_16x16x32_bf16 a[12:15], a[72:75], a[132:135], a[12:15]
    s_waitcnt lgkmcnt(8)
    v_mfma_f32_16x16x32_bf16 a[16:19], a[76:79], a[120:123], a[16:19]
    ds_read_b64_tr_b16 a[72:73], v242 offset:9248
    v_mfma_f32_16x16x32_bf16 a[20:23], a[76:79], a[124:127], a[20:23]
    ds_read_b64_tr_b16 a[74:75], v242 offset:11552
    v_mfma_f32_16x16x32_bf16 a[24:27], a[76:79], a[128:131], a[24:27]
    s_add_u32 m0, s29, 115712
    s_nop 0
    buffer_load_dwordx4 v231, s[24:27], s36 offen lds
    v_mfma_f32_16x16x32_bf16 a[28:31], a[76:79], a[132:135], a[28:31]
    s_cbranch_vccnz GG_SL3
GG_RT3:
    s_waitcnt lgkmcnt(8)
    v_mfma_f32_16x16x32_bf16 a[32:35], a[80:83], a[120:123], a[32:35]
    ds_read_b64_tr_b16 a[76:77], v242 offset:27680
    v_mfma_f32_16x16x32_bf16 a[36:39], a[80:83], a[124:127], a[36:39]
    ds_read_b64_tr_b16 a[78:79], v242 offset:29984
    v_mfma_f32_16x16x32_bf16 a[40:43], a[80:83], a[128:131], a[40:43]
    s_add_u32 m0, s29, 116736
    s_nop 0
    buffer_load_dwordx4 v232, s[24:27], s36 offen lds
    v_mfma_f32_16x16x32_bf16 a[44:47], a[80:83], a[132:135], a[44:47]
    s_waitcnt lgkmcnt(8)
    v_mfma_f32_16x16x32_bf16 a[48:51], a[84:87], a[120:123], a[48:51]
    ds_read_b64_tr_b16 a[80:81], v242 offset:9280
    v_mfma_f32_16x16x32_bf16 a[52:55], a[84:87], a[124:127], a[52:55]
    ds_read_b64_tr_b16 a[82:83], v242 offset:11584
    v_mfma_f32_16x16x32_bf16 a[56:59], a[84:87], a[128:131], a[56:59]
    v_mfma_f32_16x16x32_bf16 a[60:63], a[84:87], a[132:135], a[60:63]
    s_waitcnt lgkmcnt(8)
    v_mfma_f32_16x16x32_bf16 v[0:3], a[64:67], a[136:139], v[0:3]
    ds_read_b64_tr_b16 a[84:85], v242 offset:27712
    v_mfma_f32_16x16x32_bf16 v[4:7], a[64:67], a[140:143], v[4:7]
    ds_read_b64_tr_b16 a[86:87], v242 offset:30016
    v_mfma_f32_16x16x32_bf16 v[8:11], a[64:67], a[144:147], v[8:11]
    s_add_u32 m0, s29, 117760
    s_nop 0
    buffer_load_dwordx4 v233, s[24:27], s36 offen lds
    v_mfma_f32_16x16x32_bf16 v[12:15], a[64:67], a[148:151], v[12:15]
    s_waitcnt lgkmcnt(8)
    v_mfma_f32_16x16x32_bf16 v[16:19], a[68:71], a[136:139], v[16:19]
    ds_read_b64_tr_b16 a[64:65], v242 offset:9312
    v_mfma_f32_16x16x32_bf16 v[20:23], a[68:71], a[140:143], v[20:23]
    ds_read_b64_tr_b16 a[66:67], v242 offset:11616
    v_mfma_f32_16x16x32_bf16 v[24:27], a[68:71], a[144:147], v[24:27]
    s_add_u32 m0, s29, 118784
    s_nop 0
    buffer_load_dwordx4 v234, s[24:27], s36 offen lds
    v_mfma_f32_16x16x32_bf16 v[28:31], a[68:71], a[148:151], v[28:31]
    s_waitcnt lgkmcnt(8)
    v_mfma_f32_16x16x32_bf16 v[32:35], a[72:75], a[136:139], v[32:35]
    ds_read_b64_tr_b16 a[68:69], v242 offset:27744
    v_mfma_f32_16x16x32_bf16 v[36:39], a[72:75], a[140:143], v[36:39]
    ds_read_b64_tr_b16 a[70:71], v242 offset:30048
    v_mfma_f32_16x16x32_bf16 v[40:43], a[72:75], a[144:147], v[40:43]
    v_mfma_f32_16x16x32_bf16 v[44:47], a[72:75], a[148:151], v[44:47]
    s_waitcnt lgkmcnt(8)
    v_mfma_f32_16x16x32_bf16 v[48:51], a[76:79], a[136:139], v[48:51]
    ds_read_b64_tr_b16 a[72:73], v242 offset:9344
    v_mfma_f32_16x16x32_bf16 v[52:55], a[76:79], a[140:143], v[52:55]
    ds_read_b64_tr_b16 a[74:75], v242 offset:11648
    v_mfma_f32_16x16x32_bf16 v[56:59], a[76:79], a[144:147], v[56:59]
    buffer_load_dwordx4 a[88:91], v237, s[8:11], s45 offen offset:1024 sc1
    v_mfma_f32_16x16x32_bf16 v[60:63], a[76:79], a[148:151], v[60:63]
    s_waitcnt lgkmcnt(8)
    v_mfma_f32_16x16x32_bf16 v[64:67], a[80:83], a[136:139], v[64:67]
    ds_read_b64_tr_b16 a[76:77], v242 offset:27776
    v_mfma_f32_16x16x32_bf16 v[68:71], a[80:83], a[140:143], v[68:71]
    ds_read_b64_tr_b16 a[78:79], v242 offset:30080
    v_mfma_f32_16x16x32_bf16 v[72:75], a[80:83], a[144:147], v[72:75]
    buffer_load_dwordx4 a[92:95], v238, s[8:11], s45 offen offset:1024 sc1
    v_mfma_f32_16x16x32_bf16 v[76:79], a[80:83], a[148:151], v[76:79]
    s_waitcnt lgkmcnt(8)
    v_mfma_f32_16x16x32_bf16 v[80:83], a[84:87], a[136:139], v[80:83]
    ds_read_b64_tr_b16 a[80:81], v242 offset:9376
    v_mfma_f32_16x16x32_bf16 v[84:87], a[84:87], a[140:143], v[84:87]
    ds_read_b64_tr_b16 a[82:83], v242 offset:11680
    v_mfma_f32_16x16x32_bf16 v[88:91], a[84:87], a[144:147], v[88:91]
    v_mfma_f32_16x16x32_bf16 v[92:95], a[84:87], a[148:151], v[92:95]
    s_waitcnt lgkmcnt(8)
    v_mfma_f32_16x16x32_bf16 v[96:99], a[64:67], a[136:139], v[96:99]
    ds_read_b64_tr_b16 a[84:85], v242 offset:27808
    v_mfma_f32_16x16x32_bf16 v[100:103], a[64:67], a[140:143], v[100:103]
    ds_read_b64_tr_b16 a[86:87], v242 offset:30112
    v_mfma_f32_16x16x32_bf16 v[104:107], a[64:67], a[144:147], v[104:107]
    buffer_load_dwordx4 a[96:99], v239, s[8:11], s45 offen offset:1024 sc1
    v_mfma_f32_16x16x32_bf16 v[108:111], a[64:67], a[148:151], v[108:111]
    s_waitcnt lgkmcnt(8)
    v_mfma_f32_16x16x32_bf16 v[112:115], a[68:71], a[136:139], v[112:115]
    ds_read_b64_tr_b16 a[64:65], v242 offset:9408
    v_mfma_f32_16x16x32_bf16 v[116:119], a[68:71], a[140:143], v[116:119]
    ds_read_b64_tr_b16 a[66:67], v242 offset:11712
    v_mfma_f32_16x16x32_bf16 v[120:123], a[68:71], a[144:147], v[120:123]
    buffer_load_dwordx4 a[100:103], v240, s[8:11], s45 offen offset:1024 sc1
    v_mfma_f32_16x16x32_bf16 v[124:127], a[68:71], a[148:151], v[124:127]
    s_waitcnt lgkmcnt(8)
    v_mfma_f32_16x16x32_bf16 v[128:131], a[72:75], a[136:139], v[128:131]
    ds_read_b64_tr_b16 a[68:69], v242 offset:27840
    v_mfma_f32_16x16x32_bf16 v[132:135], a[72:75], a[140:143], v[132:135]
    ds_read_b64_tr_b16 a[70:71], v242 offset:30144
    v_mfma_f32_16x16x32_bf16 v[136:139], a[72:75], a[144:147], v[136:139]
    v_mfma_f32_16x16x32_bf16 v[140:143], a[72:75], a[148:151], v[140:143]
    s_waitcnt lgkmcnt(8)
    v_mfma_f32_16x16x32_bf16 v[144:147], a[76:79], a[136:139], v[144:147]
    ds_read_b64_tr_b16 a[72:73], v242 offset:9440
    v_mfma_f32_16x16x32_bf16 v[148:151], a[76:79], a[140:143], v[148:151]
    ds_read_b64_tr_b16 a[74:75], v242 offset:11744
    v_mfma_f32_16x16x32_bf16 v[152:155], a[76:79], a[144:147], v[152:155]
    buffer_load_dwordx4 a[104:107], v237, s[8:11], s46 offen offset:0 sc1
    v_mfma_f32_16x16x32_bf16 v[156:159], a[76:79], a[148:151], v[156:159]
    s_waitcnt lgkmcnt(8)
    v_mfma_f32_16x16x32_bf16 v[160:163], a[80:83], a[136:139], v[160:163]
    ds_read_b64_tr_b16 a[76:77], v242 offset:27872
    v_mfma_f32_16x16x32_bf16 v[164:167], a[80:83], a[140:143], v[164:167]
    ds_read_b64_tr_b16 a[78:79], v242 offset:30176
    v_mfma_f32_16x16x32_bf16 v[168:171], a[80:83], a[144:147], v[168:171]
    buffer_load_dwordx4 a[108:111], v238, s[8:11], s46 offen offset:0 sc1
    v_mfma_f32_16x16x32_bf16 v[172:175], a[80:83], a[148:151], v[172:175]
    s_waitcnt lgkmcnt(8)
    v_mfma_f32_16x16x32_bf16 v[176:179], a[84:87], a[136:139], v[176:179]
    ds_read_b64_tr_b16 a[80:81], v242 offset:9472
    v_mfma_f32_16x16x32_bf16 v[180:183], a[84:87], a[140:143], v[180:183]
    ds_read_b64_tr_b16 a[82:83], v242 offset:11776
    v_mfma_f32_16x16x32_bf16 v[184:187], a[84:87], a[144:147], v[184:187]
    v_mfma_f32_16x16x32_bf16 v[188:191], a[84:87], a[148:151], v[188:191]
    s_waitcnt vmcnt(32)
    s_waitcnt lgkmcnt(8)
    v_mfma_f32_16x16x32_bf16 v[192:195], a[64:67], a[136:139], v[192:195]
    ds_read_b64_tr_b16 a[84:85], v242 offset:27904
    v_accvgpr_read_b32 v250, a152
    v_mfma_f32_16x16x32_bf16 v[196:199], a[64:67], a[140:143], v[196:199]
    ds_read_b64_tr_b16 a[86:87], v242 offset:30208
    v_accvgpr_read_b32 v251, a156
    v_mfma_f32_16x16x32_bf16 v[200:203], a[64:67], a[144:147], v[200:203]
    buffer_load_dwordx4 a[112:115], v239, s[8:11], s46 offen offset:0 sc1
    v_mfma_f32_16x16x32_bf16 v[204:207], a[64:67], a[148:151], v[204:207]
    v_accvgpr_read_b32 v252, a160
    v_accvgpr_read_b32 v253, a164
    s_waitcnt vmcnt(24)
    s_barrier
    s_waitcnt lgkmcnt(8)
    v_mfma_f32_16x16x32_bf16 v[208:211], a[68:71], a[136:139], v[208:211]
    ds_read_b64_tr_b16 a[64:65], v243 offset:0
    v_max3_u32 v250, v250, v251, v252
    v_mfma_f32_16x16x32_bf16 v[212:215], a[68:71], a[140:143], v[212:215]
    ds_read_b64_tr_b16 a[66:67], v243 offset:2304
    v_max_u32 v250, v250, v253
    v_mfma_f32_16x16x32_bf16 v[216:219], a[68:71], a[144:147], v[216:219]
    buffer_load_dwordx4 a[116:119], v240, s[8:11], s46 offen offset:0 sc1
    v_mfma_f32_16x16x32_bf16 v[220:223], a[68:71], a[148:151], v[220:223]
    v_cmp_eq_u32 vcc, -1, v250
    s_waitcnt lgkmcnt(8)
    v_mfma_f32_16x16x32_bf16 a[0:3], a[72:75], a[136:139], a[0:3]
    ds_read_b64_tr_b16 a[68:69], v243 offset:18432
    v_mfma_f32_16x16x32_bf16 a[4:7], a[72:75], a[140:143], a[4:7]
    ds_read_b64_tr_b16 a[70:71], v243 offset:20736
    v_mfma_f32_16x16x32_bf16 a[8:11], a[72:75], a[144:147], a[8:11]
    v_mfma_f32_16x16x32_bf16 a[12:15], a[72:75], a[148:151], a[12:15]
    s_waitcnt lgkmcnt(8)
    v_mfma_f32_16x16x32_bf16 a[16:19], a[76:79], a[136:139], a[16:19]
    ds_read_b64_tr_b16 a[72:73], v243 offset:32
    v_mfma_f32_16x16x32_bf16 a[20:23], a[76:79], a[140:143], a[20:23]
    ds_read_b64_tr_b16 a[74:75], v243 offset:2336
    v_mfma_f32_16x16x32_bf16 a[24:27], a[76:79], a[144:147], a[24:27]
    s_add_u32 m0, s29, 0
    s_nop 0
    buffer_load_dwordx4 v226, s[24:27], s37 offen lds
    v_mfma_f32_16x16x32_bf16 a[28:31], a[76:79], a[148:151], a[28:31]
    s_cbranch_vccnz GG_SL4
GG_RT4:
    s_waitcnt lgkmcnt(8)
    v_mfma_f32_16x16x32_bf16 a[32:35], a[80:83], a[136:139], a[32:35]
    ds_read_b64_tr_b16 a[76:77], v243 offset:18464
    v_mfma_f32_16x16x32_bf16 a[36:39], a[80:83], a[140:143], a[36:39]
    ds_read_b64_tr_b16 a[78:79], v243 offset:20768
    v_mfma_f32_16x16x32_bf16 a[40:43], a[80:83], a[144:147], a[40:43]
    s_add_u32 m0, s29, 1024
    s_nop 0
    buffer_load_dwordx4 v227, s[24:27], s37 offen lds
    v_mfma_f32_16x16x32_bf16 a[44:47], a[80:83], a[148:151], a[44:47]
    s_waitcnt lgkmcnt(8)
    v_mfma_f32_16x16x32_bf16 a[48:51], a[84:87], a[136:139], a[48:51]
    ds_read_b64_tr_b16 a[80:81], v243 offset:64
    v_mfma_f32_16x16x32_bf16 a[52:55], a[84:87], a[140:143], a[52:55]
    ds_read_b64_tr_b16 a[82:83], v243 offset:2368
    v_mfma_f32_16x16x32_bf16 a[56:59], a[84:87], a[144:147], a[56:59]
    v_mfma_f32_16x16x32_bf16 a[60:63], a[84:87], a[148:151], a[60:63]
    s_waitcnt lgkmcnt(8)
    v_mfma_f32_16x16x32_bf16 v[0:3], a[64:67], a[152:155], v[0:3]
    ds_read_b64_tr_b16 a[84:85], v243 offset:18496
    v_mfma_f32_16x16x32_bf16 v[4:7], a[64:67], a[156:159], v[4:7]
    ds_read_b64_tr_b16 a[86:87], v243 offset:20800
    v_mfma_f32_16x16x32_bf16 v[8:11], a[64:67], a[160:163], v[8:11]
    s_add_u32 m0, s29, 2048
    s_nop 0
    buffer_load_dwordx4 v228, s[24:27], s37 offen lds
    v_mfma_f32_16x16x32_bf16 v[12:15], a[64:67], a[164:167], v[12:15]
    s_waitcnt lgkmcnt(8)
    v_mfma_f32_16x16x32_bf16 v[16:19], a[68:71], a[152:155], v[16:19]
    ds_read_b64_tr_b16 a[64:65], v243 offset:96
    v_mfma_f32_16x16x32_bf16 v[20:23], a[68:71], a[156:159], v[20:23]
    ds_read_b64_tr_b16 a[66:67], v243 offset:2400
    v_mfma_f32_16x16x32_bf16 v[24:27], a[68:71], a[160:163], v[24:27]
    s_add_u32 m0, s29, 3072
    s_nop 0
    buffer_load_dwordx4 v229, s[24:27], s37 offen lds
    v_mfma_f32_16x16x32_bf16 v[28:31], a[68:71], a[164:167], v[28:31]
    s_waitcnt lgkmcnt(8)
    v_mfma_f32_16x16x32_bf16 v[32:35], a[72:75], a[152:155], v[32:35]
    ds_read_b64_tr_b16 a[68:69], v243 offset:18528
    v_mfma_f32_16x16x32_bf16 v[36:39], a[72:75], a[156:159], v[36:39]
    ds_read_b64_tr_b16 a[70:71], v243 offset:20832
    v_mfma_f32_16x16x32_bf16 v[40:43], a[72:75], a[160:163], v[40:43]
    v_mfma_f32_16x16x32_bf16 v[44:47], a[72:75], a[164:167], v[44:47]
    s_waitcnt lgkmcnt(8)
    v_mfma_f32_16x16x32_bf16 v[48:51], a[76:79], a[152:155], v[48:51]
    ds_read_b64_tr_b16 a[72:73], v243 offset:128
    v_mfma_f32_16x16x32_bf16 v[52:55], a[76:79], a[156:159], v[52:55]
    ds_read_b64_tr_b16 a[74:75], v243 offset:2432
    v_mfma_f32_16x16x32_bf16 v[56:59], a[76:79], a[160:163], v[56:59]
    s_add_u32 m0, s29, 4096
    s_nop 0
    buffer_load_dwordx4 v230, s[24:27], s37 offen lds
    v_mfma_f32_16x16x32_bf16 v[60:63], a[76:79], a[164:167], v[60:63]
    s_waitcnt lgkmcnt(8)
    v_mfma_f32_16x16x32_bf16 v[64:67], a[80:83], a[152:155], v[64:67]
    ds_read_b64_tr_b16 a[76:77], v243 offset:18560
    v_mfma_f32_16x16x32_bf16 v[68:71], a[80:83], a[156:159], v[68:71]
    ds_read_b64_tr_b16 a[78:79], v243 offset:20864
    v_mfma_f32_16x16x32_bf16 v[72:75], a[80:83], a[160:163], v[72:75]
    s_add_u32 m0, s29, 5120
    s_nop 0
    buffer_load_dwordx4 v231, s[24:27], s37 offen lds
    v_mfma_f32_16x16x32_bf16 v[76:79], a[80:83], a[164:167], v[76:79]
    s_waitcnt lgkmcnt(8)
    v_mfma_f32_16x16x32_bf16 v[80:83], a[84:87], a[152:155], v[80:83]
    ds_read_b64_tr_b16 a[80:81], v243 offset:160
    v_mfma_f32_16x16x32_bf16 v[84:87], a[84:87], a[156:159], v[84:87]
    ds_read_b64_tr_b16 a[82:83], v243 offset:2464
    v_mfma_f32_16x16x32_bf16 v[88:91], a[84:87], a[160:163], v[88:91]
    v_mfma_f32_16x16x32_bf16 v[92:95], a[84:87], a[164:167], v[92:95]
    s_waitcnt lgkmcnt(8)
    v_mfma_f32_16x16x32_bf16 v[96:99], a[64:67], a[152:155], v[96:99]
    ds_read_b64_tr_b16 a[84:85], v243 offset:18592
    v_mfma_f32_16x16x32_bf16 v[100:103], a[64:67], a[156:159], v[100:103]
    ds_read_b64_tr_b16 a[86:87], v243 offset:20896
    v_mfma_f32_16x16x32_bf16 v[104:107], a[64:67], a[160:163], v[104:107]
    s_add_u32 m0, s29, 6144
    s_nop 0
    buffer_load_dwordx4 v232, s[24:27], s37 offen lds
    v_mfma_f32_16x16x32_bf16 v[108:111], a[64:67], a[164:167], v[108:111]
    s_waitcnt lgkmcnt(8)
    v_mfma_f32_16x16x32_bf16 v[112:115], a[68:71], a[152:155], v[112:115]
    ds_read_b64_tr_b16 a[64:65], v243 offset:192
    v_mfma_f32_16x16x32_bf16 v[116:119], a[68:71], a[156:159], v[116:119]
    ds_read_b64_tr_b16 a[66:67], v243 offset:2496
    v_mfma_f32_16x16x32_bf16 v[120:123], a[68:71], a[160:163], v[120:123]
    s_add_u32 m0, s29, 7168
    s_nop 0
    buffer_load_dwordx4 v233, s[24:27], s37 offen lds
    v_mfma_f32_16x16x32_bf16 v[124:127], a[68:71], a[164:167], v[124:127]
    s_waitcnt lgkmcnt(8)
    v_mfma_f32_16x16x32_bf16 v[128:131], a[72:75], a[152:155], v[128:131]
    ds_read_b64_tr_b16 a[68:69], v243 offset:18624
    v_mfma_f32_16x16x32_bf16 v[132:135], a[72:75], a[156:159], v[132:135]
    ds_read_b64_tr_b16 a[70:71], v243 offset:20928
    v_mfma_f32_16x16x32_bf16 v[136:139], a[72:75], a[160:163], v[136:139]
    v_mfma_f32_16x16x32_bf16 v[140:143], a[72:75], a[164:167], v[140:143]
    s_waitcnt lgkmcnt(8)
    v_mfma_f32_16x16x32_bf16 v[144:147], a[76:79], a[152:155], v[144:147]
    ds_read_b64_tr_b16 a[72:73], v243 offset:224
    v_mfma_f32_16x16x32_bf16 v[148:151], a[76:79], a[156:159], v[148:151]
    ds_read_b64_tr_b16 a[74:75], v243 offset:2528
    v_mfma_f32_16x16x32_bf16 v[152:155], a[76:79], a[160:163], v[152:155]
    s_add_u32 m0, s29, 8192
    s_nop 0
    buffer_load_dwordx4 v234, s[24:27], s37 offen lds
    v_mfma_f32_16x16x32_bf16 v[156:159], a[76:79], a[164:167], v[156:159]
    s_waitcnt lgkmcnt(8)
    v_mfma_f32_16x16x32_bf16 v[160:163], a[80:83], a[152:155], v[160:163]
    ds_read_b64_tr_b16 a[76:77], v243 offset:18656
    v_mfma_f32_16x16x32_bf16 v[164:167], a[80:83], a[156:159], v[164:167]
    ds_read_b64_tr_b16 a[78:79], v243 offset:20960
    v_mfma_f32_16x16x32_bf16 v[168:171], a[80:83], a[160:163], v[168:171]
    buffer_load_dwordx4 a[120:123], v237, s[8:11], s46 offen offset:1024 sc1
    v_mfma_f32_16x16x32_bf16 v[172:175], a[80:83], a[164:167], v[172:175]
    s_waitcnt lgkmcnt(8)
    v_mfma_f32_16x16x32_bf16 v[176:179], a[84:87], a[152:155], v[176:179]
    ds_read_b64_tr_b16 a[80:81], v243 offset:256
    v_mfma_f32_16x16x32_bf16 v[180:183], a[84:87], a[156:159], v[180:183]
    ds_read_b64_tr_b16 a[82:83], v243 offset:2560
    v_mfma_f32_16x16x32_bf16 v[184:187], a[84:87], a[160:163], v[184:187]
    v_mfma_f32_16x16x32_bf16 v[188:191], a[84:87], a[164:167], v[188:191]
    s_waitcnt vmcnt(31)
    s_waitcnt lgkmcnt(8)
    v_mfma_f32_16x16x32_bf16 v[192:195], a[64:67], a[152:155], v[192:195]
    ds_read_b64_tr_b16 a[84:85], v243 offset:18688
    v_accvgpr_read_b32 v250, a168
    v_mfma_f32_16x16x32_bf16 v[196:199], a[64:67], a[156:159], v[196:199]
    ds_read_b64_tr_b16 a[86:87], v243 offset:20992
    v_accvgpr_read_b32 v251, a172
    v_mfma_f32_16x16x32_bf16 v[200:203], a[64:67], a[160:163], v[200:203]
    buffer_load_dwordx4 a[124:127], v238, s[8:11], s46 offen offset:1024 sc1
    v_mfma_f32_16x16x32_bf16 v[204:207], a[64:67], a[164:167], v[204:207]
    v_accvgpr_read_b32 v252, a176
    v_accvgpr_read_b32 v253, a180
    s_waitcnt lgkmcnt(8)
    v_mfma_f32_16x16x32_bf16 v[208:211], a[68:71], a[152:155], v[208:211]
    ds_read_b64_tr_b16 a[64:65], v243 offset:9216
    v_max3_u32 v250, v250, v251, v252
    v_mfma_f32_16x16x32_bf16 v[212:215], a[68:71], a[156:159], v[212:215]
    ds_read_b64_tr_b16 a[66:67], v243 offset:11520
    v_max_u32 v250, v250, v253
    v_mfma_f32_16x16x32_bf16 v[216:219], a[68:71], a[160:163], v[216:219]
    buffer_load_dwordx4 a[128:131], v239, s[8:11], s46 offen offset:1024 sc1
    v_mfma_f32_16x16x32_bf16 v[220:223], a[68:71], a[164:167], v[220:223]
    v_cmp_eq_u32 vcc, -1, v250
    s_waitcnt lgkmcnt(8)
    v_mfma_f32_16x16x32_bf16 a[0:3], a[72:75], a[152:155], a[0:3]
    ds_read_b64_tr_b16 a[68:69], v243 offset:27648
    v_mfma_f32_16x16x32_bf16 a[4:7], a[72:75], a[156:159], a[4:7]
    ds_read_b64_tr_b16 a[70:71], v243 offset:29952
    v_mfma_f32_16x16x32_bf16 a[8:11], a[72:75], a[160:163], a[8:11]
    v_mfma_f32_16x16x32_bf16 a[12:15], a[72:75], a[164:167], a[12:15]
    s_waitcnt lgkmcnt(8)
    v_mfma_f32_16x16x32_bf16 a[16:19], a[76:79], a[152:155], a[16:19]
    ds_read_b64_tr_b16 a[72:73], v243 offset:9248
    v_mfma_f32_16x16x32_bf16 a[20:23], a[76:79], a[156:159], a[20:23]
    ds_read_b64_tr_b16 a[74:75], v243 offset:11552
    v_mfma_f32_16x16x32_bf16 a[24:27], a[76:79], a[160:163], a[24:27]
    buffer_load_dwordx4 a[132:135], v240, s[8:11], s46 offen offset:1024 sc1
    v_mfma_f32_16x16x32_bf16 a[28:31], a[76:79], a[164:167], a[28:31]
    s_cbranch_vccnz GG_SL5
GG_RT5:
    s_waitcnt lgkmcnt(8)
    v_mfma_f32_16x16x32_bf16 a[32:35], a[80:83], a[152:155], a[32:35]
    ds_read_b64_tr_b16 a[76:77], v243 offset:27680
    v_mfma_f32_16x16x32_bf16 a[36:39], a[80:83], a[156:159], a[36:39]
    ds_read_b64_tr_b16 a[78:79], v243 offset:29984
    v_mfma_f32_16x16x32_bf16 a[40:43], a[80:83], a[160:163], a[40:43]
    buffer_load_dwordx4 a[136:139], v237, s[8:11], s47 offen offset:0 sc1
    v_mfma_f32_16x16x32_bf16 a[44:47], a[80:83], a[164:167], a[44:47]
    s_waitcnt lgkmcnt(8)
    v_mfma_f32_16x16x32_bf16 a[48:51], a[84:87], a[152:155], a[48:51]
    ds_read_b64_tr_b16 a[80:81], v243 offset:9280
    v_mfma_f32_16x16x32_bf16 a[52:55], a[84:87], a[156:159], a[52:55]
    ds_read_b64_tr_b16 a[82:83], v243 offset:11584
    v_mfma_f32_16x16x32_bf16 a[56:59], a[84:87], a[160:163], a[56:59]
    v_mfma_f32_16x16x32_bf16 a[60:63], a[84:87], a[164:167], a[60:63]
    s_waitcnt lgkmcnt(8)
    v_mfma_f32_16x16x32_bf16 v[0:3], a[64:67], a[168:171], v[0:3]
    ds_read_b64_tr_b16 a[84:85], v243 offset:27712
    v_mfma_f32_16x16x32_bf16 v[4:7], a[64:67], a[172:175], v[4:7]
    ds_read_b64_tr_b16 a[86:87], v243 offset:30016
    v_mfma_f32_16x16x32_bf16 v[8:11], a[64:67], a[176:179], v[8:11]
    buffer_load_dwordx4 a[140:143], v238, s[8:11], s47 offen offset:0 sc1
    v_mfma_f32_16x16x32_bf16 v[12:15], a[64:67], a[180:183], v[12:15]
    s_waitcnt lgkmcnt(8)
    v_mfma_f32_16x16x32_bf16 v[16:19], a[68:71], a[168:171], v[16:19]
    ds_read_b64_tr_b16 a[64:65], v243 offset:9312
    v_mfma_f32_16x16x32_bf16 v[20:23], a[68:71], a[172:175], v[20:23]
    ds_read_b64_tr_b16 a[66:67], v243 offset:11616
    v_mfma_f32_16x16x32_bf16 v[24:27], a[68:71], a[176:179], v[24:27]
    buffer_load_dwordx4 a[144:147], v239, s[8:11], s47 offen offset:0 sc1
    v_mfma_f32_16x16x32_bf16 v[28:31], a[68:71], a[180:183], v[28:31]
    s_waitcnt lgkmcnt(8)
    v_mfma_f32_16x16x32_bf16 v[32:35], a[72:75], a[168:171], v[32:35]
    ds_read_b64_tr_b16 a[68:69], v243 offset:27744
    v_mfma_f32_16x16x32_bf16 v[36:39], a[72:75], a[172:175], v[36:39]
    ds_read_b64_tr_b16 a[70:71], v243 offset:30048
    v_mfma_f32_16x16x32_bf16 v[40:43], a[72:75], a[176:179], v[40:43]
    v_mfma_f32_16x16x32_bf16 v[44:47], a[72:75], a[180:183], v[44:47]
    s_waitcnt lgkmcnt(8)
    v_mfma_f32_16x16x32_bf16 v[48:51], a[76:79], a[168:171], v[48:51]
    ds_read_b64_tr_b16 a[72:73], v243 offset:9344
    v_mfma_f32_16x16x32_bf16 v[52:55], a[76:79], a[172:175], v[52:55]
    ds_read_b64_tr_b16 a[74:75], v243 offset:11648
    v_mfma_f32_16x16x32_bf16 v[56:59], a[76:79], a[176:179], v[56:59]
    buffer_load_dwordx4 a[148:151], v240, s[8:11], s47 offen offset:0 sc1
    v_mfma_f32_16x16x32_bf16 v[60:63], a[76:79], a[180:183], v[60:63]
    s_waitcnt lgkmcnt(8)
    v_mfma_f32_16x16x32_bf16 v[64:67], a[80:83], a[168:171], v[64:67]
    ds_read_b64_tr_b16 a[76:77], v243 offset:27776
    v_mfma_f32_16x16x32_bf16 v[68:71], a[80:83], a[172:175], v[68:71]
    ds_read_b64_tr_b16 a[78:79], v243 offset:30080
    v_mfma_f32_16x16x32_bf16 v[72:75], a[80:83], a[176:179], v[72:75]
    buffer_load_dwordx4 a[152:155], v237, s[8:11], s47 offen offset:1024 sc1
    v_mfma_f32_16x16x32_bf16 v[76:79], a[80:83], a[180:183], v[76:79]
    s_waitcnt lgkmcnt(8)
    v_mfma_f32_16x16x32_bf16 v[80:83], a[84:87], a[168:171], v[80:83]
    ds_read_b64_tr_b16 a[80:81], v243 offset:9376
    v_mfma_f32_16x16x32_bf16 v[84:87], a[84:87], a[172:175], v[84:87]
    ds_read_b64_tr_b16 a[82:83], v243 offset:11680
    v_mfma_f32_16x16x32_bf16 v[88:91], a[84:87], a[176:179], v[88:91]
    v_mfma_f32_16x16x32_bf16 v[92:95], a[84:87], a[180:183], v[92:95]
    s_waitcnt lgkmcnt(8)
    v_mfma_f32_16x16x32_bf16 v[96:99], a[64:67], a[168:171], v[96:99]
    ds_read_b64_tr_b16 a[84:85], v243 offset:27808
    v_mfma_f32_16x16x32_bf16 v[100:103], a[64:67], a[172:175], v[100:103]
    ds_read_b64_tr_b16 a[86:87], v243 offset:30112
    v_mfma_f32_16x16x32_bf16 v[104:107], a[64:67], a[176:179], v[104:107]
    buffer_load_dwordx4 a[156:159], v238, s[8:11], s47 offen offset:1024 sc1
    v_mfma_f32_16x16x32_bf16 v[108:111], a[64:67], a[180:183], v[108:111]
    s_waitcnt lgkmcnt(8)
    v_mfma_f32_16x16x32_bf16 v[112:115], a[68:71], a[168:171], v[112:115]
    ds_read_b64_tr_b16 a[64:65], v243 offset:9408
    v_mfma_f32_16x16x32_bf16 v[116:119], a[68:71], a[172:175], v[116:119]
    ds_read_b64_tr_b16 a[66:67], v243 offset:11712
    v_mfma_f32_16x16x32_bf16 v[120:123], a[68:71], a[176:179], v[120:123]
    buffer_load_dwordx4 a[160:163], v239, s[8:11], s47 offen offset:1024 sc1
    v_mfma_f32_16x16x32_bf16 v[124:127], a[68:71], a[180:183], v[124:127]
    s_waitcnt lgkmcnt(8)
    v_mfma_f32_16x16x32_bf16 v[128:131], a[72:75], a[168:171], v[128:131]
    ds_read_b64_tr_b16 a[68:69], v243 offset:27840
    v_mfma_f32_16x16x32_bf16 v[132:135], a[72:75], a[172:175], v[132:135]
    ds_read_b64_tr_b16 a[70:71], v243 offset:30144
    v_mfma_f32_16x16x32_bf16 v[136:139], a[72:75], a[176:179], v[136:139]
    v_mfma_f32_16x16x32_bf16 v[140:143], a[72:75], a[180:183], v[140:143]
    s_waitcnt lgkmcnt(8)
    v_mfma_f32_16x16x32_bf16 v[144:147], a[76:79], a[168:171], v[144:147]
    ds_read_b64_tr_b16 a[72:73], v243 offset:9440
    v_mfma_f32_16x16x32_bf16 v[148:151], a[76:79], a[172:175], v[148:151]
    ds_read_b64_tr_b16 a[74:75], v243 offset:11744
    v_mfma_f32_16x16x32_bf16 v[152:155], a[76:79], a[176:179], v[152:155]
    buffer_load_dwordx4 a[164:167], v240, s[8:11], s47 offen offset:1024 sc1
    v_mfma_f32_16x16x32_bf16 v[156:159], a[76:79], a[180:183], v[156:159]
    s_waitcnt lgkmcnt(8)
    v_mfma_f32_16x16x32_bf16 v[160:163], a[80:83], a[168:171], v[160:163]
    ds_read_b64_tr_b16 a[76:77], v243 offset:27872
    v_mfma_f32_16x16x32_bf16 v[164:167], a[80:83], a[172:175], v[164:167]
    ds_read_b64_tr_b16 a[78:79], v243 offset:30176
    v_mfma_f32_16x16x32_bf16 v[168:171], a[80:83], a[176:179], v[168:171]
    buffer_store_dwordx4 v[246:249], v237, s[8:11], s30 offen offset:0 sc1
    v_mfma_f32_16x16x32_bf16 v[172:175], a[80:83], a[180:183], v[172:175]
    s_waitcnt lgkmcnt(8)
    v_mfma_f32_16x16x32_bf16 v[176:179], a[84:87], a[168:171], v[176:179]
    ds_read_b64_tr_b16 a[80:81], v243 offset:9472
    v_mfma_f32_16x16x32_bf16 v[180:183], a[84:87], a[172:175], v[180:183]
    ds_read_b64_tr_b16 a[82:83], v243 offset:11776
    v_mfma_f32_16x16x32_bf16 v[184:187], a[84:87], a[176:179], v[184:187]
    v_mfma_f32_16x16x32_bf16 v[188:191], a[84:87], a[180:183], v[188:191]
    s_waitcnt vmcnt(39)
    s_waitcnt lgkmcnt(8)
    v_mfma_f32_16x16x32_bf16 v[192:195], a[64:67], a[168:171], v[192:195]
    ds_read_b64_tr_b16 a[84:85], v243 offset:27904
    v_accvgpr_read_b32 v250, a184
    v_mfma_f32_16x16x32_bf16 v[196:199], a[64:67], a[172:175], v[196:199]
    ds_read_b64_tr_b16 a[86:87], v243 offset:30208
    v_accvgpr_read_b32 v251, a188
    v_mfma_f32_16x16x32_bf16 v[200:203], a[64:67], a[176:179], v[200:203]
    buffer_store_dwordx4 v[246:249], v237, s[8:11], s30 offen offset:1024 sc1
    v_mfma_f32_16x16x32_bf16 v[204:207], a[64:67], a[180:183], v[204:207]
    v_accvgpr_read_b32 v252, a192
    v_accvgpr_read_b32 v253, a196
    s_waitcnt vmcnt(31)
    s_barrier
    s_waitcnt lgkmcnt(8)
    v_mfma_f32_16x16x32_bf16 v[208:211], a[68:71], a[168:171], v[208:211]
    ds_read_b64_tr_b16 a[64:65], v244 offset:0
    v_max3_u32 v250, v250, v251, v252
    v_mfma_f32_16x16x32_bf16 v[212:215], a[68:71], a[172:175], v[212:215]
    ds_read_b64_tr_b16 a[66:67], v244 offset:2304
    v_max_u32 v250, v250, v253
    v_mfma_f32_16x16x32_bf16 v[216:219], a[68:71], a[176:179], v[216:219]
    s_add_u32 m0, s29, 36864
    s_nop 0
    buffer_load_dwordx4 v226, s[24:27], s38 offen lds
    v_mfma_f32_16x16x32_bf16 v[220:223], a[68:71], a[180:183], v[220:223]
    v_cmp_eq_u32 vcc, -1, v250
    s_waitcnt lgkmcnt(8)
    v_mfma_f32_16x16x32_bf16 a[0:3], a[72:75], a[168:171], a[0:3]
    ds_read_b64_tr_b16 a[68:69], v244 offset:18432
    v_mfma_f32_16x16x32_bf16 a[4:7], a[72:75], a[172:175], a[4:7]
    ds_read_b64_tr_b16 a[70:71], v244 offset:20736
    v_mfma_f32_16x16x32_bf16 a[8:11], a[72:75], a[176:179], a[8:11]
    v_mfma_f32_16x16x32_bf16 a[12:15], a[72:75], a[180:183], a[12:15]
    s_waitcnt lgkmcnt(8)
    v_mfma_f32_16x16x32_bf16 a[16:19], a[76:79], a[168:171], a[16:19]
    ds_read_b64_tr_b16 a[72:73], v244 offset:32
    v_mfma_f32_16x16x32_bf16 a[20:23], a[76:79], a[172:175], a[20:23]
    ds_read_b64_tr_b16 a[74:75], v244 offset:2336
    v_mfma_f32_16x16x32_bf16 a[24:27], a[76:79], a[176:179], a[24:27]
    s_add_u32 m0, s29, 37888
    s_nop 0
    buffer_load_dwordx4 v227, s[24:27], s38 offen lds
    v_mfma_f32_16x16x32_bf16 a[28:31], a[76:79], a[180:183], a[28:31]
    s_cbranch_vccnz GG_SL6
GG_RT6:
    s_waitcnt lgkmcnt(8)
    v_mfma_f32_16x16x32_bf16 a[32:35], a[80:83], a[168:171], a[32:35]
    ds_read_b64_tr_b16 a[76:77], v244 offset:18464
    v_mfma_f32_16x16x32_bf16 a[36:39], a[80:83], a[172:175], a[36:39]
    ds_read_b64_tr_b16 a[78:79], v244 offset:20768
    v_mfma_f32_16x16x32_bf16 a[40:43], a[80:83], a[176:179], a[40:43]
    s_add_u32 m0, s29, 38912
    s_nop 0
    buffer_load_dwordx4 v228, s[24:27], s38 offen lds
    v_mfma_f32_16x16x32_bf16 a[44:47], a[80:83], a[180:183], a[44:47]
    s_waitcnt lgkmcnt(8)
    v_mfma_f32_16x16x32_bf16 a[48:51], a[84:87], a[168:171], a[48:51]
    ds_read_b64_tr_b16 a[80:81], v244 offset:64
    v_mfma_f32_16x16x32_bf16 a[52:55], a[84:87], a[172:175], a[52:55]
    ds_read_b64_tr_b16 a[82:83], v244 offset:2368
    v_mfma_f32_16x16x32_bf16 a[56:59], a[84:87], a[176:179], a[56:59]
    v_mfma_f32_16x16x32_bf16 a[60:63], a[84:87], a[180:183], a[60:63]
    s_waitcnt lgkmcnt(8)
    v_mfma_f32_16x16x32_bf16 v[0:3], a[64:67], a[184:187], v[0:3]
    ds_read_b64_tr_b16 a[84:85], v244 offset:18496
    v_mfma_f32_16x16x32_bf16 v[4:7], a[64:67], a[188:191], v[4:7]
    ds_read_b64_tr_b16 a[86:87], v244 offset:20800
    v_mfma_f32_16x16x32_bf16 v[8:11], a[64:67], a[192:195], v[8:11]
    s_add_u32 m0, s29, 39936
    s_nop 0
    buffer_load_dwordx4 v229, s[24:27], s38 offen lds
    v_mfma_f32_16x16x32_bf16 v[12:15], a[64:67], a[196:199], v[12:15]
    s_waitcnt lgkmcnt(8)
    v_mfma_f32_16x16x32_bf16 v[16:19], a[68:71], a[184:187], v[16:19]
    ds_read_b64_tr_b16 a[64:65], v244 offset:96
    v_mfma_f32_16x16x32_bf16 v[20:23], a[68:71], a[188:191], v[20:23]
    ds_read_b64_tr_b16 a[66:67], v244 offset:2400
    v_mfma_f32_16x16x32_bf16 v[24:27], a[68:71], a[192:195], v[24:27]
    s_add_u32 m0, s29, 40960
    s_nop 0
    buffer_load_dwordx4 v230, s[24:27], s38 offen lds
    v_mfma_f32_16x16x32_bf16 v[28:31], a[68:71], a[196:199], v[28:31]
    s_waitcnt lgkmcnt(8)
    v_mfma_f32_16x16x32_bf16 v[32:35], a[72:75], a[184:187], v[32:35]
    ds_read_b64_tr_b16 a[68:69], v244 offset:18528
    v_mfma_f32_16x16x32_bf16 v[36:39], a[72:75], a[188:191], v[36:39]
    ds_read_b64_tr_b16 a[70:71], v244 offset:20832
    v_mfma_f32_16x16x32_bf16 v[40:43], a[72:75], a[192:195], v[40:43]
    v_mfma_f32_16x16x32_bf16 v[44:47], a[72:75], a[196:199], v[44:47]
    s_waitcnt lgkmcnt(8)
    v_mfma_f32_16x16x32_bf16 v[48:51], a[76:79], a[184:187], v[48:51]
    ds_read_b64_tr_b16 a[72:73], v244 offset:128
    v_mfma_f32_16x16x32_bf16 v[52:55], a[76:79], a[188:191], v[52:55]
    ds_read_b64_tr_b16 a[74:75], v244 offset:2432
    v_mfma_f32_16x16x32_bf16 v[56:59], a[76:79], a[192:195], v[56:59]
    s_add_u32 m0, s29, 41984
    s_nop 0
    buffer_load_dwordx4 v231, s[24:27], s38 offen lds
    v_mfma_f32_16x16x32_bf16 v[60:63], a[76:79], a[196:199], v[60:63]
    s_waitcnt lgkmcnt(8)
    v_mfma_f32_16x16x32_bf16 v[64:67], a[80:83], a[184:187], v[64:67]
    ds_read_b64_tr_b16 a[76:77], v244 offset:18560
    v_mfma_f32_16x16x32_bf16 v[68:71], a[80:83], a[188:191], v[68:71]
    ds_read_b64_tr_b16 a[78:79], v244 offset:20864
    v_mfma_f32_16x16x32_bf16 v[72:75], a[80:83], a[192:195], v[72:75]
    s_add_u32 m0, s29, 43008
    s_nop 0
    buffer_load_dwordx4 v232, s[24:27], s38 offen lds
    v_mfma_f32_16x16x32_bf16 v[76:79], a[80:83], a[196:199], v[76:79]
    s_waitcnt lgkmcnt(8)
    v_mfma_f32_16x16x32_bf16 v[80:83], a[84:87], a[184:187], v[80:83]
    ds_read_b64_tr_b16 a[80:81], v244 offset:160
    v_mfma_f32_16x16x32_bf16 v[84:87], a[84:87], a[188:191], v[84:87]
    ds_read_b64_tr_b16 a[82:83], v244 offset:2464
    v_mfma_f32_16x16x32_bf16 v[88:91], a[84:87], a[192:195], v[88:91]
    v_mfma_f32_16x16x32_bf16 v[92:95], a[84:87], a[196:199], v[92:95]
    s_waitcnt lgkmcnt(8)
    v_mfma_f32_16x16x32_bf16 v[96:99], a[64:67], a[184:187], v[96:99]
    ds_read_b64_tr_b16 a[84:85], v244 offset:18592
    v_mfma_f32_16x16x32_bf16 v[100:103], a[64:67], a[188:191], v[100:103]
    ds_read_b64_tr_b16 a[86:87], v244 offset:20896
    v_mfma_f32_16x16x32_bf16 v[104:107], a[64:67], a[192:195], v[104:107]
    s_add_u32 m0, s29, 44032
    s_nop 0
    buffer_load_dwordx4 v233, s[24:27], s38 offen lds
    v_mfma_f32_16x16x32_bf16 v[108:111], a[64:67], a[196:199], v[108:111]
    s_waitcnt lgkmcnt(8)
    v_mfma_f32_16x16x32_bf16 v[112:115], a[68:71], a[184:187], v[112:115]
    ds_read_b64_tr_b16 a[64:65], v244 offset:192
    v_mfma_f32_16x16x32_bf16 v[116:119], a[68:71], a[188:191], v[116:119]
    ds_read_b64_tr_b16 a[66:67], v244 offset:2496
    v_mfma_f32_16x16x32_bf16 v[120:123], a[68:71], a[192:195], v[120:123]
    s_add_u32 m0, s29, 45056
    s_nop 0
    buffer_load_dwordx4 v234, s[24:27], s38 offen lds
    v_mfma_f32_16x16x32_bf16 v[124:127], a[68:71], a[196:199], v[124:127]
    s_waitcnt lgkmcnt(8)
    v_mfma_f32_16x16x32_bf16 v[128:131], a[72:75], a[184:187], v[128:131]
    ds_read_b64_tr_b16 a[68:69], v244 offset:18624
    v_mfma_f32_16x16x32_bf16 v[132:135], a[72:75], a[188:191], v[132:135]
    ds_read_b64_tr_b16 a[70:71], v244 offset:20928
    v_mfma_f32_16x16x32_bf16 v[136:139], a[72:75], a[192:195], v[136:139]
    v_mfma_f32_16x16x32_bf16 v[140:143], a[72:75], a[196:199], v[140:143]
    s_waitcnt lgkmcnt(8)
    v_mfma_f32_16x16x32_bf16 v[144:147], a[76:79], a[184:187], v[144:147]
    ds_read_b64_tr_b16 a[72:73], v244 offset:224
    v_mfma_f32_16x16x32_bf16 v[148:151], a[76:79], a[188:191], v[148:151]
    ds_read_b64_tr_b16 a[74:75], v244 offset:2528
    v_mfma_f32_16x16x32_bf16 v[152:155], a[76:79], a[192:195], v[152:155]
    buffer_load_dwordx4 a[168:171], v237, s[8:11], s48 offen offset:0 sc1
    v_mfma_f32_16x16x32_bf16 v[156:159], a[76:79], a[196:199], v[156:159]
    s_waitcnt lgkmcnt(8)
    v_mfma_f32_16x16x32_bf16 v[160:163], a[80:83], a[184:187], v[160:163]
    ds_read_b64_tr_b16 a[76:77], v244 offset:18656
    v_mfma_f32_16x16x32_bf16 v[164:167], a[80:83], a[188:191], v[164:167]
    ds_read_b64_tr_b16 a[78:79], v244 offset:20960
    v_mfma_f32_16x16x32_bf16 v[168:171], a[80:83], a[192:195], v[168:171]
    buffer_load_dwordx4 a[172:175], v238, s[8:11], s48 offen offset:0 sc1
    v_mfma_f32_16x16x32_bf16 v[172:175], a[80:83], a[196:199], v[172:175]
    s_waitcnt lgkmcnt(8)
    v_mfma_f32_16x16x32_bf16 v[176:179], a[84:87], a[184:187], v[176:179]
    ds_read_b64_tr_b16 a[80:81], v244 offset:256
    v_mfma_f32_16x16x32_bf16 v[180:183], a[84:87], a[188:191], v[180:183]
    ds_read_b64_tr_b16 a[82:83], v244 offset:2560
    v_mfma_f32_16x16x32_bf16 v[184:187], a[84:87], a[192:195], v[184:187]
    v_mfma_f32_16x16x32_bf16 v[188:191], a[84:87], a[196:199], v[188:191]
    s_waitcnt vmcnt(38)
    s_waitcnt lgkmcnt(8)
    v_mfma_f32_16x16x32_bf16 v[192:195], a[64:67], a[184:187], v[192:195]
    ds_read_b64_tr_b16 a[84:85], v244 offset:18688
    v_accvgpr_read_b32 v250, a88
    v_mfma_f32_16x16x32_bf16 v[196:199], a[64:67], a[188:191], v[196:199]
    ds_read_b64_tr_b16 a[86:87], v244 offset:20992
    v_accvgpr_read_b32 v251, a92
    v_mfma_f32_16x16x32_bf16 v[200:203], a[64:67], a[192:195], v[200:203]
    buffer_load_dwordx4 a[176:179], v239, s[8:11], s48 offen offset:0 sc1
    v_mfma_f32_16x16x32_bf16 v[204:207], a[64:67], a[196:199], v[204:207]
    v_accvgpr_read_b32 v252, a96
    v_accvgpr_read_b32 v253, a100
    s_waitcnt lgkmcnt(8)
    v_mfma_f32_16x16x32_bf16 v[208:211], a[68:71], a[184:187], v[208:211]
    ds_read_b64_tr_b16 a[64:65], v244 offset:9216
    v_max3_u32 v250, v250, v251, v252
    v_mfma_f32_16x16x32_bf16 v[212:215], a[68:71], a[188:191], v[212:215]
    ds_read_b64_tr_b16 a[66:67], v244 offset:11520
    v_max_u32 v250, v250, v253
    v_mfma_f32_16x16x32_bf16 v[216:219], a[68:71], a[192:195], v[216:219]
    buffer_load_dwordx4 a[180:183], v240, s[8:11], s48 offen offset:0 sc1
    v_mfma_f32_16x16x32_bf16 v[220:223], a[68:71], a[196:199], v[220:223]
    v_cmp_eq_u32 vcc, -1, v250
    s_waitcnt lgkmcnt(8)
    v_mfma_f32_16x16x32_bf16 a[0:3], a[72:75], a[184:187], a[0:3]
    ds_read_b64_tr_b16 a[68:69], v244 offset:27648
    v_mfma_f32_16x16x32_bf16 a[4:7], a[72:75], a[188:191], a[4:7]
    ds_read_b64_tr_b16 a[70:71], v244 offset:29952
    v_mfma_f32_16x16x32_bf16 a[8:11], a[72:75], a[192:195], a[8:11]
    v_mfma_f32_16x16x32_bf16 a[12:15], a[72:75], a[196:199], a[12:15]
    s_waitcnt lgkmcnt(8)
    v_mfma_f32_16x16x32_bf16 a[16:19], a[76:79], a[184:187], a[16:19]
    ds_read_b64_tr_b16 a[72:73], v244 offset:9248
    v_mfma_f32_16x16x32_bf16 a[20:23], a[76:79], a[188:191], a[20:23]
    ds_read_b64_tr_b16 a[74:75], v244 offset:11552
    v_mfma_f32_16x16x32_bf16 a[24:27], a[76:79], a[192:195], a[24:27]
    buffer_store_dwordx4 v[246:249], v237, s[8:11], s30 offen offset:2048 sc1
    v_mfma_f32_16x16x32_bf16 a[28:31], a[76:79], a[196:199], a[28:31]
    s_cbranch_vccnz GG_SL7
GG_RT7:
    s_waitcnt lgkmcnt(8)
    v_mfma_f32_16x16x32_bf16 a[32:35], a[80:83], a[184:187], a[32:35]
    ds_read_b64_tr_b16 a[76:77], v244 offset:27680
    v_mfma_f32_16x16x32_bf16 a[36:39], a[80:83], a[188:191], a[36:39]
    ds_read_b64_tr_b16 a[78:79], v244 offset:29984
    v_mfma_f32_16x16x32_bf16 a[40:43], a[80:83], a[192:195], a[40:43]
    buffer_store_dwordx4 v[246:249], v237, s[8:11], s30 offen offset:3072 sc1
    v_mfma_f32_16x16x32_bf16 a[44:47], a[80:83], a[196:199], a[44:47]
    s_waitcnt lgkmcnt(8)
    v_mfma_f32_16x16x32_bf16 a[48:51], a[84:87], a[184:187], a[48:51]
    ds_read_b64_tr_b16 a[80:81], v244 offset:9280
    v_mfma_f32_16x16x32_bf16 a[52:55], a[84:87], a[188:191], a[52:55]
    ds_read_b64_tr_b16 a[82:83], v244 offset:11584
    v_mfma_f32_16x16x32_bf16 a[56:59], a[84:87], a[192:195], a[56:59]
    v_mfma_f32_16x16x32_bf16 a[60:63], a[84:87], a[196:199], a[60:63]
    s_waitcnt lgkmcnt(8)
    v_mfma_f32_16x16x32_bf16 v[0:3], a[64:67], a[88:91], v[0:3]
    ds_read_b64_tr_b16 a[84:85], v244 offset:27712
    v_mfma_f32_16x16x32_bf16 v[4:7], a[64:67], a[92:95], v[4:7]
    ds_read_b64_tr_b16 a[86:87], v244 offset:30016
    v_mfma_f32_16x16x32_bf16 v[8:11], a[64:67], a[96:99], v[8:11]
    buffer_load_dwordx4 a[184:187], v237, s[8:11], s48 offen offset:1024 sc1
    v_mfma_f32_16x16x32_bf16 v[12:15], a[64:67], a[100:103], v[12:15]
    s_waitcnt lgkmcnt(8)
    v_mfma_f32_16x16x32_bf16 v[16:19], a[68:71], a[88:91], v[16:19]
    ds_read_b64_tr_b16 a[64:65], v244 offset:9312
    v_mfma_f32_16x16x32_bf16 v[20:23], a[68:71], a[92:95], v[20:23]
    ds_read_b64_tr_b16 a[66:67], v244 offset:11616
    v_mfma_f32_16x16x32_bf16 v[24:27], a[68:71], a[96:99], v[24:27]
    buffer_load_dwordx4 a[188:191], v238, s[8:11], s48 offen offset:1024 sc1
    v_mfma_f32_16x16x32_bf16 v[28:31], a[68:71], a[100:103], v[28:31]
    s_waitcnt lgkmcnt(8)
    v_mfma_f32_16x16x32_bf16 v[32:35], a[72:75], a[88:91], v[32:35]
    ds_read_b64_tr_b16 a[68:69], v244 offset:27744
    v_mfma_f32_16x16x32_bf16 v[36:39], a[72:75], a[92:95], v[36:39]
    ds_read_b64_tr_b16 a[70:71], v244 offset:30048
    v_mfma_f32_16x16x32_bf16 v[40:43], a[72:75], a[96:99], v[40:43]
    v_mfma_f32_16x16x32_bf16 v[44:47], a[72:75], a[100:103], v[44:47]
    s_waitcnt lgkmcnt(8)
    v_mfma_f32_16x16x32_bf16 v[48:51], a[76:79], a[88:91], v[48:51]
    ds_read_b64_tr_b16 a[72:73], v244 offset:9344
    v_mfma_f32_16x16x32_bf16 v[52:55], a[76:79], a[92:95], v[52:55]
    ds_read_b64_tr_b16 a[74:75], v244 offset:11648
    v_mfma_f32_16x16x32_bf16 v[56:59], a[76:79], a[96:99], v[56:59]
    buffer_load_dwordx4 a[192:195], v239, s[8:11], s48 offen offset:1024 sc1
    v_mfma_f32_16x16x32_bf16 v[60:63], a[76:79], a[100:103], v[60:63]
    s_waitcnt lgkmcnt(8)
    v_mfma_f32_16x16x32_bf16 v[64:67], a[80:83], a[88:91], v[64:67]
    ds_read_b64_tr_b16 a[76:77], v244 offset:27776
    v_mfma_f32_16x16x32_bf16 v[68:71], a[80:83], a[92:95], v[68:71]
    ds_read_b64_tr_b16 a[78:79], v244 offset:30080
    v_mfma_f32_16x16x32_bf16 v[72:75], a[80:83], a[96:99], v[72:75]
    buffer_load_dwordx4 a[196:199], v240, s[8:11], s48 offen offset:1024 sc1
    v_mfma_f32_16x16x32_bf16 v[76:79], a[80:83], a[100:103], v[76:79]
    s_waitcnt lgkmcnt(8)
    v_mfma_f32_16x16x32_bf16 v[80:83], a[84:87], a[88:91], v[80:83]
    ds_read_b64_tr_b16 a[80:81], v244 offset:9376
    v_mfma_f32_16x16x32_bf16 v[84:87], a[84:87], a[92:95], v[84:87]
    ds_read_b64_tr_b16 a[82:83], v244 offset:11680
    v_mfma_f32_16x16x32_bf16 v[88:91], a[84:87], a[96:99], v[88:91]
    v_mfma_f32_16x16x32_bf16 v[92:95], a[84:87], a[100:103], v[92:95]
    s_waitcnt lgkmcnt(8)
    v_mfma_f32_16x16x32_bf16 v[96:99], a[64:67], a[88:91], v[96:99]
    ds_read_b64_tr_b16 a[84:85], v244 offset:27808
    v_mfma_f32_16x16x32_bf16 v[100:103], a[64:67], a[92:95], v[100:103]
    ds_read_b64_tr_b16 a[86:87], v244 offset:30112
    v_mfma_f32_16x16x32_bf16 v[104:107], a[64:67], a[96:99], v[104:107]
    buffer_store_dwordx4 v[246:249], v237, s[8:11], s32 offen offset:0 sc1
    v_mfma_f32_16x16x32_bf16 v[108:111], a[64:67], a[100:103], v[108:111]
    s_waitcnt lgkmcnt(8)
    v_mfma_f32_16x16x32_bf16 v[112:115], a[68:71], a[88:91], v[112:115]
    ds_read_b64_tr_b16 a[64:65], v244 offset:9408
    v_mfma_f32_16x16x32_bf16 v[116:119], a[68:71], a[92:95], v[116:119]
    ds_read_b64_tr_b16 a[66:67], v244 offset:11712
    v_mfma_f32_16x16x32_bf16 v[120:123], a[68:71], a[96:99], v[120:123]
    v_mfma_f32_16x16x32_bf16 v[124:127], a[68:71], a[100:103], v[124:127]
    s_waitcnt lgkmcnt(8)
    v_mfma_f32_16x16x32_bf16 v[128:131], a[72:75], a[88:91], v[128:131]
    ds_read_b64_tr_b16 a[68:69], v244 offset:27840
    v_mfma_f32_16x16x32_bf16 v[132:135], a[72:75], a[92:95], v[132:135]
    ds_read_b64_tr_b16 a[70:71], v244 offset:30144
    v_mfma_f32_16x16x32_bf16 v[136:139], a[72:75], a[96:99], v[136:139]
    v_mfma_f32_16x16x32_bf16 v[140:143], a[72:75], a[100:103], v[140:143]
    s_waitcnt lgkmcnt(8)
    v_mfma_f32_16x16x32_bf16 v[144:147], a[76:79], a[88:91], v[144:147]
    ds_read_b64_tr_b16 a[72:73], v244 offset:9440
    v_mfma_f32_16x16x32_bf16 v[148:151], a[76:79], a[92:95], v[148:151]
    ds_read_b64_tr_b16 a[74:75], v244 offset:11744
    v_mfma_f32_16x16x32_bf16 v[152:155], a[76:79], a[96:99], v[152:155]
    v_mfma_f32_16x16x32_bf16 v[156:159], a[76:79], a[100:103], v[156:159]
    s_waitcnt lgkmcnt(8)
    v_mfma_f32_16x16x32_bf16 v[160:163], a[80:83], a[88:91], v[160:163]
    ds_read_b64_tr_b16 a[76:77], v244 offset:27872
    v_mfma_f32_16x16x32_bf16 v[164:167], a[80:83], a[92:95], v[164:167]
    ds_read_b64_tr_b16 a[78:79], v244 offset:30176
    v_mfma_f32_16x16x32_bf16 v[168:171], a[80:83], a[96:99], v[168:171]
    v_mfma_f32_16x16x32_bf16 v[172:175], a[80:83], a[100:103], v[172:175]
    s_waitcnt lgkmcnt(8)
    v_mfma_f32_16x16x32_bf16 v[176:179], a[84:87], a[88:91], v[176:179]
    ds_read_b64_tr_b16 a[80:81], v244 offset:9472
    v_mfma_f32_16x16x32_bf16 v[180:183], a[84:87], a[92:95], v[180:183]
    ds_read_b64_tr_b16 a[82:83], v244 offset:11776
    v_mfma_f32_16x16x32_bf16 v[184:187], a[84:87], a[96:99], v[184:187]
    v_mfma_f32_16x16x32_bf16 v[188:191], a[84:87], a[100:103], v[188:191]
    s_waitcnt vmcnt(43)
    s_waitcnt lgkmcnt(8)
    v_mfma_f32_16x16x32_bf16 v[192:195], a[64:67], a[88:91], v[192:195]
    ds_read_b64_tr_b16 a[84:85], v244 offset:27904
    v_accvgpr_read_b32 v250, a104
    v_mfma_f32_16x16x32_bf16 v[196:199], a[64:67], a[92:95], v[196:199]
    ds_read_b64_tr_b16 a[86:87], v244 offset:30208
    v_accvgpr_read_b32 v251, a108
    v_mfma_f32_16x16x32_bf16 v[200:203], a[64:67], a[96:99], v[200:203]
    v_accvgpr_read_b32 v252, a112
    v_accvgpr_read_b32 v253, a116
    v_mfma_f32_16x16x32_bf16 v[204:207], a[64:67], a[100:103], v[204:207]
    v_max3_u32 v250, v250, v251, v252
    v_max_u32 v250, v250, v253
    s_waitcnt vmcnt(34)
    s_barrier
    s_waitcnt lgkmcnt(8)
    v_mfma_f32_16x16x32_bf16 v[208:211], a[68:71], a[88:91], v[208:211]
    ds_read_b64_tr_b16 a[64:65], v241 offset:0
    v_cmp_eq_u32 vcc, -1, v250
    v_mfma_f32_16x16x32_bf16 v[212:215], a[68:71], a[92:95], v[212:215]
    ds_read_b64_tr_b16 a[66:67], v241 offset:2304
    v_mfma_f32_16x16x32_bf16 v[216:219], a[68:71], a[96:99], v[216:219]
    s_add_u32 m0, s29, 73728
    s_nop 0
    buffer_load_dwordx4 v226, s[24:27], s39 offen lds
    v_mfma_f32_16x16x32_bf16 v[220:223], a[68:71], a[100:103], v[220:223]
    s_waitcnt lgkmcnt(8)
    v_mfma_f32_16x16x32_bf16 a[0:3], a[72:75], a[88:91], a[0:3]
    ds_read_b64_tr_b16 a[68:69], v241 offset:18432
    v_mfma_f32_16x16x32_bf16 a[4:7], a[72:75], a[92:95], a[4:7]
    ds_read_b64_tr_b16 a[70:71], v241 offset:20736
    v_mfma_f32_16x16x32_bf16 a[8:11], a[72:75], a[96:99], a[8:11]
    v_mfma_f32_16x16x32_bf16 a[12:15], a[72:75], a[100:103], a[12:15]
    s_waitcnt lgkmcnt(8)
    v_mfma_f32_16x16x32_bf16 a[16:19], a[76:79], a[88:91], a[16:19]
    ds_read_b64_tr_b16 a[72:73], v241 offset:32
    v_mfma_f32_16x16x32_bf16 a[20:23], a[76:79], a[92:95], a[20:23]
    ds_read_b64_tr_b16 a[74:75], v241 offset:2336
    v_mfma_f32_16x16x32_bf16 a[24:27], a[76:79], a[96:99], a[24:27]
    s_add_u32 m0, s29, 74752
    s_nop 0
    buffer_load_dwordx4 v227, s[24:27], s39 offen lds
    v_mfma_f32_16x16x32_bf16 a[28:31], a[76:79], a[100:103], a[28:31]
    s_cbranch_vccnz GG_SL8
GG_RT8:
    s_waitcnt lgkmcnt(8)
    v_mfma_f32_16x16x32_bf16 a[32:35], a[80:83], a[88:91], a[32:35]
    ds_read_b64_tr_b16 a[76:77], v241 offset:18464
    v_mfma_f32_16x16x32_bf16 a[36:39], a[80:83], a[92:95], a[36:39]
    ds_read_b64_tr_b16 a[78:79], v241 offset:20768
    v_mfma_f32_16x16x32_bf16 a[40:43], a[80:83], a[96:99], a[40:43]
    s_add_u32 m0, s29, 75776
    s_nop 0
    buffer_load_dwordx4 v228, s[24:27], s39 offen lds
    v_mfma_f32_16x16x32_bf16 a[44:47], a[80:83], a[100:103], a[44:47]
    s_waitcnt lgkmcnt(8)
    v_mfma_f32_16x16x32_bf16 a[48:51], a[84:87], a[88:91], a[48:51]
    ds_read_b64_tr_b16 a[80:81], v241 offset:64
    v_mfma_f32_16x16x32_bf16 a[52:55], a[84:87], a[92:95], a[52:55]
    ds_read_b64_tr_b16 a[82:83], v241 offset:2368
    v_mfma_f32_16x16x32_bf16 a[56:59], a[84:87], a[96:99], a[56:59]
    v_mfma_f32_16x16x32_bf16 a[60:63], a[84:87], a[100:103], a[60:63]
    s_waitcnt lgkmcnt(8)
    v_mfma_f32_16x16x32_bf16 v[0:3], a[64:67], a[104:107], v[0:3]
    ds_read_b64_tr_b16 a[84:85], v241 offset:18496
    v_mfma_f32_16x16x32_bf16 v[4:7], a[64:67], a[108:111], v[4:7]
    ds_read_b64_tr_b16 a[86:87], v241 offset:20800
    v_mfma_f32_16x16x32_bf16 v[8:11], a[64:67], a[112:115], v[8:11]
    s_add_u32 m0, s29, 76800
    s_nop 0
    buffer_load_dwordx4 v229, s[24:27], s39 offen lds
    v_mfma_f32_16x16x32_bf16 v[12:15], a[64:67], a[116:119], v[12:15]
    s_waitcnt lgkmcnt(8)
    v_mfma_f32_16x16x32_bf16 v[16:19], a[68:71], a[104:107], v[16:19]
    ds_read_b64_tr_b16 a[64:65], v241 offset:96
    v_mfma_f32_16x16x32_bf16 v[20:23], a[68:71], a[108:111], v[20:23]
    ds_read_b64_tr_b16 a[66:67], v241 offset:2400
    v_mfma_f32_16x16x32_bf16 v[24:27], a[68:71], a[112:115], v[24:27]
    s_add_u32 m0, s29, 77824
    s_nop 0
    buffer_load_dwordx4 v230, s[24:27], s39 offen lds
    v_mfma_f32_16x16x32_bf16 v[28:31], a[68:71], a[116:119], v[28:31]
    s_waitcnt lgkmcnt(8)
    v_mfma_f32_16x16x32_bf16 v[32:35], a[72:75], a[104:107], v[32:35]
    ds_read_b64_tr_b16 a[68:69], v241 offset:18528
    v_mfma_f32_16x16x32_bf16 v[36:39], a[72:75], a[108:111], v[36:39]
    ds_read_b64_tr_b16 a[70:71], v241 offset:20832
    v_mfma_f32_16x16x32_bf16 v[40:43], a[72:75], a[112:115], v[40:43]
    v_mfma_f32_16x16x32_bf16 v[44:47], a[72:75], a[116:119], v[44:47]
    s_waitcnt lgkmcnt(8)
    v_mfma_f32_16x16x32_bf16 v[48:51], a[76:79], a[104:107], v[48:51]
    ds_read_b64_tr_b16 a[72:73], v241 offset:128
    v_mfma_f32_16x16x32_bf16 v[52:55], a[76:79], a[108:111], v[52:55]
    ds_read_b64_tr_b16 a[74:75], v241 offset:2432
    v_mfma_f32_16x16x32_bf16 v[56:59], a[76:79], a[112:115], v[56:59]
    s_add_u32 m0, s29, 78848
    s_nop 0
    buffer_load_dwordx4 v231, s[24:27], s39 offen lds
    v_mfma_f32_16x16x32_bf16 v[60:63], a[76:79], a[116:119], v[60:63]
    s_waitcnt lgkmcnt(8)
    v_mfma_f32_16x16x32_bf16 v[64:67], a[80:83], a[104:107], v[64:67]
    ds_read_b64_tr_b16 a[76:77], v241 offset:18560
    v_mfma_f32_16x16x32_bf16 v[68:71], a[80:83], a[108:111], v[68:71]
    ds_read_b64_tr_b16 a[78:79], v241 offset:20864
    v_mfma_f32_16x16x32_bf16 v[72:75], a[80:83], a[112:115], v[72:75]
    s_add_u32 m0, s29, 79872
    s_nop 0
    buffer_load_dwordx4 v232, s[24:27], s39 offen lds
    v_mfma_f32_16x16x32_bf16 v[76:79], a[80:83], a[116:119], v[76:79]
    s_waitcnt lgkmcnt(8)
    v_mfma_f32_16x16x32_bf16 v[80:83], a[84:87], a[104:107], v[80:83]
    ds_read_b64_tr_b16 a[80:81], v241 offset:160
    v_mfma_f32_16x16x32_bf16 v[84:87], a[84:87], a[108:111], v[84:87]
    ds_read_b64_tr_b16 a[82:83], v241 offset:2464
    v_mfma_f32_16x16x32_bf16 v[88:91], a[84:87], a[112:115], v[88:91]
    v_mfma_f32_16x16x32_bf16 v[92:95], a[84:87], a[116:119], v[92:95]
    s_waitcnt lgkmcnt(8)
    v_mfma_f32_16x16x32_bf16 v[96:99], a[64:67], a[104:107], v[96:99]
    ds_read_b64_tr_b16 a[84:85], v241 offset:18592
    v_mfma_f32_16x16x32_bf16 v[100:103], a[64:67], a[108:111], v[100:103]
    ds_read_b64_tr_b16 a[86:87], v241 offset:20896
    v_mfma_f32_16x16x32_bf16 v[104:107], a[64:67], a[112:115], v[104:107]
    s_add_u32 m0, s29, 80896
    s_nop 0
    buffer_load_dwordx4 v233, s[24:27], s39 offen lds
    v_mfma_f32_16x16x32_bf16 v[108:111], a[64:67], a[116:119], v[108:111]
    s_waitcnt lgkmcnt(8)
    v_mfma_f32_16x16x32_bf16 v[112:115], a[68:71], a[104:107], v[112:115]
    ds_read_b64_tr_b16 a[64:65], v241 offset:192
    v_mfma_f32_16x16x32_bf16 v[116:119], a[68:71], a[108:111], v[116:119]
    ds_read_b64_tr_b16 a[66:67], v241 offset:2496
    v_mfma_f32_16x16x32_bf16 v[120:123], a[68:71], a[112:115], v[120:123]
    s_add_u32 m0, s29, 81920
    s_nop 0
    buffer_load_dwordx4 v234, s[24:27], s39 offen lds
    v_mfma_f32_16x16x32_bf16 v[124:127], a[68:71], a[116:119], v[124:127]
    s_waitcnt lgkmcnt(8)
    v_mfma_f32_16x16x32_bf16 v[128:131], a[72:75], a[104:107], v[128:131]
    ds_read_b64_tr_b16 a[68:69], v241 offset:18624
    v_mfma_f32_16x16x32_bf16 v[132:135], a[72:75], a[108:111], v[132:135]
    ds_read_b64_tr_b16 a[70:71], v241 offset:20928
    v_mfma_f32_16x16x32_bf16 v[136:139], a[72:75], a[112:115], v[136:139]
    v_mfma_f32_16x16x32_bf16 v[140:143], a[72:75], a[116:119], v[140:143]
    s_waitcnt lgkmcnt(8)
    v_mfma_f32_16x16x32_bf16 v[144:147], a[76:79], a[104:107], v[144:147]
    ds_read_b64_tr_b16 a[72:73], v241 offset:224
    v_mfma_f32_16x16x32_bf16 v[148:151], a[76:79], a[108:111], v[148:151]
    ds_read_b64_tr_b16 a[74:75], v241 offset:2528
    v_mfma_f32_16x16x32_bf16 v[152:155], a[76:79], a[112:115], v[152:155]
    buffer_load_dwordx4 a[88:91], v237, s[8:11], s49 offen offset:0 sc1
    v_mfma_f32_16x16x32_bf16 v[156:159], a[76:79], a[116:119], v[156:159]
    s_waitcnt lgkmcnt(8)
    v_mfma_f32_16x16x32_bf16 v[160:163], a[80:83], a[104:107], v[160:163]
    ds_read_b64_tr_b16 a[76:77], v241 offset:18656
    v_mfma_f32_16x16x32_bf16 v[164:167], a[80:83], a[108:111], v[164:167]
    ds_read_b64_tr_b16 a[78:79], v241 offset:20960
    v_mfma_f32_16x16x32_bf16 v[168:171], a[80:83], a[112:115], v[168:171]
    buffer_load_dwordx4 a[92:95], v238, s[8:11], s49 offen offset:0 sc1
    v_mfma_f32_16x16x32_bf16 v[172:175], a[80:83], a[116:119], v[172:175]
    s_waitcnt lgkmcnt(8)
    v_mfma_f32_16x16x32_bf16 v[176:179], a[84:87], a[104:107], v[176:179]
    ds_read_b64_tr_b16 a[80:81], v241 offset:256
    v_mfma_f32_16x16x32_bf16 v[180:183], a[84:87], a[108:111], v[180:183]
    ds_read_b64_tr_b16 a[82:83], v241 offset:2560
    v_mfma_f32_16x16x32_bf16 v[184:187], a[84:87], a[112:115], v[184:187]
    v_mfma_f32_16x16x32_bf16 v[188:191], a[84:87], a[116:119], v[188:191]
    s_waitcnt vmcnt(41)
    s_waitcnt lgkmcnt(8)
    v_mfma_f32_16x16x32_bf16 v[192:195], a[64:67], a[104:107], v[192:195]
    ds_read_b64_tr_b16 a[84:85], v241 offset:18688
    v_accvgpr_read_b32 v250, a120
    v_mfma_f32_16x16x32_bf16 v[196:199], a[64:67], a[108:111], v[196:199]
    ds_read_b64_tr_b16 a[86:87], v241 offset:20992
    v_accvgpr_read_b32 v251, a124
    v_mfma_f32_16x16x32_bf16 v[200:203], a[64:67], a[112:115], v[200:203]
    buffer_load_dwordx4 a[96:99], v239, s[8:11], s49 offen offset:0 sc1
    v_mfma_f32_16x16x32_bf16 v[204:207], a[64:67], a[116:119], v[204:207]
    v_accvgpr_read_b32 v252, a128
    v_accvgpr_read_b32 v253, a132
    s_waitcnt lgkmcnt(8)
    v_mfma_f32_16x16x32_bf16 v[208:211], a[68:71], a[104:107], v[208:211]
    ds_read_b64_tr_b16 a[64:65], v241 offset:9216
    v_max3_u32 v250, v250, v251, v252
    v_mfma_f32_16x16x32_bf16 v[212:215], a[68:71], a[108:111], v[212:215]
    ds_read_b64_tr_b16 a[66:67], v241 offset:11520
    v_max_u32 v250, v250, v253
    v_mfma_f32_16x16x32_bf16 v[216:219], a[68:71], a[112:115], v[216:219]
    buffer_load_dwordx4 a[100:103], v240, s[8:11], s49 offen offset:0 sc1
    v_mfma_f32_16x16x32_bf16 v[220:223], a[68:71], a[116:119], v[220:223]
    v_cmp_eq_u32 vcc, -1, v250
    s_waitcnt lgkmcnt(8)
    v_mfma_f32_16x16x32_bf16 a[0:3], a[72:75], a[104:107], a[0:3]
    ds_read_b64_tr_b16 a[68:69], v241 offset:27648
    v_mfma_f32_16x16x32_bf16 a[4:7], a[72:75], a[108:111], a[4:7]
    ds_read_b64_tr_b16 a[70:71], v241 offset:29952
    v_mfma_f32_16x16x32_bf16 a[8:11], a[72:75], a[112:115], a[8:11]
    v_mfma_f32_16x16x32_bf16 a[12:15], a[72:75], a[116:119], a[12:15]
    s_waitcnt lgkmcnt(8)
    v_mfma_f32_16x16x32_bf16 a[16:19], a[76:79], a[104:107], a[16:19]
    ds_read_b64_tr_b16 a[72:73], v241 offset:9248
    v_mfma_f32_16x16x32_bf16 a[20:23], a[76:79], a[108:111], a[20:23]
    ds_read_b64_tr_b16 a[74:75], v241 offset:11552
    v_mfma_f32_16x16x32_bf16 a[24:27], a[76:79], a[112:115], a[24:27]
    buffer_store_dwordx4 v[246:249], v237, s[8:11], s32 offen offset:1024 sc1
    v_mfma_f32_16x16x32_bf16 a[28:31], a[76:79], a[116:119], a[28:31]
    s_cbranch_vccnz GG_SL9
GG_RT9:
    s_waitcnt lgkmcnt(8)
    v_mfma_f32_16x16x32_bf16 a[32:35], a[80:83], a[104:107], a[32:35]
    ds_read_b64_tr_b16 a[76:77], v241 offset:27680
    v_mfma_f32_16x16x32_bf16 a[36:39], a[80:83], a[108:111], a[36:39]
    ds_read_b64_tr_b16 a[78:79], v241 offset:29984
    v_mfma_f32_16x16x32_bf16 a[40:43], a[80:83], a[112:115], a[40:43]
    v_mfma_f32_16x16x32_bf16 a[44:47], a[80:83], a[116:119], a[44:47]
    s_waitcnt lgkmcnt(8)
    v_mfma_f32_16x16x32_bf16 a[48:51], a[84:87], a[104:107], a[48:51]
    ds_read_b64_tr_b16 a[80:81], v241 offset:9280
    v_mfma_f32_16x16x32_bf16 a[52:55], a[84:87], a[108:111], a[52:55]
    ds_read_b64_tr_b16 a[82:83], v241 offset:11584
    v_mfma_f32_16x16x32_bf16 a[56:59], a[84:87], a[112:115], a[56:59]
    v_mfma_f32_16x16x32_bf16 a[60:63], a[84:87], a[116:119], a[60:63]
    s_waitcnt lgkmcnt(8)
    v_mfma_f32_16x16x32_bf16 v[0:3], a[64:67], a[120:123], v[0:3]
    ds_read_b64_tr_b16 a[84:85], v241 offset:27712
    v_mfma_f32_16x16x32_bf16 v[4:7], a[64:67], a[124:127], v[4:7]
    ds_read_b64_tr_b16 a[86:87], v241 offset:30016
    v_mfma_f32_16x16x32_bf16 v[8:11], a[64:67], a[128:131], v[8:11]
    buffer_load_dwordx4 a[104:107], v237, s[8:11], s49 offen offset:1024 sc1
    v_mfma_f32_16x16x32_bf16 v[12:15], a[64:67], a[132:135], v[12:15]
    s_waitcnt lgkmcnt(8)
    v_mfma_f32_16x16x32_bf16 v[16:19], a[68:71], a[120:123], v[16:19]
    ds_read_b64_tr_b16 a[64:65], v241 offset:9312
    v_mfma_f32_16x16x32_bf16 v[20:23], a[68:71], a[124:127], v[20:23]
    ds_read_b64_tr_b16 a[66:67], v241 offset:11616
    v_mfma_f32_16x16x32_bf16 v[24:27], a[68:71], a[128:131], v[24:27]
    buffer_load_dwordx4 a[108:111], v238, s[8:11], s49 offen offset:1024 sc1
    v_mfma_f32_16x16x32_bf16 v[28:31], a[68:71], a[132:135], v[28:31]
    s_waitcnt lgkmcnt(8)
    v_mfma_f32_16x16x32_bf16 v[32:35], a[72:75], a[120:123], v[32:35]
    ds_read_b64_tr_b16 a[68:69], v241 offset:27744
    v_mfma_f32_16x16x32_bf16 v[36:39], a[72:75], a[124:127], v[36:39]
    ds_read_b64_tr_b16 a[70:71], v241 offset:30048
    v_mfma_f32_16x16x32_bf16 v[40:43], a[72:75], a[128:131], v[40:43]
    v_mfma_f32_16x16x32_bf16 v[44:47], a[72:75], a[132:135], v[44:47]
    s_waitcnt lgkmcnt(8)
    v_mfma_f32_16x16x32_bf16 v[48:51], a[76:79], a[120:123], v[48:51]
    ds_read_b64_tr_b16 a[72:73], v241 offset:9344
    v_mfma_f32_16x16x32_bf16 v[52:55], a[76:79], a[124:127], v[52:55]
    ds_read_b64_tr_b16 a[74:75], v241 offset:11648
    v_mfma_f32_16x16x32_bf16 v[56:59], a[76:79], a[128:131], v[56:59]
    buffer_load_dwordx4 a[112:115], v239, s[8:11], s49 offen offset:1024 sc1
    v_mfma_f32_16x16x32_bf16 v[60:63], a[76:79], a[132:135], v[60:63]
    s_waitcnt lgkmcnt(8)
    v_mfma_f32_16x16x32_bf16 v[64:67], a[80:83], a[120:123], v[64:67]
    ds_read_b64_tr_b16 a[76:77], v241 offset:27776
    v_mfma_f32_16x16x32_bf16 v[68:71], a[80:83], a[124:127], v[68:71]
    ds_read_b64_tr_b16 a[78:79], v241 offset:30080
    v_mfma_f32_16x16x32_bf16 v[72:75], a[80:83], a[128:131], v[72:75]
    buffer_load_dwordx4 a[116:119], v240, s[8:11], s49 offen offset:1024 sc1
    v_mfma_f32_16x16x32_bf16 v[76:79], a[80:83], a[132:135], v[76:79]
    s_waitcnt lgkmcnt(8)
    v_mfma_f32_16x16x32_bf16 v[80:83], a[84:87], a[120:123], v[80:83]
    ds_read_b64_tr_b16 a[80:81], v241 offset:9376
    v_mfma_f32_16x16x32_bf16 v[84:87], a[84:87], a[124:127], v[84:87]
    ds_read_b64_tr_b16 a[82:83], v241 offset:11680
    v_mfma_f32_16x16x32_bf16 v[88:91], a[84:87], a[128:131], v[88:91]
    v_mfma_f32_16x16x32_bf16 v[92:95], a[84:87], a[132:135], v[92:95]
    s_waitcnt lgkmcnt(8)
    v_mfma_f32_16x16x32_bf16 v[96:99], a[64:67], a[120:123], v[96:99]
    ds_read_b64_tr_b16 a[84:85], v241 offset:27808
    v_mfma_f32_16x16x32_bf16 v[100:103], a[64:67], a[124:127], v[100:103]
    ds_read_b64_tr_b16 a[86:87], v241 offset:30112
    v_mfma_f32_16x16x32_bf16 v[104:107], a[64:67], a[128:131], v[104:107]
    v_mfma_f32_16x16x32_bf16 v[108:111], a[64:67], a[132:135], v[108:111]
    s_waitcnt lgkmcnt(8)
    v_mfma_f32_16x16x32_bf16 v[112:115], a[68:71], a[120:123], v[112:115]
    ds_read_b64_tr_b16 a[64:65], v241 offset:9408
    v_mfma_f32_16x16x32_bf16 v[116:119], a[68:71], a[124:127], v[116:119]
    ds_read_b64_tr_b16 a[66:67], v241 offset:11712
    v_mfma_f32_16x16x32_bf16 v[120:123], a[68:71], a[128:131], v[120:123]
    v_mfma_f32_16x16x32_bf16 v[124:127], a[68:71], a[132:135], v[124:127]
    s_waitcnt lgkmcnt(8)
    v_mfma_f32_16x16x32_bf16 v[128:131], a[72:75], a[120:123], v[128:131]
    ds_read_b64_tr_b16 a[68:69], v241 offset:27840
    v_mfma_f32_16x16x32_bf16 v[132:135], a[72:75], a[124:127], v[132:135]
    ds_read_b64_tr_b16 a[70:71], v241 offset:30144
    v_mfma_f32_16x16x32_bf16 v[136:139], a[72:75], a[128:131], v[136:139]
    v_mfma_f32_16x16x32_bf16 v[140:143], a[72:75], a[132:135], v[140:143]
    s_waitcnt lgkmcnt(8)
    v_mfma_f32_16x16x32_bf16 v[144:147], a[76:79], a[120:123], v[144:147]
    ds_read_b64_tr_b16 a[72:73], v241 offset:9440
    v_mfma_f32_16x16x32_bf16 v[148:151], a[76:79], a[124:127], v[148:151]
    ds_read_b64_tr_b16 a[74:75], v241 offset:11744
    v_mfma_f32_16x16x32_bf16 v[152:155], a[76:79], a[128:131], v[152:155]
    v_mfma_f32_16x16x32_bf16 v[156:159], a[76:79], a[132:135], v[156:159]
    s_waitcnt lgkmcnt(8)
    v_mfma_f32_16x16x32_bf16 v[160:163], a[80:83], a[120:123], v[160:163]
    ds_read_b64_tr_b16 a[76:77], v241 offset:27872
    v_mfma_f32_16x16x32_bf16 v[164:167], a[80:83], a[124:127], v[164:167]
    ds_read_b64_tr_b16 a[78:79], v241 offset:30176
    v_mfma_f32_16x16x32_bf16 v[168:171], a[80:83], a[128:131], v[168:171]
    buffer_store_dwordx4 v[246:249], v237, s[8:11], s32 offen offset:2048 sc1
    v_mfma_f32_16x16x32_bf16 v[172:175], a[80:83], a[132:135], v[172:175]
    s_waitcnt lgkmcnt(8)
    v_mfma_f32_16x16x32_bf16 v[176:179], a[84:87], a[120:123], v[176:179]
    ds_read_b64_tr_b16 a[80:81], v241 offset:9472
    v_mfma_f32_16x16x32_bf16 v[180:183], a[84:87], a[124:127], v[180:183]
    ds_read_b64_tr_b16 a[82:83], v241 offset:11776
    v_mfma_f32_16x16x32_bf16 v[184:187], a[84:87], a[128:131], v[184:187]
    v_mfma_f32_16x16x32_bf16 v[188:191], a[84:87], a[132:135], v[188:191]
    s_waitcnt vmcnt(45)
    s_waitcnt lgkmcnt(8)
    v_mfma_f32_16x16x32_bf16 v[192:195], a[64:67], a[120:123], v[192:195]
    ds_read_b64_tr_b16 a[84:85], v241 offset:27904
    v_accvgpr_read_b32 v250, a136
    v_mfma_f32_16x16x32_bf16 v[196:199], a[64:67], a[124:127], v[196:199]
    ds_read_b64_tr_b16 a[86:87], v241 offset:30208
    v_accvgpr_read_b32 v251, a140
    v_mfma_f32_16x16x32_bf16 v[200:203], a[64:67], a[128:131], v[200:203]
    v_accvgpr_read_b32 v252, a144
    v_accvgpr_read_b32 v253, a148
    v_mfma_f32_16x16x32_bf16 v[204:207], a[64:67], a[132:135], v[204:207]
    v_max3_u32 v250, v250, v251, v252
    v_max_u32 v250, v250, v253
    s_waitcnt vmcnt(30)
    s_barrier
    s_waitcnt lgkmcnt(8)
    v_mfma_f32_16x16x32_bf16 v[208:211], a[68:71], a[120:123], v[208:211]
    ds_read_b64_tr_b16 a[64:65], v242 offset:0
    v_cmp_eq_u32 vcc, -1, v250
    v_mfma_f32_16x16x32_bf16 v[212:215], a[68:71], a[124:127], v[212:215]
    ds_read_b64_tr_b16 a[66:67], v242 offset:2304
    v_mfma_f32_16x16x32_bf16 v[216:219], a[68:71], a[128:131], v[216:219]
    s_add_u32 m0, s29, 110592
    s_nop 0
    buffer_load_dwordx4 v226, s[24:27], s40 offen lds
    v_mfma_f32_16x16x32_bf16 v[220:223], a[68:71], a[132:135], v[220:223]
    s_waitcnt lgkmcnt(8)
    v_mfma_f32_16x16x32_bf16 a[0:3], a[72:75], a[120:123], a[0:3]
    ds_read_b64_tr_b16 a[68:69], v242 offset:18432
    v_mfma_f32_16x16x32_bf16 a[4:7], a[72:75], a[124:127], a[4:7]
    ds_read_b64_tr_b16 a[70:71], v242 offset:20736
    v_mfma_f32_16x16x32_bf16 a[8:11], a[72:75], a[128:131], a[8:11]
    v_mfma_f32_16x16x32_bf16 a[12:15], a[72:75], a[132:135], a[12:15]
    s_waitcnt lgkmcnt(8)
    v_mfma_f32_16x16x32_bf16 a[16:19], a[76:79], a[120:123], a[16:19]
    ds_read_b64_tr_b16 a[72:73], v242 offset:32
    v_mfma_f32_16x16x32_bf16 a[20:23], a[76:79], a[124:127], a[20:23]
    ds_read_b64_tr_b16 a[74:75], v242 offset:2336
    v_mfma_f32_16x16x32_bf16 a[24:27], a[76:79], a[128:131], a[24:27]
    s_add_u32 m0, s29, 111616
    s_nop 0
    buffer_load_dwordx4 v227, s[24:27], s40 offen lds
    v_mfma_f32_16x16x32_bf16 a[28:31], a[76:79], a[132:135], a[28:31]
    s_cbranch_vccnz GG_SL10
GG_RT10:
    s_waitcnt lgkmcnt(8)
    v_mfma_f32_16x16x32_bf16 a[32:35], a[80:83], a[120:123], a[32:35]
    ds_read_b64_tr_b16 a[76:77], v242 offset:18464
    v_mfma_f32_16x16x32_bf16 a[36:39], a[80:83], a[124:127], a[36:39]
    ds_read_b64_tr_b16 a[78:79], v242 offset:20768
    v_mfma_f32_16x16x32_bf16 a[40:43], a[80:83], a[128:131], a[40:43]
    s_add_u32 m0, s29, 112640
    s_nop 0
    buffer_load_dwordx4 v228, s[24:27], s40 offen lds
    v_mfma_f32_16x16x32_bf16 a[44:47], a[80:83], a[132:135], a[44:47]
    s_waitcnt lgkmcnt(8)
    v_mfma_f32_16x16x32_bf16 a[48:51], a[84:87], a[120:123], a[48:51]
    ds_read_b64_tr_b16 a[80:81], v242 offset:64
    v_mfma_f32_16x16x32_bf16 a[52:55], a[84:87], a[124:127], a[52:55]
    ds_read_b64_tr_b16 a[82:83], v242 offset:2368
    v_mfma_f32_16x16x32_bf16 a[56:59], a[84:87], a[128:131], a[56:59]
    v_mfma_f32_16x16x32_bf16 a[60:63], a[84:87], a[132:135], a[60:63]
    s_waitcnt lgkmcnt(8)
    v_mfma_f32_16x16x32_bf16 v[0:3], a[64:67], a[136:139], v[0:3]
    ds_read_b64_tr_b16 a[84:85], v242 offset:18496
    v_mfma_f32_16x16x32_bf16 v[4:7], a[64:67], a[140:143], v[4:7]
    ds_read_b64_tr_b16 a[86:87], v242 offset:20800
    v_mfma_f32_16x16x32_bf16 v[8:11], a[64:67], a[144:147], v[8:11]
    buffer_load_dwordx4 a[120:123], v237, s[8:11], s50 offen offset:0 sc1
    v_mfma_f32_16x16x32_bf16 v[12:15], a[64:67], a[148:151], v[12:15]
    s_waitcnt lgkmcnt(8)
    v_mfma_f32_16x16x32_bf16 v[16:19], a[68:71], a[136:139], v[16:19]
    ds_read_b64_tr_b16 a[64:65], v242 offset:96
    v_mfma_f32_16x16x32_bf16 v[20:23], a[68:71], a[140:143], v[20:23]
    ds_read_b64_tr_b16 a[66:67], v242 offset:2400
    v_mfma_f32_16x16x32_bf16 v[24:27], a[68:71], a[144:147], v[24:27]
    buffer_load_dwordx4 a[124:127], v238, s[8:11], s50 offen offset:0 sc1
    v_mfma_f32_16x16x32_bf16 v[28:31], a[68:71], a[148:151], v[28:31]
    s_waitcnt lgkmcnt(8)
    v_mfma_f32_16x16x32_bf16 v[32:35], a[72:75], a[136:139], v[32:35]
    ds_read_b64_tr_b16 a[68:69], v242 offset:18528
    v_mfma_f32_16x16x32_bf16 v[36:39], a[72:75], a[140:143], v[36:39]
    ds_read_b64_tr_b16 a[70:71], v242 offset:20832
    v_mfma_f32_16x16x32_bf16 v[40:43], a[72:75], a[144:147], v[40:43]
    v_mfma_f32_16x16x32_bf16 v[44:47], a[72:75], a[148:151], v[44:47]
    s_waitcnt lgkmcnt(8)
    v_mfma_f32_16x16x32_bf16 v[48:51], a[76:79], a[136:139], v[48:51]
    ds_read_b64_tr_b16 a[72:73], v242 offset:128
    v_mfma_f32_16x16x32_bf16 v[52:55], a[76:79], a[140:143], v[52:55]
    ds_read_b64_tr_b16 a[74:75], v242 offset:2432
    v_mfma_f32_16x16x32_bf16 v[56:59], a[76:79], a[144:147], v[56:59]
    buffer_load_dwordx4 a[128:131], v239, s[8:11], s50 offen offset:0 sc1
    v_mfma_f32_16x16x32_bf16 v[60:63], a[76:79], a[148:151], v[60:63]
    s_waitcnt lgkmcnt(8)
    v_mfma_f32_16x16x32_bf16 v[64:67], a[80:83], a[136:139], v[64:67]
    ds_read_b64_tr_b16 a[76:77], v242 offset:18560
    v_mfma_f32_16x16x32_bf16 v[68:71], a[80:83], a[140:143], v[68:71]
    ds_read_b64_tr_b16 a[78:79], v242 offset:20864
    v_mfma_f32_16x16x32_bf16 v[72:75], a[80:83], a[144:147], v[72:75]
    buffer_load_dwordx4 a[132:135], v240, s[8:11], s50 offen offset:0 sc1
    v_mfma_f32_16x16x32_bf16 v[76:79], a[80:83], a[148:151], v[76:79]
    s_waitcnt lgkmcnt(8)
    v_mfma_f32_16x16x32_bf16 v[80:83], a[84:87], a[136:139], v[80:83]
    ds_read_b64_tr_b16 a[80:81], v242 offset:160
    v_mfma_f32_16x16x32_bf16 v[84:87], a[84:87], a[140:143], v[84:87]
    ds_read_b64_tr_b16 a[82:83], v242 offset:2464
    v_mfma_f32_16x16x32_bf16 v[88:91], a[84:87], a[144:147], v[88:91]
    v_mfma_f32_16x16x32_bf16 v[92:95], a[84:87], a[148:151], v[92:95]
    s_waitcnt lgkmcnt(8)
    v_mfma_f32_16x16x32_bf16 v[96:99], a[64:67], a[136:139], v[96:99]
    ds_read_b64_tr_b16 a[84:85], v242 offset:18592
    v_mfma_f32_16x16x32_bf16 v[100:103], a[64:67], a[140:143], v[100:103]
    ds_read_b64_tr_b16 a[86:87], v242 offset:20896
    v_mfma_f32_16x16x32_bf16 v[104:107], a[64:67], a[144:147], v[104:107]
    s_add_u32 m0, s29, 113664
    s_nop 0
    buffer_load_dwordx4 v229, s[24:27], s40 offen lds
    v_mfma_f32_16x16x32_bf16 v[108:111], a[64:67], a[148:151], v[108:111]
    s_waitcnt lgkmcnt(8)
    v_mfma_f32_16x16x32_bf16 v[112:115], a[68:71], a[136:139], v[112:115]
    ds_read_b64_tr_b16 a[64:65], v242 offset:192
    v_mfma_f32_16x16x32_bf16 v[116:119], a[68:71], a[140:143], v[116:119]
    ds_read_b64_tr_b16 a[66:67], v242 offset:2496
    v_mfma_f32_16x16x32_bf16 v[120:123], a[68:71], a[144:147], v[120:123]
    s_add_u32 m0, s29, 114688
    s_nop 0
    buffer_load_dwordx4 v230, s[24:27], s40 offen lds
    v_mfma_f32_16x16x32_bf16 v[124:127], a[68:71], a[148:151], v[124:127]
    s_waitcnt lgkmcnt(8)
    v_mfma_f32_16x16x32_bf16 v[128:131], a[72:75], a[136:139], v[128:131]
    ds_read_b64_tr_b16 a[68:69], v242 offset:18624
    v_mfma_f32_16x16x32_bf16 v[132:135], a[72:75], a[140:143], v[132:135]
    ds_read_b64_tr_b16 a[70:71], v242 offset:20928
    v_mfma_f32_16x16x32_bf16 v[136:139], a[72:75], a[144:147], v[136:139]
    v_mfma_f32_16x16x32_bf16 v[140:143], a[72:75], a[148:151], v[140:143]
    s_waitcnt lgkmcnt(8)
    v_mfma_f32_16x16x32_bf16 v[144:147], a[76:79], a[136:139], v[144:147]
    ds_read_b64_tr_b16 a[72:73], v242 offset:224
    v_mfma_f32_16x16x32_bf16 v[148:151], a[76:79], a[140:143], v[148:151]
    ds_read_b64_tr_b16 a[74:75], v242 offset:2528
    v_mfma_f32_16x16x32_bf16 v[152:155], a[76:79], a[144:147], v[152:155]
    s_add_u32 m0, s29, 115712
    s_nop 0
    buffer_load_dwordx4 v231, s[24:27], s40 offen lds
    v_mfma_f32_16x16x32_bf16 v[156:159], a[76:79], a[148:151], v[156:159]
    s_waitcnt lgkmcnt(8)
    v_mfma_f32_16x16x32_bf16 v[160:163], a[80:83], a[136:139], v[160:163]
    ds_read_b64_tr_b16 a[76:77], v242 offset:18656
    v_mfma_f32_16x16x32_bf16 v[164:167], a[80:83], a[140:143], v[164:167]
    ds_read_b64_tr_b16 a[78:79], v242 offset:20960
    v_mfma_f32_16x16x32_bf16 v[168:171], a[80:83], a[144:147], v[168:171]
    s_add_u32 m0, s29, 116736
    s_nop 0
    buffer_load_dwordx4 v232, s[24:27], s40 offen lds
    v_mfma_f32_16x16x32_bf16 v[172:175], a[80:83], a[148:151], v[172:175]
    s_waitcnt lgkmcnt(8)
    v_mfma_f32_16x16x32_bf16 v[176:179], a[84:87], a[136:139], v[176:179]
    ds_read_b64_tr_b16 a[80:81], v242 offset:256
    v_mfma_f32_16x16x32_bf16 v[180:183], a[84:87], a[140:143], v[180:183]
    ds_read_b64_tr_b16 a[82:83], v242 offset:2560
    v_mfma_f32_16x16x32_bf16 v[184:187], a[84:87], a[144:147], v[184:187]
    v_mfma_f32_16x16x32_bf16 v[188:191], a[84:87], a[148:151], v[188:191]
    s_waitcnt lgkmcnt(8)
    v_mfma_f32_16x16x32_bf16 v[192:195], a[64:67], a[136:139], v[192:195]
    ds_read_b64_tr_b16 a[84:85], v242 offset:18688
    v_accvgpr_read_b32 v250, a152
    v_mfma_f32_16x16x32_bf16 v[196:199], a[64:67], a[140:143], v[196:199]
    ds_read_b64_tr_b16 a[86:87], v242 offset:20992
    v_accvgpr_read_b32 v251, a156
    v_mfma_f32_16x16x32_bf16 v[200:203], a[64:67], a[144:147], v[200:203]
    s_add_u32 m0, s29, 117760
    s_nop 0
    buffer_load_dwordx4 v233, s[24:27], s40 offen lds
    v_mfma_f32_16x16x32_bf16 v[204:207], a[64:67], a[148:151], v[204:207]
    v_accvgpr_read_b32 v252, a160
    v_accvgpr_read_b32 v253, a164
    s_waitcnt lgkmcnt(8)
    v_mfma_f32_16x16x32_bf16 v[208:211], a[68:71], a[136:139], v[208:211]
    ds_read_b64_tr_b16 a[64:65], v242 offset:9216
    v_max3_u32 v250, v250, v251, v252
    v_mfma_f32_16x16x32_bf16 v[212:215], a[68:71], a[140:143], v[212:215]
    ds_read_b64_tr_b16 a[66:67], v242 offset:11520
    v_max_u32 v250, v250, v253
    v_mfma_f32_16x16x32_bf16 v[216:219], a[68:71], a[144:147], v[216:219]
    s_add_u32 m0, s29, 118784
    s_nop 0
    buffer_load_dwordx4 v234, s[24:27], s40 offen lds
    v_mfma_f32_16x16x32_bf16 v[220:223], a[68:71], a[148:151], v[220:223]
    v_cmp_eq_u32 vcc, -1, v250
    s_waitcnt lgkmcnt(8)
    v_mfma_f32_16x16x32_bf16 a[0:3], a[72:75], a[136:139], a[0:3]
    ds_read_b64_tr_b16 a[68:69], v242 offset:27648
    v_mfma_f32_16x16x32_bf16 a[4:7], a[72:75], a[140:143], a[4:7]
    ds_read_b64_tr_b16 a[70:71], v242 offset:29952
    v_mfma_f32_16x16x32_bf16 a[8:11], a[72:75], a[144:147], a[8:11]
    v_mfma_f32_16x16x32_bf16 a[12:15], a[72:75], a[148:151], a[12:15]
    s_waitcnt lgkmcnt(8)
    v_mfma_f32_16x16x32_bf16 a[16:19], a[76:79], a[136:139], a[16:19]
    ds_read_b64_tr_b16 a[72:73], v242 offset:9248
    v_mfma_f32_16x16x32_bf16 a[20:23], a[76:79], a[140:143], a[20:23]
    ds_read_b64_tr_b16 a[74:75], v242 offset:11552
    v_mfma_f32_16x16x32_bf16 a[24:27], a[76:79], a[144:147], a[24:27]
    buffer_store_dwordx4 v[246:249], v237, s[8:11], s32 offen offset:3072 sc1
    v_mfma_f32_16x16x32_bf16 a[28:31], a[76:79], a[148:151], a[28:31]
    s_cbranch_vccnz GG_SL11
GG_RT11:
    s_waitcnt lgkmcnt(8)
    v_mfma_f32_16x16x32_bf16 a[32:35], a[80:83], a[136:139], a[32:35]
    ds_read_b64_tr_b16 a[76:77], v242 offset:27680
    v_mfma_f32_16x16x32_bf16 a[36:39], a[80:83], a[140:143], a[36:39]
    ds_read_b64_tr_b16 a[78:79], v242 offset:29984
    v_mfma_f32_16x16x32_bf16 a[40:43], a[80:83], a[144:147], a[40:43]
    v_mfma_f32_16x16x32_bf16 a[44:47], a[80:83], a[148:151], a[44:47]
    s_waitcnt lgkmcnt(8)
    v_mfma_f32_16x16x32_bf16 a[48:51], a[84:87], a[136:139], a[48:51]
    ds_read_b64_tr_b16 a[80:81], v242 offset:9280
    v_mfma_f32_16x16x32_bf16 a[52:55], a[84:87], a[140:143], a[52:55]
    ds_read_b64_tr_b16 a[82:83], v242 offset:11584
    v_mfma_f32_16x16x32_bf16 a[56:59], a[84:87], a[144:147], a[56:59]
    v_mfma_f32_16x16x32_bf16 a[60:63], a[84:87], a[148:151], a[60:63]
    s_waitcnt lgkmcnt(8)
    v_mfma_f32_16x16x32_bf16 v[0:3], a[64:67], a[152:155], v[0:3]
    ds_read_b64_tr_b16 a[84:85], v242 offset:27712
    v_mfma_f32_16x16x32_bf16 v[4:7], a[64:67], a[156:159], v[4:7]
    ds_read_b64_tr_b16 a[86:87], v242 offset:30016
    v_mfma_f32_16x16x32_bf16 v[8:11], a[64:67], a[160:163], v[8:11]
    buffer_load_dwordx4 a[136:139], v237, s[8:11], s50 offen offset:1024 sc1
    v_mfma_f32_16x16x32_bf16 v[12:15], a[64:67], a[164:167], v[12:15]
    s_waitcnt lgkmcnt(8)
    v_mfma_f32_16x16x32_bf16 v[16:19], a[68:71], a[152:155], v[16:19]
    ds_read_b64_tr_b16 a[64:65], v242 offset:9312
    v_mfma_f32_16x16x32_bf16 v[20:23], a[68:71], a[156:159], v[20:23]
    ds_read_b64_tr_b16 a[66:67], v242 offset:11616
    v_mfma_f32_16x16x32_bf16 v[24:27], a[68:71], a[160:163], v[24:27]
    buffer_load_dwordx4 a[140:143], v238, s[8:11], s50 offen offset:1024 sc1
    v_mfma_f32_16x16x32_bf16 v[28:31], a[68:71], a[164:167], v[28:31]
    s_waitcnt lgkmcnt(8)
    v_mfma_f32_16x16x32_bf16 v[32:35], a[72:75], a[152:155], v[32:35]
    ds_read_b64_tr_b16 a[68:69], v242 offset:27744
    v_mfma_f32_16x16x32_bf16 v[36:39], a[72:75], a[156:159], v[36:39]
    ds_read_b64_tr_b16 a[70:71], v242 offset:30048
    v_mfma_f32_16x16x32_bf16 v[40:43], a[72:75], a[160:163], v[40:43]
    v_mfma_f32_16x16x32_bf16 v[44:47], a[72:75], a[164:167], v[44:47]
    s_waitcnt lgkmcnt(8)
    v_mfma_f32_16x16x32_bf16 v[48:51], a[76:79], a[152:155], v[48:51]
    ds_read_b64_tr_b16 a[72:73], v242 offset:9344
    v_mfma_f32_16x16x32_bf16 v[52:55], a[76:79], a[156:159], v[52:55]
    ds_read_b64_tr_b16 a[74:75], v242 offset:11648
    v_mfma_f32_16x16x32_bf16 v[56:59], a[76:79], a[160:163], v[56:59]
    buffer_load_dwordx4 a[144:147], v239, s[8:11], s50 offen offset:1024 sc1
    v_mfma_f32_16x16x32_bf16 v[60:63], a[76:79], a[164:167], v[60:63]
    s_waitcnt lgkmcnt(8)
    v_mfma_f32_16x16x32_bf16 v[64:67], a[80:83], a[152:155], v[64:67]
    ds_read_b64_tr_b16 a[76:77], v242 offset:27776
    v_mfma_f32_16x16x32_bf16 v[68:71], a[80:83], a[156:159], v[68:71]
    ds_read_b64_tr_b16 a[78:79], v242 offset:30080
    v_mfma_f32_16x16x32_bf16 v[72:75], a[80:83], a[160:163], v[72:75]
    buffer_load_dwordx4 a[148:151], v240, s[8:11], s50 offen offset:1024 sc1
    v_mfma_f32_16x16x32_bf16 v[76:79], a[80:83], a[164:167], v[76:79]
    s_waitcnt lgkmcnt(8)
    v_mfma_f32_16x16x32_bf16 v[80:83], a[84:87], a[152:155], v[80:83]
    ds_read_b64_tr_b16 a[80:81], v242 offset:9376
    v_mfma_f32_16x16x32_bf16 v[84:87], a[84:87], a[156:159], v[84:87]
    ds_read_b64_tr_b16 a[82:83], v242 offset:11680
    v_mfma_f32_16x16x32_bf16 v[88:91], a[84:87], a[160:163], v[88:91]
    v_mfma_f32_16x16x32_bf16 v[92:95], a[84:87], a[164:167], v[92:95]
    s_waitcnt lgkmcnt(8)
    v_mfma_f32_16x16x32_bf16 v[96:99], a[64:67], a[152:155], v[96:99]
    ds_read_b64_tr_b16 a[84:85], v242 offset:27808
    v_mfma_f32_16x16x32_bf16 v[100:103], a[64:67], a[156:159], v[100:103]
    ds_read_b64_tr_b16 a[86:87], v242 offset:30112
    v_mfma_f32_16x16x32_bf16 v[104:107], a[64:67], a[160:163], v[104:107]
    v_mfma_f32_16x16x32_bf16 v[108:111], a[64:67], a[164:167], v[108:111]
    s_waitcnt lgkmcnt(8)
    v_mfma_f32_16x16x32_bf16 v[112:115], a[68:71], a[152:155], v[112:115]
    ds_read_b64_tr_b16 a[64:65], v242 offset:9408
    v_mfma_f32_16x16x32_bf16 v[116:119], a[68:71], a[156:159], v[116:119]
    ds_read_b64_tr_b16 a[66:67], v242 offset:11712
    v_mfma_f32_16x16x32_bf16 v[120:123], a[68:71], a[160:163], v[120:123]
    v_mfma_f32_16x16x32_bf16 v[124:127], a[68:71], a[164:167], v[124:127]
    s_waitcnt lgkmcnt(8)
    v_mfma_f32_16x16x32_bf16 v[128:131], a[72:75], a[152:155], v[128:131]
    ds_read_b64_tr_b16 a[68:69], v242 offset:27840
    v_mfma_f32_16x16x32_bf16 v[132:135], a[72:75], a[156:159], v[132:135]
    ds_read_b64_tr_b16 a[70:71], v242 offset:30144
    v_mfma_f32_16x16x32_bf16 v[136:139], a[72:75], a[160:163], v[136:139]
    v_mfma_f32_16x16x32_bf16 v[140:143], a[72:75], a[164:167], v[140:143]
    s_waitcnt lgkmcnt(8)
    v_mfma_f32_16x16x32_bf16 v[144:147], a[76:79], a[152:155], v[144:147]
    ds_read_b64_tr_b16 a[72:73], v242 offset:9440
    v_mfma_f32_16x16x32_bf16 v[148:151], a[76:79], a[156:159], v[148:151]
    ds_read_b64_tr_b16 a[74:75], v242 offset:11744
    v_mfma_f32_16x16x32_bf16 v[152:155], a[76:79], a[160:163], v[152:155]
    v_mfma_f32_16x16x32_bf16 v[156:159], a[76:79], a[164:167], v[156:159]
    s_waitcnt lgkmcnt(8)
    v_mfma_f32_16x16x32_bf16 v[160:163], a[80:83], a[152:155], v[160:163]
    ds_read_b64_tr_b16 a[76:77], v242 offset:27872
    v_mfma_f32_16x16x32_bf16 v[164:167], a[80:83], a[156:159], v[164:167]
    ds_read_b64_tr_b16 a[78:79], v242 offset:30176
    v_mfma_f32_16x16x32_bf16 v[168:171], a[80:83], a[160:163], v[168:171]
    v_mfma_f32_16x16x32_bf16 v[172:175], a[80:83], a[164:167], v[172:175]
    s_waitcnt lgkmcnt(8)
    v_mfma_f32_16x16x32_bf16 v[176:179], a[84:87], a[152:155], v[176:179]
    ds_read_b64_tr_b16 a[80:81], v242 offset:9472
    v_mfma_f32_16x16x32_bf16 v[180:183], a[84:87], a[156:159], v[180:183]
    ds_read_b64_tr_b16 a[82:83], v242 offset:11776
    v_mfma_f32_16x16x32_bf16 v[184:187], a[84:87], a[160:163], v[184:187]
    v_mfma_f32_16x16x32_bf16 v[188:191], a[84:87], a[164:167], v[188:191]
    s_waitcnt vmcnt(44)
    s_waitcnt lgkmcnt(8)
    v_mfma_f32_16x16x32_bf16 v[192:195], a[64:67], a[152:155], v[192:195]
    ds_read_b64_tr_b16 a[84:85], v242 offset:27904
    v_accvgpr_read_b32 v250, a168
    v_mfma_f32_16x16x32_bf16 v[196:199], a[64:67], a[156:159], v[196:199]
    ds_read_b64_tr_b16 a[86:87], v242 offset:30208
    v_accvgpr_read_b32 v251, a172
    v_mfma_f32_16x16x32_bf16 v[200:203], a[64:67], a[160:163], v[200:203]
    v_accvgpr_read_b32 v252, a176
    v_accvgpr_read_b32 v253, a180
    v_mfma_f32_16x16x32_bf16 v[204:207], a[64:67], a[164:167], v[204:207]
    v_max3_u32 v250, v250, v251, v252
    v_max_u32 v250, v250, v253
    s_waitcnt vmcnt(28)
    s_barrier
    s_waitcnt lgkmcnt(8)
    v_mfma_f32_16x16x32_bf16 v[208:211], a[68:71], a[152:155], v[208:211]
    ds_read_b64_tr_b16 a[64:65], v243 offset:0
    v_cmp_eq_u32 vcc, -1, v250
    v_mfma_f32_16x16x32_bf16 v[212:215], a[68:71], a[156:159], v[212:215]
    ds_read_b64_tr_b16 a[66:67], v243 offset:2304
    v_mfma_f32_16x16x32_bf16 v[216:219], a[68:71], a[160:163], v[216:219]
    s_add_u32 m0, s29, 0
    s_nop 0
    buffer_load_dwordx4 v226, s[24:27], s41 offen lds
    v_mfma_f32_16x16x32_bf16 v[220:223], a[68:71], a[164:167], v[220:223]
    s_waitcnt lgkmcnt(8)
    v_mfma_f32_16x16x32_bf16 a[0:3], a[72:75], a[152:155], a[0:3]
    ds_read_b64_tr_b16 a[68:69], v243 offset:18432
    v_mfma_f32_16x16x32_bf16 a[4:7], a[72:75], a[156:159], a[4:7]
    ds_read_b64_tr_b16 a[70:71], v243 offset:20736
    v_mfma_f32_16x16x32_bf16 a[8:11], a[72:75], a[160:163], a[8:11]
    v_mfma_f32_16x16x32_bf16 a[12:15], a[72:75], a[164:167], a[12:15]
    s_waitcnt lgkmcnt(8)
    v_mfma_f32_16x16x32_bf16 a[16:19], a[76:79], a[152:155], a[16:19]
    ds_read_b64_tr_b16 a[72:73], v243 offset:32
    v_mfma_f32_16x16x32_bf16 a[20:23], a[76:79], a[156:159], a[20:23]
    ds_read_b64_tr_b16 a[74:75], v243 offset:2336
    v_mfma_f32_16x16x32_bf16 a[24:27], a[76:79], a[160:163], a[24:27]
    s_add_u32 m0, s29, 1024
    s_nop 0
    buffer_load_dwordx4 v227, s[24:27], s41 offen lds
    v_mfma_f32_16x16x32_bf16 a[28:31], a[76:79], a[164:167], a[28:31]
    s_cbranch_vccnz GG_SL12
GG_RT12:
    s_waitcnt lgkmcnt(8)
    v_mfma_f32_16x16x32_bf16 a[32:35], a[80:83], a[152:155], a[32:35]
    ds_read_b64_tr_b16 a[76:77], v243 offset:18464
    v_mfma_f32_16x16x32_bf16 a[36:39], a[80:83], a[156:159], a[36:39]
    ds_read_b64_tr_b16 a[78:79], v243 offset:20768
    v_mfma_f32_16x16x32_bf16 a[40:43], a[80:83], a[160:163], a[40:43]
    s_add_u32 m0, s29, 2048
    s_nop 0
    buffer_load_dwordx4 v228, s[24:27], s41 offen lds
    v_mfma_f32_16x16x32_bf16 a[44:47], a[80:83], a[164:167], a[44:47]
    s_waitcnt lgkmcnt(8)
    v_mfma_f32_16x16x32_bf16 a[48:51], a[84:87], a[152:155], a[48:51]
    ds_read_b64_tr_b16 a[80:81], v243 offset:64
    v_mfma_f32_16x16x32_bf16 a[52:55], a[84:87], a[156:159], a[52:55]
    ds_read_b64_tr_b16 a[82:83], v243 offset:2368
    v_mfma_f32_16x16x32_bf16 a[56:59], a[84:87], a[160:163], a[56:59]
    v_mfma_f32_16x16x32_bf16 a[60:63], a[84:87], a[164:167], a[60:63]
    s_waitcnt lgkmcnt(8)
    v_mfma_f32_16x16x32_bf16 v[0:3], a[64:67], a[168:171], v[0:3]
    ds_read_b64_tr_b16 a[84:85], v243 offset:18496
    v_mfma_f32_16x16x32_bf16 v[4:7], a[64:67], a[172:175], v[4:7]
    ds_read_b64_tr_b16 a[86:87], v243 offset:20800
    v_mfma_f32_16x16x32_bf16 v[8:11], a[64:67], a[176:179], v[8:11]
    s_add_u32 m0, s29, 3072
    s_nop 0
    buffer_load_dwordx4 v229, s[24:27], s41 offen lds
    v_mfma_f32_16x16x32_bf16 v[12:15], a[64:67], a[180:183], v[12:15]
    s_waitcnt lgkmcnt(8)
    v_mfma_f32_16x16x32_bf16 v[16:19], a[68:71], a[168:171], v[16:19]
    ds_read_b64_tr_b16 a[64:65], v243 offset:96
    v_mfma_f32_16x16x32_bf16 v[20:23], a[68:71], a[172:175], v[20:23]
    ds_read_b64_tr_b16 a[66:67], v243 offset:2400
    v_mfma_f32_16x16x32_bf16 v[24:27], a[68:71], a[176:179], v[24:27]
    s_add_u32 m0, s29, 4096
    s_nop 0
    buffer_load_dwordx4 v230, s[24:27], s41 offen lds
    v_mfma_f32_16x16x32_bf16 v[28:31], a[68:71], a[180:183], v[28:31]
    s_waitcnt lgkmcnt(8)
    v_mfma_f32_16x16x32_bf16 v[32:35], a[72:75], a[168:171], v[32:35]
    ds_read_b64_tr_b16 a[68:69], v243 offset:18528
    v_accvgpr_read_b32 v250, a184
    v_mfma_f32_16x16x32_bf16 v[36:39], a[72:75], a[172:175], v[36:39]
    ds_read_b64_tr_b16 a[70:71], v243 offset:20832
    v_accvgpr_read_b32 v251, a188
    v_mfma_f32_16x16x32_bf16 v[40:43], a[72:75], a[176:179], v[40:43]
    v_accvgpr_read_b32 v252, a192
    v_accvgpr_read_b32 v253, a196
    v_mfma_f32_16x16x32_bf16 v[44:47], a[72:75], a[180:183], v[44:47]
    v_max3_u32 v250, v250, v251, v252
    v_max_u32 v250, v250, v253
    s_waitcnt lgkmcnt(8)
    v_mfma_f32_16x16x32_bf16 v[48:51], a[76:79], a[168:171], v[48:51]
    ds_read_b64_tr_b16 a[72:73], v243 offset:128
    v_cmp_eq_u32 vcc, -1, v250
    v_mfma_f32_16x16x32_bf16 v[52:55], a[76:79], a[172:175], v[52:55]
    ds_read_b64_tr_b16 a[74:75], v243 offset:2432
    v_mfma_f32_16x16x32_bf16 v[56:59], a[76:79], a[176:179], v[56:59]
    s_add_u32 m0, s29, 5120
    s_nop 0
    buffer_load_dwordx4 v231, s[24:27], s41 offen lds
    v_mfma_f32_16x16x32_bf16 v[60:63], a[76:79], a[180:183], v[60:63]
    s_waitcnt lgkmcnt(8)
    v_mfma_f32_16x16x32_bf16 v[64:67], a[80:83], a[168:171], v[64:67]
    ds_read_b64_tr_b16 a[76:77], v243 offset:18560
    v_mfma_f32_16x16x32_bf16 v[68:71], a[80:83], a[172:175], v[68:71]
    ds_read_b64_tr_b16 a[78:79], v243 offset:20864
    v_mfma_f32_16x16x32_bf16 v[72:75], a[80:83], a[176:179], v[72:75]
    s_add_u32 m0, s29, 6144
    s_nop 0
    buffer_load_dwordx4 v232, s[24:27], s41 offen lds
    v_mfma_f32_16x16x32_bf16 v[76:79], a[80:83], a[180:183], v[76:79]
    s_waitcnt lgkmcnt(8)
    v_mfma_f32_16x16x32_bf16 v[80:83], a[84:87], a[168:171], v[80:83]
    ds_read_b64_tr_b16 a[80:81], v243 offset:160
    v_mfma_f32_16x16x32_bf16 v[84:87], a[84:87], a[172:175], v[84:87]
    ds_read_b64_tr_b16 a[82:83], v243 offset:2464
    v_mfma_f32_16x16x32_bf16 v[88:91], a[84:87], a[176:179], v[88:91]
    v_mfma_f32_16x16x32_bf16 v[92:95], a[84:87], a[180:183], v[92:95]
    s_cbranch_vccnz GG_SL13
GG_RT13:
    s_waitcnt vmcnt(31)
    s_waitcnt lgkmcnt(8)
    v_mfma_f32_16x16x32_bf16 v[96:99], a[64:67], a[168:171], v[96:99]
    ds_read_b64_tr_b16 a[84:85], v243 offset:18592
    v_accvgpr_read_b32 v250, a88
    v_mfma_f32_16x16x32_bf16 v[100:103], a[64:67], a[172:175], v[100:103]
    ds_read_b64_tr_b16 a[86:87], v243 offset:20896
    v_accvgpr_read_b32 v251, a92
    v_mfma_f32_16x16x32_bf16 v[104:107], a[64:67], a[176:179], v[104:107]
    s_add_u32 m0, s29, 7168
    s_nop 0
    buffer_load_dwordx4 v233, s[24:27], s41 offen lds
    v_mfma_f32_16x16x32_bf16 v[108:111], a[64:67], a[180:183], v[108:111]
    v_accvgpr_read_b32 v252, a96
    v_accvgpr_read_b32 v253, a100
    s_waitcnt lgkmcnt(8)
    v_mfma_f32_16x16x32_bf16 v[112:115], a[68:71], a[168:171], v[112:115]
    ds_read_b64_tr_b16 a[64:65], v243 offset:192
    v_max3_u32 v250, v250, v251, v252
    v_mfma_f32_16x16x32_bf16 v[116:119], a[68:71], a[172:175], v[116:119]
    ds_read_b64_tr_b16 a[66:67], v243 offset:2496
    v_max_u32 v250, v250, v253
    v_mfma_f32_16x16x32_bf16 v[120:123], a[68:71], a[176:179], v[120:123]
    s_add_u32 m0, s29, 8192
    s_nop 0
    buffer_load_dwordx4 v234, s[24:27], s41 offen lds
    v_mfma_f32_16x16x32_bf16 v[124:127], a[68:71], a[180:183], v[124:127]
    v_cmp_eq_u32 vcc, -1, v250
    s_waitcnt lgkmcnt(8)
    v_mfma_f32_16x16x32_bf16 v[128:131], a[72:75], a[168:171], v[128:131]
    ds_read_b64_tr_b16 a[68:69], v243 offset:18624
    v_mfma_f32_16x16x32_bf16 v[132:135], a[72:75], a[172:175], v[132:135]
    ds_read_b64_tr_b16 a[70:71], v243 offset:20928
    v_mfma_f32_16x16x32_bf16 v[136:139], a[72:75], a[176:179], v[136:139]
    v_mfma_f32_16x16x32_bf16 v[140:143], a[72:75], a[180:183], v[140:143]
    s_waitcnt lgkmcnt(8)
    v_mfma_f32_16x16x32_bf16 v[144:147], a[76:79], a[168:171], v[144:147]
    ds_read_b64_tr_b16 a[72:73], v243 offset:224
    v_mfma_f32_16x16x32_bf16 v[148:151], a[76:79], a[172:175], v[148:151]
    ds_read_b64_tr_b16 a[74:75], v243 offset:2528
    v_mfma_f32_16x16x32_bf16 v[152:155], a[76:79], a[176:179], v[152:155]
    buffer_store_dwordx4 v[246:249], v237, s[8:11], s28 offen offset:0 sc1
    v_mfma_f32_16x16x32_bf16 v[156:159], a[76:79], a[180:183], v[156:159]
    s_cbranch_vccnz GG_SL14
GG_RT14:
    s_waitcnt vmcnt(29)
    s_waitcnt lgkmcnt(8)
    v_mfma_f32_16x16x32_bf16 v[160:163], a[80:83], a[168:171], v[160:163]
    ds_read_b64_tr_b16 a[76:77], v243 offset:18656
    v_accvgpr_read_b32 v250, a104
    v_mfma_f32_16x16x32_bf16 v[164:167], a[80:83], a[172:175], v[164:167]
    ds_read_b64_tr_b16 a[78:79], v243 offset:20960
    v_accvgpr_read_b32 v251, a108
    v_mfma_f32_16x16x32_bf16 v[168:171], a[80:83], a[176:179], v[168:171]
    v_accvgpr_read_b32 v252, a112
    v_accvgpr_read_b32 v253, a116
    v_mfma_f32_16x16x32_bf16 v[172:175], a[80:83], a[180:183], v[172:175]
    v_max3_u32 v250, v250, v251, v252
    v_max_u32 v250, v250, v253
    s_waitcnt lgkmcnt(8)
    v_mfma_f32_16x16x32_bf16 v[176:179], a[84:87], a[168:171], v[176:179]
    ds_read_b64_tr_b16 a[80:81], v243 offset:256
    v_cmp_eq_u32 vcc, -1, v250
    v_mfma_f32_16x16x32_bf16 v[180:183], a[84:87], a[172:175], v[180:183]
    ds_read_b64_tr_b16 a[82:83], v243 offset:2560
    v_mfma_f32_16x16x32_bf16 v[184:187], a[84:87], a[176:179], v[184:187]
    v_mfma_f32_16x16x32_bf16 v[188:191], a[84:87], a[180:183], v[188:191]
    s_waitcnt lgkmcnt(8)
    v_mfma_f32_16x16x32_bf16 v[192:195], a[64:67], a[168:171], v[192:195]
    ds_read_b64_tr_b16 a[84:85], v243 offset:18688
    v_mfma_f32_16x16x32_bf16 v[196:199], a[64:67], a[172:175], v[196:199]
    ds_read_b64_tr_b16 a[86:87], v243 offset:20992
    v_mfma_f32_16x16x32_bf16 v[200:203], a[64:67], a[176:179], v[200:203]
    v_mfma_f32_16x16x32_bf16 v[204:207], a[64:67], a[180:183], v[204:207]
    s_waitcnt lgkmcnt(8)
    v_mfma_f32_16x16x32_bf16 v[208:211], a[68:71], a[168:171], v[208:211]
    ds_read_b64_tr_b16 a[64:65], v243 offset:9216
    v_mfma_f32_16x16x32_bf16 v[212:215], a[68:71], a[172:175], v[212:215]
    ds_read_b64_tr_b16 a[66:67], v243 offset:11520
    v_mfma_f32_16x16x32_bf16 v[216:219], a[68:71], a[176:179], v[216:219]
    v_mfma_f32_16x16x32_bf16 v[220:223], a[68:71], a[180:183], v[220:223]
    s_cbranch_vccnz GG_SL15
GG_RT15:
    s_waitcnt vmcnt(21)
    s_waitcnt lgkmcnt(8)
    v_mfma_f32_16x16x32_bf16 a[0:3], a[72:75], a[168:171], a[0:3]
    ds_read_b64_tr_b16 a[68:69], v243 offset:27648
    v_accvgpr_read_b32 v250, a120
    v_mfma_f32_16x16x32_bf16 a[4:7], a[72:75], a[172:175], a[4:7]
    ds_read_b64_tr_b16 a[70:71], v243 offset:29952
    v_accvgpr_read_b32 v251, a124
    v_mfma_f32_16x16x32_bf16 a[8:11], a[72:75], a[176:179], a[8:11]
    v_accvgpr_read_b32 v252, a128
    v_accvgpr_read_b32 v253, a132
    v_mfma_f32_16x16x32_bf16 a[12:15], a[72:75], a[180:183], a[12:15]
    v_max3_u32 v250, v250, v251, v252
    v_max_u32 v250, v250, v253
    s_waitcnt lgkmcnt(8)
    v_mfma_f32_16x16x32_bf16 a[16:19], a[76:79], a[168:171], a[16:19]
    ds_read_b64_tr_b16 a[72:73], v243 offset:9248
    v_cmp_eq_u32 vcc, -1, v250
    v_mfma_f32_16x16x32_bf16 a[20:23], a[76:79], a[172:175], a[20:23]
    ds_read_b64_tr_b16 a[74:75], v243 offset:11552
    v_mfma_f32_16x16x32_bf16 a[24:27], a[76:79], a[176:179], a[24:27]
    v_mfma_f32_16x16x32_bf16 a[28:31], a[76:79], a[180:183], a[28:31]
    s_waitcnt lgkmcnt(8)
    v_mfma_f32_16x16x32_bf16 a[32:35], a[80:83], a[168:171], a[32:35]
    ds_read_b64_tr_b16 a[76:77], v243 offset:27680
    v_mfma_f32_16x16x32_bf16 a[36:39], a[80:83], a[172:175], a[36:39]
    ds_read_b64_tr_b16 a[78:79], v243 offset:29984
    v_mfma_f32_16x16x32_bf16 a[40:43], a[80:83], a[176:179], a[40:43]
    v_mfma_f32_16x16x32_bf16 a[44:47], a[80:83], a[180:183], a[44:47]
    s_waitcnt lgkmcnt(8)
    v_mfma_f32_16x16x32_bf16 a[48:51], a[84:87], a[168:171], a[48:51]
    ds_read_b64_tr_b16 a[80:81], v243 offset:9280
    v_mfma_f32_16x16x32_bf16 a[52:55], a[84:87], a[172:175], a[52:55]
    ds_read_b64_tr_b16 a[82:83], v243 offset:11584
    v_mfma_f32_16x16x32_bf16 a[56:59], a[84:87], a[176:179], a[56:59]
    v_mfma_f32_16x16x32_bf16 a[60:63], a[84:87], a[180:183], a[60:63]
    s_cbranch_vccnz GG_SL16
GG_RT16:
    s_waitcnt vmcnt(10)
    s_waitcnt lgkmcnt(8)
    v_mfma_f32_16x16x32_bf16 v[0:3], a[64:67], a[184:187], v[0:3]
    ds_read_b64_tr_b16 a[84:85], v243 offset:27712
    v_accvgpr_read_b32 v250, a136
    v_mfma_f32_16x16x32_bf16 v[4:7], a[64:67], a[188:191], v[4:7]
    ds_read_b64_tr_b16 a[86:87], v243 offset:30016
    v_accvgpr_read_b32 v251, a140
    v_mfma_f32_16x16x32_bf16 v[8:11], a[64:67], a[192:195], v[8:11]
    v_accvgpr_read_b32 v252, a144
    v_accvgpr_read_b32 v253, a148
    v_mfma_f32_16x16x32_bf16 v[12:15], a[64:67], a[196:199], v[12:15]
    v_max3_u32 v250, v250, v251, v252
    v_max_u32 v250, v250, v253
    s_waitcnt lgkmcnt(8)
    v_mfma_f32_16x16x32_bf16 v[16:19], a[68:71], a[184:187], v[16:19]
    ds_read_b64_tr_b16 a[64:65], v243 offset:9312
    v_cmp_eq_u32 vcc, -1, v250
    v_mfma_f32_16x16x32_bf16 v[20:23], a[68:71], a[188:191], v[20:23]
    ds_read_b64_tr_b16 a[66:67], v243 offset:11616
    v_mfma_f32_16x16x32_bf16 v[24:27], a[68:71], a[192:195], v[24:27]
    v_mfma_f32_16x16x32_bf16 v[28:31], a[68:71], a[196:199], v[28:31]
    s_waitcnt lgkmcnt(8)
    v_mfma_f32_16x16x32_bf16 v[32:35], a[72:75], a[184:187], v[32:35]
    ds_read_b64_tr_b16 a[68:69], v243 offset:27744
    v_mfma_f32_16x16x32_bf16 v[36:39], a[72:75], a[188:191], v[36:39]
    ds_read_b64_tr_b16 a[70:71], v243 offset:30048
    v_mfma_f32_16x16x32_bf16 v[40:43], a[72:75], a[192:195], v[40:43]
    v_mfma_f32_16x16x32_bf16 v[44:47], a[72:75], a[196:199], v[44:47]
    s_waitcnt lgkmcnt(8)
    v_mfma_f32_16x16x32_bf16 v[48:51], a[76:79], a[184:187], v[48:51]
    ds_read_b64_tr_b16 a[72:73], v243 offset:9344
    v_mfma_f32_16x16x32_bf16 v[52:55], a[76:79], a[188:191], v[52:55]
    ds_read_b64_tr_b16 a[74:75], v243 offset:11648
    v_mfma_f32_16x16x32_bf16 v[56:59], a[76:79], a[192:195], v[56:59]
    v_mfma_f32_16x16x32_bf16 v[60:63], a[76:79], a[196:199], v[60:63]
    s_cbranch_vccnz GG_SL17
GG_RT17:
    s_waitcnt lgkmcnt(8)
    v_mfma_f32_16x16x32_bf16 v[64:67], a[80:83], a[184:187], v[64:67]
    ds_read_b64_tr_b16 a[76:77], v243 offset:27776
    v_mfma_f32_16x16x32_bf16 v[68:71], a[80:83], a[188:191], v[68:71]
    ds_read_b64_tr_b16 a[78:79], v243 offset:30080
    v_mfma_f32_16x16x32_bf16 v[72:75], a[80:83], a[192:195], v[72:75]
    v_mfma_f32_16x16x32_bf16 v[76:79], a[80:83], a[196:199], v[76:79]
    s_waitcnt lgkmcnt(8)
    v_mfma_f32_16x16x32_bf16 v[80:83], a[84:87], a[184:187], v[80:83]
    ds_read_b64_tr_b16 a[80:81], v243 offset:9376
    v_mfma_f32_16x16x32_bf16 v[84:87], a[84:87], a[188:191], v[84:87]
    ds_read_b64_tr_b16 a[82:83], v243 offset:11680
    v_mfma_f32_16x16x32_bf16 v[88:91], a[84:87], a[192:195], v[88:91]
    v_mfma_f32_16x16x32_bf16 v[92:95], a[84:87], a[196:199], v[92:95]
    s_waitcnt lgkmcnt(8)
    v_mfma_f32_16x16x32_bf16 v[96:99], a[64:67], a[184:187], v[96:99]
    ds_read_b64_tr_b16 a[84:85], v243 offset:27808
    v_mfma_f32_16x16x32_bf16 v[100:103], a[64:67], a[188:191], v[100:103]
    ds_read_b64_tr_b16 a[86:87], v243 offset:30112
    v_mfma_f32_16x16x32_bf16 v[104:107], a[64:67], a[192:195], v[104:107]
    v_mfma_f32_16x16x32_bf16 v[108:111], a[64:67], a[196:199], v[108:111]
    s_waitcnt lgkmcnt(8)
    v_mfma_f32_16x16x32_bf16 v[112:115], a[68:71], a[184:187], v[112:115]
    ds_read_b64_tr_b16 a[64:65], v243 offset:9408
    v_mfma_f32_16x16x32_bf16 v[116:119], a[68:71], a[188:191], v[116:119]
    ds_read_b64_tr_b16 a[66:67], v243 offset:11712
    v_mfma_f32_16x16x32_bf16 v[120:123], a[68:71], a[192:195], v[120:123]
    v_mfma_f32_16x16x32_bf16 v[124:127], a[68:71], a[196:199], v[124:127]
    s_bitcmp1_b32 s17, 0
    s_cbranch_scc1 GG_ODD
    s_waitcnt lgkmcnt(8)
    v_mfma_f32_16x16x32_bf16 v[128:131], a[72:75], a[184:187], v[128:131]
    ds_read_b64_tr_b16 a[68:69], v243 offset:27840
    v_mfma_f32_16x16x32_bf16 v[132:135], a[72:75], a[188:191], v[132:135]
    ds_read_b64_tr_b16 a[70:71], v243 offset:30144
    v_mfma_f32_16x16x32_bf16 v[136:139], a[72:75], a[192:195], v[136:139]
    v_mfma_f32_16x16x32_bf16 v[140:143], a[72:75], a[196:199], v[140:143]
    s_waitcnt lgkmcnt(8)
    v_mfma_f32_16x16x32_bf16 v[144:147], a[76:79], a[184:187], v[144:147]
    ds_read_b64_tr_b16 a[72:73], v243 offset:9440
    v_mfma_f32_16x16x32_bf16 v[148:151], a[76:79], a[188:191], v[148:151]
    ds_read_b64_tr_b16 a[74:75], v243 offset:11744
    v_mfma_f32_16x16x32_bf16 v[152:155], a[76:79], a[192:195], v[152:155]
    v_mfma_f32_16x16x32_bf16 v[156:159], a[76:79], a[196:199], v[156:159]
    s_waitcnt lgkmcnt(8)
    v_mfma_f32_16x16x32_bf16 v[160:163], a[80:83], a[184:187], v[160:163]
    ds_read_b64_tr_b16 a[76:77], v243 offset:27872
    v_mfma_f32_16x16x32_bf16 v[164:167], a[80:83], a[188:191], v[164:167]
    ds_read_b64_tr_b16 a[78:79], v243 offset:30176
    v_mfma_f32_16x16x32_bf16 v[168:171], a[80:83], a[192:195], v[168:171]
    v_mfma_f32_16x16x32_bf16 v[172:175], a[80:83], a[196:199], v[172:175]
    s_waitcnt lgkmcnt(8)
    v_mfma_f32_16x16x32_bf16 v[176:179], a[84:87], a[184:187], v[176:179]
    ds_read_b64_tr_b16 a[80:81], v243 offset:9472
    v_mfma_f32_16x16x32_bf16 v[180:183], a[84:87], a[188:191], v[180:183]
    ds_read_b64_tr_b16 a[82:83], v243 offset:11776
    v_mfma_f32_16x16x32_bf16 v[184:187], a[84:87], a[192:195], v[184:187]
    v_mfma_f32_16x16x32_bf16 v[188:191], a[84:87], a[196:199], v[188:191]
    s_waitcnt lgkmcnt(8)
    v_mfma_f32_16x16x32_bf16 v[192:195], a[64:67], a[184:187], v[192:195]
    ds_read_b64_tr_b16 a[84:85], v243 offset:27904
    v_mfma_f32_16x16x32_bf16 v[196:199], a[64:67], a[188:191], v[196:199]
    ds_read_b64_tr_b16 a[86:87], v243 offset:30208
    v_mfma_f32_16x16x32_bf16 v[200:203], a[64:67], a[192:195], v[200:203]
    v_mfma_f32_16x16x32_bf16 v[204:207], a[64:67], a[196:199], v[204:207]
    s_waitcnt vmcnt(1)
    s_barrier
    s_waitcnt lgkmcnt(8)
    v_mfma_f32_16x16x32_bf16 v[208:211], a[68:71], a[184:187], v[208:211]
    ds_read_b64_tr_b16 a[64:65], v244 offset:0
    v_mfma_f32_16x16x32_bf16 v[212:215], a[68:71], a[188:191], v[212:215]
    ds_read_b64_tr_b16 a[66:67], v244 offset:2304
    v_mfma_f32_16x16x32_bf16 v[216:219], a[68:71], a[192:195], v[216:219]
    v_accvgpr_read_b32 v226, a200
    v_accvgpr_read_b32 v227, a201
    v_accvgpr_read_b32 v228, a202
    v_accvgpr_read_b32 v229, a203
    v_accvgpr_read_b32 v230, a204
    v_accvgpr_read_b32 v231, a205
    v_accvgpr_read_b32 v232, a206
    v_accvgpr_read_b32 v233, a207
    v_accvgpr_read_b32 v234, a208
    v_mfma_f32_16x16x32_bf16 v[220:223], a[68:71], a[196:199], v[220:223]
    s_waitcnt lgkmcnt(8)
    v_mfma_f32_16x16x32_bf16 a[0:3], a[72:75], a[184:187], a[0:3]
    ds_read_b64_tr_b16 a[68:69], v244 offset:18432
    v_mfma_f32_16x16x32_bf16 a[4:7], a[72:75], a[188:191], a[4:7]
    ds_read_b64_tr_b16 a[70:71], v244 offset:20736
    v_mfma_f32_16x16x32_bf16 a[8:11], a[72:75], a[192:195], a[8:11]
    v_mfma_f32_16x16x32_bf16 a[12:15], a[72:75], a[196:199], a[12:15]
    s_waitcnt lgkmcnt(8)
    v_mfma_f32_16x16x32_bf16 a[16:19], a[76:79], a[184:187], a[16:19]
    ds_read_b64_tr_b16 a[72:73], v244 offset:9216
    v_mfma_f32_16x16x32_bf16 a[20:23], a[76:79], a[188:191], a[20:23]
    ds_read_b64_tr_b16 a[74:75], v244 offset:11520
    v_mfma_f32_16x16x32_bf16 a[24:27], a[76:79], a[192:195], a[24:27]
    s_add_u32 m0, s51, 36864
    s_nop 0
    buffer_load_dwordx4 v226, s[12:15], s60 offen lds
    v_mfma_f32_16x16x32_bf16 a[28:31], a[76:79], a[196:199], a[28:31]
    s_waitcnt lgkmcnt(8)
    v_mfma_f32_16x16x32_bf16 a[32:35], a[80:83], a[184:187], a[32:35]
    ds_read_b64_tr_b16 a[76:77], v244 offset:27648
    v_mfma_f32_16x16x32_bf16 a[36:39], a[80:83], a[188:191], a[36:39]
    ds_read_b64_tr_b16 a[78:79], v244 offset:29952
    v_mfma_f32_16x16x32_bf16 a[40:43], a[80:83], a[192:195], a[40:43]
    s_add_u32 m0, s51, 37888
    s_nop 0
    buffer_load_dwordx4 v227, s[12:15], s60 offen lds
    v_mfma_f32_16x16x32_bf16 a[44:47], a[80:83], a[196:199], a[44:47]
    s_waitcnt lgkmcnt(8)
    v_mfma_f32_16x16x32_bf16 a[48:51], a[84:87], a[184:187], a[48:51]
    ds_read_b64_tr_b16 a[80:81], v241 offset:0
    v_mfma_f32_16x16x32_bf16 a[52:55], a[84:87], a[188:191], a[52:55]
    ds_read_b64_tr_b16 a[82:83], v241 offset:2304
    v_mfma_f32_16x16x32_bf16 a[56:59], a[84:87], a[192:195], a[56:59]
    v_mfma_f32_16x16x32_bf16 a[60:63], a[84:87], a[196:199], a[60:63]
    s_waitcnt lgkmcnt(8)
    v_mfma_f32_16x16x32_bf16 v[0:3], a[64:67], a[88:91], v[0:3]
    ds_read_b64_tr_b16 a[84:85], v241 offset:18432
    v_mfma_f32_16x16x32_bf16 v[4:7], a[64:67], a[92:95], v[4:7]
    ds_read_b64_tr_b16 a[86:87], v241 offset:20736
    v_mfma_f32_16x16x32_bf16 v[8:11], a[64:67], a[96:99], v[8:11]
    s_add_u32 m0, s51, 38912
    s_nop 0
    buffer_load_dwordx4 v228, s[12:15], s60 offen lds
    v_mfma_f32_16x16x32_bf16 v[12:15], a[64:67], a[100:103], v[12:15]
    s_waitcnt lgkmcnt(8)
    v_mfma_f32_16x16x32_bf16 v[16:19], a[68:71], a[88:91], v[16:19]
    ds_read_b64_tr_b16 a[64:65], v241 offset:9216
    v_mfma_f32_16x16x32_bf16 v[20:23], a[68:71], a[92:95], v[20:23]
    ds_read_b64_tr_b16 a[66:67], v241 offset:11520
    v_mfma_f32_16x16x32_bf16 v[24:27], a[68:71], a[96:99], v[24:27]
    s_add_u32 m0, s51, 39936
    s_nop 0
    buffer_load_dwordx4 v229, s[12:15], s60 offen lds
    v_mfma_f32_16x16x32_bf16 v[28:31], a[68:71], a[100:103], v[28:31]
    s_barrier
    s_waitcnt lgkmcnt(8)
    v_mfma_f32_16x16x32_bf16 v[0:3], a[72:75], a[104:107], v[0:3]
    ds_read_b64_tr_b16 a[68:69], v241 offset:27648
    v_mfma_f32_16x16x32_bf16 v[4:7], a[72:75], a[108:111], v[4:7]
    ds_read_b64_tr_b16 a[70:71], v241 offset:29952
    v_mfma_f32_16x16x32_bf16 v[8:11], a[72:75], a[112:115], v[8:11]
    s_add_u32 m0, s51, 40960
    s_nop 0
    buffer_load_dwordx4 v230, s[12:15], s60 offen lds
    v_mfma_f32_16x16x32_bf16 v[12:15], a[72:75], a[116:119], v[12:15]
    s_waitcnt lgkmcnt(8)
    v_mfma_f32_16x16x32_bf16 v[16:19], a[76:79], a[104:107], v[16:19]
    ds_read_b64_tr_b16 a[72:73], v244 offset:32
    v_mfma_f32_16x16x32_bf16 v[20:23], a[76:79], a[108:111], v[20:23]
    ds_read_b64_tr_b16 a[74:75], v244 offset:2336
    v_mfma_f32_16x16x32_bf16 v[24:27], a[76:79], a[112:115], v[24:27]
    s_add_u32 m0, s51, 41984
    s_nop 0
    buffer_load_dwordx4 v231, s[12:15], s60 offen lds
    v_mfma_f32_16x16x32_bf16 v[28:31], a[76:79], a[116:119], v[28:31]
    s_waitcnt lgkmcnt(8)
    v_mfma_f32_16x16x32_bf16 v[0:3], a[80:83], a[120:123], v[0:3]
    ds_read_b64_tr_b16 a[76:77], v244 offset:18464
    v_mfma_f32_16x16x32_bf16 v[4:7], a[80:83], a[124:127], v[4:7]
    ds_read_b64_tr_b16 a[78:79], v244 offset:20768
    v_mfma_f32_16x16x32_bf16 v[8:11], a[80:83], a[128:131], v[8:11]
    s_add_u32 m0, s51, 43008
    s_nop 0
    buffer_load_dwordx4 v232, s[12:15], s60 offen lds
    v_mfma_f32_16x16x32_bf16 v[12:15], a[80:83], a[132:135], v[12:15]
    s_waitcnt lgkmcnt(8)
    v_mfma_f32_16x16x32_bf16 v[16:19], a[84:87], a[120:123], v[16:19]
    ds_read_b64_tr_b16 a[80:81], v244 offset:9248
    v_mfma_f32_16x16x32_bf16 v[20:23], a[84:87], a[124:127], v[20:23]
    ds_read_b64_tr_b16 a[82:83], v244 offset:11552
    v_mfma_f32_16x16x32_bf16 v[24:27], a[84:87], a[128:131], v[24:27]
    s_add_u32 m0, s51, 44032
    s_nop 0
    buffer_load_dwordx4 v233, s[12:15], s60 offen lds
    v_mfma_f32_16x16x32_bf16 v[28:31], a[84:87], a[132:135], v[28:31]
    s_waitcnt lgkmcnt(8)
    v_mfma_f32_16x16x32_bf16 v[0:3], a[64:67], a[136:139], v[0:3]
    ds_read_b64_tr_b16 a[84:85], v244 offset:27680
    v_mfma_f32_16x16x32_bf16 v[4:7], a[64:67], a[140:143], v[4:7]
    ds_read_b64_tr_b16 a[86:87], v244 offset:29984
    v_mfma_f32_16x16x32_bf16 v[8:11], a[64:67], a[144:147], v[8:11]
    s_add_u32 m0, s51, 45056
    s_nop 0
    buffer_load_dwordx4 v234, s[12:15], s60 offen lds
    v_mfma_f32_16x16x32_bf16 v[12:15], a[64:67], a[148:151], v[12:15]
    s_waitcnt lgkmcnt(8)
    v_mfma_f32_16x16x32_bf16 v[16:19], a[68:71], a[136:139], v[16:19]
    ds_read_b64_tr_b16 a[64:65], v241 offset:32
    v_mfma_f32_16x16x32_bf16 v[20:23], a[68:71], a[140:143], v[20:23]
    ds_read_b64_tr_b16 a[66:67], v241 offset:2336
    v_mfma_f32_16x16x32_bf16 v[24:27], a[68:71], a[144:147], v[24:27]
    s_add_u32 m0, s51, 73728
    s_nop 0
    buffer_load_dwordx4 v226, s[12:15], s61 offen lds
    v_mfma_f32_16x16x32_bf16 v[28:31], a[68:71], a[148:151], v[28:31]
    s_waitcnt lgkmcnt(8)
    v_mfma_f32_16x16x32_bf16 v[32:35], a[72:75], a[88:91], v[32:35]
    ds_read_b64_tr_b16 a[68:69], v241 offset:18464
    v_mfma_f32_16x16x32_bf16 v[36:39], a[72:75], a[92:95], v[36:39]
    ds_read_b64_tr_b16 a[70:71], v241 offset:20768
    v_mfma_f32_16x16x32_bf16 v[40:43], a[72:75], a[96:99], v[40:43]
    s_add_u32 m0, s51, 74752
    s_nop 0
    buffer_load_dwordx4 v227, s[12:15], s61 offen lds
    v_mfma_f32_16x16x32_bf16 v[44:47], a[72:75], a[100:103], v[44:47]
    s_waitcnt lgkmcnt(8)
    v_mfma_f32_16x16x32_bf16 v[48:51], a[76:79], a[88:91], v[48:51]
    ds_read_b64_tr_b16 a[72:73], v241 offset:9248
    v_mfma_f32_16x16x32_bf16 v[52:55], a[76:79], a[92:95], v[52:55]
    ds_read_b64_tr_b16 a[74:75], v241 offset:11552
    v_mfma_f32_16x16x32_bf16 v[56:59], a[76:79], a[96:99], v[56:59]
    s_add_u32 m0, s51, 75776
    s_nop 0
    buffer_load_dwordx4 v228, s[12:15], s61 offen lds
    v_mfma_f32_16x16x32_bf16 v[60:63], a[76:79], a[100:103], v[60:63]
    s_waitcnt lgkmcnt(8)
    v_mfma_f32_16x16x32_bf16 v[32:35], a[80:83], a[104:107], v[32:35]
    ds_read_b64_tr_b16 a[76:77], v241 offset:27680
    v_mfma_f32_16x16x32_bf16 v[36:39], a[80:83], a[108:111], v[36:39]
    ds_read_b64_tr_b16 a[78:79], v241 offset:29984
    v_mfma_f32_16x16x32_bf16 v[40:43], a[80:83], a[112:115], v[40:43]
    s_add_u32 m0, s51, 76800
    s_nop 0
    buffer_load_dwordx4 v229, s[12:15], s61 offen lds
    v_mfma_f32_16x16x32_bf16 v[44:47], a[80:83], a[116:119], v[44:47]
    s_waitcnt lgkmcnt(8)
    v_mfma_f32_16x16x32_bf16 v[48:51], a[84:87], a[104:107], v[48:51]
    ds_read_b64_tr_b16 a[80:81], v244 offset:64
    v_mfma_f32_16x16x32_bf16 v[52:55], a[84:87], a[108:111], v[52:55]
    ds_read_b64_tr_b16 a[82:83], v244 offset:2368
    v_mfma_f32_16x16x32_bf16 v[56:59], a[84:87], a[112:115], v[56:59]
    s_add_u32 m0, s51, 77824
    s_nop 0
    buffer_load_dwordx4 v230, s[12:15], s61 offen lds
    v_mfma_f32_16x16x32_bf16 v[60:63], a[84:87], a[116:119], v[60:63]
    s_waitcnt lgkmcnt(8)
    v_mfma_f32_16x16x32_bf16 v[32:35], a[64:67], a[120:123], v[32:35]
    ds_read_b64_tr_b16 a[84:85], v244 offset:18496
    v_mfma_f32_16x16x32_bf16 v[36:39], a[64:67], a[124:127], v[36:39]
    ds_read_b64_tr_b16 a[86:87], v244 offset:20800
    v_mfma_f32_16x16x32_bf16 v[40:43], a[64:67], a[128:131], v[40:43]
    s_add_u32 m0, s51, 78848
    s_nop 0
    buffer_load_dwordx4 v231, s[12:15], s61 offen lds
    v_mfma_f32_16x16x32_bf16 v[44:47], a[64:67], a[132:135], v[44:47]
    s_waitcnt lgkmcnt(8)
    v_mfma_f32_16x16x32_bf16 v[48:51], a[68:71], a[120:123], v[48:51]
    ds_read_b64_tr_b16 a[64:65], v244 offset:9280
    v_mfma_f32_16x16x32_bf16 v[52:55], a[68:71], a[124:127], v[52:55]
    ds_read_b64_tr_b16 a[66:67], v244 offset:11584
    v_mfma_f32_16x16x32_bf16 v[56:59], a[68:71], a[128:131], v[56:59]
    s_add_u32 m0, s51, 79872
    s_nop 0
    buffer_load_dwordx4 v232, s[12:15], s61 offen lds
    v_mfma_f32_16x16x32_bf16 v[60:63], a[68:71], a[132:135], v[60:63]
    s_waitcnt lgkmcnt(8)
    v_mfma_f32_16x16x32_bf16 v[32:35], a[72:75], a[136:139], v[32:35]
    ds_read_b64_tr_b16 a[68:69], v244 offset:27712
    v_mfma_f32_16x16x32_bf16 v[36:39], a[72:75], a[140:143], v[36:39]
    ds_read_b64_tr_b16 a[70:71], v244 offset:30016
    v_mfma_f32_16x16x32_bf16 v[40:43], a[72:75], a[144:147], v[40:43]
    s_add_u32 m0, s51, 80896
    s_nop 0
    buffer_load_dwordx4 v233, s[12:15], s61 offen lds
    v_mfma_f32_16x16x32_bf16 v[44:47], a[72:75], a[148:151], v[44:47]
    s_waitcnt lgkmcnt(8)
    v_mfma_f32_16x16x32_bf16 v[48:51], a[76:79], a[136:139], v[48:51]
    ds_read_b64_tr_b16 a[72:73], v241 offset:64
    v_mfma_f32_16x16x32_bf16 v[52:55], a[76:79], a[140:143], v[52:55]
    ds_read_b64_tr_b16 a[74:75], v241 offset:2368
    v_mfma_f32_16x16x32_bf16 v[56:59], a[76:79], a[144:147], v[56:59]
    s_add_u32 m0, s51, 81920
    s_nop 0
    buffer_load_dwordx4 v234, s[12:15], s61 offen lds
    v_mfma_f32_16x16x32_bf16 v[60:63], a[76:79], a[148:151], v[60:63]
    s_waitcnt lgkmcnt(8)
    v_mfma_f32_16x16x32_bf16 v[64:67], a[80:83], a[88:91], v[64:67]
    ds_read_b64_tr_b16 a[76:77], v241 offset:18496
    v_mfma_f32_16x16x32_bf16 v[68:71], a[80:83], a[92:95], v[68:71]
    ds_read_b64_tr_b16 a[78:79], v241 offset:20800
    v_mfma_f32_16x16x32_bf16 v[72:75], a[80:83], a[96:99], v[72:75]
    v_mfma_f32_16x16x32_bf16 v[76:79], a[80:83], a[100:103], v[76:79]
    s_waitcnt lgkmcnt(8)
    v_mfma_f32_16x16x32_bf16 v[80:83], a[84:87], a[88:91], v[80:83]
    ds_read_b64_tr_b16 a[80:81], v241 offset:9280
    v_mfma_f32_16x16x32_bf16 v[84:87], a[84:87], a[92:95], v[84:87]
    ds_read_b64_tr_b16 a[82:83], v241 offset:11584
    v_mfma_f32_16x16x32_bf16 v[88:91], a[84:87], a[96:99], v[88:91]
    v_mfma_f32_16x16x32_bf16 v[92:95], a[84:87], a[100:103], v[92:95]
    s_waitcnt lgkmcnt(8)
    v_mfma_f32_16x16x32_bf16 v[64:67], a[64:67], a[104:107], v[64:67]
    ds_read_b64_tr_b16 a[84:85], v241 offset:27712
    v_mul_f32 v0, v0, v16
    v_mfma_f32_16x16x32_bf16 v[68:71], a[64:67], a[108:111], v[68:71]
    ds_read_b64_tr_b16 a[86:87], v241 offset:30016
    v_mul_f32 v1, v1, v17
    v_mfma_f32_16x16x32_bf16 v[72:75], a[64:67], a[112:115], v[72:75]
    v_mul_f32 v2, v2, v18
    v_mul_f32 v3, v3, v19
    v_mfma_f32_16x16x32_bf16 v[76:79], a[64:67], a[116:119], v[76:79]
    v_cvt_pk_bf16_f32 v246, v0, v1
    v_cvt_pk_bf16_f32 v247, v2, v3
    s_waitcnt lgkmcnt(8)
    v_mfma_f32_16x16x32_bf16 v[80:83], a[68:71], a[104:107], v[80:83]
    ds_read_b64_tr_b16 a[64:65], v244 offset:96
    v_mul_f32 v32, v32, v48
    v_mfma_f32_16x16x32_bf16 v[84:87], a[68:71], a[108:111], v[84:87]
    ds_read_b64_tr_b16 a[66:67], v244 offset:2400
    v_mul_f32 v33, v33, v49
    v_mfma_f32_16x16x32_bf16 v[88:91], a[68:71], a[112:115], v[88:91]
    v_mul_f32 v34, v34, v50
    v_mul_f32 v35, v35, v51
    v_mfma_f32_16x16x32_bf16 v[92:95], a[68:71], a[116:119], v[92:95]
    v_cvt_pk_bf16_f32 v248, v32, v33
    v_cvt_pk_bf16_f32 v249, v34, v35
    s_waitcnt lgkmcnt(8)
    v_mfma_f32_16x16x32_bf16 v[64:67], a[72:75], a[120:123], v[64:67]
    ds_read_b64_tr_b16 a[68:69], v244 offset:18528
    buffer_store_dwordx4 v[246:249], v237, s[8:11], s52 offen offset:0 sc1
    v_mfma_f32_16x16x32_bf16 v[68:71], a[72:75], a[124:127], v[68:71]
    ds_read_b64_tr_b16 a[70:71], v244 offset:20832
    v_mul_f32 v4, v4, v20
    v_mfma_f32_16x16x32_bf16 v[72:75], a[72:75], a[128:131], v[72:75]
    v_mul_f32 v5, v5, v21
    v_mul_f32 v6, v6, v22
    v_mfma_f32_16x16x32_bf16 v[76:79], a[72:75], a[132:135], v[76:79]
    v_mul_f32 v7, v7, v23
    v_cvt_pk_bf16_f32 v250, v4, v5
    s_waitcnt lgkmcnt(8)
    v_mfma_f32_16x16x32_bf16 v[80:83], a[76:79], a[120:123], v[80:83]
    ds_read_b64_tr_b16 a[72:73], v244 offset:9312
    v_cvt_pk_bf16_f32 v251, v6, v7
    v_mfma_f32_16x16x32_bf16 v[84:87], a[76:79], a[124:127], v[84:87]
    ds_read_b64_tr_b16 a[74:75], v244 offset:11616
    v_mul_f32 v36, v36, v52
    v_mfma_f32_16x16x32_bf16 v[88:91], a[76:79], a[128:131], v[88:91]
    v_mul_f32 v37, v37, v53
    v_mul_f32 v38, v38, v54
    v_mfma_f32_16x16x32_bf16 v[92:95], a[76:79], a[132:135], v[92:95]
    v_mul_f32 v39, v39, v55
    v_cvt_pk_bf16_f32 v252, v36, v37
    s_waitcnt lgkmcnt(8)
    v_mfma_f32_16x16x32_bf16 v[64:67], a[80:83], a[136:139], v[64:67]
    ds_read_b64_tr_b16 a[76:77], v244 offset:27744
    v_cvt_pk_bf16_f32 v253, v38, v39
    v_mfma_f32_16x16x32_bf16 v[68:71], a[80:83], a[140:143], v[68:71]
    ds_read_b64_tr_b16 a[78:79], v244 offset:30048
    buffer_store_dwordx4 v[250:253], v237, s[8:11], s53 offen offset:0 sc1
    v_mfma_f32_16x16x32_bf16 v[72:75], a[80:83], a[144:147], v[72:75]
    v_mul_f32 v8, v8, v24
    v_mul_f32 v9, v9, v25
    v_mfma_f32_16x16x32_bf16 v[76:79], a[80:83], a[148:151], v[76:79]
    v_mul_f32 v10, v10, v26
    v_mul_f32 v11, v11, v27
    s_waitcnt lgkmcnt(8)
    v_mfma_f32_16x16x32_bf16 v[80:83], a[84:87], a[136:139], v[80:83]
    ds_read_b64_tr_b16 a[80:81], v241 offset:96
    v_cvt_pk_bf16_f32 v246, v8, v9
    v_mfma_f32_16x16x32_bf16 v[84:87], a[84:87], a[140:143], v[84:87]
    ds_read_b64_tr_b16 a[82:83], v241 offset:2400
    v_cvt_pk_bf16_f32 v247, v10, v11
    v_mfma_f32_16x16x32_bf16 v[88:91], a[84:87], a[144:147], v[88:91]
    v_mul_f32 v40, v40, v56
    v_mul_f32 v41, v41, v57
    v_mfma_f32_16x16x32_bf16 v[92:95], a[84:87], a[148:151], v[92:95]
    v_mul_f32 v42, v42, v58
    v_mul_f32 v43, v43, v59
    s_waitcnt lgkmcnt(8)
    v_mfma_f32_16x16x32_bf16 v[96:99], a[64:67], a[88:91], v[96:99]
    ds_read_b64_tr_b16 a[84:85], v241 offset:18528
    v_cvt_pk_bf16_f32 v248, v40, v41
    v_mfma_f32_16x16x32_bf16 v[100:103], a[64:67], a[92:95], v[100:103]
    ds_read_b64_tr_b16 a[86:87], v241 offset:20832
    v_cvt_pk_bf16_f32 v249, v42, v43
    v_mfma_f32_16x16x32_bf16 v[104:107], a[64:67], a[96:99], v[104:107]
    buffer_store_dwordx4 v[246:249], v237, s[8:11], s54 offen offset:0 sc1
    v_mul_f32 v12, v12, v28
    v_mfma_f32_16x16x32_bf16 v[108:111], a[64:67], a[100:103], v[108:111]
    v_mul_f32 v13, v13, v29
    v_mul_f32 v14, v14, v30
    s_waitcnt lgkmcnt(8)
    v_mfma_f32_16x16x32_bf16 v[112:115], a[68:71], a[88:91], v[112:115]
    ds_read_b64_tr_b16 a[64:65], v241 offset:9312
    v_mul_f32 v15, v15, v31
    v_mfma_f32_16x16x32_bf16 v[116:119], a[68:71], a[92:95], v[116:119]
    ds_read_b64_tr_b16 a[66:67], v241 offset:11616
    v_cvt_pk_bf16_f32 v250, v12, v13
    v_mfma_f32_16x16x32_bf16 v[120:123], a[68:71], a[96:99], v[120:123]
    v_cvt_pk_bf16_f32 v251, v14, v15
    v_mul_f32 v44, v44, v60
    v_mfma_f32_16x16x32_bf16 v[124:127], a[68:71], a[100:103], v[124:127]
    v_mul_f32 v45, v45, v61
    v_mul_f32 v46, v46, v62
    s_waitcnt lgkmcnt(8)
    v_mfma_f32_16x16x32_bf16 v[96:99], a[72:75], a[104:107], v[96:99]
    ds_read_b64_tr_b16 a[68:69], v241 offset:27744
    v_mul_f32 v47, v47, v63
    v_mfma_f32_16x16x32_bf16 v[100:103], a[72:75], a[108:111], v[100:103]
    ds_read_b64_tr_b16 a[70:71], v241 offset:30048
    v_cvt_pk_bf16_f32 v252, v44, v45
    v_mfma_f32_16x16x32_bf16 v[104:107], a[72:75], a[112:115], v[104:107]
    v_cvt_pk_bf16_f32 v253, v46, v47
    buffer_store_dwordx4 v[250:253], v237, s[8:11], s55 offen offset:0 sc1
    v_mfma_f32_16x16x32_bf16 v[108:111], a[72:75], a[116:119], v[108:111]
    s_waitcnt lgkmcnt(8)
    v_mfma_f32_16x16x32_bf16 v[112:115], a[76:79], a[104:107], v[112:115]
    ds_read_b64_tr_b16 a[72:73], v244 offset:128
    v_mfma_f32_16x16x32_bf16 v[116:119], a[76:79], a[108:111], v[116:119]
    ds_read_b64_tr_b16 a[74:75], v244 offset:2432
    v_mfma_f32_16x16x32_bf16 v[120:123], a[76:79], a[112:115], v[120:123]
    v_mfma_f32_16x16x32_bf16 v[124:127], a[76:79], a[116:119], v[124:127]
    s_waitcnt lgkmcnt(8)
    v_mfma_f32_16x16x32_bf16 v[96:99], a[80:83], a[120:123], v[96:99]
    ds_read_b64_tr_b16 a[76:77], v244 offset:18560
    v_mfma_f32_16x16x32_bf16 v[100:103], a[80:83], a[124:127], v[100:103]
    ds_read_b64_tr_b16 a[78:79], v244 offset:20864
    v_mfma_f32_16x16x32_bf16 v[104:107], a[80:83], a[128:131], v[104:107]
    v_mfma_f32_16x16x32_bf16 v[108:111], a[80:83], a[132:135], v[108:111]
    s_waitcnt lgkmcnt(8)
    v_mfma_f32_16x16x32_bf16 v[112:115], a[84:87], a[120:123], v[112:115]
    ds_read_b64_tr_b16 a[80:81], v244 offset:9344
    v_mfma_f32_16x16x32_bf16 v[116:119], a[84:87], a[124:127], v[116:119]
    ds_read_b64_tr_b16 a[82:83], v244 offset:11648
    v_mfma_f32_16x16x32_bf16 v[120:123], a[84:87], a[128:131], v[120:123]
    v_mfma_f32_16x16x32_bf16 v[124:127], a[84:87], a[132:135], v[124:127]
    s_waitcnt lgkmcnt(8)
    v_mfma_f32_16x16x32_bf16 v[96:99], a[64:67], a[136:139], v[96:99]
    ds_read_b64_tr_b16 a[84:85], v244 offset:27776
    v_mfma_f32_16x16x32_bf16 v[100:103], a[64:67], a[140:143], v[100:103]
    ds_read_b64_tr_b16 a[86:87], v244 offset:30080
    v_mfma_f32_16x16x32_bf16 v[104:107], a[64:67], a[144:147], v[104:107]
    v_mfma_f32_16x16x32_bf16 v[108:111], a[64:67], a[148:151], v[108:111]
    s_waitcnt lgkmcnt(8)
    v_mfma_f32_16x16x32_bf16 v[112:115], a[68:71], a[136:139], v[112:115]
    ds_read_b64_tr_b16 a[64:65], v241 offset:128
    v_mfma_f32_16x16x32_bf16 v[116:119], a[68:71], a[140:143], v[116:119]
    ds_read_b64_tr_b16 a[66:67], v241 offset:2432
    v_mfma_f32_16x16x32_bf16 v[120:123], a[68:71], a[144:147], v[120:123]
    v_mfma_f32_16x16x32_bf16 v[124:127], a[68:71], a[148:151], v[124:127]
    s_waitcnt lgkmcnt(8)
    v_mfma_f32_16x16x32_bf16 v[128:131], a[72:75], a[88:91], v[128:131]
    ds_read_b64_tr_b16 a[68:69], v241 offset:18560
    v_mfma_f32_16x16x32_bf16 v[132:135], a[72:75], a[92:95], v[132:135]
    ds_read_b64_tr_b16 a[70:71], v241 offset:20864
    v_mfma_f32_16x16x32_bf16 v[136:139], a[72:75], a[96:99], v[136:139]
    v_mfma_f32_16x16x32_bf16 v[140:143], a[72:75], a[100:103], v[140:143]
    s_waitcnt lgkmcnt(8)
    v_mfma_f32_16x16x32_bf16 v[144:147], a[76:79], a[88:91], v[144:147]
    ds_read_b64_tr_b16 a[72:73], v241 offset:9344
    v_mfma_f32_16x16x32_bf16 v[148:151], a[76:79], a[92:95], v[148:151]
    ds_read_b64_tr_b16 a[74:75], v241 offset:11648
    v_mfma_f32_16x16x32_bf16 v[152:155], a[76:79], a[96:99], v[152:155]
    v_mfma_f32_16x16x32_bf16 v[156:159], a[76:79], a[100:103], v[156:159]
    s_waitcnt lgkmcnt(8)
    v_mfma_f32_16x16x32_bf16 v[128:131], a[80:83], a[104:107], v[128:131]
    ds_read_b64_tr_b16 a[76:77], v241 offset:27776
    v_mul_f32 v64, v64, v80
    v_mfma_f32_16x16x32_bf16 v[132:135], a[80:83], a[108:111], v[132:135]
    ds_read_b64_tr_b16 a[78:79], v241 offset:30080
    v_mul_f32 v65, v65, v81
    v_mfma_f32_16x16x32_bf16 v[136:139], a[80:83], a[112:115], v[136:139]
    v_mul_f32 v66, v66, v82
    v_mul_f32 v67, v67, v83
    v_mfma_f32_16x16x32_bf16 v[140:143], a[80:83], a[116:119], v[140:143]
    v_cvt_pk_bf16_f32 v246, v64, v65
    v_cvt_pk_bf16_f32 v247, v66, v67
    s_waitcnt lgkmcnt(8)
    v_mfma_f32_16x16x32_bf16 v[144:147], a[84:87], a[104:107], v[144:147]
    ds_read_b64_tr_b16 a[80:81], v244 offset:160
    v_mul_f32 v96, v96, v112
    v_mfma_f32_16x16x32_bf16 v[148:151], a[84:87], a[108:111], v[148:151]
    ds_read_b64_tr_b16 a[82:83], v244 offset:2464
    v_mul_f32 v97, v97, v113
    v_mfma_f32_16x16x32_bf16 v[152:155], a[84:87], a[112:115], v[152:155]
    v_mul_f32 v98, v98, v114
    v_mul_f32 v99, v99, v115
    v_mfma_f32_16x16x32_bf16 v[156:159], a[84:87], a[116:119], v[156:159]
    v_cvt_pk_bf16_f32 v248, v96, v97
    v_cvt_pk_bf16_f32 v249, v98, v99
    s_waitcnt lgkmcnt(8)
    v_mfma_f32_16x16x32_bf16 v[128:131], a[64:67], a[120:123], v[128:131]
    ds_read_b64_tr_b16 a[84:85], v244 offset:18592
    buffer_store_dwordx4 v[246:249], v237, s[8:11], s52 offen offset:1024 sc1
    v_mfma_f32_16x16x32_bf16 v[132:135], a[64:67], a[124:127], v[132:135]
    ds_read_b64_tr_b16 a[86:87], v244 offset:20896
    v_mul_f32 v68, v68, v84
    v_mfma_f32_16x16x32_bf16 v[136:139], a[64:67], a[128:131], v[136:139]
    v_mul_f32 v69, v69, v85
    v_mul_f32 v70, v70, v86
    v_mfma_f32_16x16x32_bf16 v[140:143], a[64:67], a[132:135], v[140:143]
    v_mul_f32 v71, v71, v87
    v_cvt_pk_bf16_f32 v250, v68, v69
    s_waitcnt lgkmcnt(8)
    v_mfma_f32_16x16x32_bf16 v[144:147], a[68:71], a[120:123], v[144:147]
    ds_read_b64_tr_b16 a[64:65], v244 offset:9376
    v_cvt_pk_bf16_f32 v251, v70, v71
    v_mfma_f32_16x16x32_bf16 v[148:151], a[68:71], a[124:127], v[148:151]
    ds_read_b64_tr_b16 a[66:67], v244 offset:11680
    v_mul_f32 v100, v100, v116
    v_mfma_f32_16x16x32_bf16 v[152:155], a[68:71], a[128:131], v[152:155]
    v_mul_f32 v101, v101, v117
    v_mul_f32 v102, v102, v118
    v_mfma_f32_16x16x32_bf16 v[156:159], a[68:71], a[132:135], v[156:159]
    v_mul_f32 v103, v103, v119
    v_cvt_pk_bf16_f32 v252, v100, v101
    s_waitcnt lgkmcnt(8)
    v_mfma_f32_16x16x32_bf16 v[128:131], a[72:75], a[136:139], v[128:131]
    ds_read_b64_tr_b16 a[68:69], v244 offset:27808
    v_cvt_pk_bf16_f32 v253, v102, v103
    v_mfma_f32_16x16x32_bf16 v[132:135], a[72:75], a[140:143], v[132:135]
    ds_read_b64_tr_b16 a[70:71], v244 offset:30112
    buffer_store_dwordx4 v[250:253], v237, s[8:11], s53 offen offset:1024 sc1
    v_mfma_f32_16x16x32_bf16 v[136:139], a[72:75], a[144:147], v[136:139]
    v_mul_f32 v72, v72, v88
    v_mul_f32 v73, v73, v89
    v_mfma_f32_16x16x32_bf16 v[140:143], a[72:75], a[148:151], v[140:143]
    v_mul_f32 v74, v74, v90
    v_mul_f32 v75, v75, v91
    s_waitcnt lgkmcnt(8)
    v_mfma_f32_16x16x32_bf16 v[144:147], a[76:79], a[136:139], v[144:147]
    ds_read_b64_tr_b16 a[72:73], v241 offset:160
    v_cvt_pk_bf16_f32 v246, v72, v73
    v_mfma_f32_16x16x32_bf16 v[148:151], a[76:79], a[140:143], v[148:151]
    ds_read_b64_tr_b16 a[74:75], v241 offset:2464
    v_cvt_pk_bf16_f32 v247, v74, v75
    v_mfma_f32_16x16x32_bf16 v[152:155], a[76:79], a[144:147], v[152:155]
    v_mul_f32 v104, v104, v120
    v_mul_f32 v105, v105, v121
    v_mfma_f32_16x16x32_bf16 v[156:159], a[76:79], a[148:151], v[156:159]
    v_mul_f32 v106, v106, v122
    v_mul_f32 v107, v107, v123
    s_waitcnt lgkmcnt(8)
    v_mfma_f32_16x16x32_bf16 v[160:163], a[80:83], a[88:91], v[160:163]
    ds_read_b64_tr_b16 a[76:77], v241 offset:18592
    v_cvt_pk_bf16_f32 v248, v104, v105
    v_mfma_f32_16x16x32_bf16 v[164:167], a[80:83], a[92:95], v[164:167]
    ds_read_b64_tr_b16 a[78:79], v241 offset:20896
    v_cvt_pk_bf16_f32 v249, v106, v107
    v_mfma_f32_16x16x32_bf16 v[168:171], a[80:83], a[96:99], v[168:171]
    buffer_store_dwordx4 v[246:249], v237, s[8:11], s54 offen offset:1024 sc1
    v_mul_f32 v76, v76, v92
    v_mfma_f32_16x16x32_bf16 v[172:175], a[80:83], a[100:103], v[172:175]
    v_mul_f32 v77, v77, v93
    v_mul_f32 v78, v78, v94
    s_waitcnt lgkmcnt(8)
    v_mfma_f32_16x16x32_bf16 v[176:179], a[84:87], a[88:91], v[176:179]
    ds_read_b64_tr_b16 a[80:81], v241 offset:9376
    v_mul_f32 v79, v79, v95
    v_mfma_f32_16x16x32_bf16 v[180:183], a[84:87], a[92:95], v[180:183]
    ds_read_b64_tr_b16 a[82:83], v241 offset:11680
    v_cvt_pk_bf16_f32 v250, v76, v77
    v_mfma_f32_16x16x32_bf16 v[184:187], a[84:87], a[96:99], v[184:187]
    v_cvt_pk_bf16_f32 v251, v78, v79
    v_mul_f32 v108, v108, v124
    v_mfma_f32_16x16x32_bf16 v[188:191], a[84:87], a[100:103], v[188:191]
    v_mul_f32 v109, v109, v125
    v_mul_f32 v110, v110, v126
    s_waitcnt lgkmcnt(8)
    v_mfma_f32_16x16x32_bf16 v[160:163], a[64:67], a[104:107], v[160:163]
    ds_read_b64_tr_b16 a[84:85], v241 offset:27808
    v_mul_f32 v111, v111, v127
    v_mfma_f32_16x16x32_bf16 v[164:167], a[64:67], a[108:111], v[164:167]
    ds_read_b64_tr_b16 a[86:87], v241 offset:30112
    v_cvt_pk_bf16_f32 v252, v108, v109
    v_mfma_f32_16x16x32_bf16 v[168:171], a[64:67], a[112:115], v[168:171]
    v_cvt_pk_bf16_f32 v253, v110, v111
    buffer_store_dwordx4 v[250:253], v237, s[8:11], s55 offen offset:1024 sc1
    v_mfma_f32_16x16x32_bf16 v[172:175], a[64:67], a[116:119], v[172:175]
    s_waitcnt lgkmcnt(8)
    v_mfma_f32_16x16x32_bf16 v[176:179], a[68:71], a[104:107], v[176:179]
    ds_read_b64_tr_b16 a[64:65], v244 offset:192
    v_mfma_f32_16x16x32_bf16 v[180:183], a[68:71], a[108:111], v[180:183]
    ds_read_b64_tr_b16 a[66:67], v244 offset:2496
    v_mfma_f32_16x16x32_bf16 v[184:187], a[68:71], a[112:115], v[184:187]
    v_mfma_f32_16x16x32_bf16 v[188:191], a[68:71], a[116:119], v[188:191]
    s_waitcnt lgkmcnt(8)
    v_mfma_f32_16x16x32_bf16 v[160:163], a[72:75], a[120:123], v[160:163]
    ds_read_b64_tr_b16 a[68:69], v244 offset:18624
    v_mfma_f32_16x16x32_bf16 v[164:167], a[72:75], a[124:127], v[164:167]
    ds_read_b64_tr_b16 a[70:71], v244 offset:20928
    v_mfma_f32_16x16x32_bf16 v[168:171], a[72:75], a[128:131], v[168:171]
    v_mfma_f32_16x16x32_bf16 v[172:175], a[72:75], a[132:135], v[172:175]
    s_waitcnt lgkmcnt(8)
    v_mfma_f32_16x16x32_bf16 v[176:179], a[76:79], a[120:123], v[176:179]
    ds_read_b64_tr_b16 a[72:73], v244 offset:9408
    v_mfma_f32_16x16x32_bf16 v[180:183], a[76:79], a[124:127], v[180:183]
    ds_read_b64_tr_b16 a[74:75], v244 offset:11712
    v_mfma_f32_16x16x32_bf16 v[184:187], a[76:79], a[128:131], v[184:187]
    v_mfma_f32_16x16x32_bf16 v[188:191], a[76:79], a[132:135], v[188:191]
    s_waitcnt lgkmcnt(8)
    v_mfma_f32_16x16x32_bf16 v[160:163], a[80:83], a[136:139], v[160:163]
    ds_read_b64_tr_b16 a[76:77], v244 offset:27840
    v_mfma_f32_16x16x32_bf16 v[164:167], a[80:83], a[140:143], v[164:167]
    ds_read_b64_tr_b16 a[78:79], v244 offset:30144
    v_mfma_f32_16x16x32_bf16 v[168:171], a[80:83], a[144:147], v[168:171]
    v_mfma_f32_16x16x32_bf16 v[172:175], a[80:83], a[148:151], v[172:175]
    s_waitcnt lgkmcnt(8)
    v_mfma_f32_16x16x32_bf16 v[176:179], a[84:87], a[136:139], v[176:179]
    ds_read_b64_tr_b16 a[80:81], v241 offset:192
    v_mfma_f32_16x16x32_bf16 v[180:183], a[84:87], a[140:143], v[180:183]
    ds_read_b64_tr_b16 a[82:83], v241 offset:2496
    v_mfma_f32_16x16x32_bf16 v[184:187], a[84:87], a[144:147], v[184:187]
    v_mfma_f32_16x16x32_bf16 v[188:191], a[84:87], a[148:151], v[188:191]
    s_waitcnt lgkmcnt(8)
    v_mfma_f32_16x16x32_bf16 v[192:195], a[64:67], a[88:91], v[192:195]
    ds_read_b64_tr_b16 a[84:85], v241 offset:18624
    v_mfma_f32_16x16x32_bf16 v[196:199], a[64:67], a[92:95], v[196:199]
    ds_read_b64_tr_b16 a[86:87], v241 offset:20928
    v_mfma_f32_16x16x32_bf16 v[200:203], a[64:67], a[96:99], v[200:203]
    v_mfma_f32_16x16x32_bf16 v[204:207], a[64:67], a[100:103], v[204:207]
    s_waitcnt lgkmcnt(8)
    v_mfma_f32_16x16x32_bf16 v[208:211], a[68:71], a[88:91], v[208:211]
    ds_read_b64_tr_b16 a[64:65], v241 offset:9408
    v_mfma_f32_16x16x32_bf16 v[212:215], a[68:71], a[92:95], v[212:215]
    ds_read_b64_tr_b16 a[66:67], v241 offset:11712
    v_mfma_f32_16x16x32_bf16 v[216:219], a[68:71], a[96:99], v[216:219]
    v_mfma_f32_16x16x32_bf16 v[220:223], a[68:71], a[100:103], v[220:223]
    s_waitcnt lgkmcnt(8)
    v_mfma_f32_16x16x32_bf16 v[192:195], a[72:75], a[104:107], v[192:195]
    ds_read_b64_tr_b16 a[68:69], v241 offset:27840
    v_mul_f32 v128, v128, v144
    v_mfma_f32_16x16x32_bf16 v[196:199], a[72:75], a[108:111], v[196:199]
    ds_read_b64_tr_b16 a[70:71], v241 offset:30144
    v_mul_f32 v129, v129, v145
    v_mfma_f32_16x16x32_bf16 v[200:203], a[72:75], a[112:115], v[200:203]
    v_mul_f32 v130, v130, v146
    v_mul_f32 v131, v131, v147
    v_mfma_f32_16x16x32_bf16 v[204:207], a[72:75], a[116:119], v[204:207]
    v_cvt_pk_bf16_f32 v246, v128, v129
    v_cvt_pk_bf16_f32 v247, v130, v131
    s_waitcnt lgkmcnt(8)
    v_mfma_f32_16x16x32_bf16 v[208:211], a[76:79], a[104:107], v[208:211]
    ds_read_b64_tr_b16 a[72:73], v244 offset:224
    v_mul_f32 v160, v160, v176
    v_mfma_f32_16x16x32_bf16 v[212:215], a[76:79], a[108:111], v[212:215]
    ds_read_b64_tr_b16 a[74:75], v244 offset:2528
    v_mul_f32 v161, v161, v177
    v_mfma_f32_16x16x32_bf16 v[216:219], a[76:79], a[112:115], v[216:219]
    v_mul_f32 v162, v162, v178
    v_mul_f32 v163, v163, v179
    v_mfma_f32_16x16x32_bf16 v[220:223], a[76:79], a[116:119], v[220:223]
    v_cvt_pk_bf16_f32 v248, v160, v161
    v_cvt_pk_bf16_f32 v249, v162, v163
    s_waitcnt lgkmcnt(8)
    v_mfma_f32_16x16x32_bf16 v[192:195], a[80:83], a[120:123], v[192:195]
    ds_read_b64_tr_b16 a[76:77], v244 offset:18656
    buffer_store_dwordx4 v[246:249], v237, s[8:11], s52 offen offset:2048 sc1
    v_mfma_f32_16x16x32_bf16 v[196:199], a[80:83], a[124:127], v[196:199]
    ds_read_b64_tr_b16 a[78:79], v244 offset:20960
    v_mul_f32 v132, v132, v148
    v_mfma_f32_16x16x32_bf16 v[200:203], a[80:83], a[128:131], v[200:203]
    v_mul_f32 v133, v133, v149
    v_mul_f32 v134, v134, v150
    v_mfma_f32_16x16x32_bf16 v[204:207], a[80:83], a[132:135], v[204:207]
    v_mul_f32 v135, v135, v151
    v_cvt_pk_bf16_f32 v250, v132, v133
    s_waitcnt lgkmcnt(8)
    v_mfma_f32_16x16x32_bf16 v[208:211], a[84:87], a[120:123], v[208:211]
    ds_read_b64_tr_b16 a[80:81], v244 offset:9440
    v_cvt_pk_bf16_f32 v251, v134, v135
    v_mfma_f32_16x16x32_bf16 v[212:215], a[84:87], a[124:127], v[212:215]
    ds_read_b64_tr_b16 a[82:83], v244 offset:11744
    v_mul_f32 v164, v164, v180
    v_mfma_f32_16x16x32_bf16 v[216:219], a[84:87], a[128:131], v[216:219]
    v_mul_f32 v165, v165, v181
    v_mul_f32 v166, v166, v182
    v_mfma_f32_16x16x32_bf16 v[220:223], a[84:87], a[132:135], v[220:223]
    v_mul_f32 v167, v167, v183
    v_cvt_pk_bf16_f32 v252, v164, v165
    s_waitcnt lgkmcnt(8)
    v_mfma_f32_16x16x32_bf16 v[192:195], a[64:67], a[136:139], v[192:195]
    ds_read_b64_tr_b16 a[84:85], v244 offset:27872
    v_cvt_pk_bf16_f32 v253, v166, v167
    v_mfma_f32_16x16x32_bf16 v[196:199], a[64:67], a[140:143], v[196:199]
    ds_read_b64_tr_b16 a[86:87], v244 offset:30176
    buffer_store_dwordx4 v[250:253], v237, s[8:11], s53 offen offset:2048 sc1
    v_mfma_f32_16x16x32_bf16 v[200:203], a[64:67], a[144:147], v[200:203]
    v_mul_f32 v136, v136, v152
    v_mul_f32 v137, v137, v153
    v_mfma_f32_16x16x32_bf16 v[204:207], a[64:67], a[148:151], v[204:207]
    v_mul_f32 v138, v138, v154
    v_mul_f32 v139, v139, v155
    s_waitcnt lgkmcnt(8)
    v_mfma_f32_16x16x32_bf16 v[208:211], a[68:71], a[136:139], v[208:211]
    ds_read_b64_tr_b16 a[64:65], v241 offset:224
    v_cvt_pk_bf16_f32 v246, v136, v137
    v_mfma_f32_16x16x32_bf16 v[212:215], a[68:71], a[140:143], v[212:215]
    ds_read_b64_tr_b16 a[66:67], v241 offset:2528
    v_cvt_pk_bf16_f32 v247, v138, v139
    v_mfma_f32_16x16x32_bf16 v[216:219], a[68:71], a[144:147], v[216:219]
    v_mul_f32 v168, v168, v184
    v_mul_f32 v169, v169, v185
    v_mfma_f32_16x16x32_bf16 v[220:223], a[68:71], a[148:151], v[220:223]
    v_mul_f32 v170, v170, v186
    v_mul_f32 v171, v171, v187
    s_waitcnt lgkmcnt(8)
    v_mfma_f32_16x16x32_bf16 a[0:3], a[72:75], a[88:91], a[0:3]
    ds_read_b64_tr_b16 a[68:69], v241 offset:18656
    v_cvt_pk_bf16_f32 v248, v168, v169
    v_mfma_f32_16x16x32_bf16 a[4:7], a[72:75], a[92:95], a[4:7]
    ds_read_b64_tr_b16 a[70:71], v241 offset:20960
    v_cvt_pk_bf16_f32 v249, v170, v171
    v_mfma_f32_16x16x32_bf16 a[8:11], a[72:75], a[96:99], a[8:11]
    buffer_store_dwordx4 v[246:249], v237, s[8:11], s54 offen offset:2048 sc1
    v_mul_f32 v140, v140, v156
    v_mfma_f32_16x16x32_bf16 a[12:15], a[72:75], a[100:103], a[12:15]
    v_mul_f32 v141, v141, v157
    v_mul_f32 v142, v142, v158
    s_waitcnt lgkmcnt(8)
    v_mfma_f32_16x16x32_bf16 a[16:19], a[76:79], a[88:91], a[16:19]
    ds_read_b64_tr_b16 a[72:73], v241 offset:9440
    v_mul_f32 v143, v143, v159
    v_mfma_f32_16x16x32_bf16 a[20:23], a[76:79], a[92:95], a[20:23]
    ds_read_b64_tr_b16 a[74:75], v241 offset:11744
    v_cvt_pk_bf16_f32 v250, v140, v141
    v_mfma_f32_16x16x32_bf16 a[24:27], a[76:79], a[96:99], a[24:27]
    v_cvt_pk_bf16_f32 v251, v142, v143
    v_mul_f32 v172, v172, v188
    v_mfma_f32_16x16x32_bf16 a[28:31], a[76:79], a[100:103], a[28:31]
    v_mul_f32 v173, v173, v189
    v_mul_f32 v174, v174, v190
    s_waitcnt lgkmcnt(8)
    v_mfma_f32_16x16x32_bf16 a[0:3], a[80:83], a[104:107], a[0:3]
    ds_read_b64_tr_b16 a[76:77], v241 offset:27872
    v_mul_f32 v175, v175, v191
    v_mfma_f32_16x16x32_bf16 a[4:7], a[80:83], a[108:111], a[4:7]
    ds_read_b64_tr_b16 a[78:79], v241 offset:30176
    v_cvt_pk_bf16_f32 v252, v172, v173
    v_mfma_f32_16x16x32_bf16 a[8:11], a[80:83], a[112:115], a[8:11]
    v_cvt_pk_bf16_f32 v253, v174, v175
    buffer_store_dwordx4 v[250:253], v237, s[8:11], s55 offen offset:2048 sc1
    v_mfma_f32_16x16x32_bf16 a[12:15], a[80:83], a[116:119], a[12:15]
    s_waitcnt lgkmcnt(8)
    v_mfma_f32_16x16x32_bf16 a[16:19], a[84:87], a[104:107], a[16:19]
    ds_read_b64_tr_b16 a[80:81], v244 offset:256
    v_mfma_f32_16x16x32_bf16 a[20:23], a[84:87], a[108:111], a[20:23]
    ds_read_b64_tr_b16 a[82:83], v244 offset:2560
    v_mfma_f32_16x16x32_bf16 a[24:27], a[84:87], a[112:115], a[24:27]
    v_mfma_f32_16x16x32_bf16 a[28:31], a[84:87], a[116:119], a[28:31]
    s_waitcnt lgkmcnt(8)
    v_mfma_f32_16x16x32_bf16 a[0:3], a[64:67], a[120:123], a[0:3]
    ds_read_b64_tr_b16 a[84:85], v244 offset:18688
    v_mfma_f32_16x16x32_bf16 a[4:7], a[64:67], a[124:127], a[4:7]
    ds_read_b64_tr_b16 a[86:87], v244 offset:20992
    v_mfma_f32_16x16x32_bf16 a[8:11], a[64:67], a[128:131], a[8:11]
    v_mfma_f32_16x16x32_bf16 a[12:15], a[64:67], a[132:135], a[12:15]
    s_waitcnt lgkmcnt(8)
    v_mfma_f32_16x16x32_bf16 a[16:19], a[68:71], a[120:123], a[16:19]
    ds_read_b64_tr_b16 a[64:65], v244 offset:9472
    v_mfma_f32_16x16x32_bf16 a[20:23], a[68:71], a[124:127], a[20:23]
    ds_read_b64_tr_b16 a[66:67], v244 offset:11776
    v_mfma_f32_16x16x32_bf16 a[24:27], a[68:71], a[128:131], a[24:27]
    v_mfma_f32_16x16x32_bf16 a[28:31], a[68:71], a[132:135], a[28:31]
    s_waitcnt lgkmcnt(8)
    v_mfma_f32_16x16x32_bf16 a[0:3], a[72:75], a[136:139], a[0:3]
    ds_read_b64_tr_b16 a[68:69], v244 offset:27904
    v_mfma_f32_16x16x32_bf16 a[4:7], a[72:75], a[140:143], a[4:7]
    ds_read_b64_tr_b16 a[70:71], v244 offset:30208
    v_mfma_f32_16x16x32_bf16 a[8:11], a[72:75], a[144:147], a[8:11]
    v_mfma_f32_16x16x32_bf16 a[12:15], a[72:75], a[148:151], a[12:15]
    s_waitcnt lgkmcnt(8)
    v_mfma_f32_16x16x32_bf16 a[16:19], a[76:79], a[136:139], a[16:19]
    ds_read_b64_tr_b16 a[72:73], v241 offset:256
    v_mfma_f32_16x16x32_bf16 a[20:23], a[76:79], a[140:143], a[20:23]
    ds_read_b64_tr_b16 a[74:75], v241 offset:2560
    v_mfma_f32_16x16x32_bf16 a[24:27], a[76:79], a[144:147], a[24:27]
    v_mfma_f32_16x16x32_bf16 a[28:31], a[76:79], a[148:151], a[28:31]
    s_waitcnt lgkmcnt(8)
    v_mfma_f32_16x16x32_bf16 a[32:35], a[80:83], a[88:91], a[32:35]
    ds_read_b64_tr_b16 a[76:77], v241 offset:18688
    v_mfma_f32_16x16x32_bf16 a[36:39], a[80:83], a[92:95], a[36:39]
    ds_read_b64_tr_b16 a[78:79], v241 offset:20992
    v_mfma_f32_16x16x32_bf16 a[40:43], a[80:83], a[96:99], a[40:43]
    v_mfma_f32_16x16x32_bf16 a[44:47], a[80:83], a[100:103], a[44:47]
    s_waitcnt lgkmcnt(8)
    v_mfma_f32_16x16x32_bf16 a[48:51], a[84:87], a[88:91], a[48:51]
    ds_read_b64_tr_b16 a[80:81], v241 offset:9472
    v_mfma_f32_16x16x32_bf16 a[52:55], a[84:87], a[92:95], a[52:55]
    ds_read_b64_tr_b16 a[82:83], v241 offset:11776
    v_mfma_f32_16x16x32_bf16 a[56:59], a[84:87], a[96:99], a[56:59]
    v_mfma_f32_16x16x32_bf16 a[60:63], a[84:87], a[100:103], a[60:63]
    s_waitcnt lgkmcnt(8)
    v_mfma_f32_16x16x32_bf16 a[32:35], a[64:67], a[104:107], a[32:35]
    ds_read_b64_tr_b16 a[84:85], v241 offset:27904
    v_mul_f32 v192, v192, v208
    v_mfma_f32_16x16x32_bf16 a[36:39], a[64:67], a[108:111], a[36:39]
    ds_read_b64_tr_b16 a[86:87], v241 offset:30208
    v_mul_f32 v193, v193, v209
    v_mfma_f32_16x16x32_bf16 a[40:43], a[64:67], a[112:115], a[40:43]
    v_mul_f32 v194, v194, v210
    v_mul_f32 v195, v195, v211
    v_mfma_f32_16x16x32_bf16 a[44:47], a[64:67], a[116:119], a[44:47]
    v_cvt_pk_bf16_f32 v246, v192, v193
    v_cvt_pk_bf16_f32 v247, v194, v195
    s_waitcnt lgkmcnt(8)
    v_mfma_f32_16x16x32_bf16 a[48:51], a[68:71], a[104:107], a[48:51]
    v_accvgpr_read_b32 v32, a0
    v_mfma_f32_16x16x32_bf16 a[52:55], a[68:71], a[108:111], a[52:55]
    v_accvgpr_read_b32 v36, a16
    v_mfma_f32_16x16x32_bf16 a[56:59], a[68:71], a[112:115], a[56:59]
    v_accvgpr_read_b32 v33, a1
    v_accvgpr_read_b32 v37, a17
    v_mfma_f32_16x16x32_bf16 a[60:63], a[68:71], a[116:119], a[60:63]
    v_accvgpr_read_b32 v34, a2
    v_accvgpr_read_b32 v38, a18
    s_waitcnt lgkmcnt(6)
    v_mfma_f32_16x16x32_bf16 a[32:35], a[72:75], a[120:123], a[32:35]
    v_accvgpr_read_b32 v35, a3
    v_mfma_f32_16x16x32_bf16 a[36:39], a[72:75], a[124:127], a[36:39]
    v_accvgpr_read_b32 v39, a19
    v_mfma_f32_16x16x32_bf16 a[40:43], a[72:75], a[128:131], a[40:43]
    v_mul_f32 v32, v32, v36
    v_mul_f32 v33, v33, v37
    v_mfma_f32_16x16x32_bf16 a[44:47], a[72:75], a[132:135], a[44:47]
    v_mul_f32 v34, v34, v38
    v_mul_f32 v35, v35, v39
    s_waitcnt lgkmcnt(4)
    v_mfma_f32_16x16x32_bf16 a[48:51], a[76:79], a[120:123], a[48:51]
    v_cvt_pk_bf16_f32 v248, v32, v33
    v_mfma_f32_16x16x32_bf16 a[52:55], a[76:79], a[124:127], a[52:55]
    v_cvt_pk_bf16_f32 v249, v34, v35
    v_mfma_f32_16x16x32_bf16 a[56:59], a[76:79], a[128:131], a[56:59]
    buffer_store_dwordx4 v[246:249], v237, s[8:11], s52 offen offset:3072 sc1
    v_mul_f32 v196, v196, v212
    v_mfma_f32_16x16x32_bf16 a[60:63], a[76:79], a[132:135], a[60:63]
    v_mul_f32 v197, v197, v213
    v_mul_f32 v198, v198, v214
    s_waitcnt lgkmcnt(2)
    v_mfma_f32_16x16x32_bf16 a[32:35], a[80:83], a[136:139], a[32:35]
    v_mul_f32 v199, v199, v215
    v_mfma_f32_16x16x32_bf16 a[36:39], a[80:83], a[140:143], a[36:39]
    v_cvt_pk_bf16_f32 v250, v196, v197
    v_mfma_f32_16x16x32_bf16 a[40:43], a[80:83], a[144:147], a[40:43]
    v_cvt_pk_bf16_f32 v251, v198, v199
    v_accvgpr_read_b32 v32, a4
    v_mfma_f32_16x16x32_bf16 a[44:47], a[80:83], a[148:151], a[44:47]
    v_accvgpr_read_b32 v36, a20
    v_accvgpr_read_b32 v33, a5
    s_waitcnt lgkmcnt(0)
    v_mfma_f32_16x16x32_bf16 a[48:51], a[84:87], a[136:139], a[48:51]
    v_accvgpr_read_b32 v37, a21
    v_mfma_f32_16x16x32_bf16 a[52:55], a[84:87], a[140:143], a[52:55]
    v_accvgpr_read_b32 v34, a6
    v_mfma_f32_16x16x32_bf16 a[56:59], a[84:87], a[144:147], a[56:59]
    v_accvgpr_read_b32 v38, a22
    v_accvgpr_read_b32 v35, a7
    v_mfma_f32_16x16x32_bf16 a[60:63], a[84:87], a[148:151], a[60:63]
    v_accvgpr_read_b32 v39, a23
    v_mul_f32 v32, v32, v36
    v_mul_f32 v33, v33, v37
    v_mul_f32 v34, v34, v38
    v_mul_f32 v35, v35, v39
    v_cvt_pk_bf16_f32 v252, v32, v33
    v_cvt_pk_bf16_f32 v253, v34, v35
    buffer_store_dwordx4 v[250:253], v237, s[8:11], s53 offen offset:3072 sc1
    v_mul_f32 v200, v200, v216
    v_mul_f32 v201, v201, v217
    v_mul_f32 v202, v202, v218
    v_mul_f32 v203, v203, v219
    v_cvt_pk_bf16_f32 v246, v200, v201
    v_cvt_pk_bf16_f32 v247, v202, v203
    v_accvgpr_read_b32 v32, a8
    v_accvgpr_read_b32 v36, a24
    v_accvgpr_read_b32 v33, a9
    v_accvgpr_read_b32 v37, a25
    v_accvgpr_read_b32 v34, a10
    v_accvgpr_read_b32 v38, a26
    v_accvgpr_read_b32 v35, a11
    v_accvgpr_read_b32 v39, a27
    v_mul_f32 v32, v32, v36
    v_mul_f32 v33, v33, v37
    v_mul_f32 v34, v34, v38
    v_mul_f32 v35, v35, v39
    v_cvt_pk_bf16_f32 v248, v32, v33
    v_cvt_pk_bf16_f32 v249, v34, v35
    buffer_store_dwordx4 v[246:249], v237, s[8:11], s54 offen offset:3072 sc1
    v_mul_f32 v204, v204, v220
    v_mul_f32 v205, v205, v221
    v_mul_f32 v206, v206, v222
    v_mul_f32 v207, v207, v223
    v_cvt_pk_bf16_f32 v250, v204, v205
    v_cvt_pk_bf16_f32 v251, v206, v207
    v_accvgpr_read_b32 v32, a12
    v_accvgpr_read_b32 v36, a28
    v_accvgpr_read_b32 v33, a13
    v_accvgpr_read_b32 v37, a29
    v_accvgpr_read_b32 v34, a14
    v_accvgpr_read_b32 v38, a30
    v_accvgpr_read_b32 v35, a15
    v_accvgpr_read_b32 v39, a31
    v_mul_f32 v32, v32, v36
    v_mul_f32 v33, v33, v37
    v_mul_f32 v34, v34, v38
    v_mul_f32 v35, v35, v39
    v_cvt_pk_bf16_f32 v252, v32, v33
    v_cvt_pk_bf16_f32 v253, v34, v35
    buffer_store_dwordx4 v[250:253], v237, s[8:11], s55 offen offset:3072 sc1
    v_accvgpr_read_b32 v32, a32
    v_accvgpr_read_b32 v36, a48
    v_accvgpr_read_b32 v33, a33
    v_accvgpr_read_b32 v37, a49
    v_accvgpr_read_b32 v34, a34
    v_accvgpr_read_b32 v38, a50
    v_accvgpr_read_b32 v35, a35
    v_accvgpr_read_b32 v39, a51
    v_mul_f32 v32, v32, v36
    v_mul_f32 v33, v33, v37
    v_mul_f32 v34, v34, v38
    v_mul_f32 v35, v35, v39
    v_cvt_pk_bf16_f32 v246, v32, v33
    v_cvt_pk_bf16_f32 v247, v34, v35
    buffer_store_dwordx2 v[246:247], v237, s[8:11], s56 offen offset:0 sc1
    v_accvgpr_read_b32 v32, a36
    v_accvgpr_read_b32 v36, a52
    v_accvgpr_read_b32 v33, a37
    v_accvgpr_read_b32 v37, a53
    v_accvgpr_read_b32 v34, a38
    v_accvgpr_read_b32 v38, a54
    v_accvgpr_read_b32 v35, a39
    v_accvgpr_read_b32 v39, a55
    v_mul_f32 v32, v32, v36
    v_mul_f32 v33, v33, v37
    v_mul_f32 v34, v34, v38
    v_mul_f32 v35, v35, v39
    v_cvt_pk_bf16_f32 v250, v32, v33
    v_cvt_pk_bf16_f32 v251, v34, v35
    buffer_store_dwordx2 v[250:251], v237, s[8:11], s57 offen offset:0 sc1
    v_accvgpr_read_b32 v32, a40
    v_accvgpr_read_b32 v36, a56
    v_accvgpr_read_b32 v33, a41
    v_accvgpr_read_b32 v37, a57
    v_accvgpr_read_b32 v34, a42
    v_accvgpr_read_b32 v38, a58
    v_accvgpr_read_b32 v35, a43
    v_accvgpr_read_b32 v39, a59
    v_mul_f32 v32, v32, v36
    v_mul_f32 v33, v33, v37
    v_mul_f32 v34, v34, v38
    v_mul_f32 v35, v35, v39
    v_cvt_pk_bf16_f32 v246, v32, v33
    v_cvt_pk_bf16_f32 v247, v34, v35
    buffer_store_dwordx2 v[246:247], v237, s[8:11], s58 offen offset:0 sc1
    v_accvgpr_read_b32 v32, a44
    v_accvgpr_read_b32 v36, a60
    v_accvgpr_read_b32 v33, a45
    v_accvgpr_read_b32 v37, a61
    v_accvgpr_read_b32 v34, a46
    v_accvgpr_read_b32 v38, a62
    v_accvgpr_read_b32 v35, a47
    v_accvgpr_read_b32 v39, a63
    v_mul_f32 v32, v32, v36
    v_mul_f32 v33, v33, v37
    v_mul_f32 v34, v34, v38
    v_mul_f32 v35, v35, v39
    v_cvt_pk_bf16_f32 v250, v32, v33
    v_cvt_pk_bf16_f32 v251, v34, v35
    buffer_store_dwordx2 v[250:251], v237, s[8:11], s59 offen offset:0 sc1
    s_branch GG_FIN
GG_ODD:
    s_waitcnt lgkmcnt(8)
    v_mfma_f32_16x16x32_bf16 v[128:131], a[72:75], a[184:187], v[128:131]
    ds_read_b64_tr_b16 a[68:69], v243 offset:27840
    v_mfma_f32_16x16x32_bf16 v[132:135], a[72:75], a[188:191], v[132:135]
    ds_read_b64_tr_b16 a[70:71], v243 offset:30144
    v_mfma_f32_16x16x32_bf16 v[136:139], a[72:75], a[192:195], v[136:139]
    v_mfma_f32_16x16x32_bf16 v[140:143], a[72:75], a[196:199], v[140:143]
    s_waitcnt lgkmcnt(8)
    v_mfma_f32_16x16x32_bf16 v[144:147], a[76:79], a[184:187], v[144:147]
    ds_read_b64_tr_b16 a[72:73], v243 offset:9440
    v_mfma_f32_16x16x32_bf16 v[148:151], a[76:79], a[188:191], v[148:151]
    ds_read_b64_tr_b16 a[74:75], v243 offset:11744
    v_mfma_f32_16x16x32_bf16 v[152:155], a[76:79], a[192:195], v[152:155]
    v_mfma_f32_16x16x32_bf16 v[156:159], a[76:79], a[196:199], v[156:159]
    s_waitcnt lgkmcnt(8)
    v_mfma_f32_16x16x32_bf16 v[160:163], a[80:83], a[184:187], v[160:163]
    ds_read_b64_tr_b16 a[76:77], v243 offset:27872
    v_mfma_f32_16x16x32_bf16 v[164:167], a[80:83], a[188:191], v[164:167]
    ds_read_b64_tr_b16 a[78:79], v243 offset:30176
    v_mfma_f32_16x16x32_bf16 v[168:171], a[80:83], a[192:195], v[168:171]
    v_mfma_f32_16x16x32_bf16 v[172:175], a[80:83], a[196:199], v[172:175]
    s_waitcnt lgkmcnt(8)
    v_mfma_f32_16x16x32_bf16 v[176:179], a[84:87], a[184:187], v[176:179]
    ds_read_b64_tr_b16 a[80:81], v243 offset:9472
    v_mfma_f32_16x16x32_bf16 v[180:183], a[84:87], a[188:191], v[180:183]
    ds_read_b64_tr_b16 a[82:83], v243 offset:11776
    v_mfma_f32_16x16x32_bf16 v[184:187], a[84:87], a[192:195], v[184:187]
    v_mfma_f32_16x16x32_bf16 v[188:191], a[84:87], a[196:199], v[188:191]
    s_waitcnt lgkmcnt(8)
    v_mfma_f32_16x16x32_bf16 v[192:195], a[64:67], a[184:187], v[192:195]
    ds_read_b64_tr_b16 a[84:85], v243 offset:27904
    v_mfma_f32_16x16x32_bf16 v[196:199], a[64:67], a[188:191], v[196:199]
    ds_read_b64_tr_b16 a[86:87], v243 offset:30208
    v_mfma_f32_16x16x32_bf16 v[200:203], a[64:67], a[192:195], v[200:203]
    v_mfma_f32_16x16x32_bf16 v[204:207], a[64:67], a[196:199], v[204:207]
    s_waitcnt vmcnt(1)
    s_barrier
    s_waitcnt lgkmcnt(8)
    v_mfma_f32_16x16x32_bf16 v[208:211], a[68:71], a[184:187], v[208:211]
    ds_read_b64_tr_b16 a[64:65], v244 offset:32
    v_mfma_f32_16x16x32_bf16 v[212:215], a[68:71], a[188:191], v[212:215]
    ds_read_b64_tr_b16 a[66:67], v244 offset:2336
    v_mfma_f32_16x16x32_bf16 v[216:219], a[68:71], a[192:195], v[216:219]
    v_accvgpr_read_b32 v226, a200
    v_accvgpr_read_b32 v227, a201
    v_accvgpr_read_b32 v228, a202
    v_accvgpr_read_b32 v229, a203
    v_accvgpr_read_b32 v230, a204
    v_accvgpr_read_b32 v231, a205
    v_accvgpr_read_b32 v232, a206
    v_accvgpr_read_b32 v233, a207
    v_accvgpr_read_b32 v234, a208
    v_mfma_f32_16x16x32_bf16 v[220:223], a[68:71], a[196:199], v[220:223]
    s_waitcnt lgkmcnt(8)
    v_mfma_f32_16x16x32_bf16 a[0:3], a[72:75], a[184:187], a[0:3]
    ds_read_b64_tr_b16 a[68:69], v244 offset:18464
    v_mfma_f32_16x16x32_bf16 a[4:7], a[72:75], a[188:191], a[4:7]
    ds_read_b64_tr_b16 a[70:71], v244 offset:20768
    v_mfma_f32_16x16x32_bf16 a[8:11], a[72:75], a[192:195], a[8:11]
    v_mfma_f32_16x16x32_bf16 a[12:15], a[72:75], a[196:199], a[12:15]
    s_waitcnt lgkmcnt(8)
    v_mfma_f32_16x16x32_bf16 a[16:19], a[76:79], a[184:187], a[16:19]
    ds_read_b64_tr_b16 a[72:73], v244 offset:9248
    v_mfma_f32_16x16x32_bf16 a[20:23], a[76:79], a[188:191], a[20:23]
    ds_read_b64_tr_b16 a[74:75], v244 offset:11552
    v_mfma_f32_16x16x32_bf16 a[24:27], a[76:79], a[192:195], a[24:27]
    s_add_u32 m0, s51, 36864
    s_nop 0
    buffer_load_dwordx4 v226, s[12:15], s60 offen lds
    v_mfma_f32_16x16x32_bf16 a[28:31], a[76:79], a[196:199], a[28:31]
    s_waitcnt lgkmcnt(8)
    v_mfma_f32_16x16x32_bf16 a[32:35], a[80:83], a[184:187], a[32:35]
    ds_read_b64_tr_b16 a[76:77], v244 offset:27680
    v_mfma_f32_16x16x32_bf16 a[36:39], a[80:83], a[188:191], a[36:39]
    ds_read_b64_tr_b16 a[78:79], v244 offset:29984
    v_mfma_f32_16x16x32_bf16 a[40:43], a[80:83], a[192:195], a[40:43]
    s_add_u32 m0, s51, 37888
    s_nop 0
    buffer_load_dwordx4 v227, s[12:15], s60 offen lds
    v_mfma_f32_16x16x32_bf16 a[44:47], a[80:83], a[196:199], a[44:47]
    s_waitcnt lgkmcnt(8)
    v_mfma_f32_16x16x32_bf16 a[48:51], a[84:87], a[184:187], a[48:51]
    ds_read_b64_tr_b16 a[80:81], v241 offset:32
    v_mfma_f32_16x16x32_bf16 a[52:55], a[84:87], a[188:191], a[52:55]
    ds_read_b64_tr_b16 a[82:83], v241 offset:2336
    v_mfma_f32_16x16x32_bf16 a[56:59], a[84:87], a[192:195], a[56:59]
    v_mfma_f32_16x16x32_bf16 a[60:63], a[84:87], a[196:199], a[60:63]
    s_waitcnt lgkmcnt(8)
    v_mfma_f32_16x16x32_bf16 v[32:35], a[64:67], a[88:91], v[32:35]
    ds_read_b64_tr_b16 a[84:85], v241 offset:18464
    v_mfma_f32_16x16x32_bf16 v[36:39], a[64:67], a[92:95], v[36:39]
    ds_read_b64_tr_b16 a[86:87], v241 offset:20768
    v_mfma_f32_16x16x32_bf16 v[40:43], a[64:67], a[96:99], v[40:43]
    s_add_u32 m0, s51, 38912
    s_nop 0
    buffer_load_dwordx4 v228, s[12:15], s60 offen lds
    v_mfma_f32_16x16x32_bf16 v[44:47], a[64:67], a[100:103], v[44:47]
    s_waitcnt lgkmcnt(8)
    v_mfma_f32_16x16x32_bf16 v[48:51], a[68:71], a[88:91], v[48:51]
    ds_read_b64_tr_b16 a[64:65], v241 offset:9248
    v_mfma_f32_16x16x32_bf16 v[52:55], a[68:71], a[92:95], v[52:55]
    ds_read_b64_tr_b16 a[66:67], v241 offset:11552
    v_mfma_f32_16x16x32_bf16 v[56:59], a[68:71], a[96:99], v[56:59]
    s_add_u32 m0, s51, 39936
    s_nop 0
    buffer_load_dwordx4 v229, s[12:15], s60 offen lds
    v_mfma_f32_16x16x32_bf16 v[60:63], a[68:71], a[100:103], v[60:63]
    s_barrier
    s_waitcnt lgkmcnt(8)
    v_mfma_f32_16x16x32_bf16 v[32:35], a[72:75], a[104:107], v[32:35]
    ds_read_b64_tr_b16 a[68:69], v241 offset:27680
    v_mfma_f32_16x16x32_bf16 v[36:39], a[72:75], a[108:111], v[36:39]
    ds_read_b64_tr_b16 a[70:71], v241 offset:29984
    v_mfma_f32_16x16x32_bf16 v[40:43], a[72:75], a[112:115], v[40:43]
    s_add_u32 m0, s51, 40960
    s_nop 0
    buffer_load_dwordx4 v230, s[12:15], s60 offen lds
    v_mfma_f32_16x16x32_bf16 v[44:47], a[72:75], a[116:119], v[44:47]
    s_waitcnt lgkmcnt(8)
    v_mfma_f32_16x16x32_bf16 v[48:51], a[76:79], a[104:107], v[48:51]
    ds_read_b64_tr_b16 a[72:73], v244 offset:64
    v_mfma_f32_16x16x32_bf16 v[52:55], a[76:79], a[108:111], v[52:55]
    ds_read_b64_tr_b16 a[74:75], v244 offset:2368
    v_mfma_f32_16x16x32_bf16 v[56:59], a[76:79], a[112:115], v[56:59]
    s_add_u32 m0, s51, 41984
    s_nop 0
    buffer_load_dwordx4 v231, s[12:15], s60 offen lds
    v_mfma_f32_16x16x32_bf16 v[60:63], a[76:79], a[116:119], v[60:63]
    s_waitcnt lgkmcnt(8)
    v_mfma_f32_16x16x32_bf16 v[32:35], a[80:83], a[120:123], v[32:35]
    ds_read_b64_tr_b16 a[76:77], v244 offset:18496
    v_mfma_f32_16x16x32_bf16 v[36:39], a[80:83], a[124:127], v[36:39]
    ds_read_b64_tr_b16 a[78:79], v244 offset:20800
    v_mfma_f32_16x16x32_bf16 v[40:43], a[80:83], a[128:131], v[40:43]
    s_add_u32 m0, s51, 43008
    s_nop 0
    buffer_load_dwordx4 v232, s[12:15], s60 offen lds
    v_mfma_f32_16x16x32_bf16 v[44:47], a[80:83], a[132:135], v[44:47]
    s_waitcnt lgkmcnt(8)
    v_mfma_f32_16x16x32_bf16 v[48:51], a[84:87], a[120:123], v[48:51]
    ds_read_b64_tr_b16 a[80:81], v244 offset:9280
    v_mfma_f32_16x16x32_bf16 v[52:55], a[84:87], a[124:127], v[52:55]
    ds_read_b64_tr_b16 a[82:83], v244 offset:11584
    v_mfma_f32_16x16x32_bf16 v[56:59], a[84:87], a[128:131], v[56:59]
    s_add_u32 m0, s51, 44032
    s_nop 0
    buffer_load_dwordx4 v233, s[12:15], s60 offen lds
    v_mfma_f32_16x16x32_bf16 v[60:63], a[84:87], a[132:135], v[60:63]
    s_waitcnt lgkmcnt(8)
    v_mfma_f32_16x16x32_bf16 v[32:35], a[64:67], a[136:139], v[32:35]
    ds_read_b64_tr_b16 a[84:85], v244 offset:27712
    v_mfma_f32_16x16x32_bf16 v[36:39], a[64:67], a[140:143], v[36:39]
    ds_read_b64_tr_b16 a[86:87], v244 offset:30016
    v_mfma_f32_16x16x32_bf16 v[40:43], a[64:67], a[144:147], v[40:43]
    s_add_u32 m0, s51, 45056
    s_nop 0
    buffer_load_dwordx4 v234, s[12:15], s60 offen lds
    v_mfma_f32_16x16x32_bf16 v[44:47], a[64:67], a[148:151], v[44:47]
    s_waitcnt lgkmcnt(8)
    v_mfma_f32_16x16x32_bf16 v[48:51], a[68:71], a[136:139], v[48:51]
    ds_read_b64_tr_b16 a[64:65], v241 offset:64
    v_mfma_f32_16x16x32_bf16 v[52:55], a[68:71], a[140:143], v[52:55]
    ds_read_b64_tr_b16 a[66:67], v241 offset:2368
    v_mfma_f32_16x16x32_bf16 v[56:59], a[68:71], a[144:147], v[56:59]
    s_add_u32 m0, s51, 73728
    s_nop 0
    buffer_load_dwordx4 v226, s[12:15], s61 offen lds
    v_mfma_f32_16x16x32_bf16 v[60:63], a[68:71], a[148:151], v[60:63]
    s_waitcnt lgkmcnt(8)
    v_mfma_f32_16x16x32_bf16 v[64:67], a[72:75], a[88:91], v[64:67]
    ds_read_b64_tr_b16 a[68:69], v241 offset:18496
    v_mfma_f32_16x16x32_bf16 v[68:71], a[72:75], a[92:95], v[68:71]
    ds_read_b64_tr_b16 a[70:71], v241 offset:20800
    v_mfma_f32_16x16x32_bf16 v[72:75], a[72:75], a[96:99], v[72:75]
    s_add_u32 m0, s51, 74752
    s_nop 0
    buffer_load_dwordx4 v227, s[12:15], s61 offen lds
    v_mfma_f32_16x16x32_bf16 v[76:79], a[72:75], a[100:103], v[76:79]
    s_waitcnt lgkmcnt(8)
    v_mfma_f32_16x16x32_bf16 v[80:83], a[76:79], a[88:91], v[80:83]
    ds_read_b64_tr_b16 a[72:73], v241 offset:9280
    v_mfma_f32_16x16x32_bf16 v[84:87], a[76:79], a[92:95], v[84:87]
    ds_read_b64_tr_b16 a[74:75], v241 offset:11584
    v_mfma_f32_16x16x32_bf16 v[88:91], a[76:79], a[96:99], v[88:91]
    s_add_u32 m0, s51, 75776
    s_nop 0
    buffer_load_dwordx4 v228, s[12:15], s61 offen lds
    v_mfma_f32_16x16x32_bf16 v[92:95], a[76:79], a[100:103], v[92:95]
    s_waitcnt lgkmcnt(8)
    v_mfma_f32_16x16x32_bf16 v[64:67], a[80:83], a[104:107], v[64:67]
    ds_read_b64_tr_b16 a[76:77], v241 offset:27712
    v_mfma_f32_16x16x32_bf16 v[68:71], a[80:83], a[108:111], v[68:71]
    ds_read_b64_tr_b16 a[78:79], v241 offset:30016
    v_mfma_f32_16x16x32_bf16 v[72:75], a[80:83], a[112:115], v[72:75]
    s_add_u32 m0, s51, 76800
    s_nop 0
    buffer_load_dwordx4 v229, s[12:15], s61 offen lds
    v_mfma_f32_16x16x32_bf16 v[76:79], a[80:83], a[116:119], v[76:79]
    s_waitcnt lgkmcnt(8)
    v_mfma_f32_16x16x32_bf16 v[80:83], a[84:87], a[104:107], v[80:83]
    ds_read_b64_tr_b16 a[80:81], v244 offset:96
    v_mfma_f32_16x16x32_bf16 v[84:87], a[84:87], a[108:111], v[84:87]
    ds_read_b64_tr_b16 a[82:83], v244 offset:2400
    v_mfma_f32_16x16x32_bf16 v[88:91], a[84:87], a[112:115], v[88:91]
    s_add_u32 m0, s51, 77824
    s_nop 0
    buffer_load_dwordx4 v230, s[12:15], s61 offen lds
    v_mfma_f32_16x16x32_bf16 v[92:95], a[84:87], a[116:119], v[92:95]
    s_waitcnt lgkmcnt(8)
    v_mfma_f32_16x16x32_bf16 v[64:67], a[64:67], a[120:123], v[64:67]
    ds_read_b64_tr_b16 a[84:85], v244 offset:18528
    v_mfma_f32_16x16x32_bf16 v[68:71], a[64:67], a[124:127], v[68:71]
    ds_read_b64_tr_b16 a[86:87], v244 offset:20832
    v_mfma_f32_16x16x32_bf16 v[72:75], a[64:67], a[128:131], v[72:75]
    s_add_u32 m0, s51, 78848
    s_nop 0
    buffer_load_dwordx4 v231, s[12:15], s61 offen lds
    v_mfma_f32_16x16x32_bf16 v[76:79], a[64:67], a[132:135], v[76:79]
    s_waitcnt lgkmcnt(8)
    v_mfma_f32_16x16x32_bf16 v[80:83], a[68:71], a[120:123], v[80:83]
    ds_read_b64_tr_b16 a[64:65], v244 offset:9312
    v_mfma_f32_16x16x32_bf16 v[84:87], a[68:71], a[124:127], v[84:87]
    ds_read_b64_tr_b16 a[66:67], v244 offset:11616
    v_mfma_f32_16x16x32_bf16 v[88:91], a[68:71], a[128:131], v[88:91]
    s_add_u32 m0, s51, 79872
    s_nop 0
    buffer_load_dwordx4 v232, s[12:15], s61 offen lds
    v_mfma_f32_16x16x32_bf16 v[92:95], a[68:71], a[132:135], v[92:95]
    s_waitcnt lgkmcnt(8)
    v_mfma_f32_16x16x32_bf16 v[64:67], a[72:75], a[136:139], v[64:67]
    ds_read_b64_tr_b16 a[68:69], v244 offset:27744
    v_mfma_f32_16x16x32_bf16 v[68:71], a[72:75], a[140:143], v[68:71]
    ds_read_b64_tr_b16 a[70:71], v244 offset:30048
    v_mfma_f32_16x16x32_bf16 v[72:75], a[72:75], a[144:147], v[72:75]
    s_add_u32 m0, s51, 80896
    s_nop 0
    buffer_load_dwordx4 v233, s[12:15], s61 offen lds
    v_mfma_f32_16x16x32_bf16 v[76:79], a[72:75], a[148:151], v[76:79]
    s_waitcnt lgkmcnt(8)
    v_mfma_f32_16x16x32_bf16 v[80:83], a[76:79], a[136:139], v[80:83]
    ds_read_b64_tr_b16 a[72:73], v241 offset:96
    v_mfma_f32_16x16x32_bf16 v[84:87], a[76:79], a[140:143], v[84:87]
    ds_read_b64_tr_b16 a[74:75], v241 offset:2400
    v_mfma_f32_16x16x32_bf16 v[88:91], a[76:79], a[144:147], v[88:91]
    s_add_u32 m0, s51, 81920
    s_nop 0
    buffer_load_dwordx4 v234, s[12:15], s61 offen lds
    v_mfma_f32_16x16x32_bf16 v[92:95], a[76:79], a[148:151], v[92:95]
    s_waitcnt lgkmcnt(8)
    v_mfma_f32_16x16x32_bf16 v[96:99], a[80:83], a[88:91], v[96:99]
    ds_read_b64_tr_b16 a[76:77], v241 offset:18528
    v_mfma_f32_16x16x32_bf16 v[100:103], a[80:83], a[92:95], v[100:103]
    ds_read_b64_tr_b16 a[78:79], v241 offset:20832
    v_mfma_f32_16x16x32_bf16 v[104:107], a[80:83], a[96:99], v[104:107]
    v_mfma_f32_16x16x32_bf16 v[108:111], a[80:83], a[100:103], v[108:111]
    s_waitcnt lgkmcnt(8)
    v_mfma_f32_16x16x32_bf16 v[112:115], a[84:87], a[88:91], v[112:115]
    ds_read_b64_tr_b16 a[80:81], v241 offset:9312
    v_mfma_f32_16x16x32_bf16 v[116:119], a[84:87], a[92:95], v[116:119]
    ds_read_b64_tr_b16 a[82:83], v241 offset:11616
    v_mfma_f32_16x16x32_bf16 v[120:123], a[84:87], a[96:99], v[120:123]
    v_mfma_f32_16x16x32_bf16 v[124:127], a[84:87], a[100:103], v[124:127]
    s_waitcnt lgkmcnt(8)
    v_mfma_f32_16x16x32_bf16 v[96:99], a[64:67], a[104:107], v[96:99]
    ds_read_b64_tr_b16 a[84:85], v241 offset:27744
    v_mul_f32 v32, v32, v48
    v_mfma_f32_16x16x32_bf16 v[100:103], a[64:67], a[108:111], v[100:103]
    ds_read_b64_tr_b16 a[86:87], v241 offset:30048
    v_mul_f32 v33, v33, v49
    v_mfma_f32_16x16x32_bf16 v[104:107], a[64:67], a[112:115], v[104:107]
    v_mul_f32 v34, v34, v50
    v_mul_f32 v35, v35, v51
    v_mfma_f32_16x16x32_bf16 v[108:111], a[64:67], a[116:119], v[108:111]
    v_cvt_pk_bf16_f32 v246, v32, v33
    v_cvt_pk_bf16_f32 v247, v34, v35
    s_waitcnt lgkmcnt(8)
    v_mfma_f32_16x16x32_bf16 v[112:115], a[68:71], a[104:107], v[112:115]
    ds_read_b64_tr_b16 a[64:65], v244 offset:128
    v_mul_f32 v64, v64, v80
    v_mfma_f32_16x16x32_bf16 v[116:119], a[68:71], a[108:111], v[116:119]
    ds_read_b64_tr_b16 a[66:67], v244 offset:2432
    v_mul_f32 v65, v65, v81
    v_mfma_f32_16x16x32_bf16 v[120:123], a[68:71], a[112:115], v[120:123]
    v_mul_f32 v66, v66, v82
    v_mul_f32 v67, v67, v83
    v_mfma_f32_16x16x32_bf16 v[124:127], a[68:71], a[116:119], v[124:127]
    v_cvt_pk_bf16_f32 v248, v64, v65
    v_cvt_pk_bf16_f32 v249, v66, v67
    s_waitcnt lgkmcnt(8)
    v_mfma_f32_16x16x32_bf16 v[96:99], a[72:75], a[120:123], v[96:99]
    ds_read_b64_tr_b16 a[68:69], v244 offset:18560
    buffer_store_dwordx4 v[246:249], v237, s[8:11], s52 offen offset:1024 sc1
    v_mfma_f32_16x16x32_bf16 v[100:103], a[72:75], a[124:127], v[100:103]
    ds_read_b64_tr_b16 a[70:71], v244 offset:20864
    v_mul_f32 v36, v36, v52
    v_mfma_f32_16x16x32_bf16 v[104:107], a[72:75], a[128:131], v[104:107]
    v_mul_f32 v37, v37, v53
    v_mul_f32 v38, v38, v54
    v_mfma_f32_16x16x32_bf16 v[108:111], a[72:75], a[132:135], v[108:111]
    v_mul_f32 v39, v39, v55
    v_cvt_pk_bf16_f32 v250, v36, v37
    s_waitcnt lgkmcnt(8)
    v_mfma_f32_16x16x32_bf16 v[112:115], a[76:79], a[120:123], v[112:115]
    ds_read_b64_tr_b16 a[72:73], v244 offset:9344
    v_cvt_pk_bf16_f32 v251, v38, v39
    v_mfma_f32_16x16x32_bf16 v[116:119], a[76:79], a[124:127], v[116:119]
    ds_read_b64_tr_b16 a[74:75], v244 offset:11648
    v_mul_f32 v68, v68, v84
    v_mfma_f32_16x16x32_bf16 v[120:123], a[76:79], a[128:131], v[120:123]
    v_mul_f32 v69, v69, v85
    v_mul_f32 v70, v70, v86
    v_mfma_f32_16x16x32_bf16 v[124:127], a[76:79], a[132:135], v[124:127]
    v_mul_f32 v71, v71, v87
    v_cvt_pk_bf16_f32 v252, v68, v69
    s_waitcnt lgkmcnt(8)
    v_mfma_f32_16x16x32_bf16 v[96:99], a[80:83], a[136:139], v[96:99]
    ds_read_b64_tr_b16 a[76:77], v244 offset:27776
    v_cvt_pk_bf16_f32 v253, v70, v71
    v_mfma_f32_16x16x32_bf16 v[100:103], a[80:83], a[140:143], v[100:103]
    ds_read_b64_tr_b16 a[78:79], v244 offset:30080
    buffer_store_dwordx4 v[250:253], v237, s[8:11], s53 offen offset:1024 sc1
    v_mfma_f32_16x16x32_bf16 v[104:107], a[80:83], a[144:147], v[104:107]
    v_mul_f32 v40, v40, v56
    v_mul_f32 v41, v41, v57
    v_mfma_f32_16x16x32_bf16 v[108:111], a[80:83], a[148:151], v[108:111]
    v_mul_f32 v42, v42, v58
    v_mul_f32 v43, v43, v59
    s_waitcnt lgkmcnt(8)
    v_mfma_f32_16x16x32_bf16 v[112:115], a[84:87], a[136:139], v[112:115]
    ds_read_b64_tr_b16 a[80:81], v241 offset:128
    v_cvt_pk_bf16_f32 v246, v40, v41
    v_mfma_f32_16x16x32_bf16 v[116:119], a[84:87], a[140:143], v[116:119]
    ds_read_b64_tr_b16 a[82:83], v241 offset:2432
    v_cvt_pk_bf16_f32 v247, v42, v43
    v_mfma_f32_16x16x32_bf16 v[120:123], a[84:87], a[144:147], v[120:123]
    v_mul_f32 v72, v72, v88
    v_mul_f32 v73, v73, v89
    v_mfma_f32_16x16x32_bf16 v[124:127], a[84:87], a[148:151], v[124:127]
    v_mul_f32 v74, v74, v90
    v_mul_f32 v75, v75, v91
    s_waitcnt lgkmcnt(8)
    v_mfma_f32_16x16x32_bf16 v[128:131], a[64:67], a[88:91], v[128:131]
    ds_read_b64_tr_b16 a[84:85], v241 offset:18560
    v_cvt_pk_bf16_f32 v248, v72, v73
    v_mfma_f32_16x16x32_bf16 v[132:135], a[64:67], a[92:95], v[132:135]
    ds_read_b64_tr_b16 a[86:87], v241 offset:20864
    v_cvt_pk_bf16_f32 v249, v74, v75
    v_mfma_f32_16x16x32_bf16 v[136:139], a[64:67], a[96:99], v[136:139]
    buffer_store_dwordx4 v[246:249], v237, s[8:11], s54 offen offset:1024 sc1
    v_mul_f32 v44, v44, v60
    v_mfma_f32_16x16x32_bf16 v[140:143], a[64:67], a[100:103], v[140:143]
    v_mul_f32 v45, v45, v61
    v_mul_f32 v46, v46, v62
    s_waitcnt lgkmcnt(8)
    v_mfma_f32_16x16x32_bf16 v[144:147], a[68:71], a[88:91], v[144:147]
    ds_read_b64_tr_b16 a[64:65], v241 offset:9344
    v_mul_f32 v47, v47, v63
    v_mfma_f32_16x16x32_bf16 v[148:151], a[68:71], a[92:95], v[148:151]
    ds_read_b64_tr_b16 a[66:67], v241 offset:11648
    v_cvt_pk_bf16_f32 v250, v44, v45
    v_mfma_f32_16x16x32_bf16 v[152:155], a[68:71], a[96:99], v[152:155]
    v_cvt_pk_bf16_f32 v251, v46, v47
    v_mul_f32 v76, v76, v92
    v_mfma_f32_16x16x32_bf16 v[156:159], a[68:71], a[100:103], v[156:159]
    v_mul_f32 v77, v77, v93
    v_mul_f32 v78, v78, v94
    s_waitcnt lgkmcnt(8)
    v_mfma_f32_16x16x32_bf16 v[128:131], a[72:75], a[104:107], v[128:131]
    ds_read_b64_tr_b16 a[68:69], v241 offset:27776
    v_mul_f32 v79, v79, v95
    v_mfma_f32_16x16x32_bf16 v[132:135], a[72:75], a[108:111], v[132:135]
    ds_read_b64_tr_b16 a[70:71], v241 offset:30080
    v_cvt_pk_bf16_f32 v252, v76, v77
    v_mfma_f32_16x16x32_bf16 v[136:139], a[72:75], a[112:115], v[136:139]
    v_cvt_pk_bf16_f32 v253, v78, v79
    buffer_store_dwordx4 v[250:253], v237, s[8:11], s55 offen offset:1024 sc1
    v_mfma_f32_16x16x32_bf16 v[140:143], a[72:75], a[116:119], v[140:143]
    s_waitcnt lgkmcnt(8)
    v_mfma_f32_16x16x32_bf16 v[144:147], a[76:79], a[104:107], v[144:147]
    ds_read_b64_tr_b16 a[72:73], v244 offset:160
    v_mfma_f32_16x16x32_bf16 v[148:151], a[76:79], a[108:111], v[148:151]
    ds_read_b64_tr_b16 a[74:75], v244 offset:2464
    v_mfma_f32_16x16x32_bf16 v[152:155], a[76:79], a[112:115], v[152:155]
    v_mfma_f32_16x16x32_bf16 v[156:159], a[76:79], a[116:119], v[156:159]
    s_waitcnt lgkmcnt(8)
    v_mfma_f32_16x16x32_bf16 v[128:131], a[80:83], a[120:123], v[128:131]
    ds_read_b64_tr_b16 a[76:77], v244 offset:18592
    v_mfma_f32_16x16x32_bf16 v[132:135], a[80:83], a[124:127], v[132:135]
    ds_read_b64_tr_b16 a[78:79], v244 offset:20896
    v_mfma_f32_16x16x32_bf16 v[136:139], a[80:83], a[128:131], v[136:139]
    v_mfma_f32_16x16x32_bf16 v[140:143], a[80:83], a[132:135], v[140:143]
    s_waitcnt lgkmcnt(8)
    v_mfma_f32_16x16x32_bf16 v[144:147], a[84:87], a[120:123], v[144:147]
    ds_read_b64_tr_b16 a[80:81], v244 offset:9376
    v_mfma_f32_16x16x32_bf16 v[148:151], a[84:87], a[124:127], v[148:151]
    ds_read_b64_tr_b16 a[82:83], v244 offset:11680
    v_mfma_f32_16x16x32_bf16 v[152:155], a[84:87], a[128:131], v[152:155]
    v_mfma_f32_16x16x32_bf16 v[156:159], a[84:87], a[132:135], v[156:159]
    s_waitcnt lgkmcnt(8)
    v_mfma_f32_16x16x32_bf16 v[128:131], a[64:67], a[136:139], v[128:131]
    ds_read_b64_tr_b16 a[84:85], v244 offset:27808
    v_mfma_f32_16x16x32_bf16 v[132:135], a[64:67], a[140:143], v[132:135]
    ds_read_b64_tr_b16 a[86:87], v244 offset:30112
    v_mfma_f32_16x16x32_bf16 v[136:139], a[64:67], a[144:147], v[136:139]
    v_mfma_f32_16x16x32_bf16 v[140:143], a[64:67], a[148:151], v[140:143]
    s_waitcnt lgkmcnt(8)
    v_mfma_f32_16x16x32_bf16 v[144:147], a[68:71], a[136:139], v[144:147]
    ds_read_b64_tr_b16 a[64:65], v241 offset:160
    v_mfma_f32_16x16x32_bf16 v[148:151], a[68:71], a[140:143], v[148:151]
    ds_read_b64_tr_b16 a[66:67], v241 offset:2464
    v_mfma_f32_16x16x32_bf16 v[152:155], a[68:71], a[144:147], v[152:155]
    v_mfma_f32_16x16x32_bf16 v[156:159], a[68:71], a[148:151], v[156:159]
    s_waitcnt lgkmcnt(8)
    v_mfma_f32_16x16x32_bf16 v[160:163], a[72:75], a[88:91], v[160:163]
    ds_read_b64_tr_b16 a[68:69], v241 offset:18592
    v_mfma_f32_16x16x32_bf16 v[164:167], a[72:75], a[92:95], v[164:167]
    ds_read_b64_tr_b16 a[70:71], v241 offset:20896
    v_mfma_f32_16x16x32_bf16 v[168:171], a[72:75], a[96:99], v[168:171]
    v_mfma_f32_16x16x32_bf16 v[172:175], a[72:75], a[100:103], v[172:175]
    s_waitcnt lgkmcnt(8)
    v_mfma_f32_16x16x32_bf16 v[176:179], a[76:79], a[88:91], v[176:179]
    ds_read_b64_tr_b16 a[72:73], v241 offset:9376
    v_mfma_f32_16x16x32_bf16 v[180:183], a[76:79], a[92:95], v[180:183]
    ds_read_b64_tr_b16 a[74:75], v241 offset:11680
    v_mfma_f32_16x16x32_bf16 v[184:187], a[76:79], a[96:99], v[184:187]
    v_mfma_f32_16x16x32_bf16 v[188:191], a[76:79], a[100:103], v[188:191]
    s_waitcnt lgkmcnt(8)
    v_mfma_f32_16x16x32_bf16 v[160:163], a[80:83], a[104:107], v[160:163]
    ds_read_b64_tr_b16 a[76:77], v241 offset:27808
    v_mul_f32 v96, v96, v112
    v_mfma_f32_16x16x32_bf16 v[164:167], a[80:83], a[108:111], v[164:167]
    ds_read_b64_tr_b16 a[78:79], v241 offset:30112
    v_mul_f32 v97, v97, v113
    v_mfma_f32_16x16x32_bf16 v[168:171], a[80:83], a[112:115], v[168:171]
    v_mul_f32 v98, v98, v114
    v_mul_f32 v99, v99, v115
    v_mfma_f32_16x16x32_bf16 v[172:175], a[80:83], a[116:119], v[172:175]
    v_cvt_pk_bf16_f32 v246, v96, v97
    v_cvt_pk_bf16_f32 v247, v98, v99
    s_waitcnt lgkmcnt(8)
    v_mfma_f32_16x16x32_bf16 v[176:179], a[84:87], a[104:107], v[176:179]
    ds_read_b64_tr_b16 a[80:81], v244 offset:192
    v_mul_f32 v128, v128, v144
    v_mfma_f32_16x16x32_bf16 v[180:183], a[84:87], a[108:111], v[180:183]
    ds_read_b64_tr_b16 a[82:83], v244 offset:2496
    v_mul_f32 v129, v129, v145
    v_mfma_f32_16x16x32_bf16 v[184:187], a[84:87], a[112:115], v[184:187]
    v_mul_f32 v130, v130, v146
    v_mul_f32 v131, v131, v147
    v_mfma_f32_16x16x32_bf16 v[188:191], a[84:87], a[116:119], v[188:191]
    v_cvt_pk_bf16_f32 v248, v128, v129
    v_cvt_pk_bf16_f32 v249, v130, v131
    s_waitcnt lgkmcnt(8)
    v_mfma_f32_16x16x32_bf16 v[160:163], a[64:67], a[120:123], v[160:163]
    ds_read_b64_tr_b16 a[84:85], v244 offset:18624
    buffer_store_dwordx4 v[246:249], v237, s[8:11], s52 offen offset:2048 sc1
    v_mfma_f32_16x16x32_bf16 v[164:167], a[64:67], a[124:127], v[164:167]
    ds_read_b64_tr_b16 a[86:87], v244 offset:20928
    v_mul_f32 v100, v100, v116
    v_mfma_f32_16x16x32_bf16 v[168:171], a[64:67], a[128:131], v[168:171]
    v_mul_f32 v101, v101, v117
    v_mul_f32 v102, v102, v118
    v_mfma_f32_16x16x32_bf16 v[172:175], a[64:67], a[132:135], v[172:175]
    v_mul_f32 v103, v103, v119
    v_cvt_pk_bf16_f32 v250, v100, v101
    s_waitcnt lgkmcnt(8)
    v_mfma_f32_16x16x32_bf16 v[176:179], a[68:71], a[120:123], v[176:179]
    ds_read_b64_tr_b16 a[64:65], v244 offset:9408
    v_cvt_pk_bf16_f32 v251, v102, v103
    v_mfma_f32_16x16x32_bf16 v[180:183], a[68:71], a[124:127], v[180:183]
    ds_read_b64_tr_b16 a[66:67], v244 offset:11712
    v_mul_f32 v132, v132, v148
    v_mfma_f32_16x16x32_bf16 v[184:187], a[68:71], a[128:131], v[184:187]
    v_mul_f32 v133, v133, v149
    v_mul_f32 v134, v134, v150
    v_mfma_f32_16x16x32_bf16 v[188:191], a[68:71], a[132:135], v[188:191]
    v_mul_f32 v135, v135, v151
    v_cvt_pk_bf16_f32 v252, v132, v133
    s_waitcnt lgkmcnt(8)
    v_mfma_f32_16x16x32_bf16 v[160:163], a[72:75], a[136:139], v[160:163]
    ds_read_b64_tr_b16 a[68:69], v244 offset:27840
    v_cvt_pk_bf16_f32 v253, v134, v135
    v_mfma_f32_16x16x32_bf16 v[164:167], a[72:75], a[140:143], v[164:167]
    ds_read_b64_tr_b16 a[70:71], v244 offset:30144
    buffer_store_dwordx4 v[250:253], v237, s[8:11], s53 offen offset:2048 sc1
    v_mfma_f32_16x16x32_bf16 v[168:171], a[72:75], a[144:147], v[168:171]
    v_mul_f32 v104, v104, v120
    v_mul_f32 v105, v105, v121
    v_mfma_f32_16x16x32_bf16 v[172:175], a[72:75], a[148:151], v[172:175]
    v_mul_f32 v106, v106, v122
    v_mul_f32 v107, v107, v123
    s_waitcnt lgkmcnt(8)
    v_mfma_f32_16x16x32_bf16 v[176:179], a[76:79], a[136:139], v[176:179]
    ds_read_b64_tr_b16 a[72:73], v241 offset:192
    v_cvt_pk_bf16_f32 v246, v104, v105
    v_mfma_f32_16x16x32_bf16 v[180:183], a[76:79], a[140:143], v[180:183]
    ds_read_b64_tr_b16 a[74:75], v241 offset:2496
    v_cvt_pk_bf16_f32 v247, v106, v107
    v_mfma_f32_16x16x32_bf16 v[184:187], a[76:79], a[144:147], v[184:187]
    v_mul_f32 v136, v136, v152
    v_mul_f32 v137, v137, v153
    v_mfma_f32_16x16x32_bf16 v[188:191], a[76:79], a[148:151], v[188:191]
    v_mul_f32 v138, v138, v154
    v_mul_f32 v139, v139, v155
    s_waitcnt lgkmcnt(8)
    v_mfma_f32_16x16x32_bf16 v[192:195], a[80:83], a[88:91], v[192:195]
    ds_read_b64_tr_b16 a[76:77], v241 offset:18624
    v_cvt_pk_bf16_f32 v248, v136, v137
    v_mfma_f32_16x16x32_bf16 v[196:199], a[80:83], a[92:95], v[196:199]
    ds_read_b64_tr_b16 a[78:79], v241 offset:20928
    v_cvt_pk_bf16_f32 v249, v138, v139
    v_mfma_f32_16x16x32_bf16 v[200:203], a[80:83], a[96:99], v[200:203]
    buffer_store_dwordx4 v[246:249], v237, s[8:11], s54 offen offset:2048 sc1
    v_mul_f32 v108, v108, v124
    v_mfma_f32_16x16x32_bf16 v[204:207], a[80:83], a[100:103], v[204:207]
    v_mul_f32 v109, v109, v125
    v_mul_f32 v110, v110, v126
    s_waitcnt lgkmcnt(8)
    v_mfma_f32_16x16x32_bf16 v[208:211], a[84:87], a[88:91], v[208:211]
    ds_read_b64_tr_b16 a[80:81], v241 offset:9408
    v_mul_f32 v111, v111, v127
    v_mfma_f32_16x16x32_bf16 v[212:215], a[84:87], a[92:95], v[212:215]
    ds_read_b64_tr_b16 a[82:83], v241 offset:11712
    v_cvt_pk_bf16_f32 v250, v108, v109
    v_mfma_f32_16x16x32_bf16 v[216:219], a[84:87], a[96:99], v[216:219]
    v_cvt_pk_bf16_f32 v251, v110, v111
    v_mul_f32 v140, v140, v156
    v_mfma_f32_16x16x32_bf16 v[220:223], a[84:87], a[100:103], v[220:223]
    v_mul_f32 v141, v141, v157
    v_mul_f32 v142, v142, v158
    s_waitcnt lgkmcnt(8)
    v_mfma_f32_16x16x32_bf16 v[192:195], a[64:67], a[104:107], v[192:195]
    ds_read_b64_tr_b16 a[84:85], v241 offset:27840
    v_mul_f32 v143, v143, v159
    v_mfma_f32_16x16x32_bf16 v[196:199], a[64:67], a[108:111], v[196:199]
    ds_read_b64_tr_b16 a[86:87], v241 offset:30144
    v_cvt_pk_bf16_f32 v252, v140, v141
    v_mfma_f32_16x16x32_bf16 v[200:203], a[64:67], a[112:115], v[200:203]
    v_cvt_pk_bf16_f32 v253, v142, v143
    buffer_store_dwordx4 v[250:253], v237, s[8:11], s55 offen offset:2048 sc1
    v_mfma_f32_16x16x32_bf16 v[204:207], a[64:67], a[116:119], v[204:207]
    s_waitcnt lgkmcnt(8)
    v_mfma_f32_16x16x32_bf16 v[208:211], a[68:71], a[104:107], v[208:211]
    ds_read_b64_tr_b16 a[64:65], v244 offset:224
    v_mfma_f32_16x16x32_bf16 v[212:215], a[68:71], a[108:111], v[212:215]
    ds_read_b64_tr_b16 a[66:67], v244 offset:2528
    v_mfma_f32_16x16x32_bf16 v[216:219], a[68:71], a[112:115], v[216:219]
    v_mfma_f32_16x16x32_bf16 v[220:223], a[68:71], a[116:119], v[220:223]
    s_waitcnt lgkmcnt(8)
    v_mfma_f32_16x16x32_bf16 v[192:195], a[72:75], a[120:123], v[192:195]
    ds_read_b64_tr_b16 a[68:69], v244 offset:18656
    v_mfma_f32_16x16x32_bf16 v[196:199], a[72:75], a[124:127], v[196:199]
    ds_read_b64_tr_b16 a[70:71], v244 offset:20960
    v_mfma_f32_16x16x32_bf16 v[200:203], a[72:75], a[128:131], v[200:203]
    v_mfma_f32_16x16x32_bf16 v[204:207], a[72:75], a[132:135], v[204:207]
    s_waitcnt lgkmcnt(8)
    v_mfma_f32_16x16x32_bf16 v[208:211], a[76:79], a[120:123], v[208:211]
    ds_read_b64_tr_b16 a[72:73], v244 offset:9440
    v_mfma_f32_16x16x32_bf16 v[212:215], a[76:79], a[124:127], v[212:215]
    ds_read_b64_tr_b16 a[74:75], v244 offset:11744
    v_mfma_f32_16x16x32_bf16 v[216:219], a[76:79], a[128:131], v[216:219]
    v_mfma_f32_16x16x32_bf16 v[220:223], a[76:79], a[132:135], v[220:223]
    s_waitcnt lgkmcnt(8)
    v_mfma_f32_16x16x32_bf16 v[192:195], a[80:83], a[136:139], v[192:195]
    ds_read_b64_tr_b16 a[76:77], v244 offset:27872
    v_mfma_f32_16x16x32_bf16 v[196:199], a[80:83], a[140:143], v[196:199]
    ds_read_b64_tr_b16 a[78:79], v244 offset:30176
    v_mfma_f32_16x16x32_bf16 v[200:203], a[80:83], a[144:147], v[200:203]
    v_mfma_f32_16x16x32_bf16 v[204:207], a[80:83], a[148:151], v[204:207]
    s_waitcnt lgkmcnt(8)
    v_mfma_f32_16x16x32_bf16 v[208:211], a[84:87], a[136:139], v[208:211]
    ds_read_b64_tr_b16 a[80:81], v241 offset:224
    v_mfma_f32_16x16x32_bf16 v[212:215], a[84:87], a[140:143], v[212:215]
    ds_read_b64_tr_b16 a[82:83], v241 offset:2528
    v_mfma_f32_16x16x32_bf16 v[216:219], a[84:87], a[144:147], v[216:219]
    v_mfma_f32_16x16x32_bf16 v[220:223], a[84:87], a[148:151], v[220:223]
    s_waitcnt lgkmcnt(8)
    v_mfma_f32_16x16x32_bf16 a[0:3], a[64:67], a[88:91], a[0:3]
    ds_read_b64_tr_b16 a[84:85], v241 offset:18656
    v_mfma_f32_16x16x32_bf16 a[4:7], a[64:67], a[92:95], a[4:7]
    ds_read_b64_tr_b16 a[86:87], v241 offset:20960
    v_mfma_f32_16x16x32_bf16 a[8:11], a[64:67], a[96:99], a[8:11]
    v_mfma_f32_16x16x32_bf16 a[12:15], a[64:67], a[100:103], a[12:15]
    s_waitcnt lgkmcnt(8)
    v_mfma_f32_16x16x32_bf16 a[16:19], a[68:71], a[88:91], a[16:19]
    ds_read_b64_tr_b16 a[64:65], v241 offset:9440
    v_mfma_f32_16x16x32_bf16 a[20:23], a[68:71], a[92:95], a[20:23]
    ds_read_b64_tr_b16 a[66:67], v241 offset:11744
    v_mfma_f32_16x16x32_bf16 a[24:27], a[68:71], a[96:99], a[24:27]
    v_mfma_f32_16x16x32_bf16 a[28:31], a[68:71], a[100:103], a[28:31]
    s_waitcnt lgkmcnt(8)
    v_mfma_f32_16x16x32_bf16 a[0:3], a[72:75], a[104:107], a[0:3]
    ds_read_b64_tr_b16 a[68:69], v241 offset:27872
    v_mul_f32 v160, v160, v176
    v_mfma_f32_16x16x32_bf16 a[4:7], a[72:75], a[108:111], a[4:7]
    ds_read_b64_tr_b16 a[70:71], v241 offset:30176
    v_mul_f32 v161, v161, v177
    v_mfma_f32_16x16x32_bf16 a[8:11], a[72:75], a[112:115], a[8:11]
    v_mul_f32 v162, v162, v178
    v_mul_f32 v163, v163, v179
    v_mfma_f32_16x16x32_bf16 a[12:15], a[72:75], a[116:119], a[12:15]
    v_cvt_pk_bf16_f32 v246, v160, v161
    v_cvt_pk_bf16_f32 v247, v162, v163
    s_waitcnt lgkmcnt(8)
    v_mfma_f32_16x16x32_bf16 a[16:19], a[76:79], a[104:107], a[16:19]
    ds_read_b64_tr_b16 a[72:73], v244 offset:256
    v_mul_f32 v192, v192, v208
    v_mfma_f32_16x16x32_bf16 a[20:23], a[76:79], a[108:111], a[20:23]
    ds_read_b64_tr_b16 a[74:75], v244 offset:2560
    v_mul_f32 v193, v193, v209
    v_mfma_f32_16x16x32_bf16 a[24:27], a[76:79], a[112:115], a[24:27]
    v_mul_f32 v194, v194, v210
    v_mul_f32 v195, v195, v211
    v_mfma_f32_16x16x32_bf16 a[28:31], a[76:79], a[116:119], a[28:31]
    v_cvt_pk_bf16_f32 v248, v192, v193
    v_cvt_pk_bf16_f32 v249, v194, v195
    s_waitcnt lgkmcnt(8)
    v_mfma_f32_16x16x32_bf16 a[0:3], a[80:83], a[120:123], a[0:3]
    ds_read_b64_tr_b16 a[76:77], v244 offset:18688
    buffer_store_dwordx4 v[246:249], v237, s[8:11], s52 offen offset:3072 sc1
    v_mfma_f32_16x16x32_bf16 a[4:7], a[80:83], a[124:127], a[4:7]
    ds_read_b64_tr_b16 a[78:79], v244 offset:20992
    v_mul_f32 v164, v164, v180
    v_mfma_f32_16x16x32_bf16 a[8:11], a[80:83], a[128:131], a[8:11]
    v_mul_f32 v165, v165, v181
    v_mul_f32 v166, v166, v182
    v_mfma_f32_16x16x32_bf16 a[12:15], a[80:83], a[132:135], a[12:15]
    v_mul_f32 v167, v167, v183
    v_cvt_pk_bf16_f32 v250, v164, v165
    s_waitcnt lgkmcnt(8)
    v_mfma_f32_16x16x32_bf16 a[16:19], a[84:87], a[120:123], a[16:19]
    ds_read_b64_tr_b16 a[80:81], v244 offset:9472
    v_cvt_pk_bf16_f32 v251, v166, v167
    v_mfma_f32_16x16x32_bf16 a[20:23], a[84:87], a[124:127], a[20:23]
    ds_read_b64_tr_b16 a[82:83], v244 offset:11776
    v_mul_f32 v196, v196, v212
    v_mfma_f32_16x16x32_bf16 a[24:27], a[84:87], a[128:131], a[24:27]
    v_mul_f32 v197, v197, v213
    v_mul_f32 v198, v198, v214
    v_mfma_f32_16x16x32_bf16 a[28:31], a[84:87], a[132:135], a[28:31]
    v_mul_f32 v199, v199, v215
    v_cvt_pk_bf16_f32 v252, v196, v197
    s_waitcnt lgkmcnt(8)
    v_mfma_f32_16x16x32_bf16 a[0:3], a[64:67], a[136:139], a[0:3]
    ds_read_b64_tr_b16 a[84:85], v244 offset:27904
    v_cvt_pk_bf16_f32 v253, v198, v199
    v_mfma_f32_16x16x32_bf16 a[4:7], a[64:67], a[140:143], a[4:7]
    ds_read_b64_tr_b16 a[86:87], v244 offset:30208
    buffer_store_dwordx4 v[250:253], v237, s[8:11], s53 offen offset:3072 sc1
    v_mfma_f32_16x16x32_bf16 a[8:11], a[64:67], a[144:147], a[8:11]
    v_mul_f32 v168, v168, v184
    v_mul_f32 v169, v169, v185
    v_mfma_f32_16x16x32_bf16 a[12:15], a[64:67], a[148:151], a[12:15]
    v_mul_f32 v170, v170, v186
    v_mul_f32 v171, v171, v187
    s_waitcnt lgkmcnt(8)
    v_mfma_f32_16x16x32_bf16 a[16:19], a[68:71], a[136:139], a[16:19]
    ds_read_b64_tr_b16 a[64:65], v241 offset:256
    v_cvt_pk_bf16_f32 v246, v168, v169
    v_mfma_f32_16x16x32_bf16 a[20:23], a[68:71], a[140:143], a[20:23]
    ds_read_b64_tr_b16 a[66:67], v241 offset:2560
    v_cvt_pk_bf16_f32 v247, v170, v171
    v_mfma_f32_16x16x32_bf16 a[24:27], a[68:71], a[144:147], a[24:27]
    v_mul_f32 v200, v200, v216
    v_mul_f32 v201, v201, v217
    v_mfma_f32_16x16x32_bf16 a[28:31], a[68:71], a[148:151], a[28:31]
    v_mul_f32 v202, v202, v218
    v_mul_f32 v203, v203, v219
    s_waitcnt lgkmcnt(8)
    v_mfma_f32_16x16x32_bf16 a[32:35], a[72:75], a[88:91], a[32:35]
    ds_read_b64_tr_b16 a[68:69], v241 offset:18688
    v_cvt_pk_bf16_f32 v248, v200, v201
    v_mfma_f32_16x16x32_bf16 a[36:39], a[72:75], a[92:95], a[36:39]
    ds_read_b64_tr_b16 a[70:71], v241 offset:20992
    v_cvt_pk_bf16_f32 v249, v202, v203
    v_mfma_f32_16x16x32_bf16 a[40:43], a[72:75], a[96:99], a[40:43]
    buffer_store_dwordx4 v[246:249], v237, s[8:11], s54 offen offset:3072 sc1
    v_mul_f32 v172, v172, v188
    v_mfma_f32_16x16x32_bf16 a[44:47], a[72:75], a[100:103], a[44:47]
    v_mul_f32 v173, v173, v189
    v_mul_f32 v174, v174, v190
    s_waitcnt lgkmcnt(8)
    v_mfma_f32_16x16x32_bf16 a[48:51], a[76:79], a[88:91], a[48:51]
    ds_read_b64_tr_b16 a[72:73], v241 offset:9472
    v_mul_f32 v175, v175, v191
    v_mfma_f32_16x16x32_bf16 a[52:55], a[76:79], a[92:95], a[52:55]
    ds_read_b64_tr_b16 a[74:75], v241 offset:11776
    v_cvt_pk_bf16_f32 v250, v172, v173
    v_mfma_f32_16x16x32_bf16 a[56:59], a[76:79], a[96:99], a[56:59]
    v_cvt_pk_bf16_f32 v251, v174, v175
    v_mul_f32 v204, v204, v220
    v_mfma_f32_16x16x32_bf16 a[60:63], a[76:79], a[100:103], a[60:63]
    v_mul_f32 v205, v205, v221
    v_mul_f32 v206, v206, v222
    s_waitcnt lgkmcnt(8)
    v_mfma_f32_16x16x32_bf16 a[32:35], a[80:83], a[104:107], a[32:35]
    ds_read_b64_tr_b16 a[76:77], v241 offset:27904
    v_mul_f32 v207, v207, v223
    v_mfma_f32_16x16x32_bf16 a[36:39], a[80:83], a[108:111], a[36:39]
    ds_read_b64_tr_b16 a[78:79], v241 offset:30208
    v_cvt_pk_bf16_f32 v252, v204, v205
    v_mfma_f32_16x16x32_bf16 a[40:43], a[80:83], a[112:115], a[40:43]
    v_cvt_pk_bf16_f32 v253, v206, v207
    buffer_store_dwordx4 v[250:253], v237, s[8:11], s55 offen offset:3072 sc1
    v_mfma_f32_16x16x32_bf16 a[44:47], a[80:83], a[116:119], a[44:47]
    s_waitcnt lgkmcnt(8)
    v_mfma_f32_16x16x32_bf16 a[48:51], a[84:87], a[104:107], a[48:51]
    ds_read_b64_tr_b16 a[80:81], v244 offset:0
    v_mfma_f32_16x16x32_bf16 a[52:55], a[84:87], a[108:111], a[52:55]
    ds_read_b64_tr_b16 a[82:83], v244 offset:2304
    v_mfma_f32_16x16x32_bf16 a[56:59], a[84:87], a[112:115], a[56:59]
    v_mfma_f32_16x16x32_bf16 a[60:63], a[84:87], a[116:119], a[60:63]
    s_waitcnt lgkmcnt(8)
    v_mfma_f32_16x16x32_bf16 a[32:35], a[64:67], a[120:123], a[32:35]
    ds_read_b64_tr_b16 a[84:85], v244 offset:18432
    v_mfma_f32_16x16x32_bf16 a[36:39], a[64:67], a[124:127], a[36:39]
    ds_read_b64_tr_b16 a[86:87], v244 offset:20736
    v_mfma_f32_16x16x32_bf16 a[40:43], a[64:67], a[128:131], a[40:43]
    v_mfma_f32_16x16x32_bf16 a[44:47], a[64:67], a[132:135], a[44:47]
    s_waitcnt lgkmcnt(8)
    v_mfma_f32_16x16x32_bf16 a[48:51], a[68:71], a[120:123], a[48:51]
    ds_read_b64_tr_b16 a[64:65], v244 offset:9216
    v_mfma_f32_16x16x32_bf16 a[52:55], a[68:71], a[124:127], a[52:55]
    ds_read_b64_tr_b16 a[66:67], v244 offset:11520
    v_mfma_f32_16x16x32_bf16 a[56:59], a[68:71], a[128:131], a[56:59]
    v_mfma_f32_16x16x32_bf16 a[60:63], a[68:71], a[132:135], a[60:63]
    s_waitcnt lgkmcnt(8)
    v_mfma_f32_16x16x32_bf16 a[32:35], a[72:75], a[136:139], a[32:35]
    ds_read_b64_tr_b16 a[68:69], v244 offset:27648
    v_mfma_f32_16x16x32_bf16 a[36:39], a[72:75], a[140:143], a[36:39]
    ds_read_b64_tr_b16 a[70:71], v244 offset:29952
    v_mfma_f32_16x16x32_bf16 a[40:43], a[72:75], a[144:147], a[40:43]
    v_mfma_f32_16x16x32_bf16 a[44:47], a[72:75], a[148:151], a[44:47]
    s_waitcnt lgkmcnt(8)
    v_mfma_f32_16x16x32_bf16 a[48:51], a[76:79], a[136:139], a[48:51]
    ds_read_b64_tr_b16 a[72:73], v241 offset:0
    v_mfma_f32_16x16x32_bf16 a[52:55], a[76:79], a[140:143], a[52:55]
    ds_read_b64_tr_b16 a[74:75], v241 offset:2304
    v_mfma_f32_16x16x32_bf16 a[56:59], a[76:79], a[144:147], a[56:59]
    v_mfma_f32_16x16x32_bf16 a[60:63], a[76:79], a[148:151], a[60:63]
    s_waitcnt lgkmcnt(8)
    v_mfma_f32_16x16x32_bf16 v[0:3], a[80:83], a[88:91], v[0:3]
    ds_read_b64_tr_b16 a[76:77], v241 offset:18432
    v_mfma_f32_16x16x32_bf16 v[4:7], a[80:83], a[92:95], v[4:7]
    ds_read_b64_tr_b16 a[78:79], v241 offset:20736
    v_mfma_f32_16x16x32_bf16 v[8:11], a[80:83], a[96:99], v[8:11]
    v_mfma_f32_16x16x32_bf16 v[12:15], a[80:83], a[100:103], v[12:15]
    s_waitcnt lgkmcnt(8)
    v_mfma_f32_16x16x32_bf16 v[16:19], a[84:87], a[88:91], v[16:19]
    ds_read_b64_tr_b16 a[80:81], v241 offset:9216
    v_mfma_f32_16x16x32_bf16 v[20:23], a[84:87], a[92:95], v[20:23]
    ds_read_b64_tr_b16 a[82:83], v241 offset:11520
    v_mfma_f32_16x16x32_bf16 v[24:27], a[84:87], a[96:99], v[24:27]
    v_mfma_f32_16x16x32_bf16 v[28:31], a[84:87], a[100:103], v[28:31]
    s_waitcnt lgkmcnt(8)
    v_mfma_f32_16x16x32_bf16 v[0:3], a[64:67], a[104:107], v[0:3]
    ds_read_b64_tr_b16 a[84:85], v241 offset:27648
    v_accvgpr_read_b32 v32, a0
    v_mfma_f32_16x16x32_bf16 v[4:7], a[64:67], a[108:111], v[4:7]
    ds_read_b64_tr_b16 a[86:87], v241 offset:29952
    v_accvgpr_read_b32 v36, a16
    v_mfma_f32_16x16x32_bf16 v[8:11], a[64:67], a[112:115], v[8:11]
    v_accvgpr_read_b32 v33, a1
    v_accvgpr_read_b32 v37, a17
    v_mfma_f32_16x16x32_bf16 v[12:15], a[64:67], a[116:119], v[12:15]
    v_accvgpr_read_b32 v34, a2
    v_accvgpr_read_b32 v38, a18
    s_waitcnt lgkmcnt(8)
    v_mfma_f32_16x16x32_bf16 v[16:19], a[68:71], a[104:107], v[16:19]
    v_accvgpr_read_b32 v35, a3
    v_mfma_f32_16x16x32_bf16 v[20:23], a[68:71], a[108:111], v[20:23]
    v_accvgpr_read_b32 v39, a19
    v_mfma_f32_16x16x32_bf16 v[24:27], a[68:71], a[112:115], v[24:27]
    v_mul_f32 v32, v32, v36
    v_mul_f32 v33, v33, v37
    v_mfma_f32_16x16x32_bf16 v[28:31], a[68:71], a[116:119], v[28:31]
    v_mul_f32 v34, v34, v38
    v_mul_f32 v35, v35, v39
    s_waitcnt lgkmcnt(6)
    v_mfma_f32_16x16x32_bf16 v[0:3], a[72:75], a[120:123], v[0:3]
    v_cvt_pk_bf16_f32 v246, v32, v33
    v_mfma_f32_16x16x32_bf16 v[4:7], a[72:75], a[124:127], v[4:7]
    v_cvt_pk_bf16_f32 v247, v34, v35
    v_mfma_f32_16x16x32_bf16 v[8:11], a[72:75], a[128:131], v[8:11]
    v_accvgpr_read_b32 v32, a32
    v_accvgpr_read_b32 v36, a48
    v_mfma_f32_16x16x32_bf16 v[12:15], a[72:75], a[132:135], v[12:15]
    v_accvgpr_read_b32 v33, a33
    v_accvgpr_read_b32 v37, a49
    s_waitcnt lgkmcnt(4)
    v_mfma_f32_16x16x32_bf16 v[16:19], a[76:79], a[120:123], v[16:19]
    v_accvgpr_read_b32 v34, a34
    v_mfma_f32_16x16x32_bf16 v[20:23], a[76:79], a[124:127], v[20:23]
    v_accvgpr_read_b32 v38, a50
    v_mfma_f32_16x16x32_bf16 v[24:27], a[76:79], a[128:131], v[24:27]
    v_accvgpr_read_b32 v35, a35
    v_accvgpr_read_b32 v39, a51
    v_mfma_f32_16x16x32_bf16 v[28:31], a[76:79], a[132:135], v[28:31]
    v_mul_f32 v32, v32, v36
    v_mul_f32 v33, v33, v37
    s_waitcnt lgkmcnt(2)
    v_mfma_f32_16x16x32_bf16 v[0:3], a[80:83], a[136:139], v[0:3]
    v_mul_f32 v34, v34, v38
    v_mfma_f32_16x16x32_bf16 v[4:7], a[80:83], a[140:143], v[4:7]
    v_mul_f32 v35, v35, v39
    v_mfma_f32_16x16x32_bf16 v[8:11], a[80:83], a[144:147], v[8:11]
    v_cvt_pk_bf16_f32 v248, v32, v33
    v_cvt_pk_bf16_f32 v249, v34, v35
    v_mfma_f32_16x16x32_bf16 v[12:15], a[80:83], a[148:151], v[12:15]
    buffer_store_dwordx4 v[246:249], v237, s[8:11], s56 offen offset:0 sc1
    v_accvgpr_read_b32 v32, a4
    s_waitcnt lgkmcnt(0)
    v_mfma_f32_16x16x32_bf16 v[16:19], a[84:87], a[136:139], v[16:19]
    v_accvgpr_read_b32 v36, a20
    v_mfma_f32_16x16x32_bf16 v[20:23], a[84:87], a[140:143], v[20:23]
    v_accvgpr_read_b32 v33, a5
    v_mfma_f32_16x16x32_bf16 v[24:27], a[84:87], a[144:147], v[24:27]
    v_accvgpr_read_b32 v37, a21
    v_accvgpr_read_b32 v34, a6
    v_mfma_f32_16x16x32_bf16 v[28:31], a[84:87], a[148:151], v[28:31]
    v_accvgpr_read_b32 v38, a22
    v_accvgpr_read_b32 v35, a7
    v_accvgpr_read_b32 v39, a23
    v_mul_f32 v32, v32, v36
    v_mul_f32 v33, v33, v37
    v_mul_f32 v34, v34, v38
    v_mul_f32 v35, v35, v39
    v_cvt_pk_bf16_f32 v250, v32, v33
    v_cvt_pk_bf16_f32 v251, v34, v35
    v_accvgpr_read_b32 v32, a36
    v_accvgpr_read_b32 v36, a52
    v_accvgpr_read_b32 v33, a37
    v_accvgpr_read_b32 v37, a53
    v_accvgpr_read_b32 v34, a38
    v_accvgpr_read_b32 v38, a54
    v_accvgpr_read_b32 v35, a39
    v_accvgpr_read_b32 v39, a55
    v_mul_f32 v32, v32, v36
    v_mul_f32 v33, v33, v37
    v_mul_f32 v34, v34, v38
    v_mul_f32 v35, v35, v39
    v_cvt_pk_bf16_f32 v252, v32, v33
    v_cvt_pk_bf16_f32 v253, v34, v35
    buffer_store_dwordx4 v[250:253], v237, s[8:11], s57 offen offset:0 sc1
    v_accvgpr_read_b32 v32, a8
    v_accvgpr_read_b32 v36, a24
    v_accvgpr_read_b32 v33, a9
    v_accvgpr_read_b32 v37, a25
    v_accvgpr_read_b32 v34, a10
    v_accvgpr_read_b32 v38, a26
    v_accvgpr_read_b32 v35, a11
    v_accvgpr_read_b32 v39, a27
    v_mul_f32 v32, v32, v36
    v_mul_f32 v33, v33, v37
    v_mul_f32 v34, v34, v38
    v_mul_f32 v35, v35, v39
    v_cvt_pk_bf16_f32 v246, v32, v33
    v_cvt_pk_bf16_f32 v247, v34, v35
    v_accvgpr_read_b32 v32, a40
    v_accvgpr_read_b32 v36, a56
    v_accvgpr_read_b32 v33, a41
    v_accvgpr_read_b32 v37, a57
    v_accvgpr_read_b32 v34, a42
    v_accvgpr_read_b32 v38, a58
    v_accvgpr_read_b32 v35, a43
    v_accvgpr_read_b32 v39, a59
    v_mul_f32 v32, v32, v36
    v_mul_f32 v33, v33, v37
    v_mul_f32 v34, v34, v38
    v_mul_f32 v35, v35, v39
    v_cvt_pk_bf16_f32 v248, v32, v33
    v_cvt_pk_bf16_f32 v249, v34, v35
    buffer_store_dwordx4 v[246:249], v237, s[8:11], s58 offen offset:0 sc1
    v_accvgpr_read_b32 v32, a12
    v_accvgpr_read_b32 v36, a28
    v_accvgpr_read_b32 v33, a13
    v_accvgpr_read_b32 v37, a29
    v_accvgpr_read_b32 v34, a14
    v_accvgpr_read_b32 v38, a30
    v_accvgpr_read_b32 v35, a15
    v_accvgpr_read_b32 v39, a31
    v_mul_f32 v32, v32, v36
    v_mul_f32 v33, v33, v37
    v_mul_f32 v34, v34, v38
    v_mul_f32 v35, v35, v39
    v_cvt_pk_bf16_f32 v250, v32, v33
    v_cvt_pk_bf16_f32 v251, v34, v35
    v_accvgpr_read_b32 v32, a44
    v_accvgpr_read_b32 v36, a60
    v_accvgpr_read_b32 v33, a45
    v_accvgpr_read_b32 v37, a61
    v_accvgpr_read_b32 v34, a46
    v_accvgpr_read_b32 v38, a62
    v_accvgpr_read_b32 v35, a47
    v_accvgpr_read_b32 v39, a63
    v_mul_f32 v32, v32, v36
    v_mul_f32 v33, v33, v37
    v_mul_f32 v34, v34, v38
    v_mul_f32 v35, v35, v39
    v_cvt_pk_bf16_f32 v252, v32, v33
    v_cvt_pk_bf16_f32 v253, v34, v35
    buffer_store_dwordx4 v[250:253], v237, s[8:11], s59 offen offset:0 sc1
    v_mul_f32 v0, v0, v16
    v_mul_f32 v1, v1, v17
    v_mul_f32 v2, v2, v18
    v_mul_f32 v3, v3, v19
    v_cvt_pk_bf16_f32 v246, v0, v1
    v_cvt_pk_bf16_f32 v247, v2, v3
    buffer_store_dwordx2 v[246:247], v237, s[8:11], s52 offen offset:8 sc1
    v_mul_f32 v4, v4, v20
    v_mul_f32 v5, v5, v21
    v_mul_f32 v6, v6, v22
    v_mul_f32 v7, v7, v23
    v_cvt_pk_bf16_f32 v250, v4, v5
    v_cvt_pk_bf16_f32 v251, v6, v7
    buffer_store_dwordx2 v[250:251], v237, s[8:11], s53 offen offset:8 sc1
    v_mul_f32 v8, v8, v24
    v_mul_f32 v9, v9, v25
    v_mul_f32 v10, v10, v26
    v_mul_f32 v11, v11, v27
    v_cvt_pk_bf16_f32 v246, v8, v9
    v_cvt_pk_bf16_f32 v247, v10, v11
    buffer_store_dwordx2 v[246:247], v237, s[8:11], s54 offen offset:8 sc1
    v_mul_f32 v12, v12, v28
    v_mul_f32 v13, v13, v29
    v_mul_f32 v14, v14, v30
    v_mul_f32 v15, v15, v31
    v_cvt_pk_bf16_f32 v250, v12, v13
    v_cvt_pk_bf16_f32 v251, v14, v15
    buffer_store_dwordx2 v[250:251], v237, s[8:11], s55 offen offset:8 sc1
GG_FIN:
    s_lshl_b32 s20, s18, 2
    s_lshr_b32 s21, s17, 3
    s_add_u32 s20, s20, s21
    s_lshl_b32 s20, s20, 7
    s_and_b32 s21, s17, 7
    s_lshl_b32 s21, s21, 2
    s_add_u32 s20, s20, s21
    s_add_u32 s20, s20, 14286848
    s_lshr_b32 s21, s4, 1
    s_lshl_b32 s21, s21, 2
    s_add_u32 s21, s21, s3
    s_lshl_b32 s21, s21, 7
    s_add_u32 s21, s21, 14286848
    s_lshl_b32 s31, s4, 3
    s_lshl_b32 s30, s16, 1
    s_add_u32 s31, s31, s30
    s_mul_i32 s31, s31, 147456
    s_mul_i32 s30, s3, 36864
    s_add_u32 s31, s31, s30
    s_add_u32 s31, s31, 14680064
    s_add_u32 s33, s60, 0
    s_add_u32 s34, s60, 147456
    s_add_u32 s35, s60, 294912
    s_add_u32 s36, s60, 442368
    s_add_u32 s37, s60, 589824
    s_add_u32 s38, s60, 737280
    s_add_u32 s39, s60, 884736
    s_add_u32 s40, s60, 1032192
    s_add_u32 s41, s60, 1179648
    s_add_u32 s42, s31, 0
    s_add_u32 s43, s31, 4096
    s_add_u32 s44, s31, 8192
    s_add_u32 s45, s31, 12288
    s_add_u32 s46, s31, 16384
    s_add_u32 s47, s31, 20480
    s_add_u32 s48, s31, 24576
    s_add_u32 s49, s31, 28672
    s_add_u32 s50, s31, 32768
    v_add_u32 v238, 147456, v237
    v_lshrrev_b32 v2, 2, v224
    v_mul_u32_u24 v241, 288, v2
    v_and_b32 v2, 3, v224
    v_lshl_add_u32 v241, v2, 3, v241
    v_add_u32 v242, 36864, v241
    v_add_u32 v243, 73728, v241
    v_add_u32 v244, 110592, v241
    v_lshlrev_b32 v239, 2, v224
    v_mov_b32 v240, 1
    s_waitcnt vmcnt(0) lgkmcnt(0)
    s_barrier
    s_cmp_lg_u32 s16, 0
    s_cbranch_scc1 GG_W1
    s_mov_b64 exec, 1
    buffer_store_dword v240, v239, s[8:11], s20 offen sc1
    s_mov_b64 exec, -1
    s_mov_b32 s22, 0x8000
    buffer_load_dword v2, v239, s[8:11], s21 offen sc1
    buffer_load_dword v3, v239, s[8:11], s21 offen sc1
    buffer_load_dword v4, v239, s[8:11], s21 offen sc1
GG_P1:
    buffer_load_dword v5, v239, s[8:11], s21 offen sc1
    s_waitcnt vmcnt(3)
    v_cmp_ne_u32 vcc, 0, v2
    s_nop 0
    s_and_b32 s23, vcc_lo, 0xff
    s_cmp_eq_u32 s23, 0xff
    s_cbranch_scc1 GG_P1_X
    buffer_load_dword v2, v239, s[8:11], s21 offen sc1
    s_waitcnt vmcnt(3)
    v_cmp_ne_u32 vcc, 0, v3
    s_nop 0
    s_and_b32 s23, vcc_lo, 0xff
    s_cmp_eq_u32 s23, 0xff
    s_cbranch_scc1 GG_P1_X
    buffer_load_dword v3, v239, s[8:11], s21 offen sc1
    s_waitcnt vmcnt(3)
    v_cmp_ne_u32 vcc, 0, v4
    s_nop 0
    s_and_b32 s23, vcc_lo, 0xff
    s_cmp_eq_u32 s23, 0xff
    s_cbranch_scc1 GG_P1_X
    buffer_load_dword v4, v239, s[8:11], s21 offen sc1
    s_waitcnt vmcnt(3)
    v_cmp_ne_u32 vcc, 0, v5
    s_nop 0
    s_and_b32 s23, vcc_lo, 0xff
    s_cmp_eq_u32 s23, 0xff
    s_cbranch_scc1 GG_P1_X
    s_sub_u32 s22, s22, 1
    s_cbranch_scc0 GG_P1
GG_P1_X:
GG_W1:
    s_add_u32 m0, s51, 110592
    s_nop 0
    buffer_load_dwordx4 v226, s[12:15], s35 offen lds
    s_add_u32 m0, s51, 111616
    s_nop 0
    buffer_load_dwordx4 v227, s[12:15], s35 offen lds
    s_add_u32 m0, s51, 112640
    s_nop 0
    buffer_load_dwordx4 v228, s[12:15], s35 offen lds
    s_add_u32 m0, s51, 113664
    s_nop 0
    buffer_load_dwordx4 v229, s[12:15], s35 offen lds
    s_add_u32 m0, s51, 114688
    s_nop 0
    buffer_load_dwordx4 v230, s[12:15], s35 offen lds
    s_add_u32 m0, s51, 115712
    s_nop 0
    buffer_load_dwordx4 v231, s[12:15], s35 offen lds
    s_add_u32 m0, s51, 116736
    s_nop 0
    buffer_load_dwordx4 v232, s[12:15], s35 offen lds
    s_add_u32 m0, s51, 117760
    s_nop 0
    buffer_load_dwordx4 v233, s[12:15], s35 offen lds
    s_add_u32 m0, s51, 118784
    s_nop 0
    buffer_load_dwordx4 v234, s[12:15], s35 offen lds
    s_add_u32 m0, s51, 0
    s_nop 0
    buffer_load_dwordx4 v226, s[12:15], s36 offen lds
    s_add_u32 m0, s51, 1024
    s_nop 0
    buffer_load_dwordx4 v227, s[12:15], s36 offen lds
    s_add_u32 m0, s51, 2048
    s_nop 0
    buffer_load_dwordx4 v228, s[12:15], s36 offen lds
    s_add_u32 m0, s51, 3072
    s_nop 0
    buffer_load_dwordx4 v229, s[12:15], s36 offen lds
    s_add_u32 m0, s51, 4096
    s_nop 0
    buffer_load_dwordx4 v230, s[12:15], s36 offen lds
    s_add_u32 m0, s51, 5120
    s_nop 0
    buffer_load_dwordx4 v231, s[12:15], s36 offen lds
    s_add_u32 m0, s51, 6144
    s_nop 0
    buffer_load_dwordx4 v232, s[12:15], s36 offen lds
    s_add_u32 m0, s51, 7168
    s_nop 0
    buffer_load_dwordx4 v233, s[12:15], s36 offen lds
    s_add_u32 m0, s51, 8192
    s_nop 0
    buffer_load_dwordx4 v234, s[12:15], s36 offen lds
    s_barrier
    s_and_b32 s22, s4, 1
    s_lshl_b32 s22, s22, 2
    s_add_u32 s22, s22, s5
    s_lshl_b32 s22, s22, 2
    s_lshr_b32 s23, s4, 1
    s_lshl_b32 s23, s23, 7
    s_add_u32 s23, s23, s22
    s_lshl_b32 s28, s3, 5
    s_add_u32 s28, s28, s23
    s_add_u32 s28, s28, s16
    s_mul_i32 s28, s28, 9216
    s_add_u32 s28, s28, 33554432
    s_add_u32 s29, s28, 4096
    s_add_u32 s30, s28, 8192
    s_add_u32 s23, s23, s3
    s_lshl_b32 s17, s16, 11
    s_add_u32 s17, s17, 33554432
    s_add_u32 s18, s3, 1
    s_and_b32 s18, s18, 3
    s_lshl_b32 s18, s18, 5
    s_add_u32 s18, s18, s23
    s_mul_i32 s18, s18, 9216
    s_add_u32 s53, s18, s17
    s_add_u32 s18, s3, 2
    s_and_b32 s18, s18, 3
    s_lshl_b32 s18, s18, 5
    s_add_u32 s18, s18, s23
    s_mul_i32 s18, s18, 9216
    s_add_u32 s54, s18, s17
    s_add_u32 s18, s3, 3
    s_and_b32 s18, s18, 3
    s_lshl_b32 s18, s18, 5
    s_add_u32 s18, s18, s23
    s_mul_i32 s18, s18, 9216
    s_add_u32 s55, s18, s17
    s_lshl_b32 s56, s4, 7
    s_lshl_b32 s18, s3, 5
    s_add_u32 s56, s56, s18
    s_mul_i32 s56, s56, 1152
    s_mul_i32 s18, s5, 288
    s_add_u32 s56, s56, s18
    s_lshl_b32 s18, s16, 6
    s_add_u32 s56, s56, s18
    s_mul_i32 s57, s5, 576
    s_lshl_b32 s18, s16, 7
    s_add_u32 s57, s57, s18
    s_add_u32 s57, s57, 14225920
    s_lshl_b32 s58, s4, 3
    s_lshl_b32 s18, s3, 1
    s_add_u32 s58, s58, s18
    s_mul_i32 s58, s58, 18432
    s_mul_i32 s18, s5, 4608
    s_add_u32 s58, s58, s18
    s_lshl_b32 s18, s16, 10
    s_add_u32 s58, s58, s18
    s_add_u32 s58, s58, 7077888
    s_lshl_b32 s59, s16, 12
    s_add_u32 s59, s59, 73728
    buffer_load_dwordx4 v[108:111], v237, s[8:11], s42 offen offset:0 sc1
    buffer_load_dwordx4 v[112:115], v238, s[8:11], s42 offen offset:0 sc1
    buffer_load_dwordx4 v[116:119], v237, s[8:11], s42 offen offset:1024 sc1
    buffer_load_dwordx4 v[120:123], v238, s[8:11], s42 offen offset:1024 sc1
    buffer_load_dwordx4 v[124:127], v237, s[8:11], s42 offen offset:2048 sc1
    buffer_load_dwordx4 v[128:131], v238, s[8:11], s42 offen offset:2048 sc1
    buffer_load_dwordx4 v[132:135], v237, s[8:11], s42 offen offset:3072 sc1
    buffer_load_dwordx4 v[136:139], v238, s[8:11], s42 offen offset:3072 sc1
    ds_read_b64_tr_b16 v[72:73], v242 offset:0
    ds_read_b64_tr_b16 v[74:75], v242 offset:4608
    ds_read_b64_tr_b16 v[76:77], v242 offset:32
    ds_read_b64_tr_b16 v[78:79], v242 offset:4640
    ds_read_b64_tr_b16 v[80:81], v242 offset:64
    ds_read_b64_tr_b16 v[82:83], v242 offset:4672
    ds_read_b64_tr_b16 v[84:85], v242 offset:96
    ds_read_b64_tr_b16 v[86:87], v242 offset:4704
    ds_read_b64_tr_b16 v[88:89], v242 offset:128
    ds_read_b64_tr_b16 v[90:91], v242 offset:4736
    ds_read_b64_tr_b16 v[92:93], v242 offset:160
    ds_read_b64_tr_b16 v[94:95], v242 offset:4768
    ds_read_b64_tr_b16 v[96:97], v242 offset:192
    ds_read_b64_tr_b16 v[98:99], v242 offset:4800
    ds_read_b64_tr_b16 v[100:101], v242 offset:224
    ds_read_b64_tr_b16 v[102:103], v242 offset:4832
    s_waitcnt vmcnt(6)
    s_waitcnt lgkmcnt(12)
    v_mfma_f32_16x16x32_bf16 v[0:3], v[72:75], v[108:111], 0
    ds_read_b64_tr_b16 v[104:105], v242 offset:256
    buffer_load_dwordx4 v[140:143], v237, s[8:11], s43 offen offset:0 sc1
    v_mfma_f32_16x16x32_bf16 v[4:7], v[72:75], v[112:115], 0
    ds_read_b64_tr_b16 v[106:107], v242 offset:4864
    v_mfma_f32_16x16x32_bf16 v[8:11], v[76:79], v[108:111], 0
    ds_read_b64_tr_b16 v[72:73], v242 offset:9216
    buffer_load_dwordx4 v[144:147], v238, s[8:11], s43 offen offset:0 sc1
    v_mfma_f32_16x16x32_bf16 v[12:15], v[76:79], v[112:115], 0
    ds_read_b64_tr_b16 v[74:75], v242 offset:13824
    buffer_load_dwordx4 v[148:151], v237, s[8:11], s43 offen offset:1024 sc1
    s_waitcnt lgkmcnt(12)
    v_mfma_f32_16x16x32_bf16 v[16:19], v[80:83], v[108:111], 0
    ds_read_b64_tr_b16 v[76:77], v242 offset:9248
    buffer_load_dwordx4 v[152:155], v238, s[8:11], s43 offen offset:1024 sc1
    v_mfma_f32_16x16x32_bf16 v[20:23], v[80:83], v[112:115], 0
    ds_read_b64_tr_b16 v[78:79], v242 offset:13856
    v_mfma_f32_16x16x32_bf16 v[24:27], v[84:87], v[108:111], 0
    ds_read_b64_tr_b16 v[80:81], v242 offset:9280
    buffer_load_dwordx4 v[156:159], v237, s[8:11], s43 offen offset:2048 sc1
    v_mfma_f32_16x16x32_bf16 v[28:31], v[84:87], v[112:115], 0
    ds_read_b64_tr_b16 v[82:83], v242 offset:13888
    buffer_load_dwordx4 v[160:163], v238, s[8:11], s43 offen offset:2048 sc1
    s_waitcnt lgkmcnt(12)
    v_mfma_f32_16x16x32_bf16 v[32:35], v[88:91], v[108:111], 0
    ds_read_b64_tr_b16 v[84:85], v242 offset:9312
    buffer_load_dwordx4 v[164:167], v237, s[8:11], s43 offen offset:3072 sc1
    v_mfma_f32_16x16x32_bf16 v[36:39], v[88:91], v[112:115], 0
    ds_read_b64_tr_b16 v[86:87], v242 offset:13920
    v_mfma_f32_16x16x32_bf16 v[40:43], v[92:95], v[108:111], 0
    ds_read_b64_tr_b16 v[88:89], v242 offset:9344
    buffer_load_dwordx4 v[168:171], v238, s[8:11], s43 offen offset:3072 sc1
    v_mfma_f32_16x16x32_bf16 v[44:47], v[92:95], v[112:115], 0
    ds_read_b64_tr_b16 v[90:91], v242 offset:13952
    buffer_load_dwordx4 v[172:175], v237, s[8:11], s44 offen offset:0 sc1
    s_waitcnt lgkmcnt(12)
    v_mfma_f32_16x16x32_bf16 v[48:51], v[96:99], v[108:111], 0
    ds_read_b64_tr_b16 v[92:93], v242 offset:9376
    buffer_load_dwordx4 v[176:179], v238, s[8:11], s44 offen offset:0 sc1
    v_mfma_f32_16x16x32_bf16 v[52:55], v[96:99], v[112:115], 0
    ds_read_b64_tr_b16 v[94:95], v242 offset:13984
    v_mfma_f32_16x16x32_bf16 v[56:59], v[100:103], v[108:111], 0
    ds_read_b64_tr_b16 v[96:97], v242 offset:9408
    buffer_load_dwordx4 v[180:183], v237, s[8:11], s44 offen offset:1024 sc1
    v_mfma_f32_16x16x32_bf16 v[60:63], v[100:103], v[112:115], 0
    ds_read_b64_tr_b16 v[98:99], v242 offset:14016
    buffer_load_dwordx4 v[184:187], v238, s[8:11], s44 offen offset:1024 sc1
    s_waitcnt lgkmcnt(12)
    v_mfma_f32_16x16x32_bf16 v[64:67], v[104:107], v[108:111], 0
    ds_read_b64_tr_b16 v[100:101], v242 offset:9440
    buffer_load_dwordx4 v[188:191], v237, s[8:11], s44 offen offset:2048 sc1
    v_mfma_f32_16x16x32_bf16 v[68:71], v[104:107], v[112:115], 0
    ds_read_b64_tr_b16 v[102:103], v242 offset:14048
    s_waitcnt vmcnt(17)
    v_mfma_f32_16x16x32_bf16 v[0:3], v[72:75], v[116:119], v[0:3]
    ds_read_b64_tr_b16 v[104:105], v242 offset:9472
    buffer_load_dwordx4 v[192:195], v238, s[8:11], s44 offen offset:2048 sc1
    v_mfma_f32_16x16x32_bf16 v[4:7], v[72:75], v[120:123], v[4:7]
    ds_read_b64_tr_b16 v[106:107], v242 offset:14080
    buffer_load_dwordx4 v[196:199], v237, s[8:11], s44 offen offset:3072 sc1
    s_waitcnt lgkmcnt(12)
    v_mfma_f32_16x16x32_bf16 v[8:11], v[76:79], v[116:119], v[8:11]
    ds_read_b64_tr_b16 v[72:73], v242 offset:18432
    buffer_load_dwordx4 v[200:203], v238, s[8:11], s44 offen offset:3072 sc1
    v_mfma_f32_16x16x32_bf16 v[12:15], v[76:79], v[120:123], v[12:15]
    ds_read_b64_tr_b16 v[74:75], v242 offset:23040
    v_mfma_f32_16x16x32_bf16 v[16:19], v[80:83], v[116:119], v[16:19]
    ds_read_b64_tr_b16 v[76:77], v242 offset:18464
    buffer_load_dwordx4 v[108:111], v237, s[8:11], s45 offen offset:0 sc1
    v_mfma_f32_16x16x32_bf16 v[20:23], v[80:83], v[120:123], v[20:23]
    ds_read_b64_tr_b16 v[78:79], v242 offset:23072
    buffer_load_dwordx4 v[112:115], v238, s[8:11], s45 offen offset:0 sc1
    s_waitcnt lgkmcnt(12)
    v_mfma_f32_16x16x32_bf16 v[24:27], v[84:87], v[116:119], v[24:27]
    ds_read_b64_tr_b16 v[80:81], v242 offset:18496
    v_mfma_f32_16x16x32_bf16 v[28:31], v[84:87], v[120:123], v[28:31]
    ds_read_b64_tr_b16 v[82:83], v242 offset:23104
    v_mfma_f32_16x16x32_bf16 v[32:35], v[88:91], v[116:119], v[32:35]
    ds_read_b64_tr_b16 v[84:85], v242 offset:18528
    v_mfma_f32_16x16x32_bf16 v[36:39], v[88:91], v[120:123], v[36:39]
    ds_read_b64_tr_b16 v[86:87], v242 offset:23136
    s_waitcnt lgkmcnt(12)
    v_mfma_f32_16x16x32_bf16 v[40:43], v[92:95], v[116:119], v[40:43]
    ds_read_b64_tr_b16 v[88:89], v242 offset:18560
    v_mfma_f32_16x16x32_bf16 v[44:47], v[92:95], v[120:123], v[44:47]
    ds_read_b64_tr_b16 v[90:91], v242 offset:23168
    v_mfma_f32_16x16x32_bf16 v[48:51], v[96:99], v[116:119], v[48:51]
    ds_read_b64_tr_b16 v[92:93], v242 offset:18592
    v_mfma_f32_16x16x32_bf16 v[52:55], v[96:99], v[120:123], v[52:55]
    ds_read_b64_tr_b16 v[94:95], v242 offset:23200
    s_waitcnt lgkmcnt(12)
    v_mfma_f32_16x16x32_bf16 v[56:59], v[100:103], v[116:119], v[56:59]
    ds_read_b64_tr_b16 v[96:97], v242 offset:18624
    v_mfma_f32_16x16x32_bf16 v[60:63], v[100:103], v[120:123], v[60:63]
    ds_read_b64_tr_b16 v[98:99], v242 offset:23232
    v_mfma_f32_16x16x32_bf16 v[64:67], v[104:107], v[116:119], v[64:67]
    ds_read_b64_tr_b16 v[100:101], v242 offset:18656
    v_mfma_f32_16x16x32_bf16 v[68:71], v[104:107], v[120:123], v[68:71]
    ds_read_b64_tr_b16 v[102:103], v242 offset:23264
    s_waitcnt vmcnt(20)
    s_waitcnt lgkmcnt(12)
    v_mfma_f32_16x16x32_bf16 v[0:3], v[72:75], v[124:127], v[0:3]
    ds_read_b64_tr_b16 v[104:105], v242 offset:18688
    buffer_load_dwordx4 v[116:119], v237, s[8:11], s45 offen offset:1024 sc1
    v_mfma_f32_16x16x32_bf16 v[4:7], v[72:75], v[128:131], v[4:7]
    ds_read_b64_tr_b16 v[106:107], v242 offset:23296
    v_mfma_f32_16x16x32_bf16 v[8:11], v[76:79], v[124:127], v[8:11]
    ds_read_b64_tr_b16 v[72:73], v242 offset:27648
    buffer_load_dwordx4 v[120:123], v238, s[8:11], s45 offen offset:1024 sc1
    v_mfma_f32_16x16x32_bf16 v[12:15], v[76:79], v[128:131], v[12:15]
    ds_read_b64_tr_b16 v[74:75], v242 offset:32256
    s_waitcnt lgkmcnt(12)
    v_mfma_f32_16x16x32_bf16 v[16:19], v[80:83], v[124:127], v[16:19]
    ds_read_b64_tr_b16 v[76:77], v242 offset:27680
    v_mfma_f32_16x16x32_bf16 v[20:23], v[80:83], v[128:131], v[20:23]
    ds_read_b64_tr_b16 v[78:79], v242 offset:32288
    v_mfma_f32_16x16x32_bf16 v[24:27], v[84:87], v[124:127], v[24:27]
    ds_read_b64_tr_b16 v[80:81], v242 offset:27712
    v_mfma_f32_16x16x32_bf16 v[28:31], v[84:87], v[128:131], v[28:31]
    ds_read_b64_tr_b16 v[82:83], v242 offset:32320
    s_waitcnt lgkmcnt(12)
    v_mfma_f32_16x16x32_bf16 v[32:35], v[88:91], v[124:127], v[32:35]
    ds_read_b64_tr_b16 v[84:85], v242 offset:27744
    v_mfma_f32_16x16x32_bf16 v[36:39], v[88:91], v[128:131], v[36:39]
    ds_read_b64_tr_b16 v[86:87], v242 offset:32352
    v_mfma_f32_16x16x32_bf16 v[40:43], v[92:95], v[124:127], v[40:43]
    ds_read_b64_tr_b16 v[88:89], v242 offset:27776
    v_mfma_f32_16x16x32_bf16 v[44:47], v[92:95], v[128:131], v[44:47]
    ds_read_b64_tr_b16 v[90:91], v242 offset:32384
    s_waitcnt lgkmcnt(12)
    v_mfma_f32_16x16x32_bf16 v[48:51], v[96:99], v[124:127], v[48:51]
    ds_read_b64_tr_b16 v[92:93], v242 offset:27808
    v_mfma_f32_16x16x32_bf16 v[52:55], v[96:99], v[128:131], v[52:55]
    ds_read_b64_tr_b16 v[94:95], v242 offset:32416
    v_mfma_f32_16x16x32_bf16 v[56:59], v[100:103], v[124:127], v[56:59]
    ds_read_b64_tr_b16 v[96:97], v242 offset:27840
    v_mfma_f32_16x16x32_bf16 v[60:63], v[100:103], v[128:131], v[60:63]
    ds_read_b64_tr_b16 v[98:99], v242 offset:32448
    s_waitcnt lgkmcnt(12)
    v_mfma_f32_16x16x32_bf16 v[64:67], v[104:107], v[124:127], v[64:67]
    ds_read_b64_tr_b16 v[100:101], v242 offset:27872
    v_mfma_f32_16x16x32_bf16 v[68:71], v[104:107], v[128:131], v[68:71]
    ds_read_b64_tr_b16 v[102:103], v242 offset:32480
    s_waitcnt vmcnt(20)
    v_mfma_f32_16x16x32_bf16 v[0:3], v[72:75], v[132:135], v[0:3]
    ds_read_b64_tr_b16 v[104:105], v242 offset:27904
    buffer_load_dwordx4 v[124:127], v237, s[8:11], s45 offen offset:2048 sc1
    v_mfma_f32_16x16x32_bf16 v[4:7], v[72:75], v[136:139], v[4:7]
    ds_read_b64_tr_b16 v[106:107], v242 offset:32512
    buffer_load_dwordx4 v[128:131], v238, s[8:11], s45 offen offset:2048 sc1
    s_barrier
    s_waitcnt lgkmcnt(12)
    v_mfma_f32_16x16x32_bf16 v[8:11], v[76:79], v[132:135], v[8:11]
    ds_read_b64_tr_b16 v[72:73], v243 offset:0
    v_mfma_f32_16x16x32_bf16 v[12:15], v[76:79], v[136:139], v[12:15]
    ds_read_b64_tr_b16 v[74:75], v243 offset:4608
    v_mfma_f32_16x16x32_bf16 v[16:19], v[80:83], v[132:135], v[16:19]
    ds_read_b64_tr_b16 v[76:77], v243 offset:32
    v_mfma_f32_16x16x32_bf16 v[20:23], v[80:83], v[136:139], v[20:23]
    ds_read_b64_tr_b16 v[78:79], v243 offset:4640
    s_waitcnt lgkmcnt(12)
    v_mfma_f32_16x16x32_bf16 v[24:27], v[84:87], v[132:135], v[24:27]
    ds_read_b64_tr_b16 v[80:81], v243 offset:64
    v_mfma_f32_16x16x32_bf16 v[28:31], v[84:87], v[136:139], v[28:31]
    ds_read_b64_tr_b16 v[82:83], v243 offset:4672
    v_mfma_f32_16x16x32_bf16 v[32:35], v[88:91], v[132:135], v[32:35]
    ds_read_b64_tr_b16 v[84:85], v243 offset:96
    v_mfma_f32_16x16x32_bf16 v[36:39], v[88:91], v[136:139], v[36:39]
    ds_read_b64_tr_b16 v[86:87], v243 offset:4704
    s_waitcnt lgkmcnt(12)
    v_mfma_f32_16x16x32_bf16 v[40:43], v[92:95], v[132:135], v[40:43]
    ds_read_b64_tr_b16 v[88:89], v243 offset:128
    v_mfma_f32_16x16x32_bf16 v[44:47], v[92:95], v[136:139], v[44:47]
    ds_read_b64_tr_b16 v[90:91], v243 offset:4736
    v_mfma_f32_16x16x32_bf16 v[48:51], v[96:99], v[132:135], v[48:51]
    ds_read_b64_tr_b16 v[92:93], v243 offset:160
    v_mfma_f32_16x16x32_bf16 v[52:55], v[96:99], v[136:139], v[52:55]
    ds_read_b64_tr_b16 v[94:95], v243 offset:4768
    s_waitcnt lgkmcnt(12)
    v_mfma_f32_16x16x32_bf16 v[56:59], v[100:103], v[132:135], v[56:59]
    ds_read_b64_tr_b16 v[96:97], v243 offset:192
    v_mfma_f32_16x16x32_bf16 v[60:63], v[100:103], v[136:139], v[60:63]
    ds_read_b64_tr_b16 v[98:99], v243 offset:4800
    v_mfma_f32_16x16x32_bf16 v[64:67], v[104:107], v[132:135], v[64:67]
    ds_read_b64_tr_b16 v[100:101], v243 offset:224
    v_mfma_f32_16x16x32_bf16 v[68:71], v[104:107], v[136:139], v[68:71]
    ds_read_b64_tr_b16 v[102:103], v243 offset:4832
    s_waitcnt vmcnt(20)
    s_waitcnt lgkmcnt(12)
    v_mfma_f32_16x16x32_bf16 v[0:3], v[72:75], v[140:143], v[0:3]
    ds_read_b64_tr_b16 v[104:105], v243 offset:256
    buffer_load_dwordx4 v[132:135], v237, s[8:11], s45 offen offset:3072 sc1
    v_mfma_f32_16x16x32_bf16 v[4:7], v[72:75], v[144:147], v[4:7]
    ds_read_b64_tr_b16 v[106:107], v243 offset:4864
    v_mfma_f32_16x16x32_bf16 v[8:11], v[76:79], v[140:143], v[8:11]
    ds_read_b64_tr_b16 v[72:73], v243 offset:9216
    buffer_load_dwordx4 v[136:139], v238, s[8:11], s45 offen offset:3072 sc1
    v_mfma_f32_16x16x32_bf16 v[12:15], v[76:79], v[144:147], v[12:15]
    ds_read_b64_tr_b16 v[74:75], v243 offset:13824
    s_waitcnt lgkmcnt(12)
    v_mfma_f32_16x16x32_bf16 v[16:19], v[80:83], v[140:143], v[16:19]
    ds_read_b64_tr_b16 v[76:77], v243 offset:9248
    v_mfma_f32_16x16x32_bf16 v[20:23], v[80:83], v[144:147], v[20:23]
    ds_read_b64_tr_b16 v[78:79], v243 offset:13856
    v_mfma_f32_16x16x32_bf16 v[24:27], v[84:87], v[140:143], v[24:27]
    ds_read_b64_tr_b16 v[80:81], v243 offset:9280
    v_mfma_f32_16x16x32_bf16 v[28:31], v[84:87], v[144:147], v[28:31]
    ds_read_b64_tr_b16 v[82:83], v243 offset:13888
    s_waitcnt lgkmcnt(12)
    v_mfma_f32_16x16x32_bf16 v[32:35], v[88:91], v[140:143], v[32:35]
    ds_read_b64_tr_b16 v[84:85], v243 offset:9312
    v_mfma_f32_16x16x32_bf16 v[36:39], v[88:91], v[144:147], v[36:39]
    ds_read_b64_tr_b16 v[86:87], v243 offset:13920
    v_mfma_f32_16x16x32_bf16 v[40:43], v[92:95], v[140:143], v[40:43]
    ds_read_b64_tr_b16 v[88:89], v243 offset:9344
    v_mfma_f32_16x16x32_bf16 v[44:47], v[92:95], v[144:147], v[44:47]
    ds_read_b64_tr_b16 v[90:91], v243 offset:13952
    s_waitcnt lgkmcnt(12)
    v_mfma_f32_16x16x32_bf16 v[48:51], v[96:99], v[140:143], v[48:51]
    ds_read_b64_tr_b16 v[92:93], v243 offset:9376
    v_mfma_f32_16x16x32_bf16 v[52:55], v[96:99], v[144:147], v[52:55]
    ds_read_b64_tr_b16 v[94:95], v243 offset:13984
    v_mfma_f32_16x16x32_bf16 v[56:59], v[100:103], v[140:143], v[56:59]
    ds_read_b64_tr_b16 v[96:97], v243 offset:9408
    v_mfma_f32_16x16x32_bf16 v[60:63], v[100:103], v[144:147], v[60:63]
    ds_read_b64_tr_b16 v[98:99], v243 offset:14016
    s_waitcnt lgkmcnt(12)
    v_mfma_f32_16x16x32_bf16 v[64:67], v[104:107], v[140:143], v[64:67]
    ds_read_b64_tr_b16 v[100:101], v243 offset:9440
    v_mfma_f32_16x16x32_bf16 v[68:71], v[104:107], v[144:147], v[68:71]
    ds_read_b64_tr_b16 v[102:103], v243 offset:14048
    s_waitcnt vmcnt(20)
    v_mfma_f32_16x16x32_bf16 v[0:3], v[72:75], v[148:151], v[0:3]
    ds_read_b64_tr_b16 v[104:105], v243 offset:9472
    buffer_load_dwordx4 v[140:143], v237, s[8:11], s46 offen offset:0 sc1
    v_mfma_f32_16x16x32_bf16 v[4:7], v[72:75], v[152:155], v[4:7]
    ds_read_b64_tr_b16 v[106:107], v243 offset:14080
    buffer_load_dwordx4 v[144:147], v238, s[8:11], s46 offen offset:0 sc1
    s_waitcnt lgkmcnt(12)
    v_mfma_f32_16x16x32_bf16 v[8:11], v[76:79], v[148:151], v[8:11]
    ds_read_b64_tr_b16 v[72:73], v243 offset:18432
    v_mfma_f32_16x16x32_bf16 v[12:15], v[76:79], v[152:155], v[12:15]
    ds_read_b64_tr_b16 v[74:75], v243 offset:23040
    v_mfma_f32_16x16x32_bf16 v[16:19], v[80:83], v[148:151], v[16:19]
    ds_read_b64_tr_b16 v[76:77], v243 offset:18464
    v_mfma_f32_16x16x32_bf16 v[20:23], v[80:83], v[152:155], v[20:23]
    ds_read_b64_tr_b16 v[78:79], v243 offset:23072
    s_waitcnt lgkmcnt(12)
    v_mfma_f32_16x16x32_bf16 v[24:27], v[84:87], v[148:151], v[24:27]
    ds_read_b64_tr_b16 v[80:81], v243 offset:18496
    v_mfma_f32_16x16x32_bf16 v[28:31], v[84:87], v[152:155], v[28:31]
    ds_read_b64_tr_b16 v[82:83], v243 offset:23104
    v_mfma_f32_16x16x32_bf16 v[32:35], v[88:91], v[148:151], v[32:35]
    ds_read_b64_tr_b16 v[84:85], v243 offset:18528
    v_mfma_f32_16x16x32_bf16 v[36:39], v[88:91], v[152:155], v[36:39]
    ds_read_b64_tr_b16 v[86:87], v243 offset:23136
    s_waitcnt lgkmcnt(12)
    v_mfma_f32_16x16x32_bf16 v[40:43], v[92:95], v[148:151], v[40:43]
    ds_read_b64_tr_b16 v[88:89], v243 offset:18560
    v_mfma_f32_16x16x32_bf16 v[44:47], v[92:95], v[152:155], v[44:47]
    ds_read_b64_tr_b16 v[90:91], v243 offset:23168
    v_mfma_f32_16x16x32_bf16 v[48:51], v[96:99], v[148:151], v[48:51]
    ds_read_b64_tr_b16 v[92:93], v243 offset:18592
    v_mfma_f32_16x16x32_bf16 v[52:55], v[96:99], v[152:155], v[52:55]
    ds_read_b64_tr_b16 v[94:95], v243 offset:23200
    s_waitcnt lgkmcnt(12)
    v_mfma_f32_16x16x32_bf16 v[56:59], v[100:103], v[148:151], v[56:59]
    ds_read_b64_tr_b16 v[96:97], v243 offset:18624
    v_mfma_f32_16x16x32_bf16 v[60:63], v[100:103], v[152:155], v[60:63]
    ds_read_b64_tr_b16 v[98:99], v243 offset:23232
    v_mfma_f32_16x16x32_bf16 v[64:67], v[104:107], v[148:151], v[64:67]
    ds_read_b64_tr_b16 v[100:101], v243 offset:18656
    v_mfma_f32_16x16x32_bf16 v[68:71], v[104:107], v[152:155], v[68:71]
    ds_read_b64_tr_b16 v[102:103], v243 offset:23264
    s_waitcnt vmcnt(20)
    s_waitcnt lgkmcnt(12)
    v_mfma_f32_16x16x32_bf16 v[0:3], v[72:75], v[156:159], v[0:3]
    ds_read_b64_tr_b16 v[104:105], v243 offset:18688
    buffer_load_dwordx4 v[148:151], v237, s[8:11], s46 offen offset:1024 sc1
    v_mfma_f32_16x16x32_bf16 v[4:7], v[72:75], v[160:163], v[4:7]
    ds_read_b64_tr_b16 v[106:107], v243 offset:23296
    v_mfma_f32_16x16x32_bf16 v[8:11], v[76:79], v[156:159], v[8:11]
    ds_read_b64_tr_b16 v[72:73], v243 offset:27648
    buffer_load_dwordx4 v[152:155], v238, s[8:11], s46 offen offset:1024 sc1
    v_mfma_f32_16x16x32_bf16 v[12:15], v[76:79], v[160:163], v[12:15]
    ds_read_b64_tr_b16 v[74:75], v243 offset:32256
    s_waitcnt lgkmcnt(12)
    v_mfma_f32_16x16x32_bf16 v[16:19], v[80:83], v[156:159], v[16:19]
    ds_read_b64_tr_b16 v[76:77], v243 offset:27680
    v_mfma_f32_16x16x32_bf16 v[20:23], v[80:83], v[160:163], v[20:23]
    ds_read_b64_tr_b16 v[78:79], v243 offset:32288
    v_mfma_f32_16x16x32_bf16 v[24:27], v[84:87], v[156:159], v[24:27]
    ds_read_b64_tr_b16 v[80:81], v243 offset:27712
    v_mfma_f32_16x16x32_bf16 v[28:31], v[84:87], v[160:163], v[28:31]
    ds_read_b64_tr_b16 v[82:83], v243 offset:32320
    s_waitcnt lgkmcnt(12)
    v_mfma_f32_16x16x32_bf16 v[32:35], v[88:91], v[156:159], v[32:35]
    ds_read_b64_tr_b16 v[84:85], v243 offset:27744
    v_mfma_f32_16x16x32_bf16 v[36:39], v[88:91], v[160:163], v[36:39]
    ds_read_b64_tr_b16 v[86:87], v243 offset:32352
    v_mfma_f32_16x16x32_bf16 v[40:43], v[92:95], v[156:159], v[40:43]
    ds_read_b64_tr_b16 v[88:89], v243 offset:27776
    v_mfma_f32_16x16x32_bf16 v[44:47], v[92:95], v[160:163], v[44:47]
    ds_read_b64_tr_b16 v[90:91], v243 offset:32384
    s_waitcnt lgkmcnt(12)
    v_mfma_f32_16x16x32_bf16 v[48:51], v[96:99], v[156:159], v[48:51]
    ds_read_b64_tr_b16 v[92:93], v243 offset:27808
    v_mfma_f32_16x16x32_bf16 v[52:55], v[96:99], v[160:163], v[52:55]
    ds_read_b64_tr_b16 v[94:95], v243 offset:32416
    v_mfma_f32_16x16x32_bf16 v[56:59], v[100:103], v[156:159], v[56:59]
    ds_read_b64_tr_b16 v[96:97], v243 offset:27840
    v_mfma_f32_16x16x32_bf16 v[60:63], v[100:103], v[160:163], v[60:63]
    ds_read_b64_tr_b16 v[98:99], v243 offset:32448
    s_waitcnt lgkmcnt(12)
    v_mfma_f32_16x16x32_bf16 v[64:67], v[104:107], v[156:159], v[64:67]
    ds_read_b64_tr_b16 v[100:101], v243 offset:27872
    v_mfma_f32_16x16x32_bf16 v[68:71], v[104:107], v[160:163], v[68:71]
    ds_read_b64_tr_b16 v[102:103], v243 offset:32480
    s_waitcnt vmcnt(20)
    v_mfma_f32_16x16x32_bf16 v[0:3], v[72:75], v[164:167], v[0:3]
    ds_read_b64_tr_b16 v[104:105], v243 offset:27904
    buffer_load_dwordx4 v[156:159], v237, s[8:11], s46 offen offset:2048 sc1
    v_mfma_f32_16x16x32_bf16 v[4:7], v[72:75], v[168:171], v[4:7]
    ds_read_b64_tr_b16 v[106:107], v243 offset:32512
    buffer_load_dwordx4 v[160:163], v238, s[8:11], s46 offen offset:2048 sc1
    s_barrier
    s_waitcnt lgkmcnt(12)
    v_mfma_f32_16x16x32_bf16 v[8:11], v[76:79], v[164:167], v[8:11]
    ds_read_b64_tr_b16 v[72:73], v244 offset:0
    s_add_u32 m0, s51, 36864
    v_mfma_f32_16x16x32_bf16 v[12:15], v[76:79], v[168:171], v[12:15]
    ds_read_b64_tr_b16 v[74:75], v244 offset:4608
    v_mfma_f32_16x16x32_bf16 v[16:19], v[80:83], v[164:167], v[16:19]
    ds_read_b64_tr_b16 v[76:77], v244 offset:32
    buffer_load_dwordx4 v226, s[12:15], s37 offen lds
    v_mfma_f32_16x16x32_bf16 v[20:23], v[80:83], v[168:171], v[20:23]
    ds_read_b64_tr_b16 v[78:79], v244 offset:4640
    s_add_u32 m0, s51, 37888
    s_waitcnt lgkmcnt(12)
    v_mfma_f32_16x16x32_bf16 v[24:27], v[84:87], v[164:167], v[24:27]
    ds_read_b64_tr_b16 v[80:81], v244 offset:64
    buffer_load_dwordx4 v227, s[12:15], s37 offen lds
    v_mfma_f32_16x16x32_bf16 v[28:31], v[84:87], v[168:171], v[28:31]
    ds_read_b64_tr_b16 v[82:83], v244 offset:4672
    v_mfma_f32_16x16x32_bf16 v[32:35], v[88:91], v[164:167], v[32:35]
    ds_read_b64_tr_b16 v[84:85], v244 offset:96
    s_add_u32 m0, s51, 38912
    v_mfma_f32_16x16x32_bf16 v[36:39], v[88:91], v[168:171], v[36:39]
    ds_read_b64_tr_b16 v[86:87], v244 offset:4704
    buffer_load_dwordx4 v228, s[12:15], s37 offen lds
    s_waitcnt lgkmcnt(12)
    v_mfma_f32_16x16x32_bf16 v[40:43], v[92:95], v[164:167], v[40:43]
    ds_read_b64_tr_b16 v[88:89], v244 offset:128
    s_add_u32 m0, s51, 39936
    v_mfma_f32_16x16x32_bf16 v[44:47], v[92:95], v[168:171], v[44:47]
    ds_read_b64_tr_b16 v[90:91], v244 offset:4736
    v_mfma_f32_16x16x32_bf16 v[48:51], v[96:99], v[164:167], v[48:51]
    ds_read_b64_tr_b16 v[92:93], v244 offset:160
    buffer_load_dwordx4 v229, s[12:15], s37 offen lds
    v_mfma_f32_16x16x32_bf16 v[52:55], v[96:99], v[168:171], v[52:55]
    ds_read_b64_tr_b16 v[94:95], v244 offset:4768
    s_add_u32 m0, s51, 40960
    s_waitcnt lgkmcnt(12)
    v_mfma_f32_16x16x32_bf16 v[56:59], v[100:103], v[164:167], v[56:59]
    ds_read_b64_tr_b16 v[96:97], v244 offset:192
    buffer_load_dwordx4 v230, s[12:15], s37 offen lds
    v_mfma_f32_16x16x32_bf16 v[60:63], v[100:103], v[168:171], v[60:63]
    ds_read_b64_tr_b16 v[98:99], v244 offset:4800
    v_mfma_f32_16x16x32_bf16 v[64:67], v[104:107], v[164:167], v[64:67]
    ds_read_b64_tr_b16 v[100:101], v244 offset:224
    s_add_u32 m0, s51, 41984
    v_mfma_f32_16x16x32_bf16 v[68:71], v[104:107], v[168:171], v[68:71]
    ds_read_b64_tr_b16 v[102:103], v244 offset:4832
    buffer_load_dwordx4 v231, s[12:15], s37 offen lds
    s_waitcnt vmcnt(26)
    s_waitcnt lgkmcnt(12)
    v_mfma_f32_16x16x32_bf16 v[0:3], v[72:75], v[172:175], v[0:3]
    ds_read_b64_tr_b16 v[104:105], v244 offset:256
    s_add_u32 m0, s51, 43008
    v_mfma_f32_16x16x32_bf16 v[4:7], v[72:75], v[176:179], v[4:7]
    ds_read_b64_tr_b16 v[106:107], v244 offset:4864
    v_mfma_f32_16x16x32_bf16 v[8:11], v[76:79], v[172:175], v[8:11]
    ds_read_b64_tr_b16 v[72:73], v244 offset:9216
    buffer_load_dwordx4 v232, s[12:15], s37 offen lds
    v_mfma_f32_16x16x32_bf16 v[12:15], v[76:79], v[176:179], v[12:15]
    ds_read_b64_tr_b16 v[74:75], v244 offset:13824
    s_add_u32 m0, s51, 44032
    s_waitcnt lgkmcnt(12)
    v_mfma_f32_16x16x32_bf16 v[16:19], v[80:83], v[172:175], v[16:19]
    ds_read_b64_tr_b16 v[76:77], v244 offset:9248
    buffer_load_dwordx4 v233, s[12:15], s37 offen lds
    v_mfma_f32_16x16x32_bf16 v[20:23], v[80:83], v[176:179], v[20:23]
    ds_read_b64_tr_b16 v[78:79], v244 offset:13856
    v_mfma_f32_16x16x32_bf16 v[24:27], v[84:87], v[172:175], v[24:27]
    ds_read_b64_tr_b16 v[80:81], v244 offset:9280
    s_add_u32 m0, s51, 45056
    v_mfma_f32_16x16x32_bf16 v[28:31], v[84:87], v[176:179], v[28:31]
    ds_read_b64_tr_b16 v[82:83], v244 offset:13888
    buffer_load_dwordx4 v234, s[12:15], s37 offen lds
    s_waitcnt lgkmcnt(12)
    v_mfma_f32_16x16x32_bf16 v[32:35], v[88:91], v[172:175], v[32:35]
    ds_read_b64_tr_b16 v[84:85], v244 offset:9312
    buffer_load_dwordx4 v[164:167], v237, s[8:11], s46 offen offset:3072 sc1
    v_mfma_f32_16x16x32_bf16 v[36:39], v[88:91], v[176:179], v[36:39]
    ds_read_b64_tr_b16 v[86:87], v244 offset:13920
    v_mfma_f32_16x16x32_bf16 v[40:43], v[92:95], v[172:175], v[40:43]
    ds_read_b64_tr_b16 v[88:89], v244 offset:9344
    buffer_load_dwordx4 v[168:171], v238, s[8:11], s46 offen offset:3072 sc1
    v_mfma_f32_16x16x32_bf16 v[44:47], v[92:95], v[176:179], v[44:47]
    ds_read_b64_tr_b16 v[90:91], v244 offset:13952
    s_waitcnt lgkmcnt(12)
    v_mfma_f32_16x16x32_bf16 v[48:51], v[96:99], v[172:175], v[48:51]
    ds_read_b64_tr_b16 v[92:93], v244 offset:9376
    v_mfma_f32_16x16x32_bf16 v[52:55], v[96:99], v[176:179], v[52:55]
    ds_read_b64_tr_b16 v[94:95], v244 offset:13984
    v_mfma_f32_16x16x32_bf16 v[56:59], v[100:103], v[172:175], v[56:59]
    ds_read_b64_tr_b16 v[96:97], v244 offset:9408
    v_mfma_f32_16x16x32_bf16 v[60:63], v[100:103], v[176:179], v[60:63]
    ds_read_b64_tr_b16 v[98:99], v244 offset:14016
    s_waitcnt lgkmcnt(12)
    v_mfma_f32_16x16x32_bf16 v[64:67], v[104:107], v[172:175], v[64:67]
    ds_read_b64_tr_b16 v[100:101], v244 offset:9440
    v_mfma_f32_16x16x32_bf16 v[68:71], v[104:107], v[176:179], v[68:71]
    ds_read_b64_tr_b16 v[102:103], v244 offset:14048
    s_waitcnt vmcnt(29)
    v_mfma_f32_16x16x32_bf16 v[0:3], v[72:75], v[180:183], v[0:3]
    ds_read_b64_tr_b16 v[104:105], v244 offset:9472
    buffer_load_dwordx4 v[172:175], v237, s[8:11], s47 offen offset:0 sc1
    v_mfma_f32_16x16x32_bf16 v[4:7], v[72:75], v[184:187], v[4:7]
    ds_read_b64_tr_b16 v[106:107], v244 offset:14080
    buffer_load_dwordx4 v[176:179], v238, s[8:11], s47 offen offset:0 sc1
    s_waitcnt lgkmcnt(12)
    v_mfma_f32_16x16x32_bf16 v[8:11], v[76:79], v[180:183], v[8:11]
    ds_read_b64_tr_b16 v[72:73], v244 offset:18432
    v_mfma_f32_16x16x32_bf16 v[12:15], v[76:79], v[184:187], v[12:15]
    ds_read_b64_tr_b16 v[74:75], v244 offset:23040
    v_mfma_f32_16x16x32_bf16 v[16:19], v[80:83], v[180:183], v[16:19]
    ds_read_b64_tr_b16 v[76:77], v244 offset:18464
    v_mfma_f32_16x16x32_bf16 v[20:23], v[80:83], v[184:187], v[20:23]
    ds_read_b64_tr_b16 v[78:79], v244 offset:23072
    s_waitcnt lgkmcnt(12)
    v_mfma_f32_16x16x32_bf16 v[24:27], v[84:87], v[180:183], v[24:27]
    ds_read_b64_tr_b16 v[80:81], v244 offset:18496
    v_mfma_f32_16x16x32_bf16 v[28:31], v[84:87], v[184:187], v[28:31]
    ds_read_b64_tr_b16 v[82:83], v244 offset:23104
    v_mfma_f32_16x16x32_bf16 v[32:35], v[88:91], v[180:183], v[32:35]
    ds_read_b64_tr_b16 v[84:85], v244 offset:18528
    v_mfma_f32_16x16x32_bf16 v[36:39], v[88:91], v[184:187], v[36:39]
    ds_read_b64_tr_b16 v[86:87], v244 offset:23136
    s_waitcnt lgkmcnt(12)
    v_mfma_f32_16x16x32_bf16 v[40:43], v[92:95], v[180:183], v[40:43]
    ds_read_b64_tr_b16 v[88:89], v244 offset:18560
    v_mfma_f32_16x16x32_bf16 v[44:47], v[92:95], v[184:187], v[44:47]
    ds_read_b64_tr_b16 v[90:91], v244 offset:23168
    v_mfma_f32_16x16x32_bf16 v[48:51], v[96:99], v[180:183], v[48:51]
    ds_read_b64_tr_b16 v[92:93], v244 offset:18592
    v_mfma_f32_16x16x32_bf16 v[52:55], v[96:99], v[184:187], v[52:55]
    ds_read_b64_tr_b16 v[94:95], v244 offset:23200
    s_waitcnt lgkmcnt(12)
    v_mfma_f32_16x16x32_bf16 v[56:59], v[100:103], v[180:183], v[56:59]
    ds_read_b64_tr_b16 v[96:97], v244 offset:18624
    v_mfma_f32_16x16x32_bf16 v[60:63], v[100:103], v[184:187], v[60:63]
    ds_read_b64_tr_b16 v[98:99], v244 offset:23232
    v_mfma_f32_16x16x32_bf16 v[64:67], v[104:107], v[180:183], v[64:67]
    ds_read_b64_tr_b16 v[100:101], v244 offset:18656
    v_mfma_f32_16x16x32_bf16 v[68:71], v[104:107], v[184:187], v[68:71]
    ds_read_b64_tr_b16 v[102:103], v244 offset:23264
    s_waitcnt vmcnt(29)
    s_waitcnt lgkmcnt(12)
    v_mfma_f32_16x16x32_bf16 v[0:3], v[72:75], v[188:191], v[0:3]
    ds_read_b64_tr_b16 v[104:105], v244 offset:18688
    buffer_load_dwordx4 v[180:183], v237, s[8:11], s47 offen offset:1024 sc1
    v_mfma_f32_16x16x32_bf16 v[4:7], v[72:75], v[192:195], v[4:7]
    ds_read_b64_tr_b16 v[106:107], v244 offset:23296
    v_mfma_f32_16x16x32_bf16 v[8:11], v[76:79], v[188:191], v[8:11]
    ds_read_b64_tr_b16 v[72:73], v244 offset:27648
    buffer_load_dwordx4 v[184:187], v238, s[8:11], s47 offen offset:1024 sc1
    v_mfma_f32_16x16x32_bf16 v[12:15], v[76:79], v[192:195], v[12:15]
    ds_read_b64_tr_b16 v[74:75], v244 offset:32256
    s_waitcnt lgkmcnt(12)
    v_mfma_f32_16x16x32_bf16 v[16:19], v[80:83], v[188:191], v[16:19]
    ds_read_b64_tr_b16 v[76:77], v244 offset:27680
    v_mfma_f32_16x16x32_bf16 v[20:23], v[80:83], v[192:195], v[20:23]
    ds_read_b64_tr_b16 v[78:79], v244 offset:32288
    v_mfma_f32_16x16x32_bf16 v[24:27], v[84:87], v[188:191], v[24:27]
    ds_read_b64_tr_b16 v[80:81], v244 offset:27712
    v_mfma_f32_16x16x32_bf16 v[28:31], v[84:87], v[192:195], v[28:31]
    ds_read_b64_tr_b16 v[82:83], v244 offset:32320
    s_waitcnt lgkmcnt(12)
    v_mfma_f32_16x16x32_bf16 v[32:35], v[88:91], v[188:191], v[32:35]
    ds_read_b64_tr_b16 v[84:85], v244 offset:27744
    v_mfma_f32_16x16x32_bf16 v[36:39], v[88:91], v[192:195], v[36:39]
    ds_read_b64_tr_b16 v[86:87], v244 offset:32352
    v_mfma_f32_16x16x32_bf16 v[40:43], v[92:95], v[188:191], v[40:43]
    ds_read_b64_tr_b16 v[88:89], v244 offset:27776
    v_mfma_f32_16x16x32_bf16 v[44:47], v[92:95], v[192:195], v[44:47]
    ds_read_b64_tr_b16 v[90:91], v244 offset:32384
    s_waitcnt lgkmcnt(12)
    v_mfma_f32_16x16x32_bf16 v[48:51], v[96:99], v[188:191], v[48:51]
    ds_read_b64_tr_b16 v[92:93], v244 offset:27808
    v_mfma_f32_16x16x32_bf16 v[52:55], v[96:99], v[192:195], v[52:55]
    ds_read_b64_tr_b16 v[94:95], v244 offset:32416
    v_mfma_f32_16x16x32_bf16 v[56:59], v[100:103], v[188:191], v[56:59]
    ds_read_b64_tr_b16 v[96:97], v244 offset:27840
    v_mfma_f32_16x16x32_bf16 v[60:63], v[100:103], v[192:195], v[60:63]
    ds_read_b64_tr_b16 v[98:99], v244 offset:32448
    s_waitcnt lgkmcnt(12)
    v_mfma_f32_16x16x32_bf16 v[64:67], v[104:107], v[188:191], v[64:67]
    ds_read_b64_tr_b16 v[100:101], v244 offset:27872
    v_mfma_f32_16x16x32_bf16 v[68:71], v[104:107], v[192:195], v[68:71]
    ds_read_b64_tr_b16 v[102:103], v244 offset:32480
    s_waitcnt vmcnt(29)
    v_mfma_f32_16x16x32_bf16 v[0:3], v[72:75], v[196:199], v[0:3]
    ds_read_b64_tr_b16 v[104:105], v244 offset:27904
    buffer_load_dwordx4 v[188:191], v237, s[8:11], s47 offen offset:2048 sc1
    v_mfma_f32_16x16x32_bf16 v[4:7], v[72:75], v[200:203], v[4:7]
    ds_read_b64_tr_b16 v[106:107], v244 offset:32512
    buffer_load_dwordx4 v[192:195], v238, s[8:11], s47 offen offset:2048 sc1
    s_barrier
    s_waitcnt lgkmcnt(12)
    v_mfma_f32_16x16x32_bf16 v[8:11], v[76:79], v[196:199], v[8:11]
    ds_read_b64_tr_b16 v[72:73], v241 offset:0
    s_add_u32 m0, s51, 73728
    v_mfma_f32_16x16x32_bf16 v[12:15], v[76:79], v[200:203], v[12:15]
    ds_read_b64_tr_b16 v[74:75], v241 offset:4608
    v_mfma_f32_16x16x32_bf16 v[16:19], v[80:83], v[196:199], v[16:19]
    ds_read_b64_tr_b16 v[76:77], v241 offset:32
    buffer_load_dwordx4 v226, s[12:15], s38 offen lds
    v_mfma_f32_16x16x32_bf16 v[20:23], v[80:83], v[200:203], v[20:23]
    ds_read_b64_tr_b16 v[78:79], v241 offset:4640
    s_add_u32 m0, s51, 74752
    s_waitcnt lgkmcnt(12)
    v_mfma_f32_16x16x32_bf16 v[24:27], v[84:87], v[196:199], v[24:27]
    ds_read_b64_tr_b16 v[80:81], v241 offset:64
    buffer_load_dwordx4 v227, s[12:15], s38 offen lds
    v_mfma_f32_16x16x32_bf16 v[28:31], v[84:87], v[200:203], v[28:31]
    ds_read_b64_tr_b16 v[82:83], v241 offset:4672
    v_mfma_f32_16x16x32_bf16 v[32:35], v[88:91], v[196:199], v[32:35]
    ds_read_b64_tr_b16 v[84:85], v241 offset:96
    s_add_u32 m0, s51, 75776
    v_mfma_f32_16x16x32_bf16 v[36:39], v[88:91], v[200:203], v[36:39]
    ds_read_b64_tr_b16 v[86:87], v241 offset:4704
    buffer_load_dwordx4 v228, s[12:15], s38 offen lds
    s_waitcnt lgkmcnt(12)
    v_mfma_f32_16x16x32_bf16 v[40:43], v[92:95], v[196:199], v[40:43]
    ds_read_b64_tr_b16 v[88:89], v241 offset:128
    s_add_u32 m0, s51, 76800
    v_mfma_f32_16x16x32_bf16 v[44:47], v[92:95], v[200:203], v[44:47]
    ds_read_b64_tr_b16 v[90:91], v241 offset:4736
    v_mfma_f32_16x16x32_bf16 v[48:51], v[96:99], v[196:199], v[48:51]
    ds_read_b64_tr_b16 v[92:93], v241 offset:160
    buffer_load_dwordx4 v229, s[12:15], s38 offen lds
    v_mfma_f32_16x16x32_bf16 v[52:55], v[96:99], v[200:203], v[52:55]
    ds_read_b64_tr_b16 v[94:95], v241 offset:4768
    s_add_u32 m0, s51, 77824
    s_waitcnt lgkmcnt(12)
    v_mfma_f32_16x16x32_bf16 v[56:59], v[100:103], v[196:199], v[56:59]
    ds_read_b64_tr_b16 v[96:97], v241 offset:192
    buffer_load_dwordx4 v230, s[12:15], s38 offen lds
    v_mfma_f32_16x16x32_bf16 v[60:63], v[100:103], v[200:203], v[60:63]
    ds_read_b64_tr_b16 v[98:99], v241 offset:4800
    v_mfma_f32_16x16x32_bf16 v[64:67], v[104:107], v[196:199], v[64:67]
    ds_read_b64_tr_b16 v[100:101], v241 offset:224
    s_add_u32 m0, s51, 78848
    v_mfma_f32_16x16x32_bf16 v[68:71], v[104:107], v[200:203], v[68:71]
    ds_read_b64_tr_b16 v[102:103], v241 offset:4832
    buffer_load_dwordx4 v231, s[12:15], s38 offen lds
    s_waitcnt vmcnt(35)
    s_waitcnt lgkmcnt(12)
    v_mfma_f32_16x16x32_bf16 v[0:3], v[72:75], v[108:111], v[0:3]
    ds_read_b64_tr_b16 v[104:105], v241 offset:256
    s_add_u32 m0, s51, 79872
    v_mfma_f32_16x16x32_bf16 v[4:7], v[72:75], v[112:115], v[4:7]
    ds_read_b64_tr_b16 v[106:107], v241 offset:4864
    v_mfma_f32_16x16x32_bf16 v[8:11], v[76:79], v[108:111], v[8:11]
    ds_read_b64_tr_b16 v[72:73], v241 offset:9216
    buffer_load_dwordx4 v232, s[12:15], s38 offen lds
    v_mfma_f32_16x16x32_bf16 v[12:15], v[76:79], v[112:115], v[12:15]
    ds_read_b64_tr_b16 v[74:75], v241 offset:13824
    s_add_u32 m0, s51, 80896
    s_waitcnt lgkmcnt(12)
    v_mfma_f32_16x16x32_bf16 v[16:19], v[80:83], v[108:111], v[16:19]
    ds_read_b64_tr_b16 v[76:77], v241 offset:9248
    buffer_load_dwordx4 v233, s[12:15], s38 offen lds
    v_mfma_f32_16x16x32_bf16 v[20:23], v[80:83], v[112:115], v[20:23]
    ds_read_b64_tr_b16 v[78:79], v241 offset:13856
    v_mfma_f32_16x16x32_bf16 v[24:27], v[84:87], v[108:111], v[24:27]
    ds_read_b64_tr_b16 v[80:81], v241 offset:9280
    s_add_u32 m0, s51, 81920
    v_mfma_f32_16x16x32_bf16 v[28:31], v[84:87], v[112:115], v[28:31]
    ds_read_b64_tr_b16 v[82:83], v241 offset:13888
    buffer_load_dwordx4 v234, s[12:15], s38 offen lds
    s_waitcnt lgkmcnt(12)
    v_mfma_f32_16x16x32_bf16 v[32:35], v[88:91], v[108:111], v[32:35]
    ds_read_b64_tr_b16 v[84:85], v241 offset:9312
    buffer_load_dwordx4 v[196:199], v237, s[8:11], s47 offen offset:3072 sc1
    v_mfma_f32_16x16x32_bf16 v[36:39], v[88:91], v[112:115], v[36:39]
    ds_read_b64_tr_b16 v[86:87], v241 offset:13920
    v_mfma_f32_16x16x32_bf16 v[40:43], v[92:95], v[108:111], v[40:43]
    ds_read_b64_tr_b16 v[88:89], v241 offset:9344
    buffer_load_dwordx4 v[200:203], v238, s[8:11], s47 offen offset:3072 sc1
    v_mfma_f32_16x16x32_bf16 v[44:47], v[92:95], v[112:115], v[44:47]
    ds_read_b64_tr_b16 v[90:91], v241 offset:13952
    s_waitcnt lgkmcnt(12)
    v_mfma_f32_16x16x32_bf16 v[48:51], v[96:99], v[108:111], v[48:51]
    ds_read_b64_tr_b16 v[92:93], v241 offset:9376
    v_mfma_f32_16x16x32_bf16 v[52:55], v[96:99], v[112:115], v[52:55]
    ds_read_b64_tr_b16 v[94:95], v241 offset:13984
    v_mfma_f32_16x16x32_bf16 v[56:59], v[100:103], v[108:111], v[56:59]
    ds_read_b64_tr_b16 v[96:97], v241 offset:9408
    v_mfma_f32_16x16x32_bf16 v[60:63], v[100:103], v[112:115], v[60:63]
    ds_read_b64_tr_b16 v[98:99], v241 offset:14016
    s_waitcnt lgkmcnt(12)
    v_mfma_f32_16x16x32_bf16 v[64:67], v[104:107], v[108:111], v[64:67]
    ds_read_b64_tr_b16 v[100:101], v241 offset:9440
    v_mfma_f32_16x16x32_bf16 v[68:71], v[104:107], v[112:115], v[68:71]
    ds_read_b64_tr_b16 v[102:103], v241 offset:14048
    s_waitcnt vmcnt(38)
    v_mfma_f32_16x16x32_bf16 v[0:3], v[72:75], v[116:119], v[0:3]
    ds_read_b64_tr_b16 v[104:105], v241 offset:9472
    buffer_load_dwordx4 v[108:111], v237, s[8:11], s48 offen offset:0 sc1
    v_mfma_f32_16x16x32_bf16 v[4:7], v[72:75], v[120:123], v[4:7]
    ds_read_b64_tr_b16 v[106:107], v241 offset:14080
    buffer_load_dwordx4 v[112:115], v238, s[8:11], s48 offen offset:0 sc1
    s_waitcnt lgkmcnt(12)
    v_mfma_f32_16x16x32_bf16 v[8:11], v[76:79], v[116:119], v[8:11]
    ds_read_b64_tr_b16 v[72:73], v241 offset:18432
    v_mfma_f32_16x16x32_bf16 v[12:15], v[76:79], v[120:123], v[12:15]
    ds_read_b64_tr_b16 v[74:75], v241 offset:23040
    v_mfma_f32_16x16x32_bf16 v[16:19], v[80:83], v[116:119], v[16:19]
    ds_read_b64_tr_b16 v[76:77], v241 offset:18464
    v_mfma_f32_16x16x32_bf16 v[20:23], v[80:83], v[120:123], v[20:23]
    ds_read_b64_tr_b16 v[78:79], v241 offset:23072
    s_waitcnt lgkmcnt(12)
    v_mfma_f32_16x16x32_bf16 v[24:27], v[84:87], v[116:119], v[24:27]
    ds_read_b64_tr_b16 v[80:81], v241 offset:18496
    v_add_u32 v207, 0, v224
    v_cmp_lt_u32 vcc, 95, v207
    v_lshlrev_b32 v207, 4, v207
    v_add_u32 v210, 16896, v207
    v_cndmask_b32 v207, v207, v210, vcc
    v_add_u32 v208, 64, v224
    v_cmp_lt_u32 vcc, 95, v208
    v_lshlrev_b32 v208, 4, v208
    v_add_u32 v210, 16896, v208
    v_cndmask_b32 v208, v208, v210, vcc
    v_add_u32 v209, 128, v224
    v_cmp_lt_u32 vcc, 95, v209
    v_lshlrev_b32 v209, 4, v209
    v_add_u32 v210, 16896, v209
    v_cndmask_b32 v209, v209, v210, vcc
    v_add_u32 v211, 73728, v237
    v_mfma_f32_16x16x32_bf16 v[28:31], v[84:87], v[120:123], v[28:31]
    ds_read_b64_tr_b16 v[82:83], v241 offset:23104
    v_mfma_f32_16x16x32_bf16 v[32:35], v[88:91], v[116:119], v[32:35]
    ds_read_b64_tr_b16 v[84:85], v241 offset:18528
    v_mfma_f32_16x16x32_bf16 v[36:39], v[88:91], v[120:123], v[36:39]
    ds_read_b64_tr_b16 v[86:87], v241 offset:23136
    s_waitcnt lgkmcnt(12)
    v_mfma_f32_16x16x32_bf16 v[40:43], v[92:95], v[116:119], v[40:43]
    ds_read_b64_tr_b16 v[88:89], v241 offset:18560
    v_mfma_f32_16x16x32_bf16 v[44:47], v[92:95], v[120:123], v[44:47]
    ds_read_b64_tr_b16 v[90:91], v241 offset:23168
    v_mfma_f32_16x16x32_bf16 v[48:51], v[96:99], v[116:119], v[48:51]
    ds_read_b64_tr_b16 v[92:93], v241 offset:18592
    v_mfma_f32_16x16x32_bf16 v[52:55], v[96:99], v[120:123], v[52:55]
    ds_read_b64_tr_b16 v[94:95], v241 offset:23200
    s_waitcnt lgkmcnt(12)
    v_mfma_f32_16x16x32_bf16 v[56:59], v[100:103], v[116:119], v[56:59]
    ds_read_b64_tr_b16 v[96:97], v241 offset:18624
    s_mul_i32 s18, s16, 3072
    s_add_u32 m0, s18, 147456
    s_nop 0
    buffer_load_dwordx4 v207, s[8:11], s58 offen lds
    s_add_u32 m0, s18, 148480
    s_nop 0
    buffer_load_dwordx4 v208, s[8:11], s58 offen lds
    s_add_u32 m0, s18, 149504
    s_nop 0
    buffer_load_dwordx4 v209, s[8:11], s58 offen lds
    v_mfma_f32_16x16x32_bf16 v[60:63], v[100:103], v[120:123], v[60:63]
    ds_read_b64_tr_b16 v[98:99], v241 offset:23232
    v_mfma_f32_16x16x32_bf16 v[64:67], v[104:107], v[116:119], v[64:67]
    ds_read_b64_tr_b16 v[100:101], v241 offset:18656
    v_mfma_f32_16x16x32_bf16 v[68:71], v[104:107], v[120:123], v[68:71]
    ds_read_b64_tr_b16 v[102:103], v241 offset:23264
    s_waitcnt vmcnt(41)
    s_waitcnt lgkmcnt(12)
    v_mfma_f32_16x16x32_bf16 v[0:3], v[72:75], v[124:127], v[0:3]
    ds_read_b64_tr_b16 v[104:105], v241 offset:18688
    buffer_load_dwordx4 v[116:119], v237, s[8:11], s48 offen offset:1024 sc1
    v_mfma_f32_16x16x32_bf16 v[4:7], v[72:75], v[128:131], v[4:7]
    ds_read_b64_tr_b16 v[106:107], v241 offset:23296
    v_mfma_f32_16x16x32_bf16 v[8:11], v[76:79], v[124:127], v[8:11]
    ds_read_b64_tr_b16 v[72:73], v241 offset:27648
    buffer_load_dwordx4 v[120:123], v238, s[8:11], s48 offen offset:1024 sc1
    v_mfma_f32_16x16x32_bf16 v[12:15], v[76:79], v[128:131], v[12:15]
    ds_read_b64_tr_b16 v[74:75], v241 offset:32256
    s_waitcnt lgkmcnt(12)
    v_mfma_f32_16x16x32_bf16 v[16:19], v[80:83], v[124:127], v[16:19]
    ds_read_b64_tr_b16 v[76:77], v241 offset:27680
    v_mfma_f32_16x16x32_bf16 v[20:23], v[80:83], v[128:131], v[20:23]
    ds_read_b64_tr_b16 v[78:79], v241 offset:32288
    v_mfma_f32_16x16x32_bf16 v[24:27], v[84:87], v[124:127], v[24:27]
    ds_read_b64_tr_b16 v[80:81], v241 offset:27712
    v_mfma_f32_16x16x32_bf16 v[28:31], v[84:87], v[128:131], v[28:31]
    ds_read_b64_tr_b16 v[82:83], v241 offset:32320
    s_waitcnt lgkmcnt(12)
    v_mfma_f32_16x16x32_bf16 v[32:35], v[88:91], v[124:127], v[32:35]
    ds_read_b64_tr_b16 v[84:85], v241 offset:27744
    v_mfma_f32_16x16x32_bf16 v[36:39], v[88:91], v[128:131], v[36:39]
    ds_read_b64_tr_b16 v[86:87], v241 offset:32352
    v_mfma_f32_16x16x32_bf16 v[40:43], v[92:95], v[124:127], v[40:43]
    ds_read_b64_tr_b16 v[88:89], v241 offset:27776
    v_mfma_f32_16x16x32_bf16 v[44:47], v[92:95], v[128:131], v[44:47]
    ds_read_b64_tr_b16 v[90:91], v241 offset:32384
    s_waitcnt lgkmcnt(12)
    v_mfma_f32_16x16x32_bf16 v[48:51], v[96:99], v[124:127], v[48:51]
    ds_read_b64_tr_b16 v[92:93], v241 offset:27808
    v_mfma_f32_16x16x32_bf16 v[52:55], v[96:99], v[128:131], v[52:55]
    ds_read_b64_tr_b16 v[94:95], v241 offset:32416
    v_mfma_f32_16x16x32_bf16 v[56:59], v[100:103], v[124:127], v[56:59]
    ds_read_b64_tr_b16 v[96:97], v241 offset:27840
    v_mfma_f32_16x16x32_bf16 v[60:63], v[100:103], v[128:131], v[60:63]
    ds_read_b64_tr_b16 v[98:99], v241 offset:32448
    s_waitcnt lgkmcnt(12)
    v_mfma_f32_16x16x32_bf16 v[64:67], v[104:107], v[124:127], v[64:67]
    ds_read_b64_tr_b16 v[100:101], v241 offset:27872
    v_mfma_f32_16x16x32_bf16 v[68:71], v[104:107], v[128:131], v[68:71]
    ds_read_b64_tr_b16 v[102:103], v241 offset:32480
    s_waitcnt vmcnt(41)
    v_mfma_f32_16x16x32_bf16 v[0:3], v[72:75], v[132:135], v[0:3]
    ds_read_b64_tr_b16 v[104:105], v241 offset:27904
    buffer_load_dwordx4 v[124:127], v237, s[8:11], s48 offen offset:2048 sc1
    v_mfma_f32_16x16x32_bf16 v[4:7], v[72:75], v[136:139], v[4:7]
    ds_read_b64_tr_b16 v[106:107], v241 offset:32512
    buffer_load_dwordx4 v[128:131], v238, s[8:11], s48 offen offset:2048 sc1
    s_waitcnt vmcnt(28)
    s_barrier
    s_waitcnt lgkmcnt(12)
    v_mfma_f32_16x16x32_bf16 v[8:11], v[76:79], v[132:135], v[8:11]
    ds_read_b64_tr_b16 v[72:73], v242 offset:0
    s_add_u32 m0, s51, 110592
    v_mfma_f32_16x16x32_bf16 v[12:15], v[76:79], v[136:139], v[12:15]
    ds_read_b64_tr_b16 v[74:75], v242 offset:4608
    v_mfma_f32_16x16x32_bf16 v[16:19], v[80:83], v[132:135], v[16:19]
    ds_read_b64_tr_b16 v[76:77], v242 offset:32
    buffer_load_dwordx4 v226, s[12:15], s39 offen lds
    v_mfma_f32_16x16x32_bf16 v[20:23], v[80:83], v[136:139], v[20:23]
    ds_read_b64_tr_b16 v[78:79], v242 offset:4640
    s_add_u32 m0, s51, 111616
    s_waitcnt lgkmcnt(12)
    v_mfma_f32_16x16x32_bf16 v[24:27], v[84:87], v[132:135], v[24:27]
    ds_read_b64_tr_b16 v[80:81], v242 offset:64
    buffer_load_dwordx4 v227, s[12:15], s39 offen lds
    v_mfma_f32_16x16x32_bf16 v[28:31], v[84:87], v[136:139], v[28:31]
    ds_read_b64_tr_b16 v[82:83], v242 offset:4672
    v_mfma_f32_16x16x32_bf16 v[32:35], v[88:91], v[132:135], v[32:35]
    ds_read_b64_tr_b16 v[84:85], v242 offset:96
    s_add_u32 m0, s51, 112640
    v_mfma_f32_16x16x32_bf16 v[36:39], v[88:91], v[136:139], v[36:39]
    ds_read_b64_tr_b16 v[86:87], v242 offset:4704
    buffer_load_dwordx4 v228, s[12:15], s39 offen lds
    s_waitcnt lgkmcnt(12)
    v_mfma_f32_16x16x32_bf16 v[40:43], v[92:95], v[132:135], v[40:43]
    ds_read_b64_tr_b16 v[88:89], v242 offset:128
    s_add_u32 m0, s51, 113664
    v_mfma_f32_16x16x32_bf16 v[44:47], v[92:95], v[136:139], v[44:47]
    ds_read_b64_tr_b16 v[90:91], v242 offset:4736
    v_mfma_f32_16x16x32_bf16 v[48:51], v[96:99], v[132:135], v[48:51]
    ds_read_b64_tr_b16 v[92:93], v242 offset:160
    buffer_load_dwordx4 v229, s[12:15], s39 offen lds
    v_mfma_f32_16x16x32_bf16 v[52:55], v[96:99], v[136:139], v[52:55]
    ds_read_b64_tr_b16 v[94:95], v242 offset:4768
    s_add_u32 m0, s51, 114688
    s_waitcnt lgkmcnt(12)
    v_mfma_f32_16x16x32_bf16 v[56:59], v[100:103], v[132:135], v[56:59]
    ds_read_b64_tr_b16 v[96:97], v242 offset:192
    buffer_load_dwordx4 v230, s[12:15], s39 offen lds
    v_mfma_f32_16x16x32_bf16 v[60:63], v[100:103], v[136:139], v[60:63]
    ds_read_b64_tr_b16 v[98:99], v242 offset:4800
    v_mfma_f32_16x16x32_bf16 v[64:67], v[104:107], v[132:135], v[64:67]
    ds_read_b64_tr_b16 v[100:101], v242 offset:224
    s_add_u32 m0, s51, 115712
    v_mfma_f32_16x16x32_bf16 v[68:71], v[104:107], v[136:139], v[68:71]
    ds_read_b64_tr_b16 v[102:103], v242 offset:4832
    buffer_load_dwordx4 v231, s[12:15], s39 offen lds
    s_waitcnt lgkmcnt(12)
    v_mfma_f32_16x16x32_bf16 v[0:3], v[72:75], v[140:143], v[0:3]
    ds_read_b64_tr_b16 v[104:105], v242 offset:256
    s_add_u32 m0, s51, 116736
    v_mfma_f32_16x16x32_bf16 v[4:7], v[72:75], v[144:147], v[4:7]
    ds_read_b64_tr_b16 v[106:107], v242 offset:4864
    v_mfma_f32_16x16x32_bf16 v[8:11], v[76:79], v[140:143], v[8:11]
    ds_read_b64_tr_b16 v[72:73], v242 offset:9216
    buffer_load_dwordx4 v232, s[12:15], s39 offen lds
    v_mfma_f32_16x16x32_bf16 v[12:15], v[76:79], v[144:147], v[12:15]
    ds_read_b64_tr_b16 v[74:75], v242 offset:13824
    s_add_u32 m0, s51, 117760
    s_waitcnt lgkmcnt(12)
    v_mfma_f32_16x16x32_bf16 v[16:19], v[80:83], v[140:143], v[16:19]
    ds_read_b64_tr_b16 v[76:77], v242 offset:9248
    buffer_load_dwordx4 v233, s[12:15], s39 offen lds
    v_mfma_f32_16x16x32_bf16 v[20:23], v[80:83], v[144:147], v[20:23]
    ds_read_b64_tr_b16 v[78:79], v242 offset:13856
    v_mfma_f32_16x16x32_bf16 v[24:27], v[84:87], v[140:143], v[24:27]
    ds_read_b64_tr_b16 v[80:81], v242 offset:9280
    s_add_u32 m0, s51, 118784
    v_mfma_f32_16x16x32_bf16 v[28:31], v[84:87], v[144:147], v[28:31]
    ds_read_b64_tr_b16 v[82:83], v242 offset:13888
    buffer_load_dwordx4 v234, s[12:15], s39 offen lds
    s_waitcnt lgkmcnt(12)
    v_mfma_f32_16x16x32_bf16 v[32:35], v[88:91], v[140:143], v[32:35]
    ds_read_b64_tr_b16 v[84:85], v242 offset:9312
    buffer_load_dwordx4 v[132:135], v237, s[8:11], s48 offen offset:3072 sc1
    v_mfma_f32_16x16x32_bf16 v[36:39], v[88:91], v[144:147], v[36:39]
    ds_read_b64_tr_b16 v[86:87], v242 offset:13920
    v_mfma_f32_16x16x32_bf16 v[40:43], v[92:95], v[140:143], v[40:43]
    ds_read_b64_tr_b16 v[88:89], v242 offset:9344
    buffer_load_dwordx4 v[136:139], v238, s[8:11], s48 offen offset:3072 sc1
    v_mfma_f32_16x16x32_bf16 v[44:47], v[92:95], v[144:147], v[44:47]
    ds_read_b64_tr_b16 v[90:91], v242 offset:13952
    s_waitcnt lgkmcnt(12)
    v_mfma_f32_16x16x32_bf16 v[48:51], v[96:99], v[140:143], v[48:51]
    ds_read_b64_tr_b16 v[92:93], v242 offset:9376
    v_mfma_f32_16x16x32_bf16 v[52:55], v[96:99], v[144:147], v[52:55]
    ds_read_b64_tr_b16 v[94:95], v242 offset:13984
    v_mfma_f32_16x16x32_bf16 v[56:59], v[100:103], v[140:143], v[56:59]
    ds_read_b64_tr_b16 v[96:97], v242 offset:9408
    v_mfma_f32_16x16x32_bf16 v[60:63], v[100:103], v[144:147], v[60:63]
    ds_read_b64_tr_b16 v[98:99], v242 offset:14016
    s_waitcnt lgkmcnt(12)
    v_mfma_f32_16x16x32_bf16 v[64:67], v[104:107], v[140:143], v[64:67]
    ds_read_b64_tr_b16 v[100:101], v242 offset:9440
    v_mfma_f32_16x16x32_bf16 v[68:71], v[104:107], v[144:147], v[68:71]
    ds_read_b64_tr_b16 v[102:103], v242 offset:14048
    v_mfma_f32_16x16x32_bf16 v[0:3], v[72:75], v[148:151], v[0:3]
    ds_read_b64_tr_b16 v[104:105], v242 offset:9472
    buffer_load_dwordx4 v[140:143], v237, s[8:11], s49 offen offset:0 sc1
    v_mfma_f32_16x16x32_bf16 v[4:7], v[72:75], v[152:155], v[4:7]
    ds_read_b64_tr_b16 v[106:107], v242 offset:14080
    buffer_load_dwordx4 v[144:147], v238, s[8:11], s49 offen offset:0 sc1
    s_waitcnt lgkmcnt(12)
    v_mfma_f32_16x16x32_bf16 v[8:11], v[76:79], v[148:151], v[8:11]
    ds_read_b64_tr_b16 v[72:73], v242 offset:18432
    v_mfma_f32_16x16x32_bf16 v[12:15], v[76:79], v[152:155], v[12:15]
    ds_read_b64_tr_b16 v[74:75], v242 offset:23040
    v_mfma_f32_16x16x32_bf16 v[16:19], v[80:83], v[148:151], v[16:19]
    ds_read_b64_tr_b16 v[76:77], v242 offset:18464
    v_mfma_f32_16x16x32_bf16 v[20:23], v[80:83], v[152:155], v[20:23]
    ds_read_b64_tr_b16 v[78:79], v242 offset:23072
    s_waitcnt lgkmcnt(12)
    v_mfma_f32_16x16x32_bf16 v[24:27], v[84:87], v[148:151], v[24:27]
    ds_read_b64_tr_b16 v[80:81], v242 offset:18496
    v_mfma_f32_16x16x32_bf16 v[28:31], v[84:87], v[152:155], v[28:31]
    ds_read_b64_tr_b16 v[82:83], v242 offset:23104
    v_mfma_f32_16x16x32_bf16 v[32:35], v[88:91], v[148:151], v[32:35]
    ds_read_b64_tr_b16 v[84:85], v242 offset:18528
    v_mfma_f32_16x16x32_bf16 v[36:39], v[88:91], v[152:155], v[36:39]
    ds_read_b64_tr_b16 v[86:87], v242 offset:23136
    s_waitcnt lgkmcnt(12)
    v_mfma_f32_16x16x32_bf16 v[40:43], v[92:95], v[148:151], v[40:43]
    ds_read_b64_tr_b16 v[88:89], v242 offset:18560
    v_mfma_f32_16x16x32_bf16 v[44:47], v[92:95], v[152:155], v[44:47]
    ds_read_b64_tr_b16 v[90:91], v242 offset:23168
    v_mfma_f32_16x16x32_bf16 v[48:51], v[96:99], v[148:151], v[48:51]
    ds_read_b64_tr_b16 v[92:93], v242 offset:18592
    v_mfma_f32_16x16x32_bf16 v[52:55], v[96:99], v[152:155], v[52:55]
    ds_read_b64_tr_b16 v[94:95], v242 offset:23200
    s_waitcnt lgkmcnt(12)
    v_mfma_f32_16x16x32_bf16 v[56:59], v[100:103], v[148:151], v[56:59]
    ds_read_b64_tr_b16 v[96:97], v242 offset:18624
    v_mfma_f32_16x16x32_bf16 v[60:63], v[100:103], v[152:155], v[60:63]
    ds_read_b64_tr_b16 v[98:99], v242 offset:23232
    v_mfma_f32_16x16x32_bf16 v[64:67], v[104:107], v[148:151], v[64:67]
    ds_read_b64_tr_b16 v[100:101], v242 offset:18656
    v_mfma_f32_16x16x32_bf16 v[68:71], v[104:107], v[152:155], v[68:71]
    ds_read_b64_tr_b16 v[102:103], v242 offset:23264
    s_waitcnt lgkmcnt(12)
    v_mfma_f32_16x16x32_bf16 v[0:3], v[72:75], v[156:159], v[0:3]
    ds_read_b64_tr_b16 v[104:105], v242 offset:18688
    buffer_load_dwordx4 v[148:151], v237, s[8:11], s49 offen offset:1024 sc1
    v_mfma_f32_16x16x32_bf16 v[4:7], v[72:75], v[160:163], v[4:7]
    ds_read_b64_tr_b16 v[106:107], v242 offset:23296
    v_mfma_f32_16x16x32_bf16 v[8:11], v[76:79], v[156:159], v[8:11]
    ds_read_b64_tr_b16 v[72:73], v242 offset:27648
    buffer_load_dwordx4 v[152:155], v238, s[8:11], s49 offen offset:1024 sc1
    v_mfma_f32_16x16x32_bf16 v[12:15], v[76:79], v[160:163], v[12:15]
    ds_read_b64_tr_b16 v[74:75], v242 offset:32256
    s_waitcnt lgkmcnt(12)
    v_mfma_f32_16x16x32_bf16 v[16:19], v[80:83], v[156:159], v[16:19]
    ds_read_b64_tr_b16 v[76:77], v242 offset:27680
    v_mfma_f32_16x16x32_bf16 v[20:23], v[80:83], v[160:163], v[20:23]
    ds_read_b64_tr_b16 v[78:79], v242 offset:32288
    v_mfma_f32_16x16x32_bf16 v[24:27], v[84:87], v[156:159], v[24:27]
    ds_read_b64_tr_b16 v[80:81], v242 offset:27712
    v_mfma_f32_16x16x32_bf16 v[28:31], v[84:87], v[160:163], v[28:31]
    ds_read_b64_tr_b16 v[82:83], v242 offset:32320
    s_waitcnt lgkmcnt(12)
    v_mfma_f32_16x16x32_bf16 v[32:35], v[88:91], v[156:159], v[32:35]
    ds_read_b64_tr_b16 v[84:85], v242 offset:27744
    v_mfma_f32_16x16x32_bf16 v[36:39], v[88:91], v[160:163], v[36:39]
    ds_read_b64_tr_b16 v[86:87], v242 offset:32352
    v_mfma_f32_16x16x32_bf16 v[40:43], v[92:95], v[156:159], v[40:43]
    ds_read_b64_tr_b16 v[88:89], v242 offset:27776
    v_mfma_f32_16x16x32_bf16 v[44:47], v[92:95], v[160:163], v[44:47]
    ds_read_b64_tr_b16 v[90:91], v242 offset:32384
    s_waitcnt lgkmcnt(12)
    v_mfma_f32_16x16x32_bf16 v[48:51], v[96:99], v[156:159], v[48:51]
    ds_read_b64_tr_b16 v[92:93], v242 offset:27808
    v_mfma_f32_16x16x32_bf16 v[52:55], v[96:99], v[160:163], v[52:55]
    ds_read_b64_tr_b16 v[94:95], v242 offset:32416
    v_mfma_f32_16x16x32_bf16 v[56:59], v[100:103], v[156:159], v[56:59]
    ds_read_b64_tr_b16 v[96:97], v242 offset:27840
    v_mfma_f32_16x16x32_bf16 v[60:63], v[100:103], v[160:163], v[60:63]
    ds_read_b64_tr_b16 v[98:99], v242 offset:32448
    s_waitcnt lgkmcnt(12)
    v_mfma_f32_16x16x32_bf16 v[64:67], v[104:107], v[156:159], v[64:67]
    ds_read_b64_tr_b16 v[100:101], v242 offset:27872
    v_mfma_f32_16x16x32_bf16 v[68:71], v[104:107], v[160:163], v[68:71]
    ds_read_b64_tr_b16 v[102:103], v242 offset:32480
    s_waitcnt vmcnt(41)
    v_mfma_f32_16x16x32_bf16 v[0:3], v[72:75], v[164:167], v[0:3]
    ds_read_b64_tr_b16 v[104:105], v242 offset:27904
    buffer_load_dwordx4 v[156:159], v237, s[8:11], s49 offen offset:2048 sc1
    v_mfma_f32_16x16x32_bf16 v[4:7], v[72:75], v[168:171], v[4:7]
    ds_read_b64_tr_b16 v[106:107], v242 offset:32512
    buffer_load_dwordx4 v[160:163], v238, s[8:11], s49 offen offset:2048 sc1
    s_waitcnt vmcnt(28)
    s_barrier
    s_waitcnt lgkmcnt(12)
    v_mfma_f32_16x16x32_bf16 v[8:11], v[76:79], v[164:167], v[8:11]
    ds_read_b64_tr_b16 v[72:73], v243 offset:0
    s_add_u32 m0, s51, 0
    v_mfma_f32_16x16x32_bf16 v[12:15], v[76:79], v[168:171], v[12:15]
    ds_read_b64_tr_b16 v[74:75], v243 offset:4608
    v_mfma_f32_16x16x32_bf16 v[16:19], v[80:83], v[164:167], v[16:19]
    ds_read_b64_tr_b16 v[76:77], v243 offset:32
    buffer_load_dwordx4 v226, s[12:15], s40 offen lds
    v_mfma_f32_16x16x32_bf16 v[20:23], v[80:83], v[168:171], v[20:23]
    ds_read_b64_tr_b16 v[78:79], v243 offset:4640
    s_add_u32 m0, s51, 1024
    s_waitcnt lgkmcnt(12)
    v_mfma_f32_16x16x32_bf16 v[24:27], v[84:87], v[164:167], v[24:27]
    ds_read_b64_tr_b16 v[80:81], v243 offset:64
    buffer_load_dwordx4 v227, s[12:15], s40 offen lds
    v_mfma_f32_16x16x32_bf16 v[28:31], v[84:87], v[168:171], v[28:31]
    ds_read_b64_tr_b16 v[82:83], v243 offset:4672
    v_mfma_f32_16x16x32_bf16 v[32:35], v[88:91], v[164:167], v[32:35]
    ds_read_b64_tr_b16 v[84:85], v243 offset:96
    s_add_u32 m0, s51, 2048
    v_mfma_f32_16x16x32_bf16 v[36:39], v[88:91], v[168:171], v[36:39]
    ds_read_b64_tr_b16 v[86:87], v243 offset:4704
    buffer_load_dwordx4 v228, s[12:15], s40 offen lds
    s_waitcnt lgkmcnt(12)
    v_mfma_f32_16x16x32_bf16 v[40:43], v[92:95], v[164:167], v[40:43]
    ds_read_b64_tr_b16 v[88:89], v243 offset:128
    s_add_u32 m0, s51, 3072
    v_mfma_f32_16x16x32_bf16 v[44:47], v[92:95], v[168:171], v[44:47]
    ds_read_b64_tr_b16 v[90:91], v243 offset:4736
    v_mfma_f32_16x16x32_bf16 v[48:51], v[96:99], v[164:167], v[48:51]
    ds_read_b64_tr_b16 v[92:93], v243 offset:160
    buffer_load_dwordx4 v229, s[12:15], s40 offen lds
    v_mfma_f32_16x16x32_bf16 v[52:55], v[96:99], v[168:171], v[52:55]
    ds_read_b64_tr_b16 v[94:95], v243 offset:4768
    s_add_u32 m0, s51, 4096
    s_waitcnt lgkmcnt(12)
    v_mfma_f32_16x16x32_bf16 v[56:59], v[100:103], v[164:167], v[56:59]
    ds_read_b64_tr_b16 v[96:97], v243 offset:192
    buffer_load_dwordx4 v230, s[12:15], s40 offen lds
    v_mfma_f32_16x16x32_bf16 v[60:63], v[100:103], v[168:171], v[60:63]
    ds_read_b64_tr_b16 v[98:99], v243 offset:4800
    v_mfma_f32_16x16x32_bf16 v[64:67], v[104:107], v[164:167], v[64:67]
    ds_read_b64_tr_b16 v[100:101], v243 offset:224
    s_add_u32 m0, s51, 5120
    v_mfma_f32_16x16x32_bf16 v[68:71], v[104:107], v[168:171], v[68:71]
    ds_read_b64_tr_b16 v[102:103], v243 offset:4832
    buffer_load_dwordx4 v231, s[12:15], s40 offen lds
    s_waitcnt lgkmcnt(12)
    v_mfma_f32_16x16x32_bf16 v[0:3], v[72:75], v[172:175], v[0:3]
    ds_read_b64_tr_b16 v[104:105], v243 offset:256
    s_add_u32 m0, s51, 6144
    v_mfma_f32_16x16x32_bf16 v[4:7], v[72:75], v[176:179], v[4:7]
    ds_read_b64_tr_b16 v[106:107], v243 offset:4864
    v_mfma_f32_16x16x32_bf16 v[8:11], v[76:79], v[172:175], v[8:11]
    ds_read_b64_tr_b16 v[72:73], v243 offset:9216
    buffer_load_dwordx4 v232, s[12:15], s40 offen lds
    v_mfma_f32_16x16x32_bf16 v[12:15], v[76:79], v[176:179], v[12:15]
    ds_read_b64_tr_b16 v[74:75], v243 offset:13824
    s_add_u32 m0, s51, 7168
    s_waitcnt lgkmcnt(12)
    v_mfma_f32_16x16x32_bf16 v[16:19], v[80:83], v[172:175], v[16:19]
    ds_read_b64_tr_b16 v[76:77], v243 offset:9248
    buffer_load_dwordx4 v233, s[12:15], s40 offen lds
    v_mfma_f32_16x16x32_bf16 v[20:23], v[80:83], v[176:179], v[20:23]
    ds_read_b64_tr_b16 v[78:79], v243 offset:13856
    v_mfma_f32_16x16x32_bf16 v[24:27], v[84:87], v[172:175], v[24:27]
    ds_read_b64_tr_b16 v[80:81], v243 offset:9280
    s_add_u32 m0, s51, 8192
    v_mfma_f32_16x16x32_bf16 v[28:31], v[84:87], v[176:179], v[28:31]
    ds_read_b64_tr_b16 v[82:83], v243 offset:13888
    buffer_load_dwordx4 v234, s[12:15], s40 offen lds
    s_waitcnt lgkmcnt(12)
    v_mfma_f32_16x16x32_bf16 v[32:35], v[88:91], v[172:175], v[32:35]
    ds_read_b64_tr_b16 v[84:85], v243 offset:9312
    buffer_load_dwordx4 v[164:167], v237, s[8:11], s49 offen offset:3072 sc1
    v_mfma_f32_16x16x32_bf16 v[36:39], v[88:91], v[176:179], v[36:39]
    ds_read_b64_tr_b16 v[86:87], v243 offset:13920
    v_mfma_f32_16x16x32_bf16 v[40:43], v[92:95], v[172:175], v[40:43]
    ds_read_b64_tr_b16 v[88:89], v243 offset:9344
    buffer_load_dwordx4 v[168:171], v238, s[8:11], s49 offen offset:3072 sc1
    v_mfma_f32_16x16x32_bf16 v[44:47], v[92:95], v[176:179], v[44:47]
    ds_read_b64_tr_b16 v[90:91], v243 offset:13952
    s_waitcnt lgkmcnt(12)
    v_mfma_f32_16x16x32_bf16 v[48:51], v[96:99], v[172:175], v[48:51]
    ds_read_b64_tr_b16 v[92:93], v243 offset:9376
    v_mfma_f32_16x16x32_bf16 v[52:55], v[96:99], v[176:179], v[52:55]
    ds_read_b64_tr_b16 v[94:95], v243 offset:13984
    v_mfma_f32_16x16x32_bf16 v[56:59], v[100:103], v[172:175], v[56:59]
    ds_read_b64_tr_b16 v[96:97], v243 offset:9408
    v_mfma_f32_16x16x32_bf16 v[60:63], v[100:103], v[176:179], v[60:63]
    ds_read_b64_tr_b16 v[98:99], v243 offset:14016
    s_waitcnt lgkmcnt(12)
    v_mfma_f32_16x16x32_bf16 v[64:67], v[104:107], v[172:175], v[64:67]
    ds_read_b64_tr_b16 v[100:101], v243 offset:9440
    v_mfma_f32_16x16x32_bf16 v[68:71], v[104:107], v[176:179], v[68:71]
    ds_read_b64_tr_b16 v[102:103], v243 offset:14048
    v_mfma_f32_16x16x32_bf16 v[0:3], v[72:75], v[180:183], v[0:3]
    ds_read_b64_tr_b16 v[104:105], v243 offset:9472
    buffer_load_dwordx4 v[172:175], v237, s[8:11], s50 offen offset:0 sc1
    v_mfma_f32_16x16x32_bf16 v[4:7], v[72:75], v[184:187], v[4:7]
    ds_read_b64_tr_b16 v[106:107], v243 offset:14080
    buffer_load_dwordx4 v[176:179], v238, s[8:11], s50 offen offset:0 sc1
    s_waitcnt lgkmcnt(12)
    v_mfma_f32_16x16x32_bf16 v[8:11], v[76:79], v[180:183], v[8:11]
    ds_read_b64_tr_b16 v[72:73], v243 offset:18432
    v_mfma_f32_16x16x32_bf16 v[12:15], v[76:79], v[184:187], v[12:15]
    ds_read_b64_tr_b16 v[74:75], v243 offset:23040
    v_mfma_f32_16x16x32_bf16 v[16:19], v[80:83], v[180:183], v[16:19]
    ds_read_b64_tr_b16 v[76:77], v243 offset:18464
    v_mfma_f32_16x16x32_bf16 v[20:23], v[80:83], v[184:187], v[20:23]
    ds_read_b64_tr_b16 v[78:79], v243 offset:23072
    s_waitcnt lgkmcnt(12)
    v_mfma_f32_16x16x32_bf16 v[24:27], v[84:87], v[180:183], v[24:27]
    ds_read_b64_tr_b16 v[80:81], v243 offset:18496
    v_mfma_f32_16x16x32_bf16 v[28:31], v[84:87], v[184:187], v[28:31]
    ds_read_b64_tr_b16 v[82:83], v243 offset:23104
    v_mfma_f32_16x16x32_bf16 v[32:35], v[88:91], v[180:183], v[32:35]
    ds_read_b64_tr_b16 v[84:85], v243 offset:18528
    v_mfma_f32_16x16x32_bf16 v[36:39], v[88:91], v[184:187], v[36:39]
    ds_read_b64_tr_b16 v[86:87], v243 offset:23136
    s_waitcnt lgkmcnt(12)
    v_mfma_f32_16x16x32_bf16 v[40:43], v[92:95], v[180:183], v[40:43]
    ds_read_b64_tr_b16 v[88:89], v243 offset:18560
    v_mfma_f32_16x16x32_bf16 v[44:47], v[92:95], v[184:187], v[44:47]
    ds_read_b64_tr_b16 v[90:91], v243 offset:23168
    v_mfma_f32_16x16x32_bf16 v[48:51], v[96:99], v[180:183], v[48:51]
    ds_read_b64_tr_b16 v[92:93], v243 offset:18592
    v_mfma_f32_16x16x32_bf16 v[52:55], v[96:99], v[184:187], v[52:55]
    ds_read_b64_tr_b16 v[94:95], v243 offset:23200
    s_waitcnt lgkmcnt(12)
    v_mfma_f32_16x16x32_bf16 v[56:59], v[100:103], v[180:183], v[56:59]
    ds_read_b64_tr_b16 v[96:97], v243 offset:18624
    v_mfma_f32_16x16x32_bf16 v[60:63], v[100:103], v[184:187], v[60:63]
    ds_read_b64_tr_b16 v[98:99], v243 offset:23232
    v_mfma_f32_16x16x32_bf16 v[64:67], v[104:107], v[180:183], v[64:67]
    ds_read_b64_tr_b16 v[100:101], v243 offset:18656
    v_mfma_f32_16x16x32_bf16 v[68:71], v[104:107], v[184:187], v[68:71]
    ds_read_b64_tr_b16 v[102:103], v243 offset:23264
    s_waitcnt lgkmcnt(12)
    v_mfma_f32_16x16x32_bf16 v[0:3], v[72:75], v[188:191], v[0:3]
    ds_read_b64_tr_b16 v[104:105], v243 offset:18688
    buffer_load_dwordx4 v[180:183], v237, s[8:11], s50 offen offset:1024 sc1
    v_mfma_f32_16x16x32_bf16 v[4:7], v[72:75], v[192:195], v[4:7]
    ds_read_b64_tr_b16 v[106:107], v243 offset:23296
    v_mfma_f32_16x16x32_bf16 v[8:11], v[76:79], v[188:191], v[8:11]
    ds_read_b64_tr_b16 v[72:73], v243 offset:27648
    buffer_load_dwordx4 v[184:187], v238, s[8:11], s50 offen offset:1024 sc1
    v_mfma_f32_16x16x32_bf16 v[12:15], v[76:79], v[192:195], v[12:15]
    ds_read_b64_tr_b16 v[74:75], v243 offset:32256
GG_CP1:
    s_getpc_b64 s[0:1]
    v_lshlrev_b32 v204, 7, v224
    s_lshl_b32 s20, s16, 13
    v_add_u32 v204, s20, v204
    v_min_u32 v205, GG_END-GG_CP1-8, v204
    global_load_dword v206, v205, s[0:1]
    s_waitcnt lgkmcnt(12)
    v_mfma_f32_16x16x32_bf16 v[16:19], v[80:83], v[188:191], v[16:19]
    ds_read_b64_tr_b16 v[76:77], v243 offset:27680
    v_mfma_f32_16x16x32_bf16 v[20:23], v[80:83], v[192:195], v[20:23]
    ds_read_b64_tr_b16 v[78:79], v243 offset:32288
    v_mfma_f32_16x16x32_bf16 v[24:27], v[84:87], v[188:191], v[24:27]
    ds_read_b64_tr_b16 v[80:81], v243 offset:27712
    v_mfma_f32_16x16x32_bf16 v[28:31], v[84:87], v[192:195], v[28:31]
    ds_read_b64_tr_b16 v[82:83], v243 offset:32320
    s_waitcnt lgkmcnt(12)
    v_mfma_f32_16x16x32_bf16 v[32:35], v[88:91], v[188:191], v[32:35]
    ds_read_b64_tr_b16 v[84:85], v243 offset:27744
    v_mfma_f32_16x16x32_bf16 v[36:39], v[88:91], v[192:195], v[36:39]
    ds_read_b64_tr_b16 v[86:87], v243 offset:32352
    v_mfma_f32_16x16x32_bf16 v[40:43], v[92:95], v[188:191], v[40:43]
    ds_read_b64_tr_b16 v[88:89], v243 offset:27776
    v_mfma_f32_16x16x32_bf16 v[44:47], v[92:95], v[192:195], v[44:47]
    ds_read_b64_tr_b16 v[90:91], v243 offset:32384
    s_waitcnt lgkmcnt(12)
    v_mfma_f32_16x16x32_bf16 v[48:51], v[96:99], v[188:191], v[48:51]
    ds_read_b64_tr_b16 v[92:93], v243 offset:27808
    v_mfma_f32_16x16x32_bf16 v[52:55], v[96:99], v[192:195], v[52:55]
    ds_read_b64_tr_b16 v[94:95], v243 offset:32416
    v_mfma_f32_16x16x32_bf16 v[56:59], v[100:103], v[188:191], v[56:59]
    ds_read_b64_tr_b16 v[96:97], v243 offset:27840
    v_mfma_f32_16x16x32_bf16 v[60:63], v[100:103], v[192:195], v[60:63]
    ds_read_b64_tr_b16 v[98:99], v243 offset:32448
    s_waitcnt lgkmcnt(12)
    v_mfma_f32_16x16x32_bf16 v[64:67], v[104:107], v[188:191], v[64:67]
    ds_read_b64_tr_b16 v[100:101], v243 offset:27872
    v_mfma_f32_16x16x32_bf16 v[68:71], v[104:107], v[192:195], v[68:71]
    ds_read_b64_tr_b16 v[102:103], v243 offset:32480
    s_waitcnt vmcnt(42)
    v_mfma_f32_16x16x32_bf16 v[0:3], v[72:75], v[196:199], v[0:3]
    ds_read_b64_tr_b16 v[104:105], v243 offset:27904
    buffer_load_dwordx4 v[188:191], v237, s[8:11], s50 offen offset:2048 sc1
    v_mfma_f32_16x16x32_bf16 v[4:7], v[72:75], v[200:203], v[4:7]
    ds_read_b64_tr_b16 v[106:107], v243 offset:32512
    buffer_load_dwordx4 v[192:195], v238, s[8:11], s50 offen offset:2048 sc1
    s_waitcnt vmcnt(26)
    s_barrier
    s_waitcnt lgkmcnt(12)
    v_mfma_f32_16x16x32_bf16 v[8:11], v[76:79], v[196:199], v[8:11]
    ds_read_b64_tr_b16 v[72:73], v244 offset:0
    s_add_u32 m0, s51, 36864
    v_mfma_f32_16x16x32_bf16 v[12:15], v[76:79], v[200:203], v[12:15]
    ds_read_b64_tr_b16 v[74:75], v244 offset:4608
    v_mfma_f32_16x16x32_bf16 v[16:19], v[80:83], v[196:199], v[16:19]
    ds_read_b64_tr_b16 v[76:77], v244 offset:32
    buffer_load_dwordx4 v226, s[12:15], s41 offen lds
    v_mfma_f32_16x16x32_bf16 v[20:23], v[80:83], v[200:203], v[20:23]
    ds_read_b64_tr_b16 v[78:79], v244 offset:4640
    s_add_u32 m0, s51, 37888
    s_waitcnt lgkmcnt(12)
    v_mfma_f32_16x16x32_bf16 v[24:27], v[84:87], v[196:199], v[24:27]
    ds_read_b64_tr_b16 v[80:81], v244 offset:64
    buffer_load_dwordx4 v227, s[12:15], s41 offen lds
    v_mfma_f32_16x16x32_bf16 v[28:31], v[84:87], v[200:203], v[28:31]
    ds_read_b64_tr_b16 v[82:83], v244 offset:4672
    v_mfma_f32_16x16x32_bf16 v[32:35], v[88:91], v[196:199], v[32:35]
    ds_read_b64_tr_b16 v[84:85], v244 offset:96
    s_add_u32 m0, s51, 38912
    v_mfma_f32_16x16x32_bf16 v[36:39], v[88:91], v[200:203], v[36:39]
    ds_read_b64_tr_b16 v[86:87], v244 offset:4704
    buffer_load_dwordx4 v228, s[12:15], s41 offen lds
    s_waitcnt lgkmcnt(12)
    v_mfma_f32_16x16x32_bf16 v[40:43], v[92:95], v[196:199], v[40:43]
    ds_read_b64_tr_b16 v[88:89], v244 offset:128
    s_add_u32 m0, s51, 39936
    v_mfma_f32_16x16x32_bf16 v[44:47], v[92:95], v[200:203], v[44:47]
    ds_read_b64_tr_b16 v[90:91], v244 offset:4736
    v_mfma_f32_16x16x32_bf16 v[48:51], v[96:99], v[196:199], v[48:51]
    ds_read_b64_tr_b16 v[92:93], v244 offset:160
    buffer_load_dwordx4 v229, s[12:15], s41 offen lds
    v_mfma_f32_16x16x32_bf16 v[52:55], v[96:99], v[200:203], v[52:55]
    ds_read_b64_tr_b16 v[94:95], v244 offset:4768
    s_add_u32 m0, s51, 40960
    s_waitcnt lgkmcnt(12)
    v_mfma_f32_16x16x32_bf16 v[56:59], v[100:103], v[196:199], v[56:59]
    ds_read_b64_tr_b16 v[96:97], v244 offset:192
    buffer_load_dwordx4 v230, s[12:15], s41 offen lds
    v_mfma_f32_16x16x32_bf16 v[60:63], v[100:103], v[200:203], v[60:63]
    ds_read_b64_tr_b16 v[98:99], v244 offset:4800
    v_mfma_f32_16x16x32_bf16 v[64:67], v[104:107], v[196:199], v[64:67]
    ds_read_b64_tr_b16 v[100:101], v244 offset:224
    s_add_u32 m0, s51, 41984
    v_mfma_f32_16x16x32_bf16 v[68:71], v[104:107], v[200:203], v[68:71]
    ds_read_b64_tr_b16 v[102:103], v244 offset:4832
    buffer_load_dwordx4 v231, s[12:15], s41 offen lds
    s_waitcnt lgkmcnt(12)
    v_mfma_f32_16x16x32_bf16 v[0:3], v[72:75], v[108:111], v[0:3]
    ds_read_b64_tr_b16 v[104:105], v244 offset:256
    s_add_u32 m0, s51, 43008
    v_mfma_f32_16x16x32_bf16 v[4:7], v[72:75], v[112:115], v[4:7]
    ds_read_b64_tr_b16 v[106:107], v244 offset:4864
    v_mfma_f32_16x16x32_bf16 v[8:11], v[76:79], v[108:111], v[8:11]
    ds_read_b64_tr_b16 v[72:73], v244 offset:9216
    buffer_load_dwordx4 v232, s[12:15], s41 offen lds
    v_mfma_f32_16x16x32_bf16 v[12:15], v[76:79], v[112:115], v[12:15]
    ds_read_b64_tr_b16 v[74:75], v244 offset:13824
    s_add_u32 m0, s51, 44032
    s_waitcnt lgkmcnt(12)
    v_mfma_f32_16x16x32_bf16 v[16:19], v[80:83], v[108:111], v[16:19]
    ds_read_b64_tr_b16 v[76:77], v244 offset:9248
    buffer_load_dwordx4 v233, s[12:15], s41 offen lds
    v_mfma_f32_16x16x32_bf16 v[20:23], v[80:83], v[112:115], v[20:23]
    ds_read_b64_tr_b16 v[78:79], v244 offset:13856
    v_mfma_f32_16x16x32_bf16 v[24:27], v[84:87], v[108:111], v[24:27]
    ds_read_b64_tr_b16 v[80:81], v244 offset:9280
    s_add_u32 m0, s51, 45056
    v_mfma_f32_16x16x32_bf16 v[28:31], v[84:87], v[112:115], v[28:31]
    ds_read_b64_tr_b16 v[82:83], v244 offset:13888
    buffer_load_dwordx4 v234, s[12:15], s41 offen lds
    s_waitcnt lgkmcnt(12)
    v_mfma_f32_16x16x32_bf16 v[32:35], v[88:91], v[108:111], v[32:35]
    ds_read_b64_tr_b16 v[84:85], v244 offset:9312
    buffer_load_dwordx4 v[196:199], v237, s[8:11], s50 offen offset:3072 sc1
    v_mfma_f32_16x16x32_bf16 v[36:39], v[88:91], v[112:115], v[36:39]
    ds_read_b64_tr_b16 v[86:87], v244 offset:13920
    v_mfma_f32_16x16x32_bf16 v[40:43], v[92:95], v[108:111], v[40:43]
    ds_read_b64_tr_b16 v[88:89], v244 offset:9344
    buffer_load_dwordx4 v[200:203], v238, s[8:11], s50 offen offset:3072 sc1
    v_mfma_f32_16x16x32_bf16 v[44:47], v[92:95], v[112:115], v[44:47]
    ds_read_b64_tr_b16 v[90:91], v244 offset:13952
    s_waitcnt lgkmcnt(12)
    v_mfma_f32_16x16x32_bf16 v[48:51], v[96:99], v[108:111], v[48:51]
    ds_read_b64_tr_b16 v[92:93], v244 offset:9376
    v_mfma_f32_16x16x32_bf16 v[52:55], v[96:99], v[112:115], v[52:55]
    ds_read_b64_tr_b16 v[94:95], v244 offset:13984
    v_mfma_f32_16x16x32_bf16 v[56:59], v[100:103], v[108:111], v[56:59]
    ds_read_b64_tr_b16 v[96:97], v244 offset:9408
    v_mfma_f32_16x16x32_bf16 v[60:63], v[100:103], v[112:115], v[60:63]
    ds_read_b64_tr_b16 v[98:99], v244 offset:14016
    s_waitcnt lgkmcnt(12)
    v_mfma_f32_16x16x32_bf16 v[64:67], v[104:107], v[108:111], v[64:67]
    ds_read_b64_tr_b16 v[100:101], v244 offset:9440
    v_mfma_f32_16x16x32_bf16 v[68:71], v[104:107], v[112:115], v[68:71]
    ds_read_b64_tr_b16 v[102:103], v244 offset:14048
    v_mfma_f32_16x16x32_bf16 v[0:3], v[72:75], v[116:119], v[0:3]
    ds_read_b64_tr_b16 v[104:105], v244 offset:9472
    v_mfma_f32_16x16x32_bf16 v[4:7], v[72:75], v[120:123], v[4:7]
    ds_read_b64_tr_b16 v[106:107], v244 offset:14080
    s_waitcnt lgkmcnt(12)
    v_mfma_f32_16x16x32_bf16 v[8:11], v[76:79], v[116:119], v[8:11]
    ds_read_b64_tr_b16 v[72:73], v244 offset:18432
    v_mfma_f32_16x16x32_bf16 v[12:15], v[76:79], v[120:123], v[12:15]
    ds_read_b64_tr_b16 v[74:75], v244 offset:23040
    v_mfma_f32_16x16x32_bf16 v[16:19], v[80:83], v[116:119], v[16:19]
    ds_read_b64_tr_b16 v[76:77], v244 offset:18464
    v_mfma_f32_16x16x32_bf16 v[20:23], v[80:83], v[120:123], v[20:23]
    ds_read_b64_tr_b16 v[78:79], v244 offset:23072
    s_waitcnt lgkmcnt(12)
    v_mfma_f32_16x16x32_bf16 v[24:27], v[84:87], v[116:119], v[24:27]
    ds_read_b64_tr_b16 v[80:81], v244 offset:18496
    v_mfma_f32_16x16x32_bf16 v[28:31], v[84:87], v[120:123], v[28:31]
    ds_read_b64_tr_b16 v[82:83], v244 offset:23104
    v_mfma_f32_16x16x32_bf16 v[32:35], v[88:91], v[116:119], v[32:35]
    ds_read_b64_tr_b16 v[84:85], v244 offset:18528
    v_mfma_f32_16x16x32_bf16 v[36:39], v[88:91], v[120:123], v[36:39]
    ds_read_b64_tr_b16 v[86:87], v244 offset:23136
    s_waitcnt lgkmcnt(12)
    v_mfma_f32_16x16x32_bf16 v[40:43], v[92:95], v[116:119], v[40:43]
    ds_read_b64_tr_b16 v[88:89], v244 offset:18560
    v_mfma_f32_16x16x32_bf16 v[44:47], v[92:95], v[120:123], v[44:47]
    ds_read_b64_tr_b16 v[90:91], v244 offset:23168
    v_mfma_f32_16x16x32_bf16 v[48:51], v[96:99], v[116:119], v[48:51]
    ds_read_b64_tr_b16 v[92:93], v244 offset:18592
    v_mfma_f32_16x16x32_bf16 v[52:55], v[96:99], v[120:123], v[52:55]
    ds_read_b64_tr_b16 v[94:95], v244 offset:23200
    s_waitcnt lgkmcnt(12)
    v_mfma_f32_16x16x32_bf16 v[56:59], v[100:103], v[116:119], v[56:59]
    ds_read_b64_tr_b16 v[96:97], v244 offset:18624
    v_mfma_f32_16x16x32_bf16 v[60:63], v[100:103], v[120:123], v[60:63]
    ds_read_b64_tr_b16 v[98:99], v244 offset:23232
    v_mfma_f32_16x16x32_bf16 v[64:67], v[104:107], v[116:119], v[64:67]
    ds_read_b64_tr_b16 v[100:101], v244 offset:18656
    v_mfma_f32_16x16x32_bf16 v[68:71], v[104:107], v[120:123], v[68:71]
    ds_read_b64_tr_b16 v[102:103], v244 offset:23264
    s_waitcnt lgkmcnt(12)
    v_mfma_f32_16x16x32_bf16 v[0:3], v[72:75], v[124:127], v[0:3]
    ds_read_b64_tr_b16 v[104:105], v244 offset:18688
    v_mfma_f32_16x16x32_bf16 v[4:7], v[72:75], v[128:131], v[4:7]
    ds_read_b64_tr_b16 v[106:107], v244 offset:23296
    v_mfma_f32_16x16x32_bf16 v[8:11], v[76:79], v[124:127], v[8:11]
    ds_read_b64_tr_b16 v[72:73], v244 offset:27648
    v_mfma_f32_16x16x32_bf16 v[12:15], v[76:79], v[128:131], v[12:15]
    ds_read_b64_tr_b16 v[74:75], v244 offset:32256
    s_waitcnt lgkmcnt(12)
    v_mfma_f32_16x16x32_bf16 v[16:19], v[80:83], v[124:127], v[16:19]
    ds_read_b64_tr_b16 v[76:77], v244 offset:27680
    v_mfma_f32_16x16x32_bf16 v[20:23], v[80:83], v[128:131], v[20:23]
    ds_read_b64_tr_b16 v[78:79], v244 offset:32288
    v_mfma_f32_16x16x32_bf16 v[24:27], v[84:87], v[124:127], v[24:27]
    ds_read_b64_tr_b16 v[80:81], v244 offset:27712
    v_mfma_f32_16x16x32_bf16 v[28:31], v[84:87], v[128:131], v[28:31]
    ds_read_b64_tr_b16 v[82:83], v244 offset:32320
    s_waitcnt lgkmcnt(12)
    v_mfma_f32_16x16x32_bf16 v[32:35], v[88:91], v[124:127], v[32:35]
    ds_read_b64_tr_b16 v[84:85], v244 offset:27744
    v_mfma_f32_16x16x32_bf16 v[36:39], v[88:91], v[128:131], v[36:39]
    ds_read_b64_tr_b16 v[86:87], v244 offset:32352
    v_mfma_f32_16x16x32_bf16 v[40:43], v[92:95], v[124:127], v[40:43]
    ds_read_b64_tr_b16 v[88:89], v244 offset:27776
    v_mfma_f32_16x16x32_bf16 v[44:47], v[92:95], v[128:131], v[44:47]
    ds_read_b64_tr_b16 v[90:91], v244 offset:32384
    s_waitcnt lgkmcnt(12)
    v_mfma_f32_16x16x32_bf16 v[48:51], v[96:99], v[124:127], v[48:51]
    ds_read_b64_tr_b16 v[92:93], v244 offset:27808
    v_mfma_f32_16x16x32_bf16 v[52:55], v[96:99], v[128:131], v[52:55]
    ds_read_b64_tr_b16 v[94:95], v244 offset:32416
    v_mfma_f32_16x16x32_bf16 v[56:59], v[100:103], v[124:127], v[56:59]
    ds_read_b64_tr_b16 v[96:97], v244 offset:27840
    v_mfma_f32_16x16x32_bf16 v[60:63], v[100:103], v[128:131], v[60:63]
    ds_read_b64_tr_b16 v[98:99], v244 offset:32448
    s_waitcnt lgkmcnt(12)
    v_mfma_f32_16x16x32_bf16 v[64:67], v[104:107], v[124:127], v[64:67]
    ds_read_b64_tr_b16 v[100:101], v244 offset:27872
    v_mfma_f32_16x16x32_bf16 v[68:71], v[104:107], v[128:131], v[68:71]
    ds_read_b64_tr_b16 v[102:103], v244 offset:32480
    s_waitcnt vmcnt(35)
    v_mfma_f32_16x16x32_bf16 v[0:3], v[72:75], v[132:135], v[0:3]
    ds_read_b64_tr_b16 v[104:105], v244 offset:27904
    v_mfma_f32_16x16x32_bf16 v[4:7], v[72:75], v[136:139], v[4:7]
    ds_read_b64_tr_b16 v[106:107], v244 offset:32512
    s_waitcnt vmcnt(20)
    s_waitcnt vmcnt(2)
    s_barrier
    s_waitcnt lgkmcnt(12)
    v_mfma_f32_16x16x32_bf16 v[8:11], v[76:79], v[132:135], v[8:11]
    ds_read_b64_tr_b16 v[72:73], v241 offset:0
    v_mfma_f32_16x16x32_bf16 v[12:15], v[76:79], v[136:139], v[12:15]
    ds_read_b64_tr_b16 v[74:75], v241 offset:4608
    v_mfma_f32_16x16x32_bf16 v[16:19], v[80:83], v[132:135], v[16:19]
    ds_read_b64_tr_b16 v[76:77], v241 offset:9216
    v_mfma_f32_16x16x32_bf16 v[20:23], v[80:83], v[136:139], v[20:23]
    ds_read_b64_tr_b16 v[78:79], v241 offset:13824
    s_waitcnt lgkmcnt(12)
    v_mfma_f32_16x16x32_bf16 v[24:27], v[84:87], v[132:135], v[24:27]
    ds_read_b64_tr_b16 v[80:81], v241 offset:18432
    v_mfma_f32_16x16x32_bf16 v[28:31], v[84:87], v[136:139], v[28:31]
    ds_read_b64_tr_b16 v[82:83], v241 offset:23040
    v_mfma_f32_16x16x32_bf16 v[32:35], v[88:91], v[132:135], v[32:35]
    ds_read_b64_tr_b16 v[84:85], v241 offset:27648
    v_mfma_f32_16x16x32_bf16 v[36:39], v[88:91], v[136:139], v[36:39]
    ds_read_b64_tr_b16 v[86:87], v241 offset:32256
    s_waitcnt lgkmcnt(12)
    v_mfma_f32_16x16x32_bf16 v[40:43], v[92:95], v[132:135], v[40:43]
    ds_read_b64_tr_b16 v[88:89], v242 offset:0
    v_mfma_f32_16x16x32_bf16 v[44:47], v[92:95], v[136:139], v[44:47]
    ds_read_b64_tr_b16 v[90:91], v242 offset:4608
    v_mfma_f32_16x16x32_bf16 v[48:51], v[96:99], v[132:135], v[48:51]
    ds_read_b64_tr_b16 v[92:93], v242 offset:9216
    v_mfma_f32_16x16x32_bf16 v[52:55], v[96:99], v[136:139], v[52:55]
    ds_read_b64_tr_b16 v[94:95], v242 offset:13824
    s_waitcnt lgkmcnt(12)
    v_mfma_f32_16x16x32_bf16 v[56:59], v[100:103], v[132:135], v[56:59]
    ds_read_b64_tr_b16 v[96:97], v242 offset:18432
    v_mfma_f32_16x16x32_bf16 v[60:63], v[100:103], v[136:139], v[60:63]
    ds_read_b64_tr_b16 v[98:99], v242 offset:23040
    v_mfma_f32_16x16x32_bf16 v[64:67], v[104:107], v[132:135], v[64:67]
    ds_read_b64_tr_b16 v[100:101], v242 offset:27648
    v_mfma_f32_16x16x32_bf16 v[68:71], v[104:107], v[136:139], v[68:71]
    ds_read_b64_tr_b16 v[102:103], v242 offset:32256
    s_waitcnt lgkmcnt(12)
    v_mfma_f32_16x16x32_bf16 v[0:3], v[72:75], v[140:143], v[0:3]
    ds_read_b64_tr_b16 v[104:105], v241 offset:32
    v_mfma_f32_16x16x32_bf16 v[4:7], v[72:75], v[144:147], v[4:7]
    ds_read_b64_tr_b16 v[106:107], v241 offset:4640
    v_mfma_f32_16x16x32_bf16 v[0:3], v[76:79], v[148:151], v[0:3]
    ds_read_b64_tr_b16 v[72:73], v241 offset:9248
    v_mfma_f32_16x16x32_bf16 v[4:7], v[76:79], v[152:155], v[4:7]
    ds_read_b64_tr_b16 v[74:75], v241 offset:13856
    s_waitcnt lgkmcnt(12)
    v_mfma_f32_16x16x32_bf16 v[0:3], v[80:83], v[156:159], v[0:3]
    ds_read_b64_tr_b16 v[76:77], v241 offset:18464
    v_mfma_f32_16x16x32_bf16 v[4:7], v[80:83], v[160:163], v[4:7]
    ds_read_b64_tr_b16 v[78:79], v241 offset:23072
    v_mfma_f32_16x16x32_bf16 v[0:3], v[84:87], v[164:167], v[0:3]
    ds_read_b64_tr_b16 v[80:81], v241 offset:27680
    v_mfma_f32_16x16x32_bf16 v[4:7], v[84:87], v[168:171], v[4:7]
    ds_read_b64_tr_b16 v[82:83], v241 offset:32288
    s_waitcnt lgkmcnt(12)
    v_mfma_f32_16x16x32_bf16 v[0:3], v[88:91], v[172:175], v[0:3]
    ds_read_b64_tr_b16 v[84:85], v242 offset:32
    v_mfma_f32_16x16x32_bf16 v[4:7], v[88:91], v[176:179], v[4:7]
    ds_read_b64_tr_b16 v[86:87], v242 offset:4640
    v_mfma_f32_16x16x32_bf16 v[0:3], v[92:95], v[180:183], v[0:3]
    ds_read_b64_tr_b16 v[88:89], v242 offset:9248
    v_mfma_f32_16x16x32_bf16 v[4:7], v[92:95], v[184:187], v[4:7]
    ds_read_b64_tr_b16 v[90:91], v242 offset:13856
    s_waitcnt lgkmcnt(12)
    v_mfma_f32_16x16x32_bf16 v[0:3], v[96:99], v[188:191], v[0:3]
    ds_read_b64_tr_b16 v[92:93], v242 offset:18464
    v_mfma_f32_16x16x32_bf16 v[4:7], v[96:99], v[192:195], v[4:7]
    ds_read_b64_tr_b16 v[94:95], v242 offset:23072
    s_waitcnt vmcnt(0)
    v_mfma_f32_16x16x32_bf16 v[0:3], v[100:103], v[196:199], v[0:3]
    ds_read_b64_tr_b16 v[96:97], v242 offset:27680
    v_mfma_f32_16x16x32_bf16 v[4:7], v[100:103], v[200:203], v[4:7]
    ds_read_b64_tr_b16 v[98:99], v242 offset:32288
    s_waitcnt lgkmcnt(12)
    v_mfma_f32_16x16x32_bf16 v[8:11], v[104:107], v[140:143], v[8:11]
    ds_read_b64_tr_b16 v[100:101], v241 offset:64
    v_mfma_f32_16x16x32_bf16 v[12:15], v[104:107], v[144:147], v[12:15]
    ds_read_b64_tr_b16 v[102:103], v241 offset:4672
    v_mfma_f32_16x16x32_bf16 v[8:11], v[72:75], v[148:151], v[8:11]
    ds_read_b64_tr_b16 v[104:105], v241 offset:9280
    v_mfma_f32_16x16x32_bf16 v[12:15], v[72:75], v[152:155], v[12:15]
    ds_read_b64_tr_b16 v[106:107], v241 offset:13888
    s_waitcnt lgkmcnt(12)
    v_mfma_f32_16x16x32_bf16 v[8:11], v[76:79], v[156:159], v[8:11]
    ds_read_b64_tr_b16 v[72:73], v241 offset:18496
    v_mfma_f32_16x16x32_bf16 v[12:15], v[76:79], v[160:163], v[12:15]
    ds_read_b64_tr_b16 v[74:75], v241 offset:23104
    s_cmp_eq_u32 s16, s3
    s_cbranch_scc1 GG_OW0
    v_cvt_pk_bf16_f32 v212, v0, v1
    v_cvt_pk_bf16_f32 v213, v2, v3
    v_cvt_pk_bf16_f32 v214, v4, v5
    v_cvt_pk_bf16_f32 v215, v6, v7
    buffer_store_dwordx4 v[212:215], v237, s[8:11], s28 offen offset:0 sc1
    s_branch GG_HD0
GG_OW0:
    ds_write_b128 v211, v[0:3] offset:0
    ds_write_b128 v211, v[4:7] offset:1024
GG_HD0:
    v_mfma_f32_16x16x32_bf16 v[8:11], v[80:83], v[164:167], v[8:11]
    ds_read_b64_tr_b16 v[76:77], v241 offset:27712
    v_mfma_f32_16x16x32_bf16 v[12:15], v[80:83], v[168:171], v[12:15]
    ds_read_b64_tr_b16 v[78:79], v241 offset:32320
    s_waitcnt lgkmcnt(12)
    v_mfma_f32_16x16x32_bf16 v[8:11], v[84:87], v[172:175], v[8:11]
    ds_read_b64_tr_b16 v[80:81], v242 offset:64
    v_mfma_f32_16x16x32_bf16 v[12:15], v[84:87], v[176:179], v[12:15]
    ds_read_b64_tr_b16 v[82:83], v242 offset:4672
    v_mfma_f32_16x16x32_bf16 v[8:11], v[88:91], v[180:183], v[8:11]
    ds_read_b64_tr_b16 v[84:85], v242 offset:9280
    v_mfma_f32_16x16x32_bf16 v[12:15], v[88:91], v[184:187], v[12:15]
    ds_read_b64_tr_b16 v[86:87], v242 offset:13888
    s_waitcnt lgkmcnt(12)
    v_mfma_f32_16x16x32_bf16 v[8:11], v[92:95], v[188:191], v[8:11]
    ds_read_b64_tr_b16 v[88:89], v242 offset:18496
    v_mfma_f32_16x16x32_bf16 v[12:15], v[92:95], v[192:195], v[12:15]
    ds_read_b64_tr_b16 v[90:91], v242 offset:23104
    v_mfma_f32_16x16x32_bf16 v[8:11], v[96:99], v[196:199], v[8:11]
    ds_read_b64_tr_b16 v[92:93], v242 offset:27712
    v_mfma_f32_16x16x32_bf16 v[12:15], v[96:99], v[200:203], v[12:15]
    ds_read_b64_tr_b16 v[94:95], v242 offset:32320
    s_waitcnt lgkmcnt(12)
    v_mfma_f32_16x16x32_bf16 v[16:19], v[100:103], v[140:143], v[16:19]
    ds_read_b64_tr_b16 v[96:97], v241 offset:96
    v_mfma_f32_16x16x32_bf16 v[20:23], v[100:103], v[144:147], v[20:23]
    ds_read_b64_tr_b16 v[98:99], v241 offset:4704
    v_mfma_f32_16x16x32_bf16 v[16:19], v[104:107], v[148:151], v[16:19]
    ds_read_b64_tr_b16 v[100:101], v241 offset:9312
    v_mfma_f32_16x16x32_bf16 v[20:23], v[104:107], v[152:155], v[20:23]
    ds_read_b64_tr_b16 v[102:103], v241 offset:13920
    s_waitcnt lgkmcnt(12)
    v_mfma_f32_16x16x32_bf16 v[16:19], v[72:75], v[156:159], v[16:19]
    ds_read_b64_tr_b16 v[104:105], v241 offset:18528
    v_mfma_f32_16x16x32_bf16 v[20:23], v[72:75], v[160:163], v[20:23]
    ds_read_b64_tr_b16 v[106:107], v241 offset:23136
    s_cmp_eq_u32 s16, s3
    s_cbranch_scc1 GG_OW1
    v_cvt_pk_bf16_f32 v216, v8, v9
    v_cvt_pk_bf16_f32 v217, v10, v11
    v_cvt_pk_bf16_f32 v218, v12, v13
    v_cvt_pk_bf16_f32 v219, v14, v15
    buffer_store_dwordx4 v[216:219], v237, s[8:11], s28 offen offset:1024 sc1
    s_branch GG_HD1
GG_OW1:
    ds_write_b128 v211, v[8:11] offset:2048
    ds_write_b128 v211, v[12:15] offset:3072
GG_HD1:
    v_mfma_f32_16x16x32_bf16 v[16:19], v[76:79], v[164:167], v[16:19]
    ds_read_b64_tr_b16 v[72:73], v241 offset:27744
    v_mfma_f32_16x16x32_bf16 v[20:23], v[76:79], v[168:171], v[20:23]
    ds_read_b64_tr_b16 v[74:75], v241 offset:32352
    s_waitcnt lgkmcnt(12)
    v_mfma_f32_16x16x32_bf16 v[16:19], v[80:83], v[172:175], v[16:19]
    ds_read_b64_tr_b16 v[76:77], v242 offset:96
    v_mfma_f32_16x16x32_bf16 v[20:23], v[80:83], v[176:179], v[20:23]
    ds_read_b64_tr_b16 v[78:79], v242 offset:4704
    v_mfma_f32_16x16x32_bf16 v[16:19], v[84:87], v[180:183], v[16:19]
    ds_read_b64_tr_b16 v[80:81], v242 offset:9312
    v_mfma_f32_16x16x32_bf16 v[20:23], v[84:87], v[184:187], v[20:23]
    ds_read_b64_tr_b16 v[82:83], v242 offset:13920
    s_waitcnt lgkmcnt(12)
    v_mfma_f32_16x16x32_bf16 v[16:19], v[88:91], v[188:191], v[16:19]
    ds_read_b64_tr_b16 v[84:85], v242 offset:18528
    v_mfma_f32_16x16x32_bf16 v[20:23], v[88:91], v[192:195], v[20:23]
    ds_read_b64_tr_b16 v[86:87], v242 offset:23136
    v_mfma_f32_16x16x32_bf16 v[16:19], v[92:95], v[196:199], v[16:19]
    ds_read_b64_tr_b16 v[88:89], v242 offset:27744
    v_mfma_f32_16x16x32_bf16 v[20:23], v[92:95], v[200:203], v[20:23]
    ds_read_b64_tr_b16 v[90:91], v242 offset:32352
    s_waitcnt lgkmcnt(12)
    v_mfma_f32_16x16x32_bf16 v[24:27], v[96:99], v[140:143], v[24:27]
    ds_read_b64_tr_b16 v[92:93], v241 offset:128
    v_mfma_f32_16x16x32_bf16 v[28:31], v[96:99], v[144:147], v[28:31]
    ds_read_b64_tr_b16 v[94:95], v241 offset:4736
    v_mfma_f32_16x16x32_bf16 v[24:27], v[100:103], v[148:151], v[24:27]
    ds_read_b64_tr_b16 v[96:97], v241 offset:9344
    v_mfma_f32_16x16x32_bf16 v[28:31], v[100:103], v[152:155], v[28:31]
    ds_read_b64_tr_b16 v[98:99], v241 offset:13952
    s_waitcnt lgkmcnt(12)
    v_mfma_f32_16x16x32_bf16 v[24:27], v[104:107], v[156:159], v[24:27]
    ds_read_b64_tr_b16 v[100:101], v241 offset:18560
    v_mfma_f32_16x16x32_bf16 v[28:31], v[104:107], v[160:163], v[28:31]
    ds_read_b64_tr_b16 v[102:103], v241 offset:23168
    s_cmp_eq_u32 s16, s3
    s_cbranch_scc1 GG_OW2
    v_cvt_pk_bf16_f32 v220, v16, v17
    v_cvt_pk_bf16_f32 v221, v18, v19
    v_cvt_pk_bf16_f32 v222, v20, v21
    v_cvt_pk_bf16_f32 v223, v22, v23
    buffer_store_dwordx4 v[220:223], v237, s[8:11], s28 offen offset:2048 sc1
    s_branch GG_HD2
GG_OW2:
    ds_write_b128 v211, v[16:19] offset:4096
    ds_write_b128 v211, v[20:23] offset:5120
GG_HD2:
    v_mfma_f32_16x16x32_bf16 v[24:27], v[72:75], v[164:167], v[24:27]
    ds_read_b64_tr_b16 v[104:105], v241 offset:27776
    v_mfma_f32_16x16x32_bf16 v[28:31], v[72:75], v[168:171], v[28:31]
    ds_read_b64_tr_b16 v[106:107], v241 offset:32384
    s_waitcnt lgkmcnt(12)
    v_mfma_f32_16x16x32_bf16 v[24:27], v[76:79], v[172:175], v[24:27]
    ds_read_b64_tr_b16 v[72:73], v242 offset:128
    v_mfma_f32_16x16x32_bf16 v[28:31], v[76:79], v[176:179], v[28:31]
    ds_read_b64_tr_b16 v[74:75], v242 offset:4736
    v_mfma_f32_16x16x32_bf16 v[24:27], v[80:83], v[180:183], v[24:27]
    ds_read_b64_tr_b16 v[76:77], v242 offset:9344
    v_mfma_f32_16x16x32_bf16 v[28:31], v[80:83], v[184:187], v[28:31]
    ds_read_b64_tr_b16 v[78:79], v242 offset:13952
    s_waitcnt lgkmcnt(12)
    v_mfma_f32_16x16x32_bf16 v[24:27], v[84:87], v[188:191], v[24:27]
    ds_read_b64_tr_b16 v[80:81], v242 offset:18560
    v_mfma_f32_16x16x32_bf16 v[28:31], v[84:87], v[192:195], v[28:31]
    ds_read_b64_tr_b16 v[82:83], v242 offset:23168
    v_mfma_f32_16x16x32_bf16 v[24:27], v[88:91], v[196:199], v[24:27]
    ds_read_b64_tr_b16 v[84:85], v242 offset:27776
    v_mfma_f32_16x16x32_bf16 v[28:31], v[88:91], v[200:203], v[28:31]
    ds_read_b64_tr_b16 v[86:87], v242 offset:32384
    s_waitcnt lgkmcnt(12)
    v_mfma_f32_16x16x32_bf16 v[32:35], v[92:95], v[140:143], v[32:35]
    ds_read_b64_tr_b16 v[88:89], v241 offset:160
    v_mfma_f32_16x16x32_bf16 v[36:39], v[92:95], v[144:147], v[36:39]
    ds_read_b64_tr_b16 v[90:91], v241 offset:4768
    v_mfma_f32_16x16x32_bf16 v[32:35], v[96:99], v[148:151], v[32:35]
    ds_read_b64_tr_b16 v[92:93], v241 offset:9376
    v_mfma_f32_16x16x32_bf16 v[36:39], v[96:99], v[152:155], v[36:39]
    ds_read_b64_tr_b16 v[94:95], v241 offset:13984
    s_waitcnt lgkmcnt(12)
    v_mfma_f32_16x16x32_bf16 v[32:35], v[100:103], v[156:159], v[32:35]
    ds_read_b64_tr_b16 v[96:97], v241 offset:18592
    v_mfma_f32_16x16x32_bf16 v[36:39], v[100:103], v[160:163], v[36:39]
    ds_read_b64_tr_b16 v[98:99], v241 offset:23200
    s_cmp_eq_u32 s16, s3
    s_cbranch_scc1 GG_OW3
    v_cvt_pk_bf16_f32 v212, v24, v25
    v_cvt_pk_bf16_f32 v213, v26, v27
    v_cvt_pk_bf16_f32 v214, v28, v29
    v_cvt_pk_bf16_f32 v215, v30, v31
    buffer_store_dwordx4 v[212:215], v237, s[8:11], s28 offen offset:3072 sc1
    s_branch GG_HD3
GG_OW3:
    ds_write_b128 v211, v[24:27] offset:6144
    ds_write_b128 v211, v[28:31] offset:7168
GG_HD3:
    v_mfma_f32_16x16x32_bf16 v[32:35], v[104:107], v[164:167], v[32:35]
    ds_read_b64_tr_b16 v[100:101], v241 offset:27808
    v_mfma_f32_16x16x32_bf16 v[36:39], v[104:107], v[168:171], v[36:39]
    ds_read_b64_tr_b16 v[102:103], v241 offset:32416
    s_waitcnt lgkmcnt(12)
    v_mfma_f32_16x16x32_bf16 v[32:35], v[72:75], v[172:175], v[32:35]
    ds_read_b64_tr_b16 v[104:105], v242 offset:160
    v_mfma_f32_16x16x32_bf16 v[36:39], v[72:75], v[176:179], v[36:39]
    ds_read_b64_tr_b16 v[106:107], v242 offset:4768
    v_mfma_f32_16x16x32_bf16 v[32:35], v[76:79], v[180:183], v[32:35]
    ds_read_b64_tr_b16 v[72:73], v242 offset:9376
    v_mfma_f32_16x16x32_bf16 v[36:39], v[76:79], v[184:187], v[36:39]
    ds_read_b64_tr_b16 v[74:75], v242 offset:13984
    s_waitcnt lgkmcnt(12)
    v_mfma_f32_16x16x32_bf16 v[32:35], v[80:83], v[188:191], v[32:35]
    ds_read_b64_tr_b16 v[76:77], v242 offset:18592
    v_mfma_f32_16x16x32_bf16 v[36:39], v[80:83], v[192:195], v[36:39]
    ds_read_b64_tr_b16 v[78:79], v242 offset:23200
    v_mfma_f32_16x16x32_bf16 v[32:35], v[84:87], v[196:199], v[32:35]
    ds_read_b64_tr_b16 v[80:81], v242 offset:27808
    v_mfma_f32_16x16x32_bf16 v[36:39], v[84:87], v[200:203], v[36:39]
    ds_read_b64_tr_b16 v[82:83], v242 offset:32416
    s_waitcnt lgkmcnt(12)
    v_mfma_f32_16x16x32_bf16 v[40:43], v[88:91], v[140:143], v[40:43]
    ds_read_b64_tr_b16 v[84:85], v241 offset:192
    v_mfma_f32_16x16x32_bf16 v[44:47], v[88:91], v[144:147], v[44:47]
    ds_read_b64_tr_b16 v[86:87], v241 offset:4800
    v_mfma_f32_16x16x32_bf16 v[40:43], v[92:95], v[148:151], v[40:43]
    ds_read_b64_tr_b16 v[88:89], v241 offset:9408
    v_mfma_f32_16x16x32_bf16 v[44:47], v[92:95], v[152:155], v[44:47]
    ds_read_b64_tr_b16 v[90:91], v241 offset:14016
    s_waitcnt lgkmcnt(12)
    v_mfma_f32_16x16x32_bf16 v[40:43], v[96:99], v[156:159], v[40:43]
    ds_read_b64_tr_b16 v[92:93], v241 offset:18624
    v_mfma_f32_16x16x32_bf16 v[44:47], v[96:99], v[160:163], v[44:47]
    ds_read_b64_tr_b16 v[94:95], v241 offset:23232
    s_cmp_eq_u32 s16, s3
    s_cbranch_scc1 GG_OW4
    v_cvt_pk_bf16_f32 v216, v32, v33
    v_cvt_pk_bf16_f32 v217, v34, v35
    v_cvt_pk_bf16_f32 v218, v36, v37
    v_cvt_pk_bf16_f32 v219, v38, v39
    buffer_store_dwordx4 v[216:219], v237, s[8:11], s29 offen offset:0 sc1
    s_branch GG_HD4
GG_OW4:
    ds_write_b128 v211, v[32:35] offset:8192
    ds_write_b128 v211, v[36:39] offset:9216
GG_HD4:
    v_mfma_f32_16x16x32_bf16 v[40:43], v[100:103], v[164:167], v[40:43]
    ds_read_b64_tr_b16 v[96:97], v241 offset:27840
    v_mfma_f32_16x16x32_bf16 v[44:47], v[100:103], v[168:171], v[44:47]
    ds_read_b64_tr_b16 v[98:99], v241 offset:32448
    s_waitcnt lgkmcnt(12)
    v_mfma_f32_16x16x32_bf16 v[40:43], v[104:107], v[172:175], v[40:43]
    ds_read_b64_tr_b16 v[100:101], v242 offset:192
    v_mfma_f32_16x16x32_bf16 v[44:47], v[104:107], v[176:179], v[44:47]
    ds_read_b64_tr_b16 v[102:103], v242 offset:4800
    v_mfma_f32_16x16x32_bf16 v[40:43], v[72:75], v[180:183], v[40:43]
    ds_read_b64_tr_b16 v[104:105], v242 offset:9408
    v_mfma_f32_16x16x32_bf16 v[44:47], v[72:75], v[184:187], v[44:47]
    ds_read_b64_tr_b16 v[106:107], v242 offset:14016
    s_waitcnt lgkmcnt(12)
    v_mfma_f32_16x16x32_bf16 v[40:43], v[76:79], v[188:191], v[40:43]
    ds_read_b64_tr_b16 v[72:73], v242 offset:18624
    v_mfma_f32_16x16x32_bf16 v[44:47], v[76:79], v[192:195], v[44:47]
    ds_read_b64_tr_b16 v[74:75], v242 offset:23232
    v_mfma_f32_16x16x32_bf16 v[40:43], v[80:83], v[196:199], v[40:43]
    ds_read_b64_tr_b16 v[76:77], v242 offset:27840
    v_mfma_f32_16x16x32_bf16 v[44:47], v[80:83], v[200:203], v[44:47]
    ds_read_b64_tr_b16 v[78:79], v242 offset:32448
    s_waitcnt lgkmcnt(12)
    v_mfma_f32_16x16x32_bf16 v[48:51], v[84:87], v[140:143], v[48:51]
    ds_read_b64_tr_b16 v[80:81], v241 offset:224
    v_mfma_f32_16x16x32_bf16 v[52:55], v[84:87], v[144:147], v[52:55]
    ds_read_b64_tr_b16 v[82:83], v241 offset:4832
    v_mfma_f32_16x16x32_bf16 v[48:51], v[88:91], v[148:151], v[48:51]
    ds_read_b64_tr_b16 v[84:85], v241 offset:9440
    v_mfma_f32_16x16x32_bf16 v[52:55], v[88:91], v[152:155], v[52:55]
    ds_read_b64_tr_b16 v[86:87], v241 offset:14048
    s_waitcnt lgkmcnt(12)
    v_mfma_f32_16x16x32_bf16 v[48:51], v[92:95], v[156:159], v[48:51]
    ds_read_b64_tr_b16 v[88:89], v241 offset:18656
    v_mfma_f32_16x16x32_bf16 v[52:55], v[92:95], v[160:163], v[52:55]
    ds_read_b64_tr_b16 v[90:91], v241 offset:23264
    s_cmp_eq_u32 s16, s3
    s_cbranch_scc1 GG_OW5
    v_cvt_pk_bf16_f32 v220, v40, v41
    v_cvt_pk_bf16_f32 v221, v42, v43
    v_cvt_pk_bf16_f32 v222, v44, v45
    v_cvt_pk_bf16_f32 v223, v46, v47
    buffer_store_dwordx4 v[220:223], v237, s[8:11], s29 offen offset:1024 sc1
    s_branch GG_HD5
GG_OW5:
    ds_write_b128 v211, v[40:43] offset:10240
    ds_write_b128 v211, v[44:47] offset:11264
GG_HD5:
    v_mfma_f32_16x16x32_bf16 v[48:51], v[96:99], v[164:167], v[48:51]
    ds_read_b64_tr_b16 v[92:93], v241 offset:27872
    v_mfma_f32_16x16x32_bf16 v[52:55], v[96:99], v[168:171], v[52:55]
    ds_read_b64_tr_b16 v[94:95], v241 offset:32480
    s_waitcnt lgkmcnt(12)
    v_mfma_f32_16x16x32_bf16 v[48:51], v[100:103], v[172:175], v[48:51]
    ds_read_b64_tr_b16 v[96:97], v242 offset:224
    v_mfma_f32_16x16x32_bf16 v[52:55], v[100:103], v[176:179], v[52:55]
    ds_read_b64_tr_b16 v[98:99], v242 offset:4832
    v_mfma_f32_16x16x32_bf16 v[48:51], v[104:107], v[180:183], v[48:51]
    ds_read_b64_tr_b16 v[100:101], v242 offset:9440
    v_mfma_f32_16x16x32_bf16 v[52:55], v[104:107], v[184:187], v[52:55]
    ds_read_b64_tr_b16 v[102:103], v242 offset:14048
    s_waitcnt lgkmcnt(12)
    v_mfma_f32_16x16x32_bf16 v[48:51], v[72:75], v[188:191], v[48:51]
    ds_read_b64_tr_b16 v[104:105], v242 offset:18656
    v_mfma_f32_16x16x32_bf16 v[52:55], v[72:75], v[192:195], v[52:55]
    ds_read_b64_tr_b16 v[106:107], v242 offset:23264
    v_mfma_f32_16x16x32_bf16 v[48:51], v[76:79], v[196:199], v[48:51]
    ds_read_b64_tr_b16 v[72:73], v242 offset:27872
    v_mfma_f32_16x16x32_bf16 v[52:55], v[76:79], v[200:203], v[52:55]
    ds_read_b64_tr_b16 v[74:75], v242 offset:32480
    s_waitcnt lgkmcnt(12)
    v_mfma_f32_16x16x32_bf16 v[56:59], v[80:83], v[140:143], v[56:59]
    ds_read_b64_tr_b16 v[76:77], v241 offset:256
    v_mfma_f32_16x16x32_bf16 v[60:63], v[80:83], v[144:147], v[60:63]
    ds_read_b64_tr_b16 v[78:79], v241 offset:4864
    v_mfma_f32_16x16x32_bf16 v[56:59], v[84:87], v[148:151], v[56:59]
    ds_read_b64_tr_b16 v[80:81], v241 offset:9472
    v_mfma_f32_16x16x32_bf16 v[60:63], v[84:87], v[152:155], v[60:63]
    ds_read_b64_tr_b16 v[82:83], v241 offset:14080
    s_waitcnt lgkmcnt(12)
    v_mfma_f32_16x16x32_bf16 v[56:59], v[88:91], v[156:159], v[56:59]
    ds_read_b64_tr_b16 v[84:85], v241 offset:18688
    v_mfma_f32_16x16x32_bf16 v[60:63], v[88:91], v[160:163], v[60:63]
    ds_read_b64_tr_b16 v[86:87], v241 offset:23296
    s_cmp_eq_u32 s16, s3
    s_cbranch_scc1 GG_OW6
    v_cvt_pk_bf16_f32 v212, v48, v49
    v_cvt_pk_bf16_f32 v213, v50, v51
    v_cvt_pk_bf16_f32 v214, v52, v53
    v_cvt_pk_bf16_f32 v215, v54, v55
    buffer_store_dwordx4 v[212:215], v237, s[8:11], s29 offen offset:2048 sc1
    s_branch GG_HD6
GG_OW6:
    ds_write_b128 v211, v[48:51] offset:12288
    ds_write_b128 v211, v[52:55] offset:13312
GG_HD6:
    v_mfma_f32_16x16x32_bf16 v[56:59], v[92:95], v[164:167], v[56:59]
    ds_read_b64_tr_b16 v[88:89], v241 offset:27904
    v_mfma_f32_16x16x32_bf16 v[60:63], v[92:95], v[168:171], v[60:63]
    ds_read_b64_tr_b16 v[90:91], v241 offset:32512
    s_waitcnt lgkmcnt(12)
    v_mfma_f32_16x16x32_bf16 v[56:59], v[96:99], v[172:175], v[56:59]
    ds_read_b64_tr_b16 v[92:93], v242 offset:256
    v_mfma_f32_16x16x32_bf16 v[60:63], v[96:99], v[176:179], v[60:63]
    ds_read_b64_tr_b16 v[94:95], v242 offset:4864
    v_mfma_f32_16x16x32_bf16 v[56:59], v[100:103], v[180:183], v[56:59]
    ds_read_b64_tr_b16 v[96:97], v242 offset:9472
    v_mfma_f32_16x16x32_bf16 v[60:63], v[100:103], v[184:187], v[60:63]
    ds_read_b64_tr_b16 v[98:99], v242 offset:14080
    s_waitcnt lgkmcnt(12)
    v_mfma_f32_16x16x32_bf16 v[56:59], v[104:107], v[188:191], v[56:59]
    ds_read_b64_tr_b16 v[100:101], v242 offset:18688
    v_mfma_f32_16x16x32_bf16 v[60:63], v[104:107], v[192:195], v[60:63]
    ds_read_b64_tr_b16 v[102:103], v242 offset:23296
    v_mfma_f32_16x16x32_bf16 v[56:59], v[72:75], v[196:199], v[56:59]
    ds_read_b64_tr_b16 v[104:105], v242 offset:27904
    v_mfma_f32_16x16x32_bf16 v[60:63], v[72:75], v[200:203], v[60:63]
    ds_read_b64_tr_b16 v[106:107], v242 offset:32512
    s_waitcnt lgkmcnt(12)
    v_mfma_f32_16x16x32_bf16 v[64:67], v[76:79], v[140:143], v[64:67]
    v_mfma_f32_16x16x32_bf16 v[68:71], v[76:79], v[144:147], v[68:71]
    v_mfma_f32_16x16x32_bf16 v[64:67], v[80:83], v[148:151], v[64:67]
    v_mfma_f32_16x16x32_bf16 v[68:71], v[80:83], v[152:155], v[68:71]
    s_waitcnt lgkmcnt(8)
    v_mfma_f32_16x16x32_bf16 v[64:67], v[84:87], v[156:159], v[64:67]
    v_mfma_f32_16x16x32_bf16 v[68:71], v[84:87], v[160:163], v[68:71]
    s_cmp_eq_u32 s16, s3
    s_cbranch_scc1 GG_OW7
    v_cvt_pk_bf16_f32 v216, v56, v57
    v_cvt_pk_bf16_f32 v217, v58, v59
    v_cvt_pk_bf16_f32 v218, v60, v61
    v_cvt_pk_bf16_f32 v219, v62, v63
    buffer_store_dwordx4 v[216:219], v237, s[8:11], s29 offen offset:3072 sc1
    s_branch GG_HD7
GG_OW7:
    ds_write_b128 v211, v[56:59] offset:14336
    ds_write_b128 v211, v[60:63] offset:15360
GG_HD7:
    v_mfma_f32_16x16x32_bf16 v[64:67], v[88:91], v[164:167], v[64:67]
    v_mfma_f32_16x16x32_bf16 v[68:71], v[88:91], v[168:171], v[68:71]
    s_waitcnt lgkmcnt(4)
    v_mfma_f32_16x16x32_bf16 v[64:67], v[92:95], v[172:175], v[64:67]
    v_mfma_f32_16x16x32_bf16 v[68:71], v[92:95], v[176:179], v[68:71]
    v_mfma_f32_16x16x32_bf16 v[64:67], v[96:99], v[180:183], v[64:67]
    v_mfma_f32_16x16x32_bf16 v[68:71], v[96:99], v[184:187], v[68:71]
    s_waitcnt lgkmcnt(0)
    v_mfma_f32_16x16x32_bf16 v[64:67], v[100:103], v[188:191], v[64:67]
    v_mfma_f32_16x16x32_bf16 v[68:71], v[100:103], v[192:195], v[68:71]
    v_mfma_f32_16x16x32_bf16 v[64:67], v[104:107], v[196:199], v[64:67]
    v_mfma_f32_16x16x32_bf16 v[68:71], v[104:107], v[200:203], v[68:71]
    s_cmp_eq_u32 s16, s3
    s_cbranch_scc1 GG_OW8
    s_nop 4
    v_cvt_pk_bf16_f32 v220, v64, v65
    v_cvt_pk_bf16_f32 v221, v66, v67
    v_cvt_pk_bf16_f32 v222, v68, v69
    v_cvt_pk_bf16_f32 v223, v70, v71
    buffer_store_dwordx4 v[220:223], v237, s[8:11], s30 offen offset:0 sc1
    s_branch GG_HD8
GG_OW8:
    s_nop 4
    ds_write_b128 v211, v[64:67] offset:16384
    ds_write_b128 v211, v[68:71] offset:17408
GG_HD8:
    v_and_b32 v140, 15, v224
    v_mul_u32_u24 v144, 1152, v140
    v_lshrrev_b32 v140, 4, v224
    v_lshl_add_u32 v144, v140, 3, v144
    v_lshlrev_b32 v145, 4, v140
    v_add_u32 v146, 18432, v144
    v_add_u32 v147, s59, v237
    v_bfe_u32 v141, v224, 2, 4
    v_lshlrev_b32 v141, 5, v141
    v_and_b32 v142, 3, v224
    v_lshl_add_u32 v141, v142, 3, v141
    s_mul_i32 s18, s16, 3072
    s_add_u32 s18, s18, 147456
    v_add_u32 v141, s18, v141
    ds_read_b64_tr_b16 v[108:109], v141 offset:0
    ds_read_b64_tr_b16 v[110:111], v141 offset:1536
    ds_read_b64_tr_b16 v[112:113], v141 offset:512
    ds_read_b64_tr_b16 v[114:115], v141 offset:2048
    ds_read_b64_tr_b16 v[116:117], v141 offset:1024
    ds_read_b64_tr_b16 v[118:119], v141 offset:2560
    buffer_load_dwordx4 v[120:123], v145, s[8:11], s57 offen offset:0
    buffer_load_dwordx4 v[124:127], v145, s[8:11], s57 offen offset:64
    buffer_load_dwordx4 v[128:131], v145, s[8:11], s57 offen offset:128
    s_mov_b32 s48, s53
    s_mov_b32 s49, s54
    s_mov_b32 s50, s55
    s_mov_b32 s34, s56
    s_mov_b32 s24, s62
    s_and_b32 s25, s63, 0xffff
    s_mov_b32 s26, 0x240000
    s_mov_b32 s27, 0x00020000
    s_waitcnt lgkmcnt(0)
    s_barrier
    ds_read_b128 v[0:3], v147 offset:0
    ds_read_b128 v[4:7], v147 offset:1024
    ds_read_b128 v[8:11], v147 offset:2048
    ds_read_b128 v[12:15], v147 offset:3072
    ds_read_b128 v[16:19], v147 offset:4096
    ds_read_b128 v[20:23], v147 offset:5120
    s_mov_b32 s22, 0x8000
GG_P2:
    buffer_load_dwordx4 v[24:27], v237, s[8:11], s48 offen offset:0 sc1
    buffer_load_dwordx4 v[28:31], v237, s[8:11], s49 offen offset:0 sc1
    buffer_load_dwordx4 v[32:35], v237, s[8:11], s50 offen offset:0 sc1
    buffer_load_dwordx4 v[36:39], v237, s[8:11], s48 offen offset:1024 sc1
    buffer_load_dwordx4 v[40:43], v237, s[8:11], s49 offen offset:1024 sc1
    buffer_load_dwordx4 v[44:47], v237, s[8:11], s50 offen offset:1024 sc1
    buffer_load_dwordx4 v[48:51], v237, s[8:11], s48 offen offset:2048 sc1
    buffer_load_dwordx4 v[52:55], v237, s[8:11], s49 offen offset:2048 sc1
    buffer_load_dwordx4 v[56:59], v237, s[8:11], s50 offen offset:2048 sc1
    s_waitcnt vmcnt(0)
    v_max3_u32 v60, v24, v25, v26
    v_max3_u32 v61, v27, v28, v29
    v_max3_u32 v60, v60, v30, v31
    v_max3_u32 v61, v61, v32, v33
    v_max3_u32 v60, v60, v34, v35
    v_max3_u32 v61, v61, v36, v37
    v_max3_u32 v60, v60, v38, v39
    v_max3_u32 v61, v61, v40, v41
    v_max3_u32 v60, v60, v42, v43
    v_max3_u32 v61, v61, v44, v45
    v_max3_u32 v60, v60, v46, v47
    v_max3_u32 v61, v61, v48, v49
    v_max3_u32 v60, v60, v50, v51
    v_max3_u32 v61, v61, v52, v53
    v_max3_u32 v60, v60, v54, v55
    v_max3_u32 v61, v61, v56, v57
    v_max3_u32 v60, v60, v58, v59
    v_max_u32 v60, v60, v61
    v_cmp_eq_u32 vcc, -1, v60
    s_sub_u32 s22, s22, 1
    s_cbranch_scc1 GG_P2X
    s_cbranch_vccnz GG_P2
GG_P2X:
    s_waitcnt lgkmcnt(0)
    v_lshlrev_b32 v60, 16, v24
    v_and_b32 v61, 0xffff0000, v24
    v_add_f32 v0, v0, v60
    v_add_f32 v1, v1, v61
    v_lshlrev_b32 v60, 16, v25
    v_and_b32 v61, 0xffff0000, v25
    v_add_f32 v2, v2, v60
    v_add_f32 v3, v3, v61
    v_lshlrev_b32 v60, 16, v28
    v_and_b32 v61, 0xffff0000, v28
    v_add_f32 v0, v0, v60
    v_add_f32 v1, v1, v61
    v_lshlrev_b32 v60, 16, v29
    v_and_b32 v61, 0xffff0000, v29
    v_add_f32 v2, v2, v60
    v_add_f32 v3, v3, v61
    v_lshlrev_b32 v60, 16, v32
    v_and_b32 v61, 0xffff0000, v32
    v_add_f32 v0, v0, v60
    v_add_f32 v1, v1, v61
    v_lshlrev_b32 v60, 16, v33
    v_and_b32 v61, 0xffff0000, v33
    v_add_f32 v2, v2, v60
    v_add_f32 v3, v3, v61
    v_cvt_pk_bf16_f32 v62, v0, v1
    v_lshlrev_b32 v0, 16, v62
    v_and_b32 v1, 0xffff0000, v62
    v_mul_f32 v0, v0, v120
    v_mul_f32 v1, v1, v121
    v_cvt_pk_bf16_f32 v62, v0, v1
    v_lshlrev_b32 v0, 16, v62
    v_and_b32 v1, 0xffff0000, v62
    v_lshlrev_b32 v62, 16, v108
    v_and_b32 v63, 0xffff0000, v108
    v_add_f32 v0, v0, v62
    v_add_f32 v1, v1, v63
    v_cvt_pk_bf16_f32 v108, v0, v1
    v_cvt_pk_bf16_f32 v62, v2, v3
    v_lshlrev_b32 v2, 16, v62
    v_and_b32 v3, 0xffff0000, v62
    v_mul_f32 v2, v2, v122
    v_mul_f32 v3, v3, v123
    v_cvt_pk_bf16_f32 v62, v2, v3
    v_lshlrev_b32 v2, 16, v62
    v_and_b32 v3, 0xffff0000, v62
    v_lshlrev_b32 v62, 16, v109
    v_and_b32 v63, 0xffff0000, v109
    v_add_f32 v2, v2, v62
    v_add_f32 v3, v3, v63
    v_cvt_pk_bf16_f32 v109, v2, v3
    buffer_store_dwordx2 v[108:109], v144, s[24:27], s34 offen offset:0
    v_lshlrev_b32 v60, 16, v26
    v_and_b32 v61, 0xffff0000, v26
    v_add_f32 v4, v4, v60
    v_add_f32 v5, v5, v61
    v_lshlrev_b32 v60, 16, v27
    v_and_b32 v61, 0xffff0000, v27
    v_add_f32 v6, v6, v60
    v_add_f32 v7, v7, v61
    v_lshlrev_b32 v60, 16, v30
    v_and_b32 v61, 0xffff0000, v30
    v_add_f32 v4, v4, v60
    v_add_f32 v5, v5, v61
    v_lshlrev_b32 v60, 16, v31
    v_and_b32 v61, 0xffff0000, v31
    v_add_f32 v6, v6, v60
    v_add_f32 v7, v7, v61
    v_lshlrev_b32 v60, 16, v34
    v_and_b32 v61, 0xffff0000, v34
    v_add_f32 v4, v4, v60
    v_add_f32 v5, v5, v61
    v_lshlrev_b32 v60, 16, v35
    v_and_b32 v61, 0xffff0000, v35
    v_add_f32 v6, v6, v60
    v_add_f32 v7, v7, v61
    v_cvt_pk_bf16_f32 v62, v4, v5
    v_lshlrev_b32 v4, 16, v62
    v_and_b32 v5, 0xffff0000, v62
    v_mul_f32 v4, v4, v120
    v_mul_f32 v5, v5, v121
    v_cvt_pk_bf16_f32 v62, v4, v5
    v_lshlrev_b32 v4, 16, v62
    v_and_b32 v5, 0xffff0000, v62
    v_lshlrev_b32 v62, 16, v110
    v_and_b32 v63, 0xffff0000, v110
    v_add_f32 v4, v4, v62
    v_add_f32 v5, v5, v63
    v_cvt_pk_bf16_f32 v110, v4, v5
    v_cvt_pk_bf16_f32 v62, v6, v7
    v_lshlrev_b32 v6, 16, v62
    v_and_b32 v7, 0xffff0000, v62
    v_mul_f32 v6, v6, v122
    v_mul_f32 v7, v7, v123
    v_cvt_pk_bf16_f32 v62, v6, v7
    v_lshlrev_b32 v6, 16, v62
    v_and_b32 v7, 0xffff0000, v62
    v_lshlrev_b32 v62, 16, v111
    v_and_b32 v63, 0xffff0000, v111
    v_add_f32 v6, v6, v62
    v_add_f32 v7, v7, v63
    v_cvt_pk_bf16_f32 v111, v6, v7
    buffer_store_dwordx2 v[110:111], v146, s[24:27], s34 offen offset:0
    v_lshlrev_b32 v60, 16, v36
    v_and_b32 v61, 0xffff0000, v36
    v_add_f32 v8, v8, v60
    v_add_f32 v9, v9, v61
    v_lshlrev_b32 v60, 16, v37
    v_and_b32 v61, 0xffff0000, v37
    v_add_f32 v10, v10, v60
    v_add_f32 v11, v11, v61
    v_lshlrev_b32 v60, 16, v40
    v_and_b32 v61, 0xffff0000, v40
    v_add_f32 v8, v8, v60
    v_add_f32 v9, v9, v61
    v_lshlrev_b32 v60, 16, v41
    v_and_b32 v61, 0xffff0000, v41
    v_add_f32 v10, v10, v60
    v_add_f32 v11, v11, v61
    v_lshlrev_b32 v60, 16, v44
    v_and_b32 v61, 0xffff0000, v44
    v_add_f32 v8, v8, v60
    v_add_f32 v9, v9, v61
    v_lshlrev_b32 v60, 16, v45
    v_and_b32 v61, 0xffff0000, v45
    v_add_f32 v10, v10, v60
    v_add_f32 v11, v11, v61
    v_cvt_pk_bf16_f32 v62, v8, v9
    v_lshlrev_b32 v8, 16, v62
    v_and_b32 v9, 0xffff0000, v62
    v_mul_f32 v8, v8, v124
    v_mul_f32 v9, v9, v125
    v_cvt_pk_bf16_f32 v62, v8, v9
    v_lshlrev_b32 v8, 16, v62
    v_and_b32 v9, 0xffff0000, v62
    v_lshlrev_b32 v62, 16, v112
    v_and_b32 v63, 0xffff0000, v112
    v_add_f32 v8, v8, v62
    v_add_f32 v9, v9, v63
    v_cvt_pk_bf16_f32 v112, v8, v9
    v_cvt_pk_bf16_f32 v62, v10, v11
    v_lshlrev_b32 v10, 16, v62
    v_and_b32 v11, 0xffff0000, v62
    v_mul_f32 v10, v10, v126
    v_mul_f32 v11, v11, v127
    v_cvt_pk_bf16_f32 v62, v10, v11
    v_lshlrev_b32 v10, 16, v62
    v_and_b32 v11, 0xffff0000, v62
    v_lshlrev_b32 v62, 16, v113
    v_and_b32 v63, 0xffff0000, v113
    v_add_f32 v10, v10, v62
    v_add_f32 v11, v11, v63
    v_cvt_pk_bf16_f32 v113, v10, v11
    buffer_store_dwordx2 v[112:113], v144, s[24:27], s34 offen offset:32
    v_lshlrev_b32 v60, 16, v38
    v_and_b32 v61, 0xffff0000, v38
    v_add_f32 v12, v12, v60
    v_add_f32 v13, v13, v61
    v_lshlrev_b32 v60, 16, v39
    v_and_b32 v61, 0xffff0000, v39
    v_add_f32 v14, v14, v60
    v_add_f32 v15, v15, v61
    v_lshlrev_b32 v60, 16, v42
    v_and_b32 v61, 0xffff0000, v42
    v_add_f32 v12, v12, v60
    v_add_f32 v13, v13, v61
    v_lshlrev_b32 v60, 16, v43
    v_and_b32 v61, 0xffff0000, v43
    v_add_f32 v14, v14, v60
    v_add_f32 v15, v15, v61
    v_lshlrev_b32 v60, 16, v46
    v_and_b32 v61, 0xffff0000, v46
    v_add_f32 v12, v12, v60
    v_add_f32 v13, v13, v61
    v_lshlrev_b32 v60, 16, v47
    v_and_b32 v61, 0xffff0000, v47
    v_add_f32 v14, v14, v60
    v_add_f32 v15, v15, v61
    v_cvt_pk_bf16_f32 v62, v12, v13
    v_lshlrev_b32 v12, 16, v62
    v_and_b32 v13, 0xffff0000, v62
    v_mul_f32 v12, v12, v124
    v_mul_f32 v13, v13, v125
    v_cvt_pk_bf16_f32 v62, v12, v13
    v_lshlrev_b32 v12, 16, v62
    v_and_b32 v13, 0xffff0000, v62
    v_lshlrev_b32 v62, 16, v114
    v_and_b32 v63, 0xffff0000, v114
    v_add_f32 v12, v12, v62
    v_add_f32 v13, v13, v63
    v_cvt_pk_bf16_f32 v114, v12, v13
    v_cvt_pk_bf16_f32 v62, v14, v15
    v_lshlrev_b32 v14, 16, v62
    v_and_b32 v15, 0xffff0000, v62
    v_mul_f32 v14, v14, v126
    v_mul_f32 v15, v15, v127
    v_cvt_pk_bf16_f32 v62, v14, v15
    v_lshlrev_b32 v14, 16, v62
    v_and_b32 v15, 0xffff0000, v62
    v_lshlrev_b32 v62, 16, v115
    v_and_b32 v63, 0xffff0000, v115
    v_add_f32 v14, v14, v62
    v_add_f32 v15, v15, v63
    v_cvt_pk_bf16_f32 v115, v14, v15
    buffer_store_dwordx2 v[114:115], v146, s[24:27], s34 offen offset:32
    v_lshlrev_b32 v60, 16, v48
    v_and_b32 v61, 0xffff0000, v48
    v_add_f32 v16, v16, v60
    v_add_f32 v17, v17, v61
    v_lshlrev_b32 v60, 16, v49
    v_and_b32 v61, 0xffff0000, v49
    v_add_f32 v18, v18, v60
    v_add_f32 v19, v19, v61
    v_lshlrev_b32 v60, 16, v52
    v_and_b32 v61, 0xffff0000, v52
    v_add_f32 v16, v16, v60
    v_add_f32 v17, v17, v61
    v_lshlrev_b32 v60, 16, v53
    v_and_b32 v61, 0xffff0000, v53
    v_add_f32 v18, v18, v60
    v_add_f32 v19, v19, v61
    v_lshlrev_b32 v60, 16, v56
    v_and_b32 v61, 0xffff0000, v56
    v_add_f32 v16, v16, v60
    v_add_f32 v17, v17, v61
    v_lshlrev_b32 v60, 16, v57
    v_and_b32 v61, 0xffff0000, v57
    v_add_f32 v18, v18, v60
    v_add_f32 v19, v19, v61
    v_cvt_pk_bf16_f32 v62, v16, v17
    v_lshlrev_b32 v16, 16, v62
    v_and_b32 v17, 0xffff0000, v62
    v_mul_f32 v16, v16, v128
    v_mul_f32 v17, v17, v129
    v_cvt_pk_bf16_f32 v62, v16, v17
    v_lshlrev_b32 v16, 16, v62
    v_and_b32 v17, 0xffff0000, v62
    v_lshlrev_b32 v62, 16, v116
    v_and_b32 v63, 0xffff0000, v116
    v_add_f32 v16, v16, v62
    v_add_f32 v17, v17, v63
    v_cvt_pk_bf16_f32 v116, v16, v17
    v_cvt_pk_bf16_f32 v62, v18, v19
    v_lshlrev_b32 v18, 16, v62
    v_and_b32 v19, 0xffff0000, v62
    v_mul_f32 v18, v18, v130
    v_mul_f32 v19, v19, v131
    v_cvt_pk_bf16_f32 v62, v18, v19
    v_lshlrev_b32 v18, 16, v62
    v_and_b32 v19, 0xffff0000, v62
    v_lshlrev_b32 v62, 16, v117
    v_and_b32 v63, 0xffff0000, v117
    v_add_f32 v18, v18, v62
    v_add_f32 v19, v19, v63
    v_cvt_pk_bf16_f32 v117, v18, v19
    buffer_store_dwordx2 v[116:117], v144, s[24:27], s34 offen offset:64
    v_lshlrev_b32 v60, 16, v50
    v_and_b32 v61, 0xffff0000, v50
    v_add_f32 v20, v20, v60
    v_add_f32 v21, v21, v61
    v_lshlrev_b32 v60, 16, v51
    v_and_b32 v61, 0xffff0000, v51
    v_add_f32 v22, v22, v60
    v_add_f32 v23, v23, v61
    v_lshlrev_b32 v60, 16, v54
    v_and_b32 v61, 0xffff0000, v54
    v_add_f32 v20, v20, v60
    v_add_f32 v21, v21, v61
    v_lshlrev_b32 v60, 16, v55
    v_and_b32 v61, 0xffff0000, v55
    v_add_f32 v22, v22, v60
    v_add_f32 v23, v23, v61
    v_lshlrev_b32 v60, 16, v58
    v_and_b32 v61, 0xffff0000, v58
    v_add_f32 v20, v20, v60
    v_add_f32 v21, v21, v61
    v_lshlrev_b32 v60, 16, v59
    v_and_b32 v61, 0xffff0000, v59
    v_add_f32 v22, v22, v60
    v_add_f32 v23, v23, v61
    v_cvt_pk_bf16_f32 v62, v20, v21
    v_lshlrev_b32 v20, 16, v62
    v_and_b32 v21, 0xffff0000, v62
    v_mul_f32 v20, v20, v128
    v_mul_f32 v21, v21, v129
    v_cvt_pk_bf16_f32 v62, v20, v21
    v_lshlrev_b32 v20, 16, v62
    v_and_b32 v21, 0xffff0000, v62
    v_lshlrev_b32 v62, 16, v118
    v_and_b32 v63, 0xffff0000, v118
    v_add_f32 v20, v20, v62
    v_add_f32 v21, v21, v63
    v_cvt_pk_bf16_f32 v118, v20, v21
    v_cvt_pk_bf16_f32 v62, v22, v23
    v_lshlrev_b32 v22, 16, v62
    v_and_b32 v23, 0xffff0000, v62
    v_mul_f32 v22, v22, v130
    v_mul_f32 v23, v23, v131
    v_cvt_pk_bf16_f32 v62, v22, v23
    v_lshlrev_b32 v22, 16, v62
    v_and_b32 v23, 0xffff0000, v62
    v_lshlrev_b32 v62, 16, v119
    v_and_b32 v63, 0xffff0000, v119
    v_add_f32 v22, v22, v62
    v_add_f32 v23, v23, v63
    v_cvt_pk_bf16_f32 v119, v22, v23
    buffer_store_dwordx2 v[118:119], v146, s[24:27], s34 offen offset:64
    s_endpgm
GG_SL0:
    buffer_load_dwordx4 a[88:91], v237, s[8:11], s42 offen offset:0 sc1
    buffer_load_dwordx4 a[92:95], v238, s[8:11], s42 offen offset:0 sc1
    buffer_load_dwordx4 a[96:99], v239, s[8:11], s42 offen offset:0 sc1
    buffer_load_dwordx4 a[100:103], v240, s[8:11], s42 offen offset:0 sc1
    buffer_load_dwordx4 a[104:107], v237, s[8:11], s42 offen offset:1024 sc1
    buffer_load_dwordx4 a[108:111], v238, s[8:11], s42 offen offset:1024 sc1
    buffer_load_dwordx4 a[112:115], v239, s[8:11], s42 offen offset:1024 sc1
    buffer_load_dwordx4 a[116:119], v240, s[8:11], s42 offen offset:1024 sc1
    s_waitcnt vmcnt(0)
    v_accvgpr_read_b32 v250, a88
    v_accvgpr_read_b32 v251, a92
    v_accvgpr_read_b32 v252, a96
    v_accvgpr_read_b32 v253, a100
    v_max3_u32 v250, v250, v251, v252
    v_max_u32 v250, v250, v253
    v_cmp_eq_u32 vcc, -1, v250
    s_sub_u32 s6, s6, 1
    s_cbranch_scc1 GG_RT0
    s_cbranch_vccnz GG_SL0
    s_branch GG_RT0
GG_SL1:
    buffer_load_dwordx4 a[104:107], v237, s[8:11], s42 offen offset:1024 sc1
    buffer_load_dwordx4 a[108:111], v238, s[8:11], s42 offen offset:1024 sc1
    buffer_load_dwordx4 a[112:115], v239, s[8:11], s42 offen offset:1024 sc1
    buffer_load_dwordx4 a[116:119], v240, s[8:11], s42 offen offset:1024 sc1
    buffer_load_dwordx4 a[120:123], v237, s[8:11], s43 offen offset:0 sc1
    buffer_load_dwordx4 a[124:127], v238, s[8:11], s43 offen offset:0 sc1
    buffer_load_dwordx4 a[128:131], v239, s[8:11], s43 offen offset:0 sc1
    buffer_load_dwordx4 a[132:135], v240, s[8:11], s43 offen offset:0 sc1
    buffer_load_dwordx4 a[136:139], v237, s[8:11], s43 offen offset:1024 sc1
    buffer_load_dwordx4 a[140:143], v238, s[8:11], s43 offen offset:1024 sc1
    buffer_load_dwordx4 a[144:147], v239, s[8:11], s43 offen offset:1024 sc1
    buffer_load_dwordx4 a[148:151], v240, s[8:11], s43 offen offset:1024 sc1
    buffer_load_dwordx4 a[152:155], v237, s[8:11], s44 offen offset:0 sc1
    buffer_load_dwordx4 a[156:159], v238, s[8:11], s44 offen offset:0 sc1
    buffer_load_dwordx4 a[160:163], v239, s[8:11], s44 offen offset:0 sc1
    s_waitcnt vmcnt(0)
    v_accvgpr_read_b32 v250, a104
    v_accvgpr_read_b32 v251, a108
    v_accvgpr_read_b32 v252, a112
    v_accvgpr_read_b32 v253, a116
    v_max3_u32 v250, v250, v251, v252
    v_max_u32 v250, v250, v253
    v_cmp_eq_u32 vcc, -1, v250
    s_sub_u32 s6, s6, 1
    s_cbranch_scc1 GG_RT1
    s_cbranch_vccnz GG_SL1
    s_branch GG_RT1
GG_SL2:
    buffer_load_dwordx4 a[120:123], v237, s[8:11], s43 offen offset:0 sc1
    buffer_load_dwordx4 a[124:127], v238, s[8:11], s43 offen offset:0 sc1
    buffer_load_dwordx4 a[128:131], v239, s[8:11], s43 offen offset:0 sc1
    buffer_load_dwordx4 a[132:135], v240, s[8:11], s43 offen offset:0 sc1
    buffer_load_dwordx4 a[136:139], v237, s[8:11], s43 offen offset:1024 sc1
    buffer_load_dwordx4 a[140:143], v238, s[8:11], s43 offen offset:1024 sc1
    buffer_load_dwordx4 a[144:147], v239, s[8:11], s43 offen offset:1024 sc1
    buffer_load_dwordx4 a[148:151], v240, s[8:11], s43 offen offset:1024 sc1
    buffer_load_dwordx4 a[152:155], v237, s[8:11], s44 offen offset:0 sc1
    buffer_load_dwordx4 a[156:159], v238, s[8:11], s44 offen offset:0 sc1
    buffer_load_dwordx4 a[160:163], v239, s[8:11], s44 offen offset:0 sc1
    buffer_load_dwordx4 a[164:167], v240, s[8:11], s44 offen offset:0 sc1
    buffer_load_dwordx4 a[168:171], v237, s[8:11], s44 offen offset:1024 sc1
    buffer_load_dwordx4 a[172:175], v238, s[8:11], s44 offen offset:1024 sc1
    s_waitcnt vmcnt(0)
    v_accvgpr_read_b32 v250, a120
    v_accvgpr_read_b32 v251, a124
    v_accvgpr_read_b32 v252, a128
    v_accvgpr_read_b32 v253, a132
    v_max3_u32 v250, v250, v251, v252
    v_max_u32 v250, v250, v253
    v_cmp_eq_u32 vcc, -1, v250
    s_sub_u32 s6, s6, 1
    s_cbranch_scc1 GG_RT2
    s_cbranch_vccnz GG_SL2
    s_branch GG_RT2
GG_SL3:
    buffer_load_dwordx4 a[136:139], v237, s[8:11], s43 offen offset:1024 sc1
    buffer_load_dwordx4 a[140:143], v238, s[8:11], s43 offen offset:1024 sc1
    buffer_load_dwordx4 a[144:147], v239, s[8:11], s43 offen offset:1024 sc1
    buffer_load_dwordx4 a[148:151], v240, s[8:11], s43 offen offset:1024 sc1
    buffer_load_dwordx4 a[152:155], v237, s[8:11], s44 offen offset:0 sc1
    buffer_load_dwordx4 a[156:159], v238, s[8:11], s44 offen offset:0 sc1
    buffer_load_dwordx4 a[160:163], v239, s[8:11], s44 offen offset:0 sc1
    buffer_load_dwordx4 a[164:167], v240, s[8:11], s44 offen offset:0 sc1
    buffer_load_dwordx4 a[168:171], v237, s[8:11], s44 offen offset:1024 sc1
    buffer_load_dwordx4 a[172:175], v238, s[8:11], s44 offen offset:1024 sc1
    buffer_load_dwordx4 a[176:179], v239, s[8:11], s44 offen offset:1024 sc1
    buffer_load_dwordx4 a[180:183], v240, s[8:11], s44 offen offset:1024 sc1
    buffer_load_dwordx4 a[184:187], v237, s[8:11], s45 offen offset:0 sc1
    buffer_load_dwordx4 a[188:191], v238, s[8:11], s45 offen offset:0 sc1
    buffer_load_dwordx4 a[192:195], v239, s[8:11], s45 offen offset:0 sc1
    buffer_load_dwordx4 a[196:199], v240, s[8:11], s45 offen offset:0 sc1
    s_waitcnt vmcnt(0)
    v_accvgpr_read_b32 v250, a136
    v_accvgpr_read_b32 v251, a140
    v_accvgpr_read_b32 v252, a144
    v_accvgpr_read_b32 v253, a148
    v_max3_u32 v250, v250, v251, v252
    v_max_u32 v250, v250, v253
    v_cmp_eq_u32 vcc, -1, v250
    s_sub_u32 s6, s6, 1
    s_cbranch_scc1 GG_RT3
    s_cbranch_vccnz GG_SL3
    s_branch GG_RT3
GG_SL4:
    buffer_load_dwordx4 a[152:155], v237, s[8:11], s44 offen offset:0 sc1
    buffer_load_dwordx4 a[156:159], v238, s[8:11], s44 offen offset:0 sc1
    buffer_load_dwordx4 a[160:163], v239, s[8:11], s44 offen offset:0 sc1
    buffer_load_dwordx4 a[164:167], v240, s[8:11], s44 offen offset:0 sc1
    buffer_load_dwordx4 a[168:171], v237, s[8:11], s44 offen offset:1024 sc1
    buffer_load_dwordx4 a[172:175], v238, s[8:11], s44 offen offset:1024 sc1
    buffer_load_dwordx4 a[176:179], v239, s[8:11], s44 offen offset:1024 sc1
    buffer_load_dwordx4 a[180:183], v240, s[8:11], s44 offen offset:1024 sc1
    buffer_load_dwordx4 a[184:187], v237, s[8:11], s45 offen offset:0 sc1
    buffer_load_dwordx4 a[188:191], v238, s[8:11], s45 offen offset:0 sc1
    buffer_load_dwordx4 a[192:195], v239, s[8:11], s45 offen offset:0 sc1
    buffer_load_dwordx4 a[196:199], v240, s[8:11], s45 offen offset:0 sc1
    buffer_load_dwordx4 a[88:91], v237, s[8:11], s45 offen offset:1024 sc1
    buffer_load_dwordx4 a[92:95], v238, s[8:11], s45 offen offset:1024 sc1
    buffer_load_dwordx4 a[96:99], v239, s[8:11], s45 offen offset:1024 sc1
    buffer_load_dwordx4 a[100:103], v240, s[8:11], s45 offen offset:1024 sc1
    buffer_load_dwordx4 a[104:107], v237, s[8:11], s46 offen offset:0 sc1
    buffer_load_dwordx4 a[108:111], v238, s[8:11], s46 offen offset:0 sc1
    buffer_load_dwordx4 a[112:115], v239, s[8:11], s46 offen offset:0 sc1
    buffer_load_dwordx4 a[116:119], v240, s[8:11], s46 offen offset:0 sc1
    s_waitcnt vmcnt(0)
    v_accvgpr_read_b32 v250, a152
    v_accvgpr_read_b32 v251, a156
    v_accvgpr_read_b32 v252, a160
    v_accvgpr_read_b32 v253, a164
    v_max3_u32 v250, v250, v251, v252
    v_max_u32 v250, v250, v253
    v_cmp_eq_u32 vcc, -1, v250
    s_sub_u32 s6, s6, 1
    s_cbranch_scc1 GG_RT4
    s_cbranch_vccnz GG_SL4
    s_branch GG_RT4
GG_SL5:
    buffer_load_dwordx4 a[168:171], v237, s[8:11], s44 offen offset:1024 sc1
    buffer_load_dwordx4 a[172:175], v238, s[8:11], s44 offen offset:1024 sc1
    buffer_load_dwordx4 a[176:179], v239, s[8:11], s44 offen offset:1024 sc1
    buffer_load_dwordx4 a[180:183], v240, s[8:11], s44 offen offset:1024 sc1
    buffer_load_dwordx4 a[184:187], v237, s[8:11], s45 offen offset:0 sc1
    buffer_load_dwordx4 a[188:191], v238, s[8:11], s45 offen offset:0 sc1
    buffer_load_dwordx4 a[192:195], v239, s[8:11], s45 offen offset:0 sc1
    buffer_load_dwordx4 a[196:199], v240, s[8:11], s45 offen offset:0 sc1
    buffer_load_dwordx4 a[88:91], v237, s[8:11], s45 offen offset:1024 sc1
    buffer_load_dwordx4 a[92:95], v238, s[8:11], s45 offen offset:1024 sc1
    buffer_load_dwordx4 a[96:99], v239, s[8:11], s45 offen offset:1024 sc1
    buffer_load_dwordx4 a[100:103], v240, s[8:11], s45 offen offset:1024 sc1
    buffer_load_dwordx4 a[104:107], v237, s[8:11], s46 offen offset:0 sc1
    buffer_load_dwordx4 a[108:111], v238, s[8:11], s46 offen offset:0 sc1
    buffer_load_dwordx4 a[112:115], v239, s[8:11], s46 offen offset:0 sc1
    buffer_load_dwordx4 a[116:119], v240, s[8:11], s46 offen offset:0 sc1
    buffer_load_dwordx4 a[120:123], v237, s[8:11], s46 offen offset:1024 sc1
    buffer_load_dwordx4 a[124:127], v238, s[8:11], s46 offen offset:1024 sc1
    buffer_load_dwordx4 a[128:131], v239, s[8:11], s46 offen offset:1024 sc1
    buffer_load_dwordx4 a[132:135], v240, s[8:11], s46 offen offset:1024 sc1
    s_waitcnt vmcnt(0)
    v_accvgpr_read_b32 v250, a168
    v_accvgpr_read_b32 v251, a172
    v_accvgpr_read_b32 v252, a176
    v_accvgpr_read_b32 v253, a180
    v_max3_u32 v250, v250, v251, v252
    v_max_u32 v250, v250, v253
    v_cmp_eq_u32 vcc, -1, v250
    s_sub_u32 s6, s6, 1
    s_cbranch_scc1 GG_RT5
    s_cbranch_vccnz GG_SL5
    s_branch GG_RT5
GG_SL6:
    buffer_load_dwordx4 a[184:187], v237, s[8:11], s45 offen offset:0 sc1
    buffer_load_dwordx4 a[188:191], v238, s[8:11], s45 offen offset:0 sc1
    buffer_load_dwordx4 a[192:195], v239, s[8:11], s45 offen offset:0 sc1
    buffer_load_dwordx4 a[196:199], v240, s[8:11], s45 offen offset:0 sc1
    buffer_load_dwordx4 a[88:91], v237, s[8:11], s45 offen offset:1024 sc1
    buffer_load_dwordx4 a[92:95], v238, s[8:11], s45 offen offset:1024 sc1
    buffer_load_dwordx4 a[96:99], v239, s[8:11], s45 offen offset:1024 sc1
    buffer_load_dwordx4 a[100:103], v240, s[8:11], s45 offen offset:1024 sc1
    buffer_load_dwordx4 a[104:107], v237, s[8:11], s46 offen offset:0 sc1
    buffer_load_dwordx4 a[108:111], v238, s[8:11], s46 offen offset:0 sc1
    buffer_load_dwordx4 a[112:115], v239, s[8:11], s46 offen offset:0 sc1
    buffer_load_dwordx4 a[116:119], v240, s[8:11], s46 offen offset:0 sc1
    buffer_load_dwordx4 a[120:123], v237, s[8:11], s46 offen offset:1024 sc1
    buffer_load_dwordx4 a[124:127], v238, s[8:11], s46 offen offset:1024 sc1
    buffer_load_dwordx4 a[128:131], v239, s[8:11], s46 offen offset:1024 sc1
    buffer_load_dwordx4 a[132:135], v240, s[8:11], s46 offen offset:1024 sc1
    buffer_load_dwordx4 a[136:139], v237, s[8:11], s47 offen offset:0 sc1
    buffer_load_dwordx4 a[140:143], v238, s[8:11], s47 offen offset:0 sc1
    buffer_load_dwordx4 a[144:147], v239, s[8:11], s47 offen offset:0 sc1
    buffer_load_dwordx4 a[148:151], v240, s[8:11], s47 offen offset:0 sc1
    buffer_load_dwordx4 a[152:155], v237, s[8:11], s47 offen offset:1024 sc1
    buffer_load_dwordx4 a[156:159], v238, s[8:11], s47 offen offset:1024 sc1
    buffer_load_dwordx4 a[160:163], v239, s[8:11], s47 offen offset:1024 sc1
    buffer_load_dwordx4 a[164:167], v240, s[8:11], s47 offen offset:1024 sc1
    s_waitcnt vmcnt(0)
    v_accvgpr_read_b32 v250, a184
    v_accvgpr_read_b32 v251, a188
    v_accvgpr_read_b32 v252, a192
    v_accvgpr_read_b32 v253, a196
    v_max3_u32 v250, v250, v251, v252
    v_max_u32 v250, v250, v253
    v_cmp_eq_u32 vcc, -1, v250
    s_sub_u32 s6, s6, 1
    s_cbranch_scc1 GG_RT6
    s_cbranch_vccnz GG_SL6
    s_branch GG_RT6
GG_SL7:
    buffer_load_dwordx4 a[88:91], v237, s[8:11], s45 offen offset:1024 sc1
    buffer_load_dwordx4 a[92:95], v238, s[8:11], s45 offen offset:1024 sc1
    buffer_load_dwordx4 a[96:99], v239, s[8:11], s45 offen offset:1024 sc1
    buffer_load_dwordx4 a[100:103], v240, s[8:11], s45 offen offset:1024 sc1
    buffer_load_dwordx4 a[104:107], v237, s[8:11], s46 offen offset:0 sc1
    buffer_load_dwordx4 a[108:111], v238, s[8:11], s46 offen offset:0 sc1
    buffer_load_dwordx4 a[112:115], v239, s[8:11], s46 offen offset:0 sc1
    buffer_load_dwordx4 a[116:119], v240, s[8:11], s46 offen offset:0 sc1
    buffer_load_dwordx4 a[120:123], v237, s[8:11], s46 offen offset:1024 sc1
    buffer_load_dwordx4 a[124:127], v238, s[8:11], s46 offen offset:1024 sc1
    buffer_load_dwordx4 a[128:131], v239, s[8:11], s46 offen offset:1024 sc1
    buffer_load_dwordx4 a[132:135], v240, s[8:11], s46 offen offset:1024 sc1
    buffer_load_dwordx4 a[136:139], v237, s[8:11], s47 offen offset:0 sc1
    buffer_load_dwordx4 a[140:143], v238, s[8:11], s47 offen offset:0 sc1
    buffer_load_dwordx4 a[144:147], v239, s[8:11], s47 offen offset:0 sc1
    buffer_load_dwordx4 a[148:151], v240, s[8:11], s47 offen offset:0 sc1
    buffer_load_dwordx4 a[152:155], v237, s[8:11], s47 offen offset:1024 sc1
    buffer_load_dwordx4 a[156:159], v238, s[8:11], s47 offen offset:1024 sc1
    buffer_load_dwordx4 a[160:163], v239, s[8:11], s47 offen offset:1024 sc1
    buffer_load_dwordx4 a[164:167], v240, s[8:11], s47 offen offset:1024 sc1
    buffer_load_dwordx4 a[168:171], v237, s[8:11], s48 offen offset:0 sc1
    buffer_load_dwordx4 a[172:175], v238, s[8:11], s48 offen offset:0 sc1
    buffer_load_dwordx4 a[176:179], v239, s[8:11], s48 offen offset:0 sc1
    buffer_load_dwordx4 a[180:183], v240, s[8:11], s48 offen offset:0 sc1
    s_waitcnt vmcnt(0)
    v_accvgpr_read_b32 v250, a88
    v_accvgpr_read_b32 v251, a92
    v_accvgpr_read_b32 v252, a96
    v_accvgpr_read_b32 v253, a100
    v_max3_u32 v250, v250, v251, v252
    v_max_u32 v250, v250, v253
    v_cmp_eq_u32 vcc, -1, v250
    s_sub_u32 s6, s6, 1
    s_cbranch_scc1 GG_RT7
    s_cbranch_vccnz GG_SL7
    s_branch GG_RT7
GG_SL8:
    buffer_load_dwordx4 a[104:107], v237, s[8:11], s46 offen offset:0 sc1
    buffer_load_dwordx4 a[108:111], v238, s[8:11], s46 offen offset:0 sc1
    buffer_load_dwordx4 a[112:115], v239, s[8:11], s46 offen offset:0 sc1
    buffer_load_dwordx4 a[116:119], v240, s[8:11], s46 offen offset:0 sc1
    buffer_load_dwordx4 a[120:123], v237, s[8:11], s46 offen offset:1024 sc1
    buffer_load_dwordx4 a[124:127], v238, s[8:11], s46 offen offset:1024 sc1
    buffer_load_dwordx4 a[128:131], v239, s[8:11], s46 offen offset:1024 sc1
    buffer_load_dwordx4 a[132:135], v240, s[8:11], s46 offen offset:1024 sc1
    buffer_load_dwordx4 a[136:139], v237, s[8:11], s47 offen offset:0 sc1
    buffer_load_dwordx4 a[140:143], v238, s[8:11], s47 offen offset:0 sc1
    buffer_load_dwordx4 a[144:147], v239, s[8:11], s47 offen offset:0 sc1
    buffer_load_dwordx4 a[148:151], v240, s[8:11], s47 offen offset:0 sc1
    buffer_load_dwordx4 a[152:155], v237, s[8:11], s47 offen offset:1024 sc1
    buffer_load_dwordx4 a[156:159], v238, s[8:11], s47 offen offset:1024 sc1
    buffer_load_dwordx4 a[160:163], v239, s[8:11], s47 offen offset:1024 sc1
    buffer_load_dwordx4 a[164:167], v240, s[8:11], s47 offen offset:1024 sc1
    buffer_load_dwordx4 a[168:171], v237, s[8:11], s48 offen offset:0 sc1
    buffer_load_dwordx4 a[172:175], v238, s[8:11], s48 offen offset:0 sc1
    buffer_load_dwordx4 a[176:179], v239, s[8:11], s48 offen offset:0 sc1
    buffer_load_dwordx4 a[180:183], v240, s[8:11], s48 offen offset:0 sc1
    buffer_load_dwordx4 a[184:187], v237, s[8:11], s48 offen offset:1024 sc1
    buffer_load_dwordx4 a[188:191], v238, s[8:11], s48 offen offset:1024 sc1
    buffer_load_dwordx4 a[192:195], v239, s[8:11], s48 offen offset:1024 sc1
    buffer_load_dwordx4 a[196:199], v240, s[8:11], s48 offen offset:1024 sc1
    s_waitcnt vmcnt(0)
    v_accvgpr_read_b32 v250, a104
    v_accvgpr_read_b32 v251, a108
    v_accvgpr_read_b32 v252, a112
    v_accvgpr_read_b32 v253, a116
    v_max3_u32 v250, v250, v251, v252
    v_max_u32 v250, v250, v253
    v_cmp_eq_u32 vcc, -1, v250
    s_sub_u32 s6, s6, 1
    s_cbranch_scc1 GG_RT8
    s_cbranch_vccnz GG_SL8
    s_branch GG_RT8
GG_SL9:
    buffer_load_dwordx4 a[120:123], v237, s[8:11], s46 offen offset:1024 sc1
    buffer_load_dwordx4 a[124:127], v238, s[8:11], s46 offen offset:1024 sc1
    buffer_load_dwordx4 a[128:131], v239, s[8:11], s46 offen offset:1024 sc1
    buffer_load_dwordx4 a[132:135], v240, s[8:11], s46 offen offset:1024 sc1
    buffer_load_dwordx4 a[136:139], v237, s[8:11], s47 offen offset:0 sc1
    buffer_load_dwordx4 a[140:143], v238, s[8:11], s47 offen offset:0 sc1
    buffer_load_dwordx4 a[144:147], v239, s[8:11], s47 offen offset:0 sc1
    buffer_load_dwordx4 a[148:151], v240, s[8:11], s47 offen offset:0 sc1
    buffer_load_dwordx4 a[152:155], v237, s[8:11], s47 offen offset:1024 sc1
    buffer_load_dwordx4 a[156:159], v238, s[8:11], s47 offen offset:1024 sc1
    buffer_load_dwordx4 a[160:163], v239, s[8:11], s47 offen offset:1024 sc1
    buffer_load_dwordx4 a[164:167], v240, s[8:11], s47 offen offset:1024 sc1
    buffer_load_dwordx4 a[168:171], v237, s[8:11], s48 offen offset:0 sc1
    buffer_load_dwordx4 a[172:175], v238, s[8:11], s48 offen offset:0 sc1
    buffer_load_dwordx4 a[176:179], v239, s[8:11], s48 offen offset:0 sc1
    buffer_load_dwordx4 a[180:183], v240, s[8:11], s48 offen offset:0 sc1
    buffer_load_dwordx4 a[184:187], v237, s[8:11], s48 offen offset:1024 sc1
    buffer_load_dwordx4 a[188:191], v238, s[8:11], s48 offen offset:1024 sc1
    buffer_load_dwordx4 a[192:195], v239, s[8:11], s48 offen offset:1024 sc1
    buffer_load_dwordx4 a[196:199], v240, s[8:11], s48 offen offset:1024 sc1
    buffer_load_dwordx4 a[88:91], v237, s[8:11], s49 offen offset:0 sc1
    buffer_load_dwordx4 a[92:95], v238, s[8:11], s49 offen offset:0 sc1
    buffer_load_dwordx4 a[96:99], v239, s[8:11], s49 offen offset:0 sc1
    buffer_load_dwordx4 a[100:103], v240, s[8:11], s49 offen offset:0 sc1
    s_waitcnt vmcnt(0)
    v_accvgpr_read_b32 v250, a120
    v_accvgpr_read_b32 v251, a124
    v_accvgpr_read_b32 v252, a128
    v_accvgpr_read_b32 v253, a132
    v_max3_u32 v250, v250, v251, v252
    v_max_u32 v250, v250, v253
    v_cmp_eq_u32 vcc, -1, v250
    s_sub_u32 s6, s6, 1
    s_cbranch_scc1 GG_RT9
    s_cbranch_vccnz GG_SL9
    s_branch GG_RT9
GG_SL10:
    buffer_load_dwordx4 a[136:139], v237, s[8:11], s47 offen offset:0 sc1
    buffer_load_dwordx4 a[140:143], v238, s[8:11], s47 offen offset:0 sc1
    buffer_load_dwordx4 a[144:147], v239, s[8:11], s47 offen offset:0 sc1
    buffer_load_dwordx4 a[148:151], v240, s[8:11], s47 offen offset:0 sc1
    buffer_load_dwordx4 a[152:155], v237, s[8:11], s47 offen offset:1024 sc1
    buffer_load_dwordx4 a[156:159], v238, s[8:11], s47 offen offset:1024 sc1
    buffer_load_dwordx4 a[160:163], v239, s[8:11], s47 offen offset:1024 sc1
    buffer_load_dwordx4 a[164:167], v240, s[8:11], s47 offen offset:1024 sc1
    buffer_load_dwordx4 a[168:171], v237, s[8:11], s48 offen offset:0 sc1
    buffer_load_dwordx4 a[172:175], v238, s[8:11], s48 offen offset:0 sc1
    buffer_load_dwordx4 a[176:179], v239, s[8:11], s48 offen offset:0 sc1
    buffer_load_dwordx4 a[180:183], v240, s[8:11], s48 offen offset:0 sc1
    buffer_load_dwordx4 a[184:187], v237, s[8:11], s48 offen offset:1024 sc1
    buffer_load_dwordx4 a[188:191], v238, s[8:11], s48 offen offset:1024 sc1
    buffer_load_dwordx4 a[192:195], v239, s[8:11], s48 offen offset:1024 sc1
    buffer_load_dwordx4 a[196:199], v240, s[8:11], s48 offen offset:1024 sc1
    buffer_load_dwordx4 a[88:91], v237, s[8:11], s49 offen offset:0 sc1
    buffer_load_dwordx4 a[92:95], v238, s[8:11], s49 offen offset:0 sc1
    buffer_load_dwordx4 a[96:99], v239, s[8:11], s49 offen offset:0 sc1
    buffer_load_dwordx4 a[100:103], v240, s[8:11], s49 offen offset:0 sc1
    buffer_load_dwordx4 a[104:107], v237, s[8:11], s49 offen offset:1024 sc1
    buffer_load_dwordx4 a[108:111], v238, s[8:11], s49 offen offset:1024 sc1
    buffer_load_dwordx4 a[112:115], v239, s[8:11], s49 offen offset:1024 sc1
    buffer_load_dwordx4 a[116:119], v240, s[8:11], s49 offen offset:1024 sc1
    s_waitcnt vmcnt(0)
    v_accvgpr_read_b32 v250, a136
    v_accvgpr_read_b32 v251, a140
    v_accvgpr_read_b32 v252, a144
    v_accvgpr_read_b32 v253, a148
    v_max3_u32 v250, v250, v251, v252
    v_max_u32 v250, v250, v253
    v_cmp_eq_u32 vcc, -1, v250
    s_sub_u32 s6, s6, 1
    s_cbranch_scc1 GG_RT10
    s_cbranch_vccnz GG_SL10
    s_branch GG_RT10
GG_SL11:
    buffer_load_dwordx4 a[152:155], v237, s[8:11], s47 offen offset:1024 sc1
    buffer_load_dwordx4 a[156:159], v238, s[8:11], s47 offen offset:1024 sc1
    buffer_load_dwordx4 a[160:163], v239, s[8:11], s47 offen offset:1024 sc1
    buffer_load_dwordx4 a[164:167], v240, s[8:11], s47 offen offset:1024 sc1
    buffer_load_dwordx4 a[168:171], v237, s[8:11], s48 offen offset:0 sc1
    buffer_load_dwordx4 a[172:175], v238, s[8:11], s48 offen offset:0 sc1
    buffer_load_dwordx4 a[176:179], v239, s[8:11], s48 offen offset:0 sc1
    buffer_load_dwordx4 a[180:183], v240, s[8:11], s48 offen offset:0 sc1
    buffer_load_dwordx4 a[184:187], v237, s[8:11], s48 offen offset:1024 sc1
    buffer_load_dwordx4 a[188:191], v238, s[8:11], s48 offen offset:1024 sc1
    buffer_load_dwordx4 a[192:195], v239, s[8:11], s48 offen offset:1024 sc1
    buffer_load_dwordx4 a[196:199], v240, s[8:11], s48 offen offset:1024 sc1
    buffer_load_dwordx4 a[88:91], v237, s[8:11], s49 offen offset:0 sc1
    buffer_load_dwordx4 a[92:95], v238, s[8:11], s49 offen offset:0 sc1
    buffer_load_dwordx4 a[96:99], v239, s[8:11], s49 offen offset:0 sc1
    buffer_load_dwordx4 a[100:103], v240, s[8:11], s49 offen offset:0 sc1
    buffer_load_dwordx4 a[104:107], v237, s[8:11], s49 offen offset:1024 sc1
    buffer_load_dwordx4 a[108:111], v238, s[8:11], s49 offen offset:1024 sc1
    buffer_load_dwordx4 a[112:115], v239, s[8:11], s49 offen offset:1024 sc1
    buffer_load_dwordx4 a[116:119], v240, s[8:11], s49 offen offset:1024 sc1
    buffer_load_dwordx4 a[120:123], v237, s[8:11], s50 offen offset:0 sc1
    buffer_load_dwordx4 a[124:127], v238, s[8:11], s50 offen offset:0 sc1
    buffer_load_dwordx4 a[128:131], v239, s[8:11], s50 offen offset:0 sc1
    buffer_load_dwordx4 a[132:135], v240, s[8:11], s50 offen offset:0 sc1
    s_waitcnt vmcnt(0)
    v_accvgpr_read_b32 v250, a152
    v_accvgpr_read_b32 v251, a156
    v_accvgpr_read_b32 v252, a160
    v_accvgpr_read_b32 v253, a164
    v_max3_u32 v250, v250, v251, v252
    v_max_u32 v250, v250, v253
    v_cmp_eq_u32 vcc, -1, v250
    s_sub_u32 s6, s6, 1
    s_cbranch_scc1 GG_RT11
    s_cbranch_vccnz GG_SL11
    s_branch GG_RT11
GG_SL12:
    buffer_load_dwordx4 a[168:171], v237, s[8:11], s48 offen offset:0 sc1
    buffer_load_dwordx4 a[172:175], v238, s[8:11], s48 offen offset:0 sc1
    buffer_load_dwordx4 a[176:179], v239, s[8:11], s48 offen offset:0 sc1
    buffer_load_dwordx4 a[180:183], v240, s[8:11], s48 offen offset:0 sc1
    buffer_load_dwordx4 a[184:187], v237, s[8:11], s48 offen offset:1024 sc1
    buffer_load_dwordx4 a[188:191], v238, s[8:11], s48 offen offset:1024 sc1
    buffer_load_dwordx4 a[192:195], v239, s[8:11], s48 offen offset:1024 sc1
    buffer_load_dwordx4 a[196:199], v240, s[8:11], s48 offen offset:1024 sc1
    buffer_load_dwordx4 a[88:91], v237, s[8:11], s49 offen offset:0 sc1
    buffer_load_dwordx4 a[92:95], v238, s[8:11], s49 offen offset:0 sc1
    buffer_load_dwordx4 a[96:99], v239, s[8:11], s49 offen offset:0 sc1
    buffer_load_dwordx4 a[100:103], v240, s[8:11], s49 offen offset:0 sc1
    buffer_load_dwordx4 a[104:107], v237, s[8:11], s49 offen offset:1024 sc1
    buffer_load_dwordx4 a[108:111], v238, s[8:11], s49 offen offset:1024 sc1
    buffer_load_dwordx4 a[112:115], v239, s[8:11], s49 offen offset:1024 sc1
    buffer_load_dwordx4 a[116:119], v240, s[8:11], s49 offen offset:1024 sc1
    buffer_load_dwordx4 a[120:123], v237, s[8:11], s50 offen offset:0 sc1
    buffer_load_dwordx4 a[124:127], v238, s[8:11], s50 offen offset:0 sc1
    buffer_load_dwordx4 a[128:131], v239, s[8:11], s50 offen offset:0 sc1
    buffer_load_dwordx4 a[132:135], v240, s[8:11], s50 offen offset:0 sc1
    buffer_load_dwordx4 a[136:139], v237, s[8:11], s50 offen offset:1024 sc1
    buffer_load_dwordx4 a[140:143], v238, s[8:11], s50 offen offset:1024 sc1
    buffer_load_dwordx4 a[144:147], v239, s[8:11], s50 offen offset:1024 sc1
    buffer_load_dwordx4 a[148:151], v240, s[8:11], s50 offen offset:1024 sc1
    s_waitcnt vmcnt(0)
    v_accvgpr_read_b32 v250, a168
    v_accvgpr_read_b32 v251, a172
    v_accvgpr_read_b32 v252, a176
    v_accvgpr_read_b32 v253, a180
    v_max3_u32 v250, v250, v251, v252
    v_max_u32 v250, v250, v253
    v_cmp_eq_u32 vcc, -1, v250
    s_sub_u32 s6, s6, 1
    s_cbranch_scc1 GG_RT12
    s_cbranch_vccnz GG_SL12
    s_branch GG_RT12
GG_SL13:
    buffer_load_dwordx4 a[184:187], v237, s[8:11], s48 offen offset:1024 sc1
    buffer_load_dwordx4 a[188:191], v238, s[8:11], s48 offen offset:1024 sc1
    buffer_load_dwordx4 a[192:195], v239, s[8:11], s48 offen offset:1024 sc1
    buffer_load_dwordx4 a[196:199], v240, s[8:11], s48 offen offset:1024 sc1
    buffer_load_dwordx4 a[88:91], v237, s[8:11], s49 offen offset:0 sc1
    buffer_load_dwordx4 a[92:95], v238, s[8:11], s49 offen offset:0 sc1
    buffer_load_dwordx4 a[96:99], v239, s[8:11], s49 offen offset:0 sc1
    buffer_load_dwordx4 a[100:103], v240, s[8:11], s49 offen offset:0 sc1
    buffer_load_dwordx4 a[104:107], v237, s[8:11], s49 offen offset:1024 sc1
    buffer_load_dwordx4 a[108:111], v238, s[8:11], s49 offen offset:1024 sc1
    buffer_load_dwordx4 a[112:115], v239, s[8:11], s49 offen offset:1024 sc1
    buffer_load_dwordx4 a[116:119], v240, s[8:11], s49 offen offset:1024 sc1
    buffer_load_dwordx4 a[120:123], v237, s[8:11], s50 offen offset:0 sc1
    buffer_load_dwordx4 a[124:127], v238, s[8:11], s50 offen offset:0 sc1
    buffer_load_dwordx4 a[128:131], v239, s[8:11], s50 offen offset:0 sc1
    buffer_load_dwordx4 a[132:135], v240, s[8:11], s50 offen offset:0 sc1
    buffer_load_dwordx4 a[136:139], v237, s[8:11], s50 offen offset:1024 sc1
    buffer_load_dwordx4 a[140:143], v238, s[8:11], s50 offen offset:1024 sc1
    buffer_load_dwordx4 a[144:147], v239, s[8:11], s50 offen offset:1024 sc1
    buffer_load_dwordx4 a[148:151], v240, s[8:11], s50 offen offset:1024 sc1
    s_waitcnt vmcnt(0)
    v_accvgpr_read_b32 v250, a184
    v_accvgpr_read_b32 v251, a188
    v_accvgpr_read_b32 v252, a192
    v_accvgpr_read_b32 v253, a196
    v_max3_u32 v250, v250, v251, v252
    v_max_u32 v250, v250, v253
    v_cmp_eq_u32 vcc, -1, v250
    s_sub_u32 s6, s6, 1
    s_cbranch_scc1 GG_RT13
    s_cbranch_vccnz GG_SL13
    s_branch GG_RT13
GG_SL14:
    buffer_load_dwordx4 a[88:91], v237, s[8:11], s49 offen offset:0 sc1
    buffer_load_dwordx4 a[92:95], v238, s[8:11], s49 offen offset:0 sc1
    buffer_load_dwordx4 a[96:99], v239, s[8:11], s49 offen offset:0 sc1
    buffer_load_dwordx4 a[100:103], v240, s[8:11], s49 offen offset:0 sc1
    buffer_load_dwordx4 a[104:107], v237, s[8:11], s49 offen offset:1024 sc1
    buffer_load_dwordx4 a[108:111], v238, s[8:11], s49 offen offset:1024 sc1
    buffer_load_dwordx4 a[112:115], v239, s[8:11], s49 offen offset:1024 sc1
    buffer_load_dwordx4 a[116:119], v240, s[8:11], s49 offen offset:1024 sc1
    buffer_load_dwordx4 a[120:123], v237, s[8:11], s50 offen offset:0 sc1
    buffer_load_dwordx4 a[124:127], v238, s[8:11], s50 offen offset:0 sc1
    buffer_load_dwordx4 a[128:131], v239, s[8:11], s50 offen offset:0 sc1
    buffer_load_dwordx4 a[132:135], v240, s[8:11], s50 offen offset:0 sc1
    buffer_load_dwordx4 a[136:139], v237, s[8:11], s50 offen offset:1024 sc1
    buffer_load_dwordx4 a[140:143], v238, s[8:11], s50 offen offset:1024 sc1
    buffer_load_dwordx4 a[144:147], v239, s[8:11], s50 offen offset:1024 sc1
    buffer_load_dwordx4 a[148:151], v240, s[8:11], s50 offen offset:1024 sc1
    s_waitcnt vmcnt(0)
    v_accvgpr_read_b32 v250, a88
    v_accvgpr_read_b32 v251, a92
    v_accvgpr_read_b32 v252, a96
    v_accvgpr_read_b32 v253, a100
    v_max3_u32 v250, v250, v251, v252
    v_max_u32 v250, v250, v253
    v_cmp_eq_u32 vcc, -1, v250
    s_sub_u32 s6, s6, 1
    s_cbranch_scc1 GG_RT14
    s_cbranch_vccnz GG_SL14
    s_branch GG_RT14
GG_SL15:
    buffer_load_dwordx4 a[104:107], v237, s[8:11], s49 offen offset:1024 sc1
    buffer_load_dwordx4 a[108:111], v238, s[8:11], s49 offen offset:1024 sc1
    buffer_load_dwordx4 a[112:115], v239, s[8:11], s49 offen offset:1024 sc1
    buffer_load_dwordx4 a[116:119], v240, s[8:11], s49 offen offset:1024 sc1
    buffer_load_dwordx4 a[120:123], v237, s[8:11], s50 offen offset:0 sc1
    buffer_load_dwordx4 a[124:127], v238, s[8:11], s50 offen offset:0 sc1
    buffer_load_dwordx4 a[128:131], v239, s[8:11], s50 offen offset:0 sc1
    buffer_load_dwordx4 a[132:135], v240, s[8:11], s50 offen offset:0 sc1
    buffer_load_dwordx4 a[136:139], v237, s[8:11], s50 offen offset:1024 sc1
    buffer_load_dwordx4 a[140:143], v238, s[8:11], s50 offen offset:1024 sc1
    buffer_load_dwordx4 a[144:147], v239, s[8:11], s50 offen offset:1024 sc1
    buffer_load_dwordx4 a[148:151], v240, s[8:11], s50 offen offset:1024 sc1
    s_waitcnt vmcnt(0)
    v_accvgpr_read_b32 v250, a104
    v_accvgpr_read_b32 v251, a108
    v_accvgpr_read_b32 v252, a112
    v_accvgpr_read_b32 v253, a116
    v_max3_u32 v250, v250, v251, v252
    v_max_u32 v250, v250, v253
    v_cmp_eq_u32 vcc, -1, v250
    s_sub_u32 s6, s6, 1
    s_cbranch_scc1 GG_RT15
    s_cbranch_vccnz GG_SL15
    s_branch GG_RT15
GG_SL16:
    buffer_load_dwordx4 a[120:123], v237, s[8:11], s50 offen offset:0 sc1
    buffer_load_dwordx4 a[124:127], v238, s[8:11], s50 offen offset:0 sc1
    buffer_load_dwordx4 a[128:131], v239, s[8:11], s50 offen offset:0 sc1
    buffer_load_dwordx4 a[132:135], v240, s[8:11], s50 offen offset:0 sc1
    buffer_load_dwordx4 a[136:139], v237, s[8:11], s50 offen offset:1024 sc1
    buffer_load_dwordx4 a[140:143], v238, s[8:11], s50 offen offset:1024 sc1
    buffer_load_dwordx4 a[144:147], v239, s[8:11], s50 offen offset:1024 sc1
    buffer_load_dwordx4 a[148:151], v240, s[8:11], s50 offen offset:1024 sc1
    s_waitcnt vmcnt(0)
    v_accvgpr_read_b32 v250, a120
    v_accvgpr_read_b32 v251, a124
    v_accvgpr_read_b32 v252, a128
    v_accvgpr_read_b32 v253, a132
    v_max3_u32 v250, v250, v251, v252
    v_max_u32 v250, v250, v253
    v_cmp_eq_u32 vcc, -1, v250
    s_sub_u32 s6, s6, 1
    s_cbranch_scc1 GG_RT16
    s_cbranch_vccnz GG_SL16
    s_branch GG_RT16
GG_SL17:
    buffer_load_dwordx4 a[136:139], v237, s[8:11], s50 offen offset:1024 sc1
    buffer_load_dwordx4 a[140:143], v238, s[8:11], s50 offen offset:1024 sc1
    buffer_load_dwordx4 a[144:147], v239, s[8:11], s50 offen offset:1024 sc1
    buffer_load_dwordx4 a[148:151], v240, s[8:11], s50 offen offset:1024 sc1
    s_waitcnt vmcnt(0)
    v_accvgpr_read_b32 v250, a136
    v_accvgpr_read_b32 v251, a140
    v_accvgpr_read_b32 v252, a144
    v_accvgpr_read_b32 v253, a148
    v_max3_u32 v250, v250, v251, v252
    v_max_u32 v250, v250, v253
    v_cmp_eq_u32 vcc, -1, v250
    s_sub_u32 s6, s6, 1
    s_cbranch_scc1 GG_RT17
    s_cbranch_vccnz GG_SL17
    s_branch GG_RT17
GG_END:
    s_endpgm
.section .rodata,"a"
.p2align 6
.amdhsa_kernel front_kernel
  .amdhsa_next_free_vgpr 128
  .amdhsa_next_free_sgpr 50
  .amdhsa_accum_offset 128
  .amdhsa_group_segment_fixed_size 0
  .amdhsa_kernarg_size 144
  .amdhsa_user_sgpr_count 2
  .amdhsa_user_sgpr_kernarg_segment_ptr 1
  .amdhsa_system_sgpr_workgroup_id_x 1
  .amdhsa_float_denorm_mode_32 3
.end_amdhsa_kernel
.p2align 6
.amdhsa_kernel gg_kernel
  .amdhsa_next_free_vgpr 468
  .amdhsa_next_free_sgpr 64
  .amdhsa_accum_offset 256
  .amdhsa_group_segment_fixed_size 0
  .amdhsa_kernarg_size 144
  .amdhsa_user_sgpr_count 2
  .amdhsa_user_sgpr_kernarg_segment_ptr 1
  .amdhsa_system_sgpr_workgroup_id_x 1
  .amdhsa_float_denorm_mode_32 3
.end_amdhsa_kernel
```
